```python
import torch

def _softmax(x, axis=-1):
    return torch.softmax(x, dim=axis)
def _gelu(x):
    return torch.nn.functional.gelu(x, approximate="tanh")
def _silu(x):
    return torch.nn.functional.silu(x)
def _sigmoid(x):
    return torch.sigmoid(x)
def _layernorm(x, axis=-1, eps=1e-5):
    m = x.mean(dim=axis, keepdim=True)
    v = x.var(dim=axis, keepdim=True, unbiased=False)
    return (x - m) / torch.sqrt(v + eps)
def _scatter_add(tgt, idx, src, axis=0):
    return tgt.clone().index_add_(axis, idx, src)
def _segment_sum(src, seg, n):
    out = torch.zeros((n,) + src.shape[1:], dtype=src.dtype)
    return out.index_add_(0, seg, src)
def _pad(x, pw):
    flat = tuple(v for pair in reversed(pw) for v in pair)
    return torch.nn.functional.pad(x, flat)

kernel_name = 'gated_mix__mha_block__compressed_kv_cla__prompt'

def setup_inputs():

    _w = (lambda a: (lambda t: t.to(torch.bfloat16) if t.is_floating_point() else t)(torch.as_tensor(a)))
    def _A_setup():
        B, S, D, H = 1, 2048, 448, 16
        return {
            "x": _w((lambda *s: torch.randn(*s, dtype=torch.bfloat16) * 0.05)(B, S, D)),
            "wqkv": _w((lambda *s: torch.randn(*s, dtype=torch.bfloat16) * 1.6)(D, 3 * D)),
            "wo": _w((lambda *s: torch.randn(*s, dtype=torch.bfloat16) * 0.05)(D, D)),
        }
    _A_in = _A_setup()

    def _B_setup():
        B, H, Sq, Sk, D, M = 1, 16, 2048, 2048, 256, 448
        Dc = 4 * D
        return {
            "x": _w((lambda *s: torch.randn(*s, dtype=torch.bfloat16) * 0.05)(B, Sq, M)),
            "c_kv": _w((lambda *s: torch.randn(*s, dtype=torch.bfloat16) * 1.6)(B, Sk, Dc)),
            "w_q": _w((lambda *s: torch.randn(*s, dtype=torch.bfloat16) * 6.4)(M, H, D) * (M ** -0.5)),
            "w_uk": _w((lambda *s: torch.randn(*s, dtype=torch.bfloat16) * 6.4)(Dc, H, D) * (Dc ** -0.5)),
            "w_uv": _w((lambda *s: torch.randn(*s, dtype=torch.bfloat16) * 1.6)(Dc, H, D) * (Dc ** -0.5)),
            "w_o": _w((lambda *s: torch.randn(*s, dtype=torch.bfloat16) * 1.6)(H, D, M) * ((H * D) ** -0.5)),
        }
    _B_in = _B_setup()

    return {
        "A_x": _A_in["x"],
        "A_wqkv": _A_in["wqkv"],
        "A_wo": _A_in["wo"],
        "B_x": _B_in["x"],
        "B_c_kv": _B_in["c_kv"],
        "B_w_q": _B_in["w_q"],
        "B_w_uk": _B_in["w_uk"],
        "B_w_uv": _B_in["w_uv"],
        "B_w_o": _B_in["w_o"],
        "gate_w": _w((lambda *s: torch.randn(*s, dtype=torch.bfloat16) * 0.05)(448) * 16.0),
    }

def reference(A_x, A_wqkv, A_wo, B_x, B_c_kv, B_w_q, B_w_uk, B_w_uv, B_w_o, gate_w):
    def _A_ref(x, wqkv, wo):
        B, S, D = x.shape
        H = 16
        Dh = D // H
        qkv = (lambda x, *d: x.permute(*d))((x @ wqkv).reshape(B, S, 3, H, Dh), 2, 0, 3, 1, 4)
        q, k, v = qkv[0], qkv[1], qkv[2]
        scores = torch.einsum("bhqd,bhkd->bhqk", q, k) * (Dh ** -0.5)
        p = _softmax(scores, axis=-1)
        o = torch.einsum("bhqk,bhkd->bhqd", p, v)
        return (lambda x, *d: x.permute(*d))(o, 0, 2, 1, 3).reshape(B, S, D) @ wo

    def _B_ref(x, c_kv, w_q, w_uk, w_uv, w_o):
        B, Sq, M = x.shape[0], x.shape[1], x.shape[2]
        Sk = c_kv.shape[1]
        H, D = w_q.shape[1], w_q.shape[2]
        q = torch.einsum("bqm,mhd->bhqd", x, w_q)
        k = torch.einsum("bkc,chd->bhkd", c_kv, w_uk)
        v = torch.einsum("bkc,chd->bhkd", c_kv, w_uv)
        scores = torch.einsum("bhqd,bhkd->bhqk", q, k) * (D ** -0.5)
        off = Sk - Sq
        qi = torch.arange(Sq)[:, None]
        kj = torch.arange(Sk)[None, :]
        cmask = kj <= (qi + off)
        scores = torch.where(cmask[None, None], scores, -1e9)
        p = _softmax(scores, axis=-1)
        ctx = torch.einsum("bhqk,bhkd->bhqd", p, v)
        return torch.einsum("bhqd,hdm->bqm", ctx, w_o)

    x = A_x
    g = _sigmoid((x * gate_w).sum(-1, keepdims=True))
    a = _A_ref(x, A_wqkv, A_wo)
    b = _B_ref(x, B_c_kv, B_w_q, B_w_uk, B_w_uv, B_w_o)
    return g * a + (1 - g) * b
```

```asm
; @launch grid=(256,1,1) block=(256,1,1) lds=163840
.amdgcn_target "amdgcn-amd-amdhsa--gfx950"
.text
.globl gated_mix__mha_block__compressed_kv_cla__prompt_kernel
.p2align 8
.type gated_mix__mha_block__compressed_kv_cla__prompt_kernel,@function
gated_mix__mha_block__compressed_kv_cla__prompt_kernel:

    s_load_dwordx16 s[4:19], s[0:1], 0
    s_load_dwordx8 s[20:27], s[0:1], 64
    s_load_dwordx2 s[28:29], s[0:1], 96
    s_load_dwordx2 s[30:31], s[0:1], 16
    s_cmp_ge_u32 s2, 256
    s_cbranch_scc1 LM_END
    s_cmp_ge_u32 s2, 8
    s_cbranch_scc1 LW0_1
    s_getpc_b64 s[40:41]
    s_mov_b32 s42, LP_START-gated_mix__mha_block__compressed_kv_cla__prompt_kernel
    s_mov_b32 s43, 0x20000
    v_lshlrev_b32 v40, 7, v0
    s_lshr_b32 s80, s2, 3
    s_lshl_b32 s80, s80, 15
    buffer_load_dword v41, v40, s[40:43], s80 offen
LW0_1:
    v_lshrrev_b32 v32, 6, v0
    v_and_b32 v0, 63, v0
    v_readfirstlane_b32 s48, v32
    v_lshlrev_b32 v1, 4, v0
    s_and_b32 s80, s2, 7
    s_bfe_u32 s81, s2, 0x10005
    s_lshl_b32 s81, s81, 3
    s_add_u32 s80, s80, s81
    s_lshr_b32 s81, s2, 7
    s_lshl_b32 s81, s81, 4
    s_add_u32 s80, s80, s81
    s_bfe_u32 s3, s2, 0x10006
    s_bfe_u32 s81, s2, 0x20003
    s_lshl_b32 s82, s3, 2
    s_add_u32 s81, s81, s82
    s_lshr_b32 s82, s48, 1
    s_and_b32 s83, s48, 1
    s_and_b32 s79, s80, 15
    s_lshr_b32 s49, s80, 4
    s_lshl_b32 s85, s82, 4
    s_add_u32 s85, s85, s83
    s_lshl_b32 s62, s85, 10
    s_add_u32 s62, s62, 65536
    s_mov_b32 s60, s62
    s_lshl_b32 s85, s85, 3
    s_lshl_b32 s86, s81, 8
    s_add_u32 s86, s86, s85
    s_lshl_b32 s52, s86, 11
    s_mov_b32 s54, 32768
    s_mov_b32 s55, 32768
    s_mov_b32 s56, 4294738048
    s_lshl_b32 s87, s82, 2
    s_add_u32 s87, s87, s83
    s_lshl_b32 s61, s87, 10
    s_lshl_b32 s53, s87, 14
    s_lshl_b32 s86, s79, 9
    s_add_u32 s53, s53, s86
    v_lshrrev_b32 v32, 4, v0
    s_lshl_b32 s86, s83, 2
    v_add_u32 v38, s86, v32
    v_and_b32 v33, 7, v0
    v_xor_b32 v32, v38, v33
    v_lshlrev_b32 v32, 4, v32
    v_lshrrev_b32 v33, 3, v0
    v_lshl_add_u32 v14, v33, 11, v32
    v_mul_u32_u24 v34, 896, v33
    v_add_u32 v16, v34, v32
    v_lshrrev_b32 v32, 5, v0
    s_lshl_b32 s86, s83, 1
    s_lshl_b32 s85, s82, 2
    s_add_u32 s86, s86, s85
    v_add_u32 v33, s86, v32
    v_bfe_u32 v34, v0, 1, 4
    v_xor_b32 v34, v34, v33
    v_and_b32 v35, 1, v0
    v_lshl_add_u32 v34, v34, 1, v35
    v_lshlrev_b32 v35, 4, v34
    v_lshl_add_u32 v15, v32, 13, v35
    s_waitcnt lgkmcnt(0)
    s_mov_b32 s32, s12
    s_mov_b32 s33, s13
    s_mov_b32 s34, 4194304
    s_mov_b32 s35, 0x20000
    s_cmp_eq_u32 s49, 0
    s_cselect_b32 s36, s16, s18
    s_cselect_b32 s37, s17, s19
    s_mov_b32 s38, 8388608
    s_mov_b32 s39, 0x20000
    s_mov_b32 m0, s60
    s_nop 0
    buffer_load_dwordx4 v14, s[32:35], s52 offen lds
    s_add_u32 m0, m0, 2048
    s_add_u32 s52, s52, s54
    buffer_load_dwordx4 v14, s[32:35], s52 offen lds
    s_add_u32 m0, m0, 2048
    s_add_u32 s52, s52, s55
    buffer_load_dwordx4 v14, s[32:35], s52 offen lds
    s_add_u32 m0, m0, 2048
    s_add_u32 s52, s52, s54
    buffer_load_dwordx4 v14, s[32:35], s52 offen lds
    s_add_u32 m0, m0, 2048
    s_add_u32 s52, s52, s55
    buffer_load_dwordx4 v14, s[32:35], s52 offen lds
    s_add_u32 m0, m0, 2048
    s_add_u32 s52, s52, s54
    buffer_load_dwordx4 v14, s[32:35], s52 offen lds
    s_add_u32 m0, m0, 2048
    s_add_u32 s52, s52, s55
    buffer_load_dwordx4 v14, s[32:35], s52 offen lds
    s_add_u32 m0, m0, 2048
    s_add_u32 s52, s52, s54
    buffer_load_dwordx4 v14, s[32:35], s52 offen lds
    s_add_u32 s52, s52, s56
    s_add_u32 s60, s60, 32768
    s_cmp_ge_u32 s60, 163840
    s_cselect_b32 s60, s62, s60
    s_mov_b32 m0, s61
    s_nop 0
    buffer_load_dwordx4 v15, s[36:39], s53 offen lds
    s_add_u32 m0, m0, 2048
    s_add_u32 s53, s53, 32768
    buffer_load_dwordx4 v15, s[36:39], s53 offen lds
    s_add_u32 m0, m0, 6144
    s_add_u32 s53, s53, 98304
    buffer_load_dwordx4 v15, s[36:39], s53 offen lds
    s_add_u32 m0, m0, 2048
    s_add_u32 s53, s53, 32768
    buffer_load_dwordx4 v15, s[36:39], s53 offen lds
    s_add_u32 m0, m0, 6144
    s_add_u32 s53, s53, 98304
    buffer_load_dwordx4 v15, s[36:39], s53 offen lds
    s_add_u32 m0, m0, 2048
    s_add_u32 s53, s53, 32768
    buffer_load_dwordx4 v15, s[36:39], s53 offen lds
    s_add_u32 m0, m0, 6144
    s_add_u32 s53, s53, 98304
    buffer_load_dwordx4 v15, s[36:39], s53 offen lds
    s_add_u32 m0, m0, 2048
    s_add_u32 s53, s53, 32768
    buffer_load_dwordx4 v15, s[36:39], s53 offen lds
    s_add_u32 s53, s53, 98304
    s_xor_b32 s61, s61, 32768
    s_and_b32 s50, s2, 15
    s_lshr_b32 s80, s2, 4
    s_sub_u32 s51, 15, s80
    s_lshl_b32 s84, s51, 7
    s_lshl_b32 s85, s50, 3
    s_add_u32 s84, s84, s85
    s_lshl_b32 s85, s48, 1
    s_add_u32 s64, s84, s85
    s_mul_i32 s84, s64, 896
    v_and_b32 v48, 31, v0
    v_lshlrev_b32 v49, 5, v48
    v_mov_b32 v51, 0x40000000
    v_cmp_gt_u32 vcc, 28, v48
    v_lshrrev_b32 v50, 5, v0
    s_nop 0
    v_cndmask_b32 v49, v51, v49, vcc
    v_mul_u32_u24 v50, 896, v50
    v_add_u32 v50, v50, v49
    s_mov_b32 s40, s4
    s_mov_b32 s41, s5
    s_mov_b32 s42, 1835008
    s_mov_b32 s43, 0x20000
    s_mov_b32 s44, s22
    s_mov_b32 s45, s23
    s_mov_b32 s46, 896
    s_mov_b32 s47, 0x20000
    buffer_load_dwordx4 v[192:195], v50, s[40:43], s84 offen
    buffer_load_dwordx4 v[196:199], v50, s[40:43], s84 offen offset:16
    buffer_load_dwordx4 v[200:203], v49, s[44:47], 0 offen
    buffer_load_dwordx4 v[204:207], v49, s[44:47], 0 offen offset:16
    s_mov_b32 m0, s60
    s_nop 0
    buffer_load_dwordx4 v14, s[32:35], s52 offen lds
    s_add_u32 m0, m0, 2048
    s_add_u32 s52, s52, s54
    buffer_load_dwordx4 v14, s[32:35], s52 offen lds
    s_add_u32 m0, m0, 2048
    s_add_u32 s52, s52, s55
    buffer_load_dwordx4 v14, s[32:35], s52 offen lds
    s_add_u32 m0, m0, 2048
    s_add_u32 s52, s52, s54
    buffer_load_dwordx4 v14, s[32:35], s52 offen lds
    s_add_u32 m0, m0, 2048
    s_add_u32 s52, s52, s55
    buffer_load_dwordx4 v14, s[32:35], s52 offen lds
    s_add_u32 m0, m0, 2048
    s_add_u32 s52, s52, s54
    buffer_load_dwordx4 v14, s[32:35], s52 offen lds
    s_add_u32 m0, m0, 2048
    s_add_u32 s52, s52, s55
    buffer_load_dwordx4 v14, s[32:35], s52 offen lds
    s_add_u32 m0, m0, 2048
    s_add_u32 s52, s52, s54
    buffer_load_dwordx4 v14, s[32:35], s52 offen lds
    s_add_u32 s52, s52, s56
    s_add_u32 s60, s60, 32768
    s_cmp_ge_u32 s60, 163840
    s_cselect_b32 s60, s62, s60
    s_mov_b32 m0, s61
    s_nop 0
    buffer_load_dwordx4 v15, s[36:39], s53 offen lds
    s_add_u32 m0, m0, 2048
    s_add_u32 s53, s53, 32768
    buffer_load_dwordx4 v15, s[36:39], s53 offen lds
    s_add_u32 m0, m0, 6144
    s_add_u32 s53, s53, 98304
    buffer_load_dwordx4 v15, s[36:39], s53 offen lds
    s_add_u32 m0, m0, 2048
    s_add_u32 s53, s53, 32768
    buffer_load_dwordx4 v15, s[36:39], s53 offen lds
    s_add_u32 m0, m0, 6144
    s_add_u32 s53, s53, 98304
    buffer_load_dwordx4 v15, s[36:39], s53 offen lds
    s_add_u32 m0, m0, 2048
    s_add_u32 s53, s53, 32768
    buffer_load_dwordx4 v15, s[36:39], s53 offen lds
    s_add_u32 m0, m0, 6144
    s_add_u32 s53, s53, 98304
    buffer_load_dwordx4 v15, s[36:39], s53 offen lds
    s_add_u32 m0, m0, 2048
    s_add_u32 s53, s53, 32768
    buffer_load_dwordx4 v15, s[36:39], s53 offen lds
    s_add_u32 s53, s53, 98304
    s_xor_b32 s61, s61, 32768
    s_mov_b32 s40, s28
    s_mov_b32 s41, s29
    s_mov_b32 s42, 268435456
    s_mov_b32 s43, 0x20000
    s_mov_b32 s44, s26
    s_mov_b32 s45, s27
    s_mov_b32 s46, 256
    s_mov_b32 s47, 0x20000
    s_mov_b32 s8, s28
    s_mov_b32 s9, s29
    s_mov_b32 s10, 268435456
    s_mov_b32 s11, 0x20000
    s_cmp_eq_u32 s3, 0
    s_cselect_b32 s10, s10, 0
    v_lshlrev_b32 v47, 2, v0
    v_mov_b32 v46, 0
    s_cmp_lg_u32 s48, 0
    s_cbranch_scc1 LM_2
    s_lshl_b32 s86, s2, 6
    s_add_u32 s86, s86, 251658240
    s_mov_b64 exec, 0xffff
    buffer_store_dword v46, v47, s[40:43], s86 offen sc1
    s_mov_b64 exec, -1
LM_2:
    s_lshl_b32 s65, s79, 20
    s_lshl_b32 s86, s81, 17
    s_add_u32 s65, s65, s86
    s_lshl_b32 s86, s82, 16
    s_add_u32 s65, s65, s86
    s_add_u32 s86, s49, 12
    s_lshl_b32 s86, s83, s86
    s_add_u32 s65, s65, s86
    s_lshl_b32 s86, s49, 24
    s_add_u32 s65, s65, s86
    s_mov_b32 s86, 8192
    s_cmp_eq_u32 s49, 0
    s_cselect_b32 s66, s86, 4096
    s_cselect_b32 s67, s86, 12288
    s_lshl_b32 s79, s79, 8
    s_lshl_b32 s86, s3, 12
    s_add_u32 s79, s79, s86
    s_lshl_b32 s86, s49, 4
    s_add_u32 s79, s79, s86
    s_and_b32 s86, s81, 3
    s_lshl_b32 s86, s86, 2
    s_add_u32 s79, s79, s86
    s_add_u32 s79, s79, 251658240
    s_and_b32 s50, s2, 15
    s_lshr_b32 s80, s2, 4
    s_sub_u32 s51, 15, s80
    s_lshl_b32 s69, s87, 14
    s_lshl_b32 s86, s50, 9
    s_add_u32 s69, s69, s86
    s_lshl_b32 s85, s51, 7
    s_lshl_b32 s86, s83, 3
    s_add_u32 s85, s85, s86
    s_mul_i32 s85, s85, 896
    s_mul_i32 s86, s83, 21504
    s_mul_i32 s84, s50, 56
    s_add_u32 s86, s86, s84
    s_cmp_eq_u32 s82, 0
    s_cselect_b32 s68, s85, s86
    s_cselect_b32 s73, s4, s6
    s_cselect_b32 s74, s5, s7
    s_mov_b32 s85, 1835008
    s_cselect_b32 s75, s85, 1204224
    s_mov_b32 s85, 14336
    s_cselect_b32 s70, s85, 10752
    s_cselect_b32 s71, s85, 32256
    s_mov_b32 s85, 4294867072
    s_cselect_b32 s72, s85, 32256
    s_cbranch_scc1 LM_3
    v_bfe_u32 v32, v0, 1, 3
    v_xor_b32 v32, v32, v38
    v_and_b32 v33, 1, v0
    v_lshl_add_u32 v32, v32, 1, v33
    v_lshrrev_b32 v33, 2, v32
    v_and_b32 v32, 3, v32
    v_lshlrev_b32 v32, 4, v32
    v_mul_u32_u24 v34, 896, v33
    v_add_u32 v32, v32, v34
    v_lshrrev_b32 v34, 4, v0
    v_mul_u32_u24 v34, 2688, v34
    v_add_u32 v32, v32, v34
    v_mov_b32 v34, 0x40000000
    v_cmp_gt_u32 vcc, 3, v33
    s_nop 1
    v_cndmask_b32 v16, v34, v32, vcc
LM_3:
    s_lshl_b32 s76, s50, 17
    s_lshl_b32 s85, s51, 13
    s_add_u32 s76, s76, s85
    s_lshl_b32 s85, s82, 12
    s_add_u32 s76, s76, s85
    s_lshl_b32 s85, s83, 8
    s_add_u32 s77, s76, s85
    s_add_u32 s77, s77, 54525952
    s_lshl_b32 s85, s83, 21
    s_add_u32 s76, s76, s85
    s_add_u32 s76, s76, 50331648
    s_cmp_eq_u32 s83, 0
    s_cselect_b32 s78, 0x3e8b97f6, 1.0
    v_and_b32 v32, 15, v0
    v_lshrrev_b32 v33, 4, v0
    v_lshrrev_b32 v34, 1, v32
    v_xor_b32 v34, v34, v33
    v_lshlrev_b32 v34, 4, v34
    v_lshl_add_u32 v34, v32, 7, v34
    s_lshl_b32 s85, s82, 14
    v_add_u32 v2, s85, v34
    v_xor_b32 v3, 64, v2
    s_lshl_b32 s85, s82, 13
    v_add_u32 v22, s85, v34
    v_xor_b32 v23, 64, v22
    v_add_u32 v4, 65536, v2
    v_add_u32 v5, 65536, v3
    s_mov_b32 s59, 98304
    v_bfe_u32 v34, v0, 2, 2
    v_lshl_add_u32 v35, v33, 3, v34
    v_lshlrev_b32 v35, 9, v35
    v_bfe_u32 v36, v0, 2, 3
    v_lshl_add_u32 v35, v36, 5, v35
    v_and_b32 v37, 3, v0
    v_lshl_add_u32 v35, v37, 3, v35
    s_lshl_b32 s85, s83, 8
    v_add_u32 v6, s85, v35
    v_xor_b32 v7, 32, v6
    v_xor_b32 v8, 64, v6
    v_xor_b32 v9, 96, v6
    v_xor_b32 v10, 128, v6
    v_xor_b32 v11, 160, v6
    v_xor_b32 v12, 192, v6
    v_xor_b32 v13, 224, v6
    v_lshrrev_b32 v35, 5, v0
    v_lshl_add_u32 v35, v35, 4, v36
    v_lshlrev_b32 v35, 8, v35
    v_lshl_add_u32 v35, v36, 5, v35
    v_lshl_add_u32 v35, v37, 3, v35
    v_add_u32 v35, 16384, v35
    s_lshl_b32 s85, s83, 6
    v_xor_b32 v24, s85, v35
    v_xor_b32 v25, 32, v24
    s_lshl_b32 s85, s83, 5
    s_add_u32 s85, s85, 128
    v_xor_b32 v26, s85, v35
    v_lshlrev_b32 v34, 9, v33
    v_bfe_u32 v35, v0, 3, 1
    v_lshl_add_u32 v36, v35, 8, v34
    v_and_b32 v35, 7, v0
    v_lshl_add_u32 v17, v35, 4, v36
    v_lshl_add_u32 v18, v32, 4, v34
    v_mov_b32 v19, s78
    v_cmp_gt_u32 vcc, 3, v33
    s_nop 1
    v_cndmask_b32 v19, 0, v19, vcc
    s_lshl_b32 s85, s83, 4
    v_add_u32 v34, s85, v32
    v_cmp_gt_u32 vcc, 28, v34
    s_nop 1
    v_cndmask_b32 v20, 0, 1.0, vcc
    v_cmp_eq_u32 vcc, 28, v34
    s_nop 1
    v_cndmask_b32 v21, 0, 1.0, vcc
    s_lshl_b32 s86, s82, 15
    s_lshl_b32 s85, s83, 12
    s_add_u32 s86, s86, s85
    s_add_u32 s86, s86, 98304
    v_add_u32 v30, s86, v1
    s_lshl_b32 s86, s48, 13
    s_add_u32 s86, s86, 98304
    v_add_u32 v31, s86, v1
    s_waitcnt vmcnt(16)
    s_mov_b32 s58, 0
    s_lshl_b32 s57, s64, 2
    s_add_u32 s57, s57, 252706816
    s_mov_b32 s63, 14
    s_mov_b32 s64, 0
    s_mov_b32 s42, 0
    s_mov_b32 s46, 0
    s_lshl_b32 s87, s2, 2
    s_add_u32 s87, s87, s48
    s_lshl_b32 s19, s87, 13
    s_mov_b64 s[12:13], s[14:15]
    s_mov_b32 s16, 3670016
    s_mov_b32 s17, s19
    s_sub_u32 s80, s19, 3670016
    s_cmp_ge_u32 s87, 448
    s_cselect_b64 s[12:13], s[4:5], s[12:13]
    s_cselect_b32 s16, 1835008, s16
    s_cselect_b32 s17, s80, s17
    s_sub_u32 s80, s19, 5505024
    s_cmp_ge_u32 s87, 672
    s_cselect_b64 s[12:13], s[6:7], s[12:13]
    s_cselect_b32 s16, 1204224, s16
    s_cselect_b32 s17, s80, s17
    s_sub_u32 s80, s19, 6709248
    s_cmp_ge_u32 s87, 819
    s_cselect_b64 s[12:13], s[30:31], s[12:13]
    s_cselect_b32 s16, 401408, s16
    s_cselect_b32 s17, s80, s17
    s_mul_i32 s80, s87, 6554
    s_lshr_b32 s80, s80, 16
    s_mul_i32 s80, s80, 10
    s_sub_u32 s18, s87, s80
    s_add_u32 s18, s18, 2
    s_lshr_b32 s86, s2, 3
    s_lshl_b32 s86, s86, 2
    s_add_u32 s86, s86, s48
    s_lshl_b32 s86, s86, 13
    s_getpc_b64 s[84:85]
LM_PC:
    s_bfe_u32 s83, s2, 0x30004
    s_add_u32 s83, s83, 2
    s_cmp_eq_u32 s48, 0
    s_cselect_b32 s83, s83, 99
    s_and_b32 s80, s2, 15
    s_lshl_b32 s80, s80, 4
    v_lshlrev_b32 v43, 12, v0
    v_add_u32 v43, s80, v43
    v_mov_b32 v42, 1
    v_and_b32 v47, 15, v0
    v_lshlrev_b32 v47, 4, v47
    v_lshlrev_b32 v40, 7, v0
    s_barrier
    ds_read_b128 v[64:67], v4 offset:0
    ds_read_b128 v[68:71], v4 offset:2048
    ds_read_b128 v[72:75], v4 offset:4096
    ds_read_b128 v[76:79], v4 offset:6144
    ds_read_b128 v[80:83], v4 offset:8192
    ds_read_b128 v[84:87], v4 offset:10240
    ds_read_b128 v[88:91], v4 offset:12288
    ds_read_b128 v[92:95], v4 offset:14336
    ds_read_b64_tr_b16 v[96:97], v6 offset:0
    ds_read_b64_tr_b16 v[98:99], v6 offset:2048
    ds_read_b64_tr_b16 v[100:101], v7 offset:0
    ds_read_b64_tr_b16 v[102:103], v7 offset:2048
    ds_read_b64_tr_b16 v[104:105], v8 offset:0
    ds_read_b64_tr_b16 v[106:107], v8 offset:2048
    ds_read_b64_tr_b16 v[108:109], v9 offset:0
    ds_read_b64_tr_b16 v[110:111], v9 offset:2048
    ds_read_b64_tr_b16 v[112:113], v10 offset:0
    ds_read_b64_tr_b16 v[114:115], v10 offset:2048
    ds_read_b64_tr_b16 v[116:117], v11 offset:0
    ds_read_b64_tr_b16 v[118:119], v11 offset:2048
    ds_read_b64_tr_b16 v[120:121], v12 offset:0
    ds_read_b64_tr_b16 v[122:123], v12 offset:2048
    ds_read_b64_tr_b16 v[124:125], v13 offset:0
    ds_read_b64_tr_b16 v[126:127], v13 offset:2048
    s_waitcnt lgkmcnt(0)
    s_cmp_eq_u32 s49, 1
    s_cbranch_scc1 LG_VT
    v_mfma_f32_16x16x32_bf16 a[0:3], v[96:99], v[64:67], 0
    ds_read_b128 v[128:131], v5 offset:0
    s_mov_b32 m0, s60
    v_mfma_f32_16x16x32_bf16 a[32:35], v[100:103], v[64:67], 0
    v_mov_b32 v56, 0
    v_lshlrev_b32 v208, 16, v192
    v_mfma_f32_16x16x32_bf16 a[36:39], v[100:103], v[68:71], 0
    ds_read_b128 v[132:135], v5 offset:2048
    v_and_b32 v209, 0xffff0000, v192
    v_mfma_f32_16x16x32_bf16 a[4:7], v[96:99], v[68:71], 0
    buffer_load_dwordx4 v14, s[32:35], s52 offen lds
    v_mfma_f32_16x16x32_bf16 a[8:11], v[96:99], v[72:75], 0
    ds_read_b128 v[136:139], v5 offset:4096
    s_add_u32 m0, m0, 2048
    v_mfma_f32_16x16x32_bf16 a[40:43], v[100:103], v[72:75], 0
    s_add_u32 s52, s52, s54
    v_lshlrev_b32 v210, 16, v200
    v_and_b32 v211, 0xffff0000, v200
    v_mfma_f32_16x16x32_bf16 a[44:47], v[100:103], v[76:79], 0
    ds_read_b128 v[140:143], v5 offset:6144
    v_mul_f32 v208, v208, v210
    v_mfma_f32_16x16x32_bf16 a[12:15], v[96:99], v[76:79], 0
    v_mul_f32 v209, v209, v211
    v_lshlrev_b32 v212, 16, v193
    v_mfma_f32_16x16x32_bf16 a[16:19], v[96:99], v[80:83], 0
    ds_read_b128 v[144:147], v5 offset:8192
    v_cvt_pk_bf16_f32 v208, v208, v209
    v_mfma_f32_16x16x32_bf16 a[48:51], v[100:103], v[80:83], 0
    v_lshlrev_b32 v209, 16, v208
    v_and_b32 v210, 0xffff0000, v208
    v_mfma_f32_16x16x32_bf16 a[52:55], v[100:103], v[84:87], 0
    ds_read_b128 v[148:151], v5 offset:10240
    v_add_f32 v56, v56, v209
    v_mfma_f32_16x16x32_bf16 a[20:23], v[96:99], v[84:87], 0
    buffer_load_dwordx4 v14, s[32:35], s52 offen lds
    v_mfma_f32_16x16x32_bf16 a[24:27], v[96:99], v[88:91], 0
    ds_read_b128 v[152:155], v5 offset:12288
    s_add_u32 m0, m0, 2048
    v_mfma_f32_16x16x32_bf16 a[56:59], v[100:103], v[88:91], 0
    s_add_u32 s52, s52, s55
    v_add_f32 v56, v56, v210
    v_and_b32 v213, 0xffff0000, v193
    v_mfma_f32_16x16x32_bf16 a[60:63], v[100:103], v[92:95], 0
    ds_read_b128 v[156:159], v5 offset:14336
    v_lshlrev_b32 v214, 16, v201
    v_mfma_f32_16x16x32_bf16 a[28:31], v[96:99], v[92:95], 0
    v_and_b32 v215, 0xffff0000, v201
    v_mul_f32 v212, v212, v214
    v_mfma_f32_16x16x32_bf16 a[92:95], v[104:107], v[92:95], 0
    ds_read_b64_tr_b16 v[160:161], v6 offset:16384
    v_mul_f32 v213, v213, v215
    v_mfma_f32_16x16x32_bf16 a[124:127], v[108:111], v[92:95], 0
    v_cvt_pk_bf16_f32 v212, v212, v213
    v_lshlrev_b32 v216, 16, v194
    v_mfma_f32_16x16x32_bf16 a[120:123], v[108:111], v[88:91], 0
    ds_read_b64_tr_b16 v[162:163], v6 offset:18432
    v_lshlrev_b32 v213, 16, v212
    v_mfma_f32_16x16x32_bf16 a[88:91], v[104:107], v[88:91], 0
    buffer_load_dwordx4 v14, s[32:35], s52 offen lds
    v_mfma_f32_16x16x32_bf16 a[84:87], v[104:107], v[84:87], 0
    ds_read_b64_tr_b16 v[164:165], v7 offset:16384
    s_add_u32 m0, m0, 2048
    v_mfma_f32_16x16x32_bf16 a[116:119], v[108:111], v[84:87], 0
    s_add_u32 s52, s52, s54
    v_and_b32 v214, 0xffff0000, v212
    v_add_f32 v56, v56, v213
    v_mfma_f32_16x16x32_bf16 a[112:115], v[108:111], v[80:83], 0
    ds_read_b64_tr_b16 v[166:167], v7 offset:18432
    v_add_f32 v56, v56, v214
    v_mfma_f32_16x16x32_bf16 a[80:83], v[104:107], v[80:83], 0
    v_and_b32 v217, 0xffff0000, v194
    v_lshlrev_b32 v218, 16, v202
    v_mfma_f32_16x16x32_bf16 a[76:79], v[104:107], v[76:79], 0
    ds_read_b64_tr_b16 v[168:169], v8 offset:16384
    v_and_b32 v219, 0xffff0000, v202
    v_mfma_f32_16x16x32_bf16 a[108:111], v[108:111], v[76:79], 0
    v_mul_f32 v216, v216, v218
    v_mul_f32 v217, v217, v219
    v_mfma_f32_16x16x32_bf16 a[104:107], v[108:111], v[72:75], 0
    ds_read_b64_tr_b16 v[170:171], v8 offset:18432
    v_cvt_pk_bf16_f32 v216, v216, v217
    v_mfma_f32_16x16x32_bf16 a[72:75], v[104:107], v[72:75], 0
    buffer_load_dwordx4 v14, s[32:35], s52 offen lds
    v_mfma_f32_16x16x32_bf16 a[68:71], v[104:107], v[68:71], 0
    ds_read_b64_tr_b16 v[172:173], v9 offset:16384
    s_add_u32 m0, m0, 2048
    v_mfma_f32_16x16x32_bf16 a[100:103], v[108:111], v[68:71], 0
    s_add_u32 s52, s52, s55
    v_lshlrev_b32 v217, 16, v216
    v_and_b32 v218, 0xffff0000, v216
    v_mfma_f32_16x16x32_bf16 a[96:99], v[108:111], v[64:67], 0
    ds_read_b64_tr_b16 v[174:175], v9 offset:18432
    v_add_f32 v56, v56, v217
    v_mfma_f32_16x16x32_bf16 a[64:67], v[104:107], v[64:67], 0
    v_add_f32 v56, v56, v218
    v_lshlrev_b32 v220, 16, v195
    v_mfma_f32_16x16x32_bf16 a[128:131], v[112:115], v[64:67], 0
    ds_read_b64_tr_b16 v[176:177], v10 offset:16384
    v_and_b32 v221, 0xffff0000, v195
    v_mfma_f32_16x16x32_bf16 a[160:163], v[116:119], v[64:67], 0
    v_lshlrev_b32 v222, 16, v203
    v_and_b32 v223, 0xffff0000, v203
    v_mfma_f32_16x16x32_bf16 a[164:167], v[116:119], v[68:71], 0
    ds_read_b64_tr_b16 v[178:179], v10 offset:18432
    v_mul_f32 v220, v220, v222
    v_mfma_f32_16x16x32_bf16 a[132:135], v[112:115], v[68:71], 0
    buffer_load_dwordx4 v14, s[32:35], s52 offen lds
    v_mfma_f32_16x16x32_bf16 a[136:139], v[112:115], v[72:75], 0
    ds_read_b64_tr_b16 v[180:181], v11 offset:16384
    s_add_u32 m0, m0, 2048
    v_mfma_f32_16x16x32_bf16 a[168:171], v[116:119], v[72:75], 0
    s_add_u32 s52, s52, s54
    v_mul_f32 v221, v221, v223
    v_lshlrev_b32 v224, 16, v196
    v_mfma_f32_16x16x32_bf16 a[172:175], v[116:119], v[76:79], 0
    ds_read_b64_tr_b16 v[182:183], v11 offset:18432
    v_cvt_pk_bf16_f32 v220, v220, v221
    v_mfma_f32_16x16x32_bf16 a[140:143], v[112:115], v[76:79], 0
    v_lshlrev_b32 v221, 16, v220
    v_and_b32 v222, 0xffff0000, v220
    v_mfma_f32_16x16x32_bf16 a[144:147], v[112:115], v[80:83], 0
    ds_read_b64_tr_b16 v[184:185], v12 offset:16384
    v_add_f32 v56, v56, v221
    v_mfma_f32_16x16x32_bf16 a[176:179], v[116:119], v[80:83], 0
    v_add_f32 v56, v56, v222
    v_and_b32 v225, 0xffff0000, v196
    v_mfma_f32_16x16x32_bf16 a[180:183], v[116:119], v[84:87], 0
    ds_read_b64_tr_b16 v[186:187], v12 offset:18432
    v_lshlrev_b32 v226, 16, v204
    v_mfma_f32_16x16x32_bf16 a[148:151], v[112:115], v[84:87], 0
    buffer_load_dwordx4 v14, s[32:35], s52 offen lds
    v_mfma_f32_16x16x32_bf16 a[152:155], v[112:115], v[88:91], 0
    ds_read_b64_tr_b16 v[188:189], v13 offset:16384
    s_add_u32 m0, m0, 2048
    v_mfma_f32_16x16x32_bf16 a[184:187], v[116:119], v[88:91], 0
    s_add_u32 s52, s52, s55
    v_and_b32 v227, 0xffff0000, v204
    v_mul_f32 v224, v224, v226
    v_mfma_f32_16x16x32_bf16 a[188:191], v[116:119], v[92:95], 0
    ds_read_b64_tr_b16 v[190:191], v13 offset:18432
    v_mul_f32 v225, v225, v227
    v_mfma_f32_16x16x32_bf16 a[156:159], v[112:115], v[92:95], 0
    v_add_u32 v4, s59, v2
    v_add_u32 v5, s59, v3
    v_mfma_f32_16x16x32_bf16 a[220:223], v[120:123], v[92:95], 0
    v_xor_b32 v6, 0x8000, v6
    v_xor_b32 v7, 0x8000, v7
    v_mfma_f32_16x16x32_bf16 a[252:255], v[124:127], v[92:95], 0
    buffer_load_dwordx4 v14, s[32:35], s52 offen lds
    v_mfma_f32_16x16x32_bf16 a[248:251], v[124:127], v[88:91], 0
    s_add_u32 m0, m0, 2048
    s_add_u32 s52, s52, s54
    v_xor_b32 v8, 0x8000, v8
    v_mfma_f32_16x16x32_bf16 a[216:219], v[120:123], v[88:91], 0
    v_xor_b32 v9, 0x8000, v9
    v_xor_b32 v10, 0x8000, v10
    v_mfma_f32_16x16x32_bf16 a[212:215], v[120:123], v[84:87], 0
    v_xor_b32 v11, 0x8000, v11
    v_xor_b32 v12, 0x8000, v12
    v_mfma_f32_16x16x32_bf16 a[244:247], v[124:127], v[84:87], 0
    v_xor_b32 v13, 0x8000, v13
    v_cvt_pk_bf16_f32 v224, v224, v225
    v_mfma_f32_16x16x32_bf16 a[240:243], v[124:127], v[80:83], 0
    v_lshlrev_b32 v225, 16, v224
    v_and_b32 v226, 0xffff0000, v224
    v_mfma_f32_16x16x32_bf16 a[208:211], v[120:123], v[80:83], 0
    buffer_load_dwordx4 v14, s[32:35], s52 offen lds
    v_mfma_f32_16x16x32_bf16 a[204:207], v[120:123], v[76:79], 0
    s_add_u32 s52, s52, s56
    s_add_u32 s60, s60, 32768
    s_cmp_ge_u32 s60, 163840
    v_mfma_f32_16x16x32_bf16 a[236:239], v[124:127], v[76:79], 0
    s_cselect_b32 s60, s62, s60
    v_add_f32 v56, v56, v225
    v_lshlrev_b32 v228, 16, v197
    v_mfma_f32_16x16x32_bf16 a[232:235], v[124:127], v[72:75], 0
    v_add_f32 v56, v56, v226
    v_and_b32 v229, 0xffff0000, v197
    v_mfma_f32_16x16x32_bf16 a[200:203], v[120:123], v[72:75], 0
    buffer_load_dword v41, v40, s[40:43], s87 offen
    v_mfma_f32_16x16x32_bf16 a[196:199], v[120:123], v[68:71], 0
    v_mfma_f32_16x16x32_bf16 a[228:231], v[124:127], v[68:71], 0
    buffer_atomic_add v42, v43, s[44:47], 0 offen
    v_mfma_f32_16x16x32_bf16 a[224:227], v[124:127], v[64:67], 0
    v_mfma_f32_16x16x32_bf16 a[192:195], v[120:123], v[64:67], 0
    s_waitcnt vmcnt(10) lgkmcnt(0)
    s_barrier
    v_mfma_f32_16x16x32_bf16 a[0:3], v[160:163], v[128:131], a[0:3]
    ds_read_b128 v[64:67], v4 offset:0
    s_add_u32 s59, s59, 32768
    v_mfma_f32_16x16x32_bf16 a[32:35], v[164:167], v[128:131], a[32:35]
    s_cmp_ge_u32 s59, 163840
    s_cselect_b32 s59, 65536, s59
    s_mov_b32 m0, s61
    v_mfma_f32_16x16x32_bf16 a[36:39], v[164:167], v[132:135], a[36:39]
    ds_read_b128 v[68:71], v4 offset:2048
    v_lshlrev_b32 v230, 16, v205
    v_mfma_f32_16x16x32_bf16 a[4:7], v[160:163], v[132:135], a[4:7]
    buffer_load_dwordx4 v15, s[36:39], s53 offen lds
    v_mfma_f32_16x16x32_bf16 a[8:11], v[160:163], v[136:139], a[8:11]
    ds_read_b128 v[72:75], v4 offset:4096
    s_add_u32 s64, s64, 1
    v_mfma_f32_16x16x32_bf16 a[40:43], v[164:167], v[136:139], a[40:43]
    s_mov_b32 s42, 0
    s_add_u32 m0, m0, 2048
    s_add_u32 s53, s53, 32768
    v_mfma_f32_16x16x32_bf16 a[44:47], v[164:167], v[140:143], a[44:47]
    ds_read_b128 v[76:79], v4 offset:6144
    v_and_b32 v231, 0xffff0000, v205
    v_mfma_f32_16x16x32_bf16 a[12:15], v[160:163], v[140:143], a[12:15]
    v_mul_f32 v228, v228, v230
    v_mul_f32 v229, v229, v231
    v_mfma_f32_16x16x32_bf16 a[16:19], v[160:163], v[144:147], a[16:19]
    ds_read_b128 v[80:83], v4 offset:8192
    v_cvt_pk_bf16_f32 v228, v228, v229
    v_mfma_f32_16x16x32_bf16 a[48:51], v[164:167], v[144:147], a[48:51]
    v_lshlrev_b32 v229, 16, v228
    v_and_b32 v230, 0xffff0000, v228
    v_mfma_f32_16x16x32_bf16 a[52:55], v[164:167], v[148:151], a[52:55]
    ds_read_b128 v[84:87], v4 offset:10240
    v_add_f32 v56, v56, v229
    v_mfma_f32_16x16x32_bf16 a[20:23], v[160:163], v[148:151], a[20:23]
    buffer_load_dwordx4 v15, s[36:39], s53 offen lds
    v_mfma_f32_16x16x32_bf16 a[24:27], v[160:163], v[152:155], a[24:27]
    ds_read_b128 v[88:91], v4 offset:12288
    s_add_u32 m0, m0, 6144
    v_mfma_f32_16x16x32_bf16 a[56:59], v[164:167], v[152:155], a[56:59]
    s_add_u32 s53, s53, 98304
    v_add_f32 v56, v56, v230
    v_lshlrev_b32 v232, 16, v198
    v_mfma_f32_16x16x32_bf16 a[60:63], v[164:167], v[156:159], a[60:63]
    ds_read_b128 v[92:95], v4 offset:14336
    v_and_b32 v233, 0xffff0000, v198
    v_mfma_f32_16x16x32_bf16 a[28:31], v[160:163], v[156:159], a[28:31]
    v_lshlrev_b32 v234, 16, v206
    v_and_b32 v235, 0xffff0000, v206
    v_mfma_f32_16x16x32_bf16 a[92:95], v[168:171], v[156:159], a[92:95]
    ds_read_b64_tr_b16 v[96:97], v6 offset:0
    v_mul_f32 v232, v232, v234
    v_mfma_f32_16x16x32_bf16 a[124:127], v[172:175], v[156:159], a[124:127]
    v_mul_f32 v233, v233, v235
    v_lshlrev_b32 v236, 16, v199
    v_mfma_f32_16x16x32_bf16 a[120:123], v[172:175], v[152:155], a[120:123]
    ds_read_b64_tr_b16 v[98:99], v6 offset:2048
    v_cvt_pk_bf16_f32 v232, v232, v233
    v_mfma_f32_16x16x32_bf16 a[88:91], v[168:171], v[152:155], a[88:91]
    buffer_load_dwordx4 v15, s[36:39], s53 offen lds
    v_mfma_f32_16x16x32_bf16 a[84:87], v[168:171], v[148:151], a[84:87]
    ds_read_b64_tr_b16 v[100:101], v7 offset:0
    s_add_u32 m0, m0, 2048
    v_mfma_f32_16x16x32_bf16 a[116:119], v[172:175], v[148:151], a[116:119]
    s_add_u32 s53, s53, 32768
    v_lshlrev_b32 v233, 16, v232
    v_and_b32 v234, 0xffff0000, v232
    v_mfma_f32_16x16x32_bf16 a[112:115], v[172:175], v[144:147], a[112:115]
    ds_read_b64_tr_b16 v[102:103], v7 offset:2048
    v_add_f32 v56, v56, v233
    v_mfma_f32_16x16x32_bf16 a[80:83], v[168:171], v[144:147], a[80:83]
    v_add_f32 v56, v56, v234
    v_and_b32 v237, 0xffff0000, v199
    v_mfma_f32_16x16x32_bf16 a[76:79], v[168:171], v[140:143], a[76:79]
    ds_read_b64_tr_b16 v[104:105], v8 offset:0
    v_lshlrev_b32 v238, 16, v207
    v_mfma_f32_16x16x32_bf16 a[108:111], v[172:175], v[140:143], a[108:111]
    v_and_b32 v239, 0xffff0000, v207
    v_mul_f32 v236, v236, v238
    v_mfma_f32_16x16x32_bf16 a[104:107], v[172:175], v[136:139], a[104:107]
    ds_read_b64_tr_b16 v[106:107], v8 offset:2048
    v_mul_f32 v237, v237, v239
    v_mfma_f32_16x16x32_bf16 a[72:75], v[168:171], v[136:139], a[72:75]
    buffer_load_dwordx4 v15, s[36:39], s53 offen lds
    v_mfma_f32_16x16x32_bf16 a[68:71], v[168:171], v[132:135], a[68:71]
    ds_read_b64_tr_b16 v[108:109], v9 offset:0
    s_add_u32 m0, m0, 6144
    v_mfma_f32_16x16x32_bf16 a[100:103], v[172:175], v[132:135], a[100:103]
    s_add_u32 s53, s53, 98304
    v_cvt_pk_bf16_f32 v236, v236, v237
    v_mfma_f32_16x16x32_bf16 a[96:99], v[172:175], v[128:131], a[96:99]
    ds_read_b64_tr_b16 v[110:111], v9 offset:2048
    v_lshlrev_b32 v237, 16, v236
    v_mfma_f32_16x16x32_bf16 a[64:67], v[168:171], v[128:131], a[64:67]
    v_and_b32 v238, 0xffff0000, v236
    v_add_f32 v56, v56, v237
    v_mfma_f32_16x16x32_bf16 a[128:131], v[176:179], v[128:131], a[128:131]
    ds_read_b64_tr_b16 v[112:113], v10 offset:0
    v_add_f32 v56, v56, v238
    v_mfma_f32_16x16x32_bf16 a[160:163], v[180:183], v[128:131], a[160:163]
    s_nop 0
    v_mfma_f32_16x16x32_bf16 a[164:167], v[180:183], v[132:135], a[164:167]
    ds_read_b64_tr_b16 v[114:115], v10 offset:2048
    v_add_f32_dpp v56, v56, v56 row_ror:8 row_mask:0xf bank_mask:0xf
    v_mfma_f32_16x16x32_bf16 a[132:135], v[176:179], v[132:135], a[132:135]
    buffer_load_dwordx4 v15, s[36:39], s53 offen lds
    v_mfma_f32_16x16x32_bf16 a[136:139], v[176:179], v[136:139], a[136:139]
    ds_read_b64_tr_b16 v[116:117], v11 offset:0
    s_add_u32 m0, m0, 2048
    v_mfma_f32_16x16x32_bf16 a[168:171], v[180:183], v[136:139], a[168:171]
    s_add_u32 s53, s53, 32768
    s_nop 0
    v_mfma_f32_16x16x32_bf16 a[172:175], v[180:183], v[140:143], a[172:175]
    ds_read_b64_tr_b16 v[118:119], v11 offset:2048
    v_add_f32_dpp v56, v56, v56 row_ror:4 row_mask:0xf bank_mask:0xf
    v_mfma_f32_16x16x32_bf16 a[140:143], v[176:179], v[140:143], a[140:143]
    s_nop 0
    v_mfma_f32_16x16x32_bf16 a[144:147], v[176:179], v[144:147], a[144:147]
    ds_read_b64_tr_b16 v[120:121], v12 offset:0
    v_add_f32_dpp v56, v56, v56 row_ror:2 row_mask:0xf bank_mask:0xf
    v_mfma_f32_16x16x32_bf16 a[176:179], v[180:183], v[144:147], a[176:179]
    s_nop 0
    v_mfma_f32_16x16x32_bf16 a[180:183], v[180:183], v[148:151], a[180:183]
    ds_read_b64_tr_b16 v[122:123], v12 offset:2048
    v_add_f32_dpp v56, v56, v56 row_ror:1 row_mask:0xf bank_mask:0xf
    v_mfma_f32_16x16x32_bf16 a[148:151], v[176:179], v[148:151], a[148:151]
    buffer_load_dwordx4 v15, s[36:39], s53 offen lds
    v_mfma_f32_16x16x32_bf16 a[152:155], v[176:179], v[152:155], a[152:155]
    ds_read_b64_tr_b16 v[124:125], v13 offset:0
    s_add_u32 m0, m0, 6144
    v_mfma_f32_16x16x32_bf16 a[184:187], v[180:183], v[152:155], a[184:187]
    s_add_u32 s53, s53, 98304
    v_mov_b32 v57, v56
    v_mfma_f32_16x16x32_bf16 a[188:191], v[180:183], v[156:159], a[188:191]
    ds_read_b64_tr_b16 v[126:127], v13 offset:2048
    s_nop 0
    v_mfma_f32_16x16x32_bf16 a[156:159], v[176:179], v[156:159], a[156:159]
    v_permlane16_swap_b32 v57, v56
    v_mfma_f32_16x16x32_bf16 a[220:223], v[184:187], v[156:159], a[220:223]
    s_nop 0
    v_mfma_f32_16x16x32_bf16 a[252:255], v[188:191], v[156:159], a[252:255]
    buffer_load_dwordx4 v15, s[36:39], s53 offen lds
    v_mfma_f32_16x16x32_bf16 a[248:251], v[188:191], v[152:155], a[248:251]
    s_add_u32 m0, m0, 2048
    s_add_u32 s53, s53, 32768
    v_add_f32 v56, v56, v57
    v_mfma_f32_16x16x32_bf16 a[216:219], v[184:187], v[152:155], a[216:219]
    v_cvt_pk_bf16_f32 v56, v56, v56
    v_mfma_f32_16x16x32_bf16 a[212:215], v[184:187], v[148:151], a[212:215]
    v_lshlrev_b32 v56, 16, v56
    v_mfma_f32_16x16x32_bf16 a[244:247], v[188:191], v[148:151], a[244:247]
    v_mul_f32 v56, 0xbfb8aa3b, v56
    v_mfma_f32_16x16x32_bf16 a[240:243], v[188:191], v[144:147], a[240:243]
    v_exp_f32 v56, v56
    v_mfma_f32_16x16x32_bf16 a[208:211], v[184:187], v[144:147], a[208:211]
    buffer_load_dwordx4 v15, s[36:39], s53 offen lds
    v_mfma_f32_16x16x32_bf16 a[204:207], v[184:187], v[140:143], a[204:207]
    s_add_u32 s53, s53, 98304
    s_xor_b32 s61, s61, 32768
    s_sub_u32 s63, s63, 1
    v_mfma_f32_16x16x32_bf16 a[236:239], v[188:191], v[140:143], a[236:239]
    s_cmp_lg_u32 s63, 0
    v_add_f32 v56, 1.0, v56
    v_mfma_f32_16x16x32_bf16 a[232:235], v[188:191], v[136:139], a[232:235]
    v_rcp_f32 v56, v56
    v_mfma_f32_16x16x32_bf16 a[200:203], v[184:187], v[136:139], a[200:203]
    v_cvt_pk_bf16_f32 v56, v56, v56
    v_mfma_f32_16x16x32_bf16 a[196:199], v[184:187], v[132:135], a[196:199]
    v_lshlrev_b32 v56, 16, v56
    v_mfma_f32_16x16x32_bf16 a[228:231], v[188:191], v[132:135], a[228:231]
    v_lshrrev_b32 v57, 5, v0
    v_mfma_f32_16x16x32_bf16 a[224:227], v[188:191], v[128:131], a[224:227]
    v_lshlrev_b32 v57, 2, v57
    v_mfma_f32_16x16x32_bf16 a[192:195], v[184:187], v[128:131], a[192:195]
    s_waitcnt lgkmcnt(0)
    s_mov_b32 s42, 268435456
    s_mov_b32 exec_lo, 1
    s_mov_b32 exec_hi, 1
    buffer_store_dword v56, v57, s[40:43], s57 offen sc1
    s_mov_b64 exec, -1
    s_mov_b32 s42, 0
LG_LOOP_KQ:
    v_mfma_f32_16x16x32_bf16 a[0:3], v[96:99], v[64:67], a[0:3]
    ds_read_b128 v[128:131], v5 offset:0
    s_mov_b32 m0, s60
    v_mfma_f32_16x16x32_bf16 a[32:35], v[100:103], v[64:67], a[32:35]
    v_mfma_f32_16x16x32_bf16 a[36:39], v[100:103], v[68:71], a[36:39]
    ds_read_b128 v[132:135], v5 offset:2048
    v_mfma_f32_16x16x32_bf16 a[4:7], v[96:99], v[68:71], a[4:7]
    buffer_load_dwordx4 v14, s[32:35], s52 offen lds
    v_mfma_f32_16x16x32_bf16 a[8:11], v[96:99], v[72:75], a[8:11]
    ds_read_b128 v[136:139], v5 offset:4096
    s_add_u32 m0, m0, 2048
    v_mfma_f32_16x16x32_bf16 a[40:43], v[100:103], v[72:75], a[40:43]
    s_add_u32 s52, s52, s54
    v_mfma_f32_16x16x32_bf16 a[44:47], v[100:103], v[76:79], a[44:47]
    ds_read_b128 v[140:143], v5 offset:6144
    v_mfma_f32_16x16x32_bf16 a[12:15], v[96:99], v[76:79], a[12:15]
    v_mfma_f32_16x16x32_bf16 a[16:19], v[96:99], v[80:83], a[16:19]
    ds_read_b128 v[144:147], v5 offset:8192
    v_mfma_f32_16x16x32_bf16 a[48:51], v[100:103], v[80:83], a[48:51]
    v_mfma_f32_16x16x32_bf16 a[52:55], v[100:103], v[84:87], a[52:55]
    ds_read_b128 v[148:151], v5 offset:10240
    v_mfma_f32_16x16x32_bf16 a[20:23], v[96:99], v[84:87], a[20:23]
    buffer_load_dwordx4 v14, s[32:35], s52 offen lds
    v_mfma_f32_16x16x32_bf16 a[24:27], v[96:99], v[88:91], a[24:27]
    ds_read_b128 v[152:155], v5 offset:12288
    s_add_u32 m0, m0, 2048
    v_mfma_f32_16x16x32_bf16 a[56:59], v[100:103], v[88:91], a[56:59]
    s_add_u32 s52, s52, s55
    v_mfma_f32_16x16x32_bf16 a[60:63], v[100:103], v[92:95], a[60:63]
    ds_read_b128 v[156:159], v5 offset:14336
    v_mfma_f32_16x16x32_bf16 a[28:31], v[96:99], v[92:95], a[28:31]
    v_mfma_f32_16x16x32_bf16 a[92:95], v[104:107], v[92:95], a[92:95]
    ds_read_b64_tr_b16 v[160:161], v6 offset:16384
    v_mfma_f32_16x16x32_bf16 a[124:127], v[108:111], v[92:95], a[124:127]
    v_mfma_f32_16x16x32_bf16 a[120:123], v[108:111], v[88:91], a[120:123]
    ds_read_b64_tr_b16 v[162:163], v6 offset:18432
    v_mfma_f32_16x16x32_bf16 a[88:91], v[104:107], v[88:91], a[88:91]
    buffer_load_dwordx4 v14, s[32:35], s52 offen lds
    v_mfma_f32_16x16x32_bf16 a[84:87], v[104:107], v[84:87], a[84:87]
    ds_read_b64_tr_b16 v[164:165], v7 offset:16384
    s_add_u32 m0, m0, 2048
    v_mfma_f32_16x16x32_bf16 a[116:119], v[108:111], v[84:87], a[116:119]
    s_add_u32 s52, s52, s54
    v_mfma_f32_16x16x32_bf16 a[112:115], v[108:111], v[80:83], a[112:115]
    ds_read_b64_tr_b16 v[166:167], v7 offset:18432
    v_mfma_f32_16x16x32_bf16 a[80:83], v[104:107], v[80:83], a[80:83]
    v_mfma_f32_16x16x32_bf16 a[76:79], v[104:107], v[76:79], a[76:79]
    ds_read_b64_tr_b16 v[168:169], v8 offset:16384
    v_mfma_f32_16x16x32_bf16 a[108:111], v[108:111], v[76:79], a[108:111]
    v_mfma_f32_16x16x32_bf16 a[104:107], v[108:111], v[72:75], a[104:107]
    ds_read_b64_tr_b16 v[170:171], v8 offset:18432
    v_mfma_f32_16x16x32_bf16 a[72:75], v[104:107], v[72:75], a[72:75]
    buffer_load_dwordx4 v14, s[32:35], s52 offen lds
    v_mfma_f32_16x16x32_bf16 a[68:71], v[104:107], v[68:71], a[68:71]
    ds_read_b64_tr_b16 v[172:173], v9 offset:16384
    s_add_u32 m0, m0, 2048
    v_mfma_f32_16x16x32_bf16 a[100:103], v[108:111], v[68:71], a[100:103]
    s_add_u32 s52, s52, s55
    v_mfma_f32_16x16x32_bf16 a[96:99], v[108:111], v[64:67], a[96:99]
    ds_read_b64_tr_b16 v[174:175], v9 offset:18432
    v_mfma_f32_16x16x32_bf16 a[64:67], v[104:107], v[64:67], a[64:67]
    v_mfma_f32_16x16x32_bf16 a[128:131], v[112:115], v[64:67], a[128:131]
    ds_read_b64_tr_b16 v[176:177], v10 offset:16384
    v_mfma_f32_16x16x32_bf16 a[160:163], v[116:119], v[64:67], a[160:163]
    v_mfma_f32_16x16x32_bf16 a[164:167], v[116:119], v[68:71], a[164:167]
    ds_read_b64_tr_b16 v[178:179], v10 offset:18432
    v_mfma_f32_16x16x32_bf16 a[132:135], v[112:115], v[68:71], a[132:135]
    buffer_load_dwordx4 v14, s[32:35], s52 offen lds
    v_mfma_f32_16x16x32_bf16 a[136:139], v[112:115], v[72:75], a[136:139]
    ds_read_b64_tr_b16 v[180:181], v11 offset:16384
    s_add_u32 m0, m0, 2048
    v_mfma_f32_16x16x32_bf16 a[168:171], v[116:119], v[72:75], a[168:171]
    s_add_u32 s52, s52, s54
    v_mfma_f32_16x16x32_bf16 a[172:175], v[116:119], v[76:79], a[172:175]
    ds_read_b64_tr_b16 v[182:183], v11 offset:18432
    v_mfma_f32_16x16x32_bf16 a[140:143], v[112:115], v[76:79], a[140:143]
    v_mfma_f32_16x16x32_bf16 a[144:147], v[112:115], v[80:83], a[144:147]
    ds_read_b64_tr_b16 v[184:185], v12 offset:16384
    v_mfma_f32_16x16x32_bf16 a[176:179], v[116:119], v[80:83], a[176:179]
    v_mfma_f32_16x16x32_bf16 a[180:183], v[116:119], v[84:87], a[180:183]
    ds_read_b64_tr_b16 v[186:187], v12 offset:18432
    v_mfma_f32_16x16x32_bf16 a[148:151], v[112:115], v[84:87], a[148:151]
    buffer_load_dwordx4 v14, s[32:35], s52 offen lds
    v_mfma_f32_16x16x32_bf16 a[152:155], v[112:115], v[88:91], a[152:155]
    ds_read_b64_tr_b16 v[188:189], v13 offset:16384
    s_add_u32 m0, m0, 2048
    v_mfma_f32_16x16x32_bf16 a[184:187], v[116:119], v[88:91], a[184:187]
    s_add_u32 s52, s52, s55
    v_mfma_f32_16x16x32_bf16 a[188:191], v[116:119], v[92:95], a[188:191]
    ds_read_b64_tr_b16 v[190:191], v13 offset:18432
    v_mfma_f32_16x16x32_bf16 a[156:159], v[112:115], v[92:95], a[156:159]
    v_add_u32 v4, s59, v2
    v_add_u32 v5, s59, v3
    v_mfma_f32_16x16x32_bf16 a[220:223], v[120:123], v[92:95], a[220:223]
    v_xor_b32 v6, 0x8000, v6
    v_xor_b32 v7, 0x8000, v7
    v_mfma_f32_16x16x32_bf16 a[252:255], v[124:127], v[92:95], a[252:255]
    buffer_load_dwordx4 v14, s[32:35], s52 offen lds
    v_mfma_f32_16x16x32_bf16 a[248:251], v[124:127], v[88:91], a[248:251]
    s_add_u32 m0, m0, 2048
    s_add_u32 s52, s52, s54
    v_xor_b32 v8, 0x8000, v8
    v_mfma_f32_16x16x32_bf16 a[216:219], v[120:123], v[88:91], a[216:219]
    v_xor_b32 v9, 0x8000, v9
    v_xor_b32 v10, 0x8000, v10
    v_mfma_f32_16x16x32_bf16 a[212:215], v[120:123], v[84:87], a[212:215]
    v_xor_b32 v11, 0x8000, v11
    v_xor_b32 v12, 0x8000, v12
    v_mfma_f32_16x16x32_bf16 a[244:247], v[124:127], v[84:87], a[244:247]
    v_xor_b32 v13, 0x8000, v13
    v_mfma_f32_16x16x32_bf16 a[240:243], v[124:127], v[80:83], a[240:243]
    v_mfma_f32_16x16x32_bf16 a[208:211], v[120:123], v[80:83], a[208:211]
    buffer_load_dwordx4 v14, s[32:35], s52 offen lds
    v_mfma_f32_16x16x32_bf16 a[204:207], v[120:123], v[76:79], a[204:207]
    s_add_u32 s52, s52, s56
    s_add_u32 s60, s60, 32768
    s_cmp_ge_u32 s60, 163840
    v_mfma_f32_16x16x32_bf16 a[236:239], v[124:127], v[76:79], a[236:239]
    s_cselect_b32 s60, s62, s60
    v_mfma_f32_16x16x32_bf16 a[232:235], v[124:127], v[72:75], a[232:235]
    v_mfma_f32_16x16x32_bf16 a[200:203], v[120:123], v[72:75], a[200:203]
    buffer_load_dword v41, v40, s[40:43], s87 offen
    v_mfma_f32_16x16x32_bf16 a[196:199], v[120:123], v[68:71], a[196:199]
    v_mfma_f32_16x16x32_bf16 a[228:231], v[124:127], v[68:71], a[228:231]
    buffer_atomic_add v42, v43, s[44:47], 0 offen
    v_mfma_f32_16x16x32_bf16 a[224:227], v[124:127], v[64:67], a[224:227]
    v_mfma_f32_16x16x32_bf16 a[192:195], v[120:123], v[64:67], a[192:195]
    s_waitcnt vmcnt(10) lgkmcnt(0)
    s_barrier
    v_mfma_f32_16x16x32_bf16 a[0:3], v[160:163], v[128:131], a[0:3]
    ds_read_b128 v[64:67], v4 offset:0
    s_add_u32 s59, s59, 32768
    v_mfma_f32_16x16x32_bf16 a[32:35], v[164:167], v[128:131], a[32:35]
    s_cmp_ge_u32 s59, 163840
    s_cselect_b32 s59, 65536, s59
    s_mov_b32 m0, s61
    v_mfma_f32_16x16x32_bf16 a[36:39], v[164:167], v[132:135], a[36:39]
    ds_read_b128 v[68:71], v4 offset:2048
    v_mfma_f32_16x16x32_bf16 a[4:7], v[160:163], v[132:135], a[4:7]
    buffer_load_dwordx4 v15, s[36:39], s53 offen lds
    v_mfma_f32_16x16x32_bf16 a[8:11], v[160:163], v[136:139], a[8:11]
    ds_read_b128 v[72:75], v4 offset:4096
    s_add_u32 s64, s64, 1
    v_mfma_f32_16x16x32_bf16 a[40:43], v[164:167], v[136:139], a[40:43]
    s_mov_b32 s42, 0
    s_add_u32 m0, m0, 2048
    s_add_u32 s53, s53, 32768
    v_mfma_f32_16x16x32_bf16 a[44:47], v[164:167], v[140:143], a[44:47]
    ds_read_b128 v[76:79], v4 offset:6144
    v_mfma_f32_16x16x32_bf16 a[12:15], v[160:163], v[140:143], a[12:15]
    v_mfma_f32_16x16x32_bf16 a[16:19], v[160:163], v[144:147], a[16:19]
    ds_read_b128 v[80:83], v4 offset:8192
    v_mfma_f32_16x16x32_bf16 a[48:51], v[164:167], v[144:147], a[48:51]
    v_mfma_f32_16x16x32_bf16 a[52:55], v[164:167], v[148:151], a[52:55]
    ds_read_b128 v[84:87], v4 offset:10240
    v_mfma_f32_16x16x32_bf16 a[20:23], v[160:163], v[148:151], a[20:23]
    buffer_load_dwordx4 v15, s[36:39], s53 offen lds
    v_mfma_f32_16x16x32_bf16 a[24:27], v[160:163], v[152:155], a[24:27]
    ds_read_b128 v[88:91], v4 offset:12288
    s_cmp_eq_u32 s64, s18
    v_mfma_f32_16x16x32_bf16 a[56:59], v[164:167], v[152:155], a[56:59]
    s_cselect_b64 s[40:41], s[12:13], s[40:41]
    s_cselect_b32 s42, s16, s42
    s_cselect_b32 s87, s17, s87
    v_mfma_f32_16x16x32_bf16 a[60:63], v[164:167], v[156:159], a[60:63]
    ds_read_b128 v[92:95], v4 offset:14336
    s_add_u32 m0, m0, 6144
    v_mfma_f32_16x16x32_bf16 a[28:31], v[160:163], v[156:159], a[28:31]
    s_add_u32 s53, s53, 98304
    v_mfma_f32_16x16x32_bf16 a[92:95], v[168:171], v[156:159], a[92:95]
    ds_read_b64_tr_b16 v[96:97], v6 offset:0
    v_mfma_f32_16x16x32_bf16 a[124:127], v[172:175], v[156:159], a[124:127]
    v_mfma_f32_16x16x32_bf16 a[120:123], v[172:175], v[152:155], a[120:123]
    ds_read_b64_tr_b16 v[98:99], v6 offset:2048
    v_mfma_f32_16x16x32_bf16 a[88:91], v[168:171], v[152:155], a[88:91]
    buffer_load_dwordx4 v15, s[36:39], s53 offen lds
    v_mfma_f32_16x16x32_bf16 a[84:87], v[168:171], v[148:151], a[84:87]
    ds_read_b64_tr_b16 v[100:101], v7 offset:0
    s_cmp_eq_u32 s64, 13
    v_mfma_f32_16x16x32_bf16 a[116:119], v[172:175], v[148:151], a[116:119]
    s_cselect_b64 s[40:41], s[84:85], s[40:41]
    s_cselect_b32 s42, LM_END-LM_PC, s42
    s_cselect_b32 s87, s86, s87
    v_mfma_f32_16x16x32_bf16 a[112:115], v[172:175], v[144:147], a[112:115]
    ds_read_b64_tr_b16 v[102:103], v7 offset:2048
    s_add_u32 m0, m0, 2048
    v_mfma_f32_16x16x32_bf16 a[80:83], v[168:171], v[144:147], a[80:83]
    s_add_u32 s53, s53, 32768
    v_mfma_f32_16x16x32_bf16 a[76:79], v[168:171], v[140:143], a[76:79]
    ds_read_b64_tr_b16 v[104:105], v8 offset:0
    v_mfma_f32_16x16x32_bf16 a[108:111], v[172:175], v[140:143], a[108:111]
    v_mfma_f32_16x16x32_bf16 a[104:107], v[172:175], v[136:139], a[104:107]
    ds_read_b64_tr_b16 v[106:107], v8 offset:2048
    v_mfma_f32_16x16x32_bf16 a[72:75], v[168:171], v[136:139], a[72:75]
    buffer_load_dwordx4 v15, s[36:39], s53 offen lds
    v_mfma_f32_16x16x32_bf16 a[68:71], v[168:171], v[132:135], a[68:71]
    ds_read_b64_tr_b16 v[108:109], v9 offset:0
    s_cmp_eq_u32 s64, s83
    v_mfma_f32_16x16x32_bf16 a[100:103], v[172:175], v[132:135], a[100:103]
    s_cselect_b32 s46, 256, 0
    s_add_u32 m0, m0, 6144
    s_add_u32 s53, s53, 98304
    v_mfma_f32_16x16x32_bf16 a[96:99], v[172:175], v[128:131], a[96:99]
    ds_read_b64_tr_b16 v[110:111], v9 offset:2048
    v_mfma_f32_16x16x32_bf16 a[64:67], v[168:171], v[128:131], a[64:67]
    v_mfma_f32_16x16x32_bf16 a[128:131], v[176:179], v[128:131], a[128:131]
    ds_read_b64_tr_b16 v[112:113], v10 offset:0
    v_mfma_f32_16x16x32_bf16 a[160:163], v[180:183], v[128:131], a[160:163]
    v_mfma_f32_16x16x32_bf16 a[164:167], v[180:183], v[132:135], a[164:167]
    ds_read_b64_tr_b16 v[114:115], v10 offset:2048
    v_mfma_f32_16x16x32_bf16 a[132:135], v[176:179], v[132:135], a[132:135]
    buffer_load_dwordx4 v15, s[36:39], s53 offen lds
    v_mfma_f32_16x16x32_bf16 a[136:139], v[176:179], v[136:139], a[136:139]
    ds_read_b64_tr_b16 v[116:117], v11 offset:0
    s_add_u32 m0, m0, 2048
    v_mfma_f32_16x16x32_bf16 a[168:171], v[180:183], v[136:139], a[168:171]
    s_add_u32 s53, s53, 32768
    v_mfma_f32_16x16x32_bf16 a[172:175], v[180:183], v[140:143], a[172:175]
    ds_read_b64_tr_b16 v[118:119], v11 offset:2048
    v_mfma_f32_16x16x32_bf16 a[140:143], v[176:179], v[140:143], a[140:143]
    v_mfma_f32_16x16x32_bf16 a[144:147], v[176:179], v[144:147], a[144:147]
    ds_read_b64_tr_b16 v[120:121], v12 offset:0
    v_mfma_f32_16x16x32_bf16 a[176:179], v[180:183], v[144:147], a[176:179]
    v_mfma_f32_16x16x32_bf16 a[180:183], v[180:183], v[148:151], a[180:183]
    ds_read_b64_tr_b16 v[122:123], v12 offset:2048
    v_mfma_f32_16x16x32_bf16 a[148:151], v[176:179], v[148:151], a[148:151]
    buffer_load_dwordx4 v15, s[36:39], s53 offen lds
    v_mfma_f32_16x16x32_bf16 a[152:155], v[176:179], v[152:155], a[152:155]
    ds_read_b64_tr_b16 v[124:125], v13 offset:0
    s_add_u32 m0, m0, 6144
    v_mfma_f32_16x16x32_bf16 a[184:187], v[180:183], v[152:155], a[184:187]
    s_add_u32 s53, s53, 98304
    v_mfma_f32_16x16x32_bf16 a[188:191], v[180:183], v[156:159], a[188:191]
    ds_read_b64_tr_b16 v[126:127], v13 offset:2048
    v_mfma_f32_16x16x32_bf16 a[156:159], v[176:179], v[156:159], a[156:159]
    v_mfma_f32_16x16x32_bf16 a[220:223], v[184:187], v[156:159], a[220:223]
    v_mfma_f32_16x16x32_bf16 a[252:255], v[188:191], v[156:159], a[252:255]
    buffer_load_dwordx4 v15, s[36:39], s53 offen lds
    v_mfma_f32_16x16x32_bf16 a[248:251], v[188:191], v[152:155], a[248:251]
    s_add_u32 m0, m0, 2048
    s_add_u32 s53, s53, 32768
    v_mfma_f32_16x16x32_bf16 a[216:219], v[184:187], v[152:155], a[216:219]
    v_mfma_f32_16x16x32_bf16 a[212:215], v[184:187], v[148:151], a[212:215]
    v_mfma_f32_16x16x32_bf16 a[244:247], v[188:191], v[148:151], a[244:247]
    v_mfma_f32_16x16x32_bf16 a[240:243], v[188:191], v[144:147], a[240:243]
    v_mfma_f32_16x16x32_bf16 a[208:211], v[184:187], v[144:147], a[208:211]
    buffer_load_dwordx4 v15, s[36:39], s53 offen lds
    v_mfma_f32_16x16x32_bf16 a[204:207], v[184:187], v[140:143], a[204:207]
    s_add_u32 s53, s53, 98304
    s_xor_b32 s61, s61, 32768
    s_sub_u32 s63, s63, 1
    v_mfma_f32_16x16x32_bf16 a[236:239], v[188:191], v[140:143], a[236:239]
    s_cmp_lg_u32 s63, 0
    v_mfma_f32_16x16x32_bf16 a[232:235], v[188:191], v[136:139], a[232:235]
    v_mfma_f32_16x16x32_bf16 a[200:203], v[184:187], v[136:139], a[200:203]
    v_mfma_f32_16x16x32_bf16 a[196:199], v[184:187], v[132:135], a[196:199]
    v_mfma_f32_16x16x32_bf16 a[228:231], v[188:191], v[132:135], a[228:231]
    v_mfma_f32_16x16x32_bf16 a[224:227], v[188:191], v[128:131], a[224:227]
    v_mfma_f32_16x16x32_bf16 a[192:195], v[184:187], v[128:131], a[192:195]
    s_waitcnt lgkmcnt(0)
    s_cbranch_scc1 LG_LOOP_KQ
    s_cmp_eq_u32 s64, 16
    s_cbranch_scc1 LG_EPI_KQ
    s_mov_b32 s63, 2
    s_cmp_eq_u32 s48, 0
    s_cselect_b32 s46, 256, 0
    buffer_load_dword v46, v47, s[44:47], 0 offen sc1
    s_mov_b32 s46, 0
    s_mov_b32 s32, s73
    s_mov_b32 s33, s74
    s_mov_b32 s34, s75
    s_mov_b32 s52, s68
    s_mov_b32 s54, s70
    s_mov_b32 s55, s71
    s_mov_b32 s56, s72
    v_mov_b32 v14, v16
    s_mov_b32 s36, s14
    s_mov_b32 s37, s15
    s_mov_b32 s38, 3670016
    s_mov_b32 s53, s69
    s_branch LG_LOOP_KQ
LG_EPI_KQ:
    s_mov_b32 s40, s28
    s_mov_b32 s41, s29
    s_mov_b32 s42, 268435456
    s_mov_b32 s43, 0x20000
    s_mov_b32 s46, 256
    v_cmp_le_u32 vcc, 16, v46
    s_cmp_lg_u32 s48, 0
    s_cbranch_scc1 LM_4
    s_mov_b32 s81, 65536
LM_5:
    s_nop 3
    s_cmp_eq_u64 vcc, -1
    s_cbranch_scc1 LM_4
    s_sub_u32 s81, s81, 1
    s_cmp_eq_u32 s81, 0
    s_cbranch_scc1 LM_4
    s_sleep 32
    buffer_load_dword v46, v47, s[44:47], 0 offen sc1
    s_waitcnt vmcnt(0)
    v_cmp_le_u32 vcc, 16, v46
    s_branch LM_5
LM_4:
    s_mov_b32 s68, s65
    v_add_u32 v4, 98304, v22
    v_add_u32 v5, 98304, v23
    v_add_u32 v27, 98304, v24
    v_add_u32 v28, 98304, v25
    v_add_u32 v29, 98304, v26
    ds_read_b128 v[64:67], v4 offset:0
    ds_read_b128 v[68:71], v4 offset:2048
    ds_read_b128 v[72:75], v4 offset:4096
    ds_read_b128 v[76:79], v4 offset:6144
    ds_read_b64_tr_b16 v[80:81], v6 offset:0
    ds_read_b64_tr_b16 v[82:83], v6 offset:2048
    ds_read_b64_tr_b16 v[84:85], v7 offset:0
    ds_read_b64_tr_b16 v[86:87], v7 offset:2048
    ds_read_b64_tr_b16 v[88:89], v8 offset:0
    ds_read_b64_tr_b16 v[90:91], v8 offset:2048
    ds_read_b64_tr_b16 v[92:93], v9 offset:0
    ds_read_b64_tr_b16 v[94:95], v9 offset:2048
    ds_read_b64_tr_b16 v[96:97], v10 offset:0
    ds_read_b64_tr_b16 v[98:99], v10 offset:2048
    ds_read_b64_tr_b16 v[100:101], v11 offset:0
    ds_read_b64_tr_b16 v[102:103], v11 offset:2048
    ds_read_b64_tr_b16 v[104:105], v12 offset:0
    ds_read_b64_tr_b16 v[106:107], v12 offset:2048
    ds_read_b64_tr_b16 v[108:109], v13 offset:0
    ds_read_b64_tr_b16 v[110:111], v13 offset:2048
    ds_read_b64_tr_b16 v[112:113], v27 offset:0
    ds_read_b64_tr_b16 v[114:115], v27 offset:2048
    ds_read_b64_tr_b16 v[116:117], v28 offset:0
    ds_read_b64_tr_b16 v[118:119], v28 offset:2048
    ds_read_b64_tr_b16 v[120:121], v29 offset:0
    ds_read_b64_tr_b16 v[122:123], v29 offset:2048
    v_accvgpr_read_b32 v48, a0
    v_accvgpr_read_b32 v49, a1
    v_accvgpr_read_b32 v50, a2
    v_accvgpr_read_b32 v51, a3
    v_accvgpr_read_b32 v52, a32
    v_accvgpr_read_b32 v53, a33
    v_accvgpr_read_b32 v54, a34
    v_accvgpr_read_b32 v55, a35
    v_cvt_pk_bf16_f32 v128, v48, v49
    v_cvt_pk_bf16_f32 v129, v50, v51
    v_cvt_pk_bf16_f32 v130, v52, v53
    v_cvt_pk_bf16_f32 v131, v54, v55
    v_accvgpr_read_b32 v56, a64
    v_accvgpr_read_b32 v57, a65
    v_accvgpr_read_b32 v58, a66
    v_accvgpr_read_b32 v59, a67
    v_accvgpr_read_b32 v60, a96
    v_accvgpr_read_b32 v61, a97
    v_accvgpr_read_b32 v62, a98
    v_accvgpr_read_b32 v63, a99
    v_cvt_pk_bf16_f32 v132, v56, v57
    v_cvt_pk_bf16_f32 v133, v58, v59
    v_cvt_pk_bf16_f32 v134, v60, v61
    v_cvt_pk_bf16_f32 v135, v62, v63
    buffer_store_dwordx4 v[128:131], v1, s[8:11], s65 offen offset:0 sc1
    v_accvgpr_read_b32 v48, a128
    v_accvgpr_read_b32 v49, a129
    v_accvgpr_read_b32 v50, a130
    v_accvgpr_read_b32 v51, a131
    v_accvgpr_read_b32 v52, a160
    v_accvgpr_read_b32 v53, a161
    v_accvgpr_read_b32 v54, a162
    v_accvgpr_read_b32 v55, a163
    v_cvt_pk_bf16_f32 v136, v48, v49
    v_cvt_pk_bf16_f32 v137, v50, v51
    v_cvt_pk_bf16_f32 v138, v52, v53
    v_cvt_pk_bf16_f32 v139, v54, v55
    v_accvgpr_read_b32 v56, a192
    v_accvgpr_read_b32 v57, a193
    v_accvgpr_read_b32 v58, a194
    v_accvgpr_read_b32 v59, a195
    v_accvgpr_read_b32 v60, a224
    v_accvgpr_read_b32 v61, a225
    v_accvgpr_read_b32 v62, a226
    v_accvgpr_read_b32 v63, a227
    v_cvt_pk_bf16_f32 v140, v56, v57
    v_cvt_pk_bf16_f32 v141, v58, v59
    v_cvt_pk_bf16_f32 v142, v60, v61
    v_cvt_pk_bf16_f32 v143, v62, v63
    buffer_store_dwordx4 v[132:135], v1, s[8:11], s65 offen offset:1024 sc1
    v_accvgpr_read_b32 v48, a4
    v_accvgpr_read_b32 v49, a5
    v_accvgpr_read_b32 v50, a6
    v_accvgpr_read_b32 v51, a7
    v_accvgpr_read_b32 v52, a36
    v_accvgpr_read_b32 v53, a37
    v_accvgpr_read_b32 v54, a38
    v_accvgpr_read_b32 v55, a39
    v_cvt_pk_bf16_f32 v144, v48, v49
    v_cvt_pk_bf16_f32 v145, v50, v51
    v_cvt_pk_bf16_f32 v146, v52, v53
    v_cvt_pk_bf16_f32 v147, v54, v55
    v_accvgpr_read_b32 v56, a68
    v_accvgpr_read_b32 v57, a69
    v_accvgpr_read_b32 v58, a70
    v_accvgpr_read_b32 v59, a71
    v_accvgpr_read_b32 v60, a100
    v_accvgpr_read_b32 v61, a101
    v_accvgpr_read_b32 v62, a102
    v_accvgpr_read_b32 v63, a103
    v_cvt_pk_bf16_f32 v148, v56, v57
    v_cvt_pk_bf16_f32 v149, v58, v59
    v_cvt_pk_bf16_f32 v150, v60, v61
    v_cvt_pk_bf16_f32 v151, v62, v63
    buffer_store_dwordx4 v[136:139], v1, s[8:11], s65 offen offset:2048 sc1
    v_accvgpr_read_b32 v48, a132
    v_accvgpr_read_b32 v49, a133
    v_accvgpr_read_b32 v50, a134
    v_accvgpr_read_b32 v51, a135
    v_accvgpr_read_b32 v52, a164
    v_accvgpr_read_b32 v53, a165
    v_accvgpr_read_b32 v54, a166
    v_accvgpr_read_b32 v55, a167
    v_cvt_pk_bf16_f32 v152, v48, v49
    v_cvt_pk_bf16_f32 v153, v50, v51
    v_cvt_pk_bf16_f32 v154, v52, v53
    v_cvt_pk_bf16_f32 v155, v54, v55
    v_accvgpr_read_b32 v56, a196
    v_accvgpr_read_b32 v57, a197
    v_accvgpr_read_b32 v58, a198
    v_accvgpr_read_b32 v59, a199
    v_accvgpr_read_b32 v60, a228
    v_accvgpr_read_b32 v61, a229
    v_accvgpr_read_b32 v62, a230
    v_accvgpr_read_b32 v63, a231
    v_cvt_pk_bf16_f32 v156, v56, v57
    v_cvt_pk_bf16_f32 v157, v58, v59
    v_cvt_pk_bf16_f32 v158, v60, v61
    v_cvt_pk_bf16_f32 v159, v62, v63
    buffer_store_dwordx4 v[140:143], v1, s[8:11], s65 offen offset:3072 sc1
    v_accvgpr_read_b32 v48, a8
    v_accvgpr_read_b32 v49, a9
    v_accvgpr_read_b32 v50, a10
    v_accvgpr_read_b32 v51, a11
    v_accvgpr_read_b32 v52, a40
    v_accvgpr_read_b32 v53, a41
    v_accvgpr_read_b32 v54, a42
    v_accvgpr_read_b32 v55, a43
    v_cvt_pk_bf16_f32 v160, v48, v49
    v_cvt_pk_bf16_f32 v161, v50, v51
    v_cvt_pk_bf16_f32 v162, v52, v53
    v_cvt_pk_bf16_f32 v163, v54, v55
    v_accvgpr_read_b32 v56, a72
    v_accvgpr_read_b32 v57, a73
    v_accvgpr_read_b32 v58, a74
    v_accvgpr_read_b32 v59, a75
    v_accvgpr_read_b32 v60, a104
    v_accvgpr_read_b32 v61, a105
    v_accvgpr_read_b32 v62, a106
    v_accvgpr_read_b32 v63, a107
    v_cvt_pk_bf16_f32 v164, v56, v57
    v_cvt_pk_bf16_f32 v165, v58, v59
    v_cvt_pk_bf16_f32 v166, v60, v61
    v_cvt_pk_bf16_f32 v167, v62, v63
    s_add_u32 s65, s65, s66
    buffer_store_dwordx4 v[144:147], v1, s[8:11], s65 offen offset:0 sc1
    v_accvgpr_read_b32 v48, a136
    v_accvgpr_read_b32 v49, a137
    v_accvgpr_read_b32 v50, a138
    v_accvgpr_read_b32 v51, a139
    v_accvgpr_read_b32 v52, a168
    v_accvgpr_read_b32 v53, a169
    v_accvgpr_read_b32 v54, a170
    v_accvgpr_read_b32 v55, a171
    v_cvt_pk_bf16_f32 v168, v48, v49
    v_cvt_pk_bf16_f32 v169, v50, v51
    v_cvt_pk_bf16_f32 v170, v52, v53
    v_cvt_pk_bf16_f32 v171, v54, v55
    v_accvgpr_read_b32 v56, a200
    v_accvgpr_read_b32 v57, a201
    v_accvgpr_read_b32 v58, a202
    v_accvgpr_read_b32 v59, a203
    v_accvgpr_read_b32 v60, a232
    v_accvgpr_read_b32 v61, a233
    v_accvgpr_read_b32 v62, a234
    v_accvgpr_read_b32 v63, a235
    v_cvt_pk_bf16_f32 v172, v56, v57
    v_cvt_pk_bf16_f32 v173, v58, v59
    v_cvt_pk_bf16_f32 v174, v60, v61
    v_cvt_pk_bf16_f32 v175, v62, v63
    buffer_store_dwordx4 v[148:151], v1, s[8:11], s65 offen offset:1024 sc1
    v_accvgpr_read_b32 v48, a12
    v_accvgpr_read_b32 v49, a13
    v_accvgpr_read_b32 v50, a14
    v_accvgpr_read_b32 v51, a15
    v_accvgpr_read_b32 v52, a44
    v_accvgpr_read_b32 v53, a45
    v_accvgpr_read_b32 v54, a46
    v_accvgpr_read_b32 v55, a47
    v_cvt_pk_bf16_f32 v176, v48, v49
    v_cvt_pk_bf16_f32 v177, v50, v51
    v_cvt_pk_bf16_f32 v178, v52, v53
    v_cvt_pk_bf16_f32 v179, v54, v55
    v_accvgpr_read_b32 v56, a76
    v_accvgpr_read_b32 v57, a77
    v_accvgpr_read_b32 v58, a78
    v_accvgpr_read_b32 v59, a79
    v_accvgpr_read_b32 v60, a108
    v_accvgpr_read_b32 v61, a109
    v_accvgpr_read_b32 v62, a110
    v_accvgpr_read_b32 v63, a111
    v_cvt_pk_bf16_f32 v180, v56, v57
    v_cvt_pk_bf16_f32 v181, v58, v59
    v_cvt_pk_bf16_f32 v182, v60, v61
    v_cvt_pk_bf16_f32 v183, v62, v63
    buffer_store_dwordx4 v[152:155], v1, s[8:11], s65 offen offset:2048 sc1
    v_accvgpr_read_b32 v48, a140
    v_accvgpr_read_b32 v49, a141
    v_accvgpr_read_b32 v50, a142
    v_accvgpr_read_b32 v51, a143
    v_accvgpr_read_b32 v52, a172
    v_accvgpr_read_b32 v53, a173
    v_accvgpr_read_b32 v54, a174
    v_accvgpr_read_b32 v55, a175
    v_cvt_pk_bf16_f32 v184, v48, v49
    v_cvt_pk_bf16_f32 v185, v50, v51
    v_cvt_pk_bf16_f32 v186, v52, v53
    v_cvt_pk_bf16_f32 v187, v54, v55
    v_accvgpr_read_b32 v56, a204
    v_accvgpr_read_b32 v57, a205
    v_accvgpr_read_b32 v58, a206
    v_accvgpr_read_b32 v59, a207
    v_accvgpr_read_b32 v60, a236
    v_accvgpr_read_b32 v61, a237
    v_accvgpr_read_b32 v62, a238
    v_accvgpr_read_b32 v63, a239
    v_cvt_pk_bf16_f32 v188, v56, v57
    v_cvt_pk_bf16_f32 v189, v58, v59
    v_cvt_pk_bf16_f32 v190, v60, v61
    v_cvt_pk_bf16_f32 v191, v62, v63
    buffer_store_dwordx4 v[156:159], v1, s[8:11], s65 offen offset:3072 sc1
    v_accvgpr_read_b32 v48, a16
    v_accvgpr_read_b32 v49, a17
    v_accvgpr_read_b32 v50, a18
    v_accvgpr_read_b32 v51, a19
    v_accvgpr_read_b32 v52, a48
    v_accvgpr_read_b32 v53, a49
    v_accvgpr_read_b32 v54, a50
    v_accvgpr_read_b32 v55, a51
    v_cvt_pk_bf16_f32 v192, v48, v49
    v_cvt_pk_bf16_f32 v193, v50, v51
    v_cvt_pk_bf16_f32 v194, v52, v53
    v_cvt_pk_bf16_f32 v195, v54, v55
    v_accvgpr_read_b32 v56, a80
    v_accvgpr_read_b32 v57, a81
    v_accvgpr_read_b32 v58, a82
    v_accvgpr_read_b32 v59, a83
    v_accvgpr_read_b32 v60, a112
    v_accvgpr_read_b32 v61, a113
    v_accvgpr_read_b32 v62, a114
    v_accvgpr_read_b32 v63, a115
    v_cvt_pk_bf16_f32 v196, v56, v57
    v_cvt_pk_bf16_f32 v197, v58, v59
    v_cvt_pk_bf16_f32 v198, v60, v61
    v_cvt_pk_bf16_f32 v199, v62, v63
    s_add_u32 s65, s65, s67
    buffer_store_dwordx4 v[160:163], v1, s[8:11], s65 offen offset:0 sc1
    v_accvgpr_read_b32 v48, a144
    v_accvgpr_read_b32 v49, a145
    v_accvgpr_read_b32 v50, a146
    v_accvgpr_read_b32 v51, a147
    v_accvgpr_read_b32 v52, a176
    v_accvgpr_read_b32 v53, a177
    v_accvgpr_read_b32 v54, a178
    v_accvgpr_read_b32 v55, a179
    v_cvt_pk_bf16_f32 v200, v48, v49
    v_cvt_pk_bf16_f32 v201, v50, v51
    v_cvt_pk_bf16_f32 v202, v52, v53
    v_cvt_pk_bf16_f32 v203, v54, v55
    v_accvgpr_read_b32 v56, a208
    v_accvgpr_read_b32 v57, a209
    v_accvgpr_read_b32 v58, a210
    v_accvgpr_read_b32 v59, a211
    v_accvgpr_read_b32 v60, a240
    v_accvgpr_read_b32 v61, a241
    v_accvgpr_read_b32 v62, a242
    v_accvgpr_read_b32 v63, a243
    v_cvt_pk_bf16_f32 v204, v56, v57
    v_cvt_pk_bf16_f32 v205, v58, v59
    v_cvt_pk_bf16_f32 v206, v60, v61
    v_cvt_pk_bf16_f32 v207, v62, v63
    buffer_store_dwordx4 v[164:167], v1, s[8:11], s65 offen offset:1024 sc1
    v_accvgpr_read_b32 v48, a20
    v_accvgpr_read_b32 v49, a21
    v_accvgpr_read_b32 v50, a22
    v_accvgpr_read_b32 v51, a23
    v_accvgpr_read_b32 v52, a52
    v_accvgpr_read_b32 v53, a53
    v_accvgpr_read_b32 v54, a54
    v_accvgpr_read_b32 v55, a55
    v_cvt_pk_bf16_f32 v208, v48, v49
    v_cvt_pk_bf16_f32 v209, v50, v51
    v_cvt_pk_bf16_f32 v210, v52, v53
    v_cvt_pk_bf16_f32 v211, v54, v55
    v_accvgpr_read_b32 v56, a84
    v_accvgpr_read_b32 v57, a85
    v_accvgpr_read_b32 v58, a86
    v_accvgpr_read_b32 v59, a87
    v_accvgpr_read_b32 v60, a116
    v_accvgpr_read_b32 v61, a117
    v_accvgpr_read_b32 v62, a118
    v_accvgpr_read_b32 v63, a119
    v_cvt_pk_bf16_f32 v212, v56, v57
    v_cvt_pk_bf16_f32 v213, v58, v59
    v_cvt_pk_bf16_f32 v214, v60, v61
    v_cvt_pk_bf16_f32 v215, v62, v63
    buffer_store_dwordx4 v[168:171], v1, s[8:11], s65 offen offset:2048 sc1
    v_accvgpr_read_b32 v48, a148
    v_accvgpr_read_b32 v49, a149
    v_accvgpr_read_b32 v50, a150
    v_accvgpr_read_b32 v51, a151
    v_accvgpr_read_b32 v52, a180
    v_accvgpr_read_b32 v53, a181
    v_accvgpr_read_b32 v54, a182
    v_accvgpr_read_b32 v55, a183
    v_cvt_pk_bf16_f32 v216, v48, v49
    v_cvt_pk_bf16_f32 v217, v50, v51
    v_cvt_pk_bf16_f32 v218, v52, v53
    v_cvt_pk_bf16_f32 v219, v54, v55
    v_accvgpr_read_b32 v56, a212
    v_accvgpr_read_b32 v57, a213
    v_accvgpr_read_b32 v58, a214
    v_accvgpr_read_b32 v59, a215
    v_accvgpr_read_b32 v60, a244
    v_accvgpr_read_b32 v61, a245
    v_accvgpr_read_b32 v62, a246
    v_accvgpr_read_b32 v63, a247
    v_cvt_pk_bf16_f32 v220, v56, v57
    v_cvt_pk_bf16_f32 v221, v58, v59
    v_cvt_pk_bf16_f32 v222, v60, v61
    v_cvt_pk_bf16_f32 v223, v62, v63
    buffer_store_dwordx4 v[172:175], v1, s[8:11], s65 offen offset:3072 sc1
    v_accvgpr_read_b32 v48, a24
    v_accvgpr_read_b32 v49, a25
    v_accvgpr_read_b32 v50, a26
    v_accvgpr_read_b32 v51, a27
    v_accvgpr_read_b32 v52, a56
    v_accvgpr_read_b32 v53, a57
    v_accvgpr_read_b32 v54, a58
    v_accvgpr_read_b32 v55, a59
    v_cvt_pk_bf16_f32 v224, v48, v49
    v_cvt_pk_bf16_f32 v225, v50, v51
    v_cvt_pk_bf16_f32 v226, v52, v53
    v_cvt_pk_bf16_f32 v227, v54, v55
    v_accvgpr_read_b32 v56, a88
    v_accvgpr_read_b32 v57, a89
    v_accvgpr_read_b32 v58, a90
    v_accvgpr_read_b32 v59, a91
    v_accvgpr_read_b32 v60, a120
    v_accvgpr_read_b32 v61, a121
    v_accvgpr_read_b32 v62, a122
    v_accvgpr_read_b32 v63, a123
    v_cvt_pk_bf16_f32 v228, v56, v57
    v_cvt_pk_bf16_f32 v229, v58, v59
    v_cvt_pk_bf16_f32 v230, v60, v61
    v_cvt_pk_bf16_f32 v231, v62, v63
    s_add_u32 s65, s65, s66
    buffer_store_dwordx4 v[176:179], v1, s[8:11], s65 offen offset:0 sc1
    v_accvgpr_read_b32 v48, a152
    v_accvgpr_read_b32 v49, a153
    v_accvgpr_read_b32 v50, a154
    v_accvgpr_read_b32 v51, a155
    v_accvgpr_read_b32 v52, a184
    v_accvgpr_read_b32 v53, a185
    v_accvgpr_read_b32 v54, a186
    v_accvgpr_read_b32 v55, a187
    v_cvt_pk_bf16_f32 v232, v48, v49
    v_cvt_pk_bf16_f32 v233, v50, v51
    v_cvt_pk_bf16_f32 v234, v52, v53
    v_cvt_pk_bf16_f32 v235, v54, v55
    v_accvgpr_read_b32 v56, a216
    v_accvgpr_read_b32 v57, a217
    v_accvgpr_read_b32 v58, a218
    v_accvgpr_read_b32 v59, a219
    v_accvgpr_read_b32 v60, a248
    v_accvgpr_read_b32 v61, a249
    v_accvgpr_read_b32 v62, a250
    v_accvgpr_read_b32 v63, a251
    v_cvt_pk_bf16_f32 v236, v56, v57
    v_cvt_pk_bf16_f32 v237, v58, v59
    v_cvt_pk_bf16_f32 v238, v60, v61
    v_cvt_pk_bf16_f32 v239, v62, v63
    buffer_store_dwordx4 v[180:183], v1, s[8:11], s65 offen offset:1024 sc1
    v_accvgpr_read_b32 v48, a28
    v_accvgpr_read_b32 v49, a29
    v_accvgpr_read_b32 v50, a30
    v_accvgpr_read_b32 v51, a31
    v_accvgpr_read_b32 v52, a60
    v_accvgpr_read_b32 v53, a61
    v_accvgpr_read_b32 v54, a62
    v_accvgpr_read_b32 v55, a63
    v_cvt_pk_bf16_f32 v240, v48, v49
    v_cvt_pk_bf16_f32 v241, v50, v51
    v_cvt_pk_bf16_f32 v242, v52, v53
    v_cvt_pk_bf16_f32 v243, v54, v55
    v_accvgpr_read_b32 v56, a92
    v_accvgpr_read_b32 v57, a93
    v_accvgpr_read_b32 v58, a94
    v_accvgpr_read_b32 v59, a95
    v_accvgpr_read_b32 v60, a124
    v_accvgpr_read_b32 v61, a125
    v_accvgpr_read_b32 v62, a126
    v_accvgpr_read_b32 v63, a127
    v_cvt_pk_bf16_f32 v244, v56, v57
    v_cvt_pk_bf16_f32 v245, v58, v59
    v_cvt_pk_bf16_f32 v246, v60, v61
    v_cvt_pk_bf16_f32 v247, v62, v63
    buffer_store_dwordx4 v[184:187], v1, s[8:11], s65 offen offset:2048 sc1
    v_accvgpr_read_b32 v48, a156
    v_accvgpr_read_b32 v49, a157
    v_accvgpr_read_b32 v50, a158
    v_accvgpr_read_b32 v51, a159
    v_accvgpr_read_b32 v52, a188
    v_accvgpr_read_b32 v53, a189
    v_accvgpr_read_b32 v54, a190
    v_accvgpr_read_b32 v55, a191
    v_cvt_pk_bf16_f32 v248, v48, v49
    v_cvt_pk_bf16_f32 v249, v50, v51
    v_cvt_pk_bf16_f32 v250, v52, v53
    v_cvt_pk_bf16_f32 v251, v54, v55
    v_accvgpr_read_b32 v56, a220
    v_accvgpr_read_b32 v57, a221
    v_accvgpr_read_b32 v58, a222
    v_accvgpr_read_b32 v59, a223
    v_accvgpr_read_b32 v60, a252
    v_accvgpr_read_b32 v61, a253
    v_accvgpr_read_b32 v62, a254
    v_accvgpr_read_b32 v63, a255
    v_cvt_pk_bf16_f32 v252, v56, v57
    v_cvt_pk_bf16_f32 v253, v58, v59
    v_cvt_pk_bf16_f32 v254, v60, v61
    v_cvt_pk_bf16_f32 v255, v62, v63
    buffer_store_dwordx4 v[188:191], v1, s[8:11], s65 offen offset:3072 sc1
    s_branch LP_START
LG_VT:
    v_mfma_f32_16x16x32_bf16 a[0:3], v[64:67], v[96:99], 0
    ds_read_b128 v[128:131], v5 offset:0
    s_mov_b32 m0, s60
    v_mfma_f32_16x16x32_bf16 a[32:35], v[64:67], v[100:103], 0
    v_mov_b32 v56, 0
    v_lshlrev_b32 v208, 16, v192
    v_mfma_f32_16x16x32_bf16 a[36:39], v[68:71], v[100:103], 0
    ds_read_b128 v[132:135], v5 offset:2048
    v_and_b32 v209, 0xffff0000, v192
    v_mfma_f32_16x16x32_bf16 a[4:7], v[68:71], v[96:99], 0
    buffer_load_dwordx4 v14, s[32:35], s52 offen lds
    v_mfma_f32_16x16x32_bf16 a[8:11], v[72:75], v[96:99], 0
    ds_read_b128 v[136:139], v5 offset:4096
    s_add_u32 m0, m0, 2048
    v_mfma_f32_16x16x32_bf16 a[40:43], v[72:75], v[100:103], 0
    s_add_u32 s52, s52, s54
    v_lshlrev_b32 v210, 16, v200
    v_and_b32 v211, 0xffff0000, v200
    v_mfma_f32_16x16x32_bf16 a[44:47], v[76:79], v[100:103], 0
    ds_read_b128 v[140:143], v5 offset:6144
    v_mul_f32 v208, v208, v210
    v_mfma_f32_16x16x32_bf16 a[12:15], v[76:79], v[96:99], 0
    v_mul_f32 v209, v209, v211
    v_lshlrev_b32 v212, 16, v193
    v_mfma_f32_16x16x32_bf16 a[16:19], v[80:83], v[96:99], 0
    ds_read_b128 v[144:147], v5 offset:8192
    v_cvt_pk_bf16_f32 v208, v208, v209
    v_mfma_f32_16x16x32_bf16 a[48:51], v[80:83], v[100:103], 0
    v_lshlrev_b32 v209, 16, v208
    v_and_b32 v210, 0xffff0000, v208
    v_mfma_f32_16x16x32_bf16 a[52:55], v[84:87], v[100:103], 0
    ds_read_b128 v[148:151], v5 offset:10240
    v_add_f32 v56, v56, v209
    v_mfma_f32_16x16x32_bf16 a[20:23], v[84:87], v[96:99], 0
    buffer_load_dwordx4 v14, s[32:35], s52 offen lds
    v_mfma_f32_16x16x32_bf16 a[24:27], v[88:91], v[96:99], 0
    ds_read_b128 v[152:155], v5 offset:12288
    s_add_u32 m0, m0, 2048
    v_mfma_f32_16x16x32_bf16 a[56:59], v[88:91], v[100:103], 0
    s_add_u32 s52, s52, s55
    v_add_f32 v56, v56, v210
    v_and_b32 v213, 0xffff0000, v193
    v_mfma_f32_16x16x32_bf16 a[60:63], v[92:95], v[100:103], 0
    ds_read_b128 v[156:159], v5 offset:14336
    v_lshlrev_b32 v214, 16, v201
    v_mfma_f32_16x16x32_bf16 a[28:31], v[92:95], v[96:99], 0
    v_and_b32 v215, 0xffff0000, v201
    v_mul_f32 v212, v212, v214
    v_mfma_f32_16x16x32_bf16 a[92:95], v[92:95], v[104:107], 0
    ds_read_b64_tr_b16 v[160:161], v6 offset:16384
    v_mul_f32 v213, v213, v215
    v_mfma_f32_16x16x32_bf16 a[124:127], v[92:95], v[108:111], 0
    v_cvt_pk_bf16_f32 v212, v212, v213
    v_lshlrev_b32 v216, 16, v194
    v_mfma_f32_16x16x32_bf16 a[120:123], v[88:91], v[108:111], 0
    ds_read_b64_tr_b16 v[162:163], v6 offset:18432
    v_lshlrev_b32 v213, 16, v212
    v_mfma_f32_16x16x32_bf16 a[88:91], v[88:91], v[104:107], 0
    buffer_load_dwordx4 v14, s[32:35], s52 offen lds
    v_mfma_f32_16x16x32_bf16 a[84:87], v[84:87], v[104:107], 0
    ds_read_b64_tr_b16 v[164:165], v7 offset:16384
    s_add_u32 m0, m0, 2048
    v_mfma_f32_16x16x32_bf16 a[116:119], v[84:87], v[108:111], 0
    s_add_u32 s52, s52, s54
    v_and_b32 v214, 0xffff0000, v212
    v_add_f32 v56, v56, v213
    v_mfma_f32_16x16x32_bf16 a[112:115], v[80:83], v[108:111], 0
    ds_read_b64_tr_b16 v[166:167], v7 offset:18432
    v_add_f32 v56, v56, v214
    v_mfma_f32_16x16x32_bf16 a[80:83], v[80:83], v[104:107], 0
    v_and_b32 v217, 0xffff0000, v194
    v_lshlrev_b32 v218, 16, v202
    v_mfma_f32_16x16x32_bf16 a[76:79], v[76:79], v[104:107], 0
    ds_read_b64_tr_b16 v[168:169], v8 offset:16384
    v_and_b32 v219, 0xffff0000, v202
    v_mfma_f32_16x16x32_bf16 a[108:111], v[76:79], v[108:111], 0
    v_mul_f32 v216, v216, v218
    v_mul_f32 v217, v217, v219
    v_mfma_f32_16x16x32_bf16 a[104:107], v[72:75], v[108:111], 0
    ds_read_b64_tr_b16 v[170:171], v8 offset:18432
    v_cvt_pk_bf16_f32 v216, v216, v217
    v_mfma_f32_16x16x32_bf16 a[72:75], v[72:75], v[104:107], 0
    buffer_load_dwordx4 v14, s[32:35], s52 offen lds
    v_mfma_f32_16x16x32_bf16 a[68:71], v[68:71], v[104:107], 0
    ds_read_b64_tr_b16 v[172:173], v9 offset:16384
    s_add_u32 m0, m0, 2048
    v_mfma_f32_16x16x32_bf16 a[100:103], v[68:71], v[108:111], 0
    s_add_u32 s52, s52, s55
    v_lshlrev_b32 v217, 16, v216
    v_and_b32 v218, 0xffff0000, v216
    v_mfma_f32_16x16x32_bf16 a[96:99], v[64:67], v[108:111], 0
    ds_read_b64_tr_b16 v[174:175], v9 offset:18432
    v_add_f32 v56, v56, v217
    v_mfma_f32_16x16x32_bf16 a[64:67], v[64:67], v[104:107], 0
    v_add_f32 v56, v56, v218
    v_lshlrev_b32 v220, 16, v195
    v_mfma_f32_16x16x32_bf16 a[128:131], v[64:67], v[112:115], 0
    ds_read_b64_tr_b16 v[176:177], v10 offset:16384
    v_and_b32 v221, 0xffff0000, v195
    v_mfma_f32_16x16x32_bf16 a[160:163], v[64:67], v[116:119], 0
    v_lshlrev_b32 v222, 16, v203
    v_and_b32 v223, 0xffff0000, v203
    v_mfma_f32_16x16x32_bf16 a[164:167], v[68:71], v[116:119], 0
    ds_read_b64_tr_b16 v[178:179], v10 offset:18432
    v_mul_f32 v220, v220, v222
    v_mfma_f32_16x16x32_bf16 a[132:135], v[68:71], v[112:115], 0
    buffer_load_dwordx4 v14, s[32:35], s52 offen lds
    v_mfma_f32_16x16x32_bf16 a[136:139], v[72:75], v[112:115], 0
    ds_read_b64_tr_b16 v[180:181], v11 offset:16384
    s_add_u32 m0, m0, 2048
    v_mfma_f32_16x16x32_bf16 a[168:171], v[72:75], v[116:119], 0
    s_add_u32 s52, s52, s54
    v_mul_f32 v221, v221, v223
    v_lshlrev_b32 v224, 16, v196
    v_mfma_f32_16x16x32_bf16 a[172:175], v[76:79], v[116:119], 0
    ds_read_b64_tr_b16 v[182:183], v11 offset:18432
    v_cvt_pk_bf16_f32 v220, v220, v221
    v_mfma_f32_16x16x32_bf16 a[140:143], v[76:79], v[112:115], 0
    v_lshlrev_b32 v221, 16, v220
    v_and_b32 v222, 0xffff0000, v220
    v_mfma_f32_16x16x32_bf16 a[144:147], v[80:83], v[112:115], 0
    ds_read_b64_tr_b16 v[184:185], v12 offset:16384
    v_add_f32 v56, v56, v221
    v_mfma_f32_16x16x32_bf16 a[176:179], v[80:83], v[116:119], 0
    v_add_f32 v56, v56, v222
    v_and_b32 v225, 0xffff0000, v196
    v_mfma_f32_16x16x32_bf16 a[180:183], v[84:87], v[116:119], 0
    ds_read_b64_tr_b16 v[186:187], v12 offset:18432
    v_lshlrev_b32 v226, 16, v204
    v_mfma_f32_16x16x32_bf16 a[148:151], v[84:87], v[112:115], 0
    buffer_load_dwordx4 v14, s[32:35], s52 offen lds
    v_mfma_f32_16x16x32_bf16 a[152:155], v[88:91], v[112:115], 0
    ds_read_b64_tr_b16 v[188:189], v13 offset:16384
    s_add_u32 m0, m0, 2048
    v_mfma_f32_16x16x32_bf16 a[184:187], v[88:91], v[116:119], 0
    s_add_u32 s52, s52, s55
    v_and_b32 v227, 0xffff0000, v204
    v_mul_f32 v224, v224, v226
    v_mfma_f32_16x16x32_bf16 a[188:191], v[92:95], v[116:119], 0
    ds_read_b64_tr_b16 v[190:191], v13 offset:18432
    v_mul_f32 v225, v225, v227
    v_mfma_f32_16x16x32_bf16 a[156:159], v[92:95], v[112:115], 0
    v_add_u32 v4, s59, v2
    v_add_u32 v5, s59, v3
    v_mfma_f32_16x16x32_bf16 a[220:223], v[92:95], v[120:123], 0
    v_xor_b32 v6, 0x8000, v6
    v_xor_b32 v7, 0x8000, v7
    v_mfma_f32_16x16x32_bf16 a[252:255], v[92:95], v[124:127], 0
    buffer_load_dwordx4 v14, s[32:35], s52 offen lds
    v_mfma_f32_16x16x32_bf16 a[248:251], v[88:91], v[124:127], 0
    s_add_u32 m0, m0, 2048
    s_add_u32 s52, s52, s54
    v_xor_b32 v8, 0x8000, v8
    v_mfma_f32_16x16x32_bf16 a[216:219], v[88:91], v[120:123], 0
    v_xor_b32 v9, 0x8000, v9
    v_xor_b32 v10, 0x8000, v10
    v_mfma_f32_16x16x32_bf16 a[212:215], v[84:87], v[120:123], 0
    v_xor_b32 v11, 0x8000, v11
    v_xor_b32 v12, 0x8000, v12
    v_mfma_f32_16x16x32_bf16 a[244:247], v[84:87], v[124:127], 0
    v_xor_b32 v13, 0x8000, v13
    v_cvt_pk_bf16_f32 v224, v224, v225
    v_mfma_f32_16x16x32_bf16 a[240:243], v[80:83], v[124:127], 0
    v_lshlrev_b32 v225, 16, v224
    v_and_b32 v226, 0xffff0000, v224
    v_mfma_f32_16x16x32_bf16 a[208:211], v[80:83], v[120:123], 0
    buffer_load_dwordx4 v14, s[32:35], s52 offen lds
    v_mfma_f32_16x16x32_bf16 a[204:207], v[76:79], v[120:123], 0
    s_add_u32 s52, s52, s56
    s_add_u32 s60, s60, 32768
    s_cmp_ge_u32 s60, 163840
    v_mfma_f32_16x16x32_bf16 a[236:239], v[76:79], v[124:127], 0
    s_cselect_b32 s60, s62, s60
    v_add_f32 v56, v56, v225
    v_lshlrev_b32 v228, 16, v197
    v_mfma_f32_16x16x32_bf16 a[232:235], v[72:75], v[124:127], 0
    v_add_f32 v56, v56, v226
    v_and_b32 v229, 0xffff0000, v197
    v_mfma_f32_16x16x32_bf16 a[200:203], v[72:75], v[120:123], 0
    buffer_load_dword v41, v40, s[40:43], s87 offen
    v_mfma_f32_16x16x32_bf16 a[196:199], v[68:71], v[120:123], 0
    v_mfma_f32_16x16x32_bf16 a[228:231], v[68:71], v[124:127], 0
    buffer_atomic_add v42, v43, s[44:47], 0 offen
    v_mfma_f32_16x16x32_bf16 a[224:227], v[64:67], v[124:127], 0
    v_mfma_f32_16x16x32_bf16 a[192:195], v[64:67], v[120:123], 0
    s_waitcnt vmcnt(10) lgkmcnt(0)
    s_barrier
    v_mfma_f32_16x16x32_bf16 a[0:3], v[128:131], v[160:163], a[0:3]
    ds_read_b128 v[64:67], v4 offset:0
    s_add_u32 s59, s59, 32768
    v_mfma_f32_16x16x32_bf16 a[32:35], v[128:131], v[164:167], a[32:35]
    s_cmp_ge_u32 s59, 163840
    s_cselect_b32 s59, 65536, s59
    s_mov_b32 m0, s61
    v_mfma_f32_16x16x32_bf16 a[36:39], v[132:135], v[164:167], a[36:39]
    ds_read_b128 v[68:71], v4 offset:2048
    v_lshlrev_b32 v230, 16, v205
    v_mfma_f32_16x16x32_bf16 a[4:7], v[132:135], v[160:163], a[4:7]
    buffer_load_dwordx4 v15, s[36:39], s53 offen lds
    v_mfma_f32_16x16x32_bf16 a[8:11], v[136:139], v[160:163], a[8:11]
    ds_read_b128 v[72:75], v4 offset:4096
    s_add_u32 s64, s64, 1
    v_mfma_f32_16x16x32_bf16 a[40:43], v[136:139], v[164:167], a[40:43]
    s_mov_b32 s42, 0
    s_add_u32 m0, m0, 2048
    s_add_u32 s53, s53, 32768
    v_mfma_f32_16x16x32_bf16 a[44:47], v[140:143], v[164:167], a[44:47]
    ds_read_b128 v[76:79], v4 offset:6144
    v_and_b32 v231, 0xffff0000, v205
    v_mfma_f32_16x16x32_bf16 a[12:15], v[140:143], v[160:163], a[12:15]
    v_mul_f32 v228, v228, v230
    v_mul_f32 v229, v229, v231
    v_mfma_f32_16x16x32_bf16 a[16:19], v[144:147], v[160:163], a[16:19]
    ds_read_b128 v[80:83], v4 offset:8192
    v_cvt_pk_bf16_f32 v228, v228, v229
    v_mfma_f32_16x16x32_bf16 a[48:51], v[144:147], v[164:167], a[48:51]
    v_lshlrev_b32 v229, 16, v228
    v_and_b32 v230, 0xffff0000, v228
    v_mfma_f32_16x16x32_bf16 a[52:55], v[148:151], v[164:167], a[52:55]
    ds_read_b128 v[84:87], v4 offset:10240
    v_add_f32 v56, v56, v229
    v_mfma_f32_16x16x32_bf16 a[20:23], v[148:151], v[160:163], a[20:23]
    buffer_load_dwordx4 v15, s[36:39], s53 offen lds
    v_mfma_f32_16x16x32_bf16 a[24:27], v[152:155], v[160:163], a[24:27]
    ds_read_b128 v[88:91], v4 offset:12288
    s_add_u32 m0, m0, 6144
    v_mfma_f32_16x16x32_bf16 a[56:59], v[152:155], v[164:167], a[56:59]
    s_add_u32 s53, s53, 98304
    v_add_f32 v56, v56, v230
    v_lshlrev_b32 v232, 16, v198
    v_mfma_f32_16x16x32_bf16 a[60:63], v[156:159], v[164:167], a[60:63]
    ds_read_b128 v[92:95], v4 offset:14336
    v_and_b32 v233, 0xffff0000, v198
    v_mfma_f32_16x16x32_bf16 a[28:31], v[156:159], v[160:163], a[28:31]
    v_lshlrev_b32 v234, 16, v206
    v_and_b32 v235, 0xffff0000, v206
    v_mfma_f32_16x16x32_bf16 a[92:95], v[156:159], v[168:171], a[92:95]
    ds_read_b64_tr_b16 v[96:97], v6 offset:0
    v_mul_f32 v232, v232, v234
    v_mfma_f32_16x16x32_bf16 a[124:127], v[156:159], v[172:175], a[124:127]
    v_mul_f32 v233, v233, v235
    v_lshlrev_b32 v236, 16, v199
    v_mfma_f32_16x16x32_bf16 a[120:123], v[152:155], v[172:175], a[120:123]
    ds_read_b64_tr_b16 v[98:99], v6 offset:2048
    v_cvt_pk_bf16_f32 v232, v232, v233
    v_mfma_f32_16x16x32_bf16 a[88:91], v[152:155], v[168:171], a[88:91]
    buffer_load_dwordx4 v15, s[36:39], s53 offen lds
    v_mfma_f32_16x16x32_bf16 a[84:87], v[148:151], v[168:171], a[84:87]
    ds_read_b64_tr_b16 v[100:101], v7 offset:0
    s_add_u32 m0, m0, 2048
    v_mfma_f32_16x16x32_bf16 a[116:119], v[148:151], v[172:175], a[116:119]
    s_add_u32 s53, s53, 32768
    v_lshlrev_b32 v233, 16, v232
    v_and_b32 v234, 0xffff0000, v232
    v_mfma_f32_16x16x32_bf16 a[112:115], v[144:147], v[172:175], a[112:115]
    ds_read_b64_tr_b16 v[102:103], v7 offset:2048
    v_add_f32 v56, v56, v233
    v_mfma_f32_16x16x32_bf16 a[80:83], v[144:147], v[168:171], a[80:83]
    v_add_f32 v56, v56, v234
    v_and_b32 v237, 0xffff0000, v199
    v_mfma_f32_16x16x32_bf16 a[76:79], v[140:143], v[168:171], a[76:79]
    ds_read_b64_tr_b16 v[104:105], v8 offset:0
    v_lshlrev_b32 v238, 16, v207
    v_mfma_f32_16x16x32_bf16 a[108:111], v[140:143], v[172:175], a[108:111]
    v_and_b32 v239, 0xffff0000, v207
    v_mul_f32 v236, v236, v238
    v_mfma_f32_16x16x32_bf16 a[104:107], v[136:139], v[172:175], a[104:107]
    ds_read_b64_tr_b16 v[106:107], v8 offset:2048
    v_mul_f32 v237, v237, v239
    v_mfma_f32_16x16x32_bf16 a[72:75], v[136:139], v[168:171], a[72:75]
    buffer_load_dwordx4 v15, s[36:39], s53 offen lds
    v_mfma_f32_16x16x32_bf16 a[68:71], v[132:135], v[168:171], a[68:71]
    ds_read_b64_tr_b16 v[108:109], v9 offset:0
    s_add_u32 m0, m0, 6144
    v_mfma_f32_16x16x32_bf16 a[100:103], v[132:135], v[172:175], a[100:103]
    s_add_u32 s53, s53, 98304
    v_cvt_pk_bf16_f32 v236, v236, v237
    v_mfma_f32_16x16x32_bf16 a[96:99], v[128:131], v[172:175], a[96:99]
    ds_read_b64_tr_b16 v[110:111], v9 offset:2048
    v_lshlrev_b32 v237, 16, v236
    v_mfma_f32_16x16x32_bf16 a[64:67], v[128:131], v[168:171], a[64:67]
    v_and_b32 v238, 0xffff0000, v236
    v_add_f32 v56, v56, v237
    v_mfma_f32_16x16x32_bf16 a[128:131], v[128:131], v[176:179], a[128:131]
    ds_read_b64_tr_b16 v[112:113], v10 offset:0
    v_add_f32 v56, v56, v238
    v_mfma_f32_16x16x32_bf16 a[160:163], v[128:131], v[180:183], a[160:163]
    s_nop 0
    v_mfma_f32_16x16x32_bf16 a[164:167], v[132:135], v[180:183], a[164:167]
    ds_read_b64_tr_b16 v[114:115], v10 offset:2048
    v_add_f32_dpp v56, v56, v56 row_ror:8 row_mask:0xf bank_mask:0xf
    v_mfma_f32_16x16x32_bf16 a[132:135], v[132:135], v[176:179], a[132:135]
    buffer_load_dwordx4 v15, s[36:39], s53 offen lds
    v_mfma_f32_16x16x32_bf16 a[136:139], v[136:139], v[176:179], a[136:139]
    ds_read_b64_tr_b16 v[116:117], v11 offset:0
    s_add_u32 m0, m0, 2048
    v_mfma_f32_16x16x32_bf16 a[168:171], v[136:139], v[180:183], a[168:171]
    s_add_u32 s53, s53, 32768
    s_nop 0
    v_mfma_f32_16x16x32_bf16 a[172:175], v[140:143], v[180:183], a[172:175]
    ds_read_b64_tr_b16 v[118:119], v11 offset:2048
    v_add_f32_dpp v56, v56, v56 row_ror:4 row_mask:0xf bank_mask:0xf
    v_mfma_f32_16x16x32_bf16 a[140:143], v[140:143], v[176:179], a[140:143]
    s_nop 0
    v_mfma_f32_16x16x32_bf16 a[144:147], v[144:147], v[176:179], a[144:147]
    ds_read_b64_tr_b16 v[120:121], v12 offset:0
    v_add_f32_dpp v56, v56, v56 row_ror:2 row_mask:0xf bank_mask:0xf
    v_mfma_f32_16x16x32_bf16 a[176:179], v[144:147], v[180:183], a[176:179]
    s_nop 0
    v_mfma_f32_16x16x32_bf16 a[180:183], v[148:151], v[180:183], a[180:183]
    ds_read_b64_tr_b16 v[122:123], v12 offset:2048
    v_add_f32_dpp v56, v56, v56 row_ror:1 row_mask:0xf bank_mask:0xf
    v_mfma_f32_16x16x32_bf16 a[148:151], v[148:151], v[176:179], a[148:151]
    buffer_load_dwordx4 v15, s[36:39], s53 offen lds
    v_mfma_f32_16x16x32_bf16 a[152:155], v[152:155], v[176:179], a[152:155]
    ds_read_b64_tr_b16 v[124:125], v13 offset:0
    s_add_u32 m0, m0, 6144
    v_mfma_f32_16x16x32_bf16 a[184:187], v[152:155], v[180:183], a[184:187]
    s_add_u32 s53, s53, 98304
    v_mov_b32 v57, v56
    v_mfma_f32_16x16x32_bf16 a[188:191], v[156:159], v[180:183], a[188:191]
    ds_read_b64_tr_b16 v[126:127], v13 offset:2048
    s_nop 0
    v_mfma_f32_16x16x32_bf16 a[156:159], v[156:159], v[176:179], a[156:159]
    v_permlane16_swap_b32 v57, v56
    v_mfma_f32_16x16x32_bf16 a[220:223], v[156:159], v[184:187], a[220:223]
    s_nop 0
    v_mfma_f32_16x16x32_bf16 a[252:255], v[156:159], v[188:191], a[252:255]
    buffer_load_dwordx4 v15, s[36:39], s53 offen lds
    v_mfma_f32_16x16x32_bf16 a[248:251], v[152:155], v[188:191], a[248:251]
    s_add_u32 m0, m0, 2048
    s_add_u32 s53, s53, 32768
    v_add_f32 v56, v56, v57
    v_mfma_f32_16x16x32_bf16 a[216:219], v[152:155], v[184:187], a[216:219]
    v_cvt_pk_bf16_f32 v56, v56, v56
    v_mfma_f32_16x16x32_bf16 a[212:215], v[148:151], v[184:187], a[212:215]
    v_lshlrev_b32 v56, 16, v56
    v_mfma_f32_16x16x32_bf16 a[244:247], v[148:151], v[188:191], a[244:247]
    v_mul_f32 v56, 0xbfb8aa3b, v56
    v_mfma_f32_16x16x32_bf16 a[240:243], v[144:147], v[188:191], a[240:243]
    v_exp_f32 v56, v56
    v_mfma_f32_16x16x32_bf16 a[208:211], v[144:147], v[184:187], a[208:211]
    buffer_load_dwordx4 v15, s[36:39], s53 offen lds
    v_mfma_f32_16x16x32_bf16 a[204:207], v[140:143], v[184:187], a[204:207]
    s_add_u32 s53, s53, 98304
    s_xor_b32 s61, s61, 32768
    s_sub_u32 s63, s63, 1
    v_mfma_f32_16x16x32_bf16 a[236:239], v[140:143], v[188:191], a[236:239]
    s_cmp_lg_u32 s63, 0
    v_add_f32 v56, 1.0, v56
    v_mfma_f32_16x16x32_bf16 a[232:235], v[136:139], v[188:191], a[232:235]
    v_rcp_f32 v56, v56
    v_mfma_f32_16x16x32_bf16 a[200:203], v[136:139], v[184:187], a[200:203]
    v_cvt_pk_bf16_f32 v56, v56, v56
    v_mfma_f32_16x16x32_bf16 a[196:199], v[132:135], v[184:187], a[196:199]
    v_lshlrev_b32 v56, 16, v56
    v_mfma_f32_16x16x32_bf16 a[228:231], v[132:135], v[188:191], a[228:231]
    v_lshrrev_b32 v57, 5, v0
    v_mfma_f32_16x16x32_bf16 a[224:227], v[128:131], v[188:191], a[224:227]
    v_lshlrev_b32 v57, 2, v57
    v_mfma_f32_16x16x32_bf16 a[192:195], v[128:131], v[184:187], a[192:195]
    s_waitcnt lgkmcnt(0)
    s_mov_b32 s42, 268435456
    s_mov_b32 exec_lo, 1
    s_mov_b32 exec_hi, 1
    buffer_store_dword v56, v57, s[40:43], s57 offen sc1
    s_mov_b64 exec, -1
    s_mov_b32 s42, 0
LG_LOOP_V:
    v_mfma_f32_16x16x32_bf16 a[0:3], v[64:67], v[96:99], a[0:3]
    ds_read_b128 v[128:131], v5 offset:0
    s_mov_b32 m0, s60
    v_mfma_f32_16x16x32_bf16 a[32:35], v[64:67], v[100:103], a[32:35]
    v_mfma_f32_16x16x32_bf16 a[36:39], v[68:71], v[100:103], a[36:39]
    ds_read_b128 v[132:135], v5 offset:2048
    v_mfma_f32_16x16x32_bf16 a[4:7], v[68:71], v[96:99], a[4:7]
    buffer_load_dwordx4 v14, s[32:35], s52 offen lds
    v_mfma_f32_16x16x32_bf16 a[8:11], v[72:75], v[96:99], a[8:11]
    ds_read_b128 v[136:139], v5 offset:4096
    s_add_u32 m0, m0, 2048
    v_mfma_f32_16x16x32_bf16 a[40:43], v[72:75], v[100:103], a[40:43]
    s_add_u32 s52, s52, s54
    v_mfma_f32_16x16x32_bf16 a[44:47], v[76:79], v[100:103], a[44:47]
    ds_read_b128 v[140:143], v5 offset:6144
    v_mfma_f32_16x16x32_bf16 a[12:15], v[76:79], v[96:99], a[12:15]
    v_mfma_f32_16x16x32_bf16 a[16:19], v[80:83], v[96:99], a[16:19]
    ds_read_b128 v[144:147], v5 offset:8192
    v_mfma_f32_16x16x32_bf16 a[48:51], v[80:83], v[100:103], a[48:51]
    v_mfma_f32_16x16x32_bf16 a[52:55], v[84:87], v[100:103], a[52:55]
    ds_read_b128 v[148:151], v5 offset:10240
    v_mfma_f32_16x16x32_bf16 a[20:23], v[84:87], v[96:99], a[20:23]
    buffer_load_dwordx4 v14, s[32:35], s52 offen lds
    v_mfma_f32_16x16x32_bf16 a[24:27], v[88:91], v[96:99], a[24:27]
    ds_read_b128 v[152:155], v5 offset:12288
    s_add_u32 m0, m0, 2048
    v_mfma_f32_16x16x32_bf16 a[56:59], v[88:91], v[100:103], a[56:59]
    s_add_u32 s52, s52, s55
    v_mfma_f32_16x16x32_bf16 a[60:63], v[92:95], v[100:103], a[60:63]
    ds_read_b128 v[156:159], v5 offset:14336
    v_mfma_f32_16x16x32_bf16 a[28:31], v[92:95], v[96:99], a[28:31]
    v_mfma_f32_16x16x32_bf16 a[92:95], v[92:95], v[104:107], a[92:95]
    ds_read_b64_tr_b16 v[160:161], v6 offset:16384
    v_mfma_f32_16x16x32_bf16 a[124:127], v[92:95], v[108:111], a[124:127]
    v_mfma_f32_16x16x32_bf16 a[120:123], v[88:91], v[108:111], a[120:123]
    ds_read_b64_tr_b16 v[162:163], v6 offset:18432
    v_mfma_f32_16x16x32_bf16 a[88:91], v[88:91], v[104:107], a[88:91]
    buffer_load_dwordx4 v14, s[32:35], s52 offen lds
    v_mfma_f32_16x16x32_bf16 a[84:87], v[84:87], v[104:107], a[84:87]
    ds_read_b64_tr_b16 v[164:165], v7 offset:16384
    s_add_u32 m0, m0, 2048
    v_mfma_f32_16x16x32_bf16 a[116:119], v[84:87], v[108:111], a[116:119]
    s_add_u32 s52, s52, s54
    v_mfma_f32_16x16x32_bf16 a[112:115], v[80:83], v[108:111], a[112:115]
    ds_read_b64_tr_b16 v[166:167], v7 offset:18432
    v_mfma_f32_16x16x32_bf16 a[80:83], v[80:83], v[104:107], a[80:83]
    v_mfma_f32_16x16x32_bf16 a[76:79], v[76:79], v[104:107], a[76:79]
    ds_read_b64_tr_b16 v[168:169], v8 offset:16384
    v_mfma_f32_16x16x32_bf16 a[108:111], v[76:79], v[108:111], a[108:111]
    v_mfma_f32_16x16x32_bf16 a[104:107], v[72:75], v[108:111], a[104:107]
    ds_read_b64_tr_b16 v[170:171], v8 offset:18432
    v_mfma_f32_16x16x32_bf16 a[72:75], v[72:75], v[104:107], a[72:75]
    buffer_load_dwordx4 v14, s[32:35], s52 offen lds
    v_mfma_f32_16x16x32_bf16 a[68:71], v[68:71], v[104:107], a[68:71]
    ds_read_b64_tr_b16 v[172:173], v9 offset:16384
    s_add_u32 m0, m0, 2048
    v_mfma_f32_16x16x32_bf16 a[100:103], v[68:71], v[108:111], a[100:103]
    s_add_u32 s52, s52, s55
    v_mfma_f32_16x16x32_bf16 a[96:99], v[64:67], v[108:111], a[96:99]
    ds_read_b64_tr_b16 v[174:175], v9 offset:18432
    v_mfma_f32_16x16x32_bf16 a[64:67], v[64:67], v[104:107], a[64:67]
    v_mfma_f32_16x16x32_bf16 a[128:131], v[64:67], v[112:115], a[128:131]
    ds_read_b64_tr_b16 v[176:177], v10 offset:16384
    v_mfma_f32_16x16x32_bf16 a[160:163], v[64:67], v[116:119], a[160:163]
    v_mfma_f32_16x16x32_bf16 a[164:167], v[68:71], v[116:119], a[164:167]
    ds_read_b64_tr_b16 v[178:179], v10 offset:18432
    v_mfma_f32_16x16x32_bf16 a[132:135], v[68:71], v[112:115], a[132:135]
    buffer_load_dwordx4 v14, s[32:35], s52 offen lds
    v_mfma_f32_16x16x32_bf16 a[136:139], v[72:75], v[112:115], a[136:139]
    ds_read_b64_tr_b16 v[180:181], v11 offset:16384
    s_add_u32 m0, m0, 2048
    v_mfma_f32_16x16x32_bf16 a[168:171], v[72:75], v[116:119], a[168:171]
    s_add_u32 s52, s52, s54
    v_mfma_f32_16x16x32_bf16 a[172:175], v[76:79], v[116:119], a[172:175]
    ds_read_b64_tr_b16 v[182:183], v11 offset:18432
    v_mfma_f32_16x16x32_bf16 a[140:143], v[76:79], v[112:115], a[140:143]
    v_mfma_f32_16x16x32_bf16 a[144:147], v[80:83], v[112:115], a[144:147]
    ds_read_b64_tr_b16 v[184:185], v12 offset:16384
    v_mfma_f32_16x16x32_bf16 a[176:179], v[80:83], v[116:119], a[176:179]
    v_mfma_f32_16x16x32_bf16 a[180:183], v[84:87], v[116:119], a[180:183]
    ds_read_b64_tr_b16 v[186:187], v12 offset:18432
    v_mfma_f32_16x16x32_bf16 a[148:151], v[84:87], v[112:115], a[148:151]
    buffer_load_dwordx4 v14, s[32:35], s52 offen lds
    v_mfma_f32_16x16x32_bf16 a[152:155], v[88:91], v[112:115], a[152:155]
    ds_read_b64_tr_b16 v[188:189], v13 offset:16384
    s_add_u32 m0, m0, 2048
    v_mfma_f32_16x16x32_bf16 a[184:187], v[88:91], v[116:119], a[184:187]
    s_add_u32 s52, s52, s55
    v_mfma_f32_16x16x32_bf16 a[188:191], v[92:95], v[116:119], a[188:191]
    ds_read_b64_tr_b16 v[190:191], v13 offset:18432
    v_mfma_f32_16x16x32_bf16 a[156:159], v[92:95], v[112:115], a[156:159]
    v_add_u32 v4, s59, v2
    v_add_u32 v5, s59, v3
    v_mfma_f32_16x16x32_bf16 a[220:223], v[92:95], v[120:123], a[220:223]
    v_xor_b32 v6, 0x8000, v6
    v_xor_b32 v7, 0x8000, v7
    v_mfma_f32_16x16x32_bf16 a[252:255], v[92:95], v[124:127], a[252:255]
    buffer_load_dwordx4 v14, s[32:35], s52 offen lds
    v_mfma_f32_16x16x32_bf16 a[248:251], v[88:91], v[124:127], a[248:251]
    s_add_u32 m0, m0, 2048
    s_add_u32 s52, s52, s54
    v_xor_b32 v8, 0x8000, v8
    v_mfma_f32_16x16x32_bf16 a[216:219], v[88:91], v[120:123], a[216:219]
    v_xor_b32 v9, 0x8000, v9
    v_xor_b32 v10, 0x8000, v10
    v_mfma_f32_16x16x32_bf16 a[212:215], v[84:87], v[120:123], a[212:215]
    v_xor_b32 v11, 0x8000, v11
    v_xor_b32 v12, 0x8000, v12
    v_mfma_f32_16x16x32_bf16 a[244:247], v[84:87], v[124:127], a[244:247]
    v_xor_b32 v13, 0x8000, v13
    v_mfma_f32_16x16x32_bf16 a[240:243], v[80:83], v[124:127], a[240:243]
    v_mfma_f32_16x16x32_bf16 a[208:211], v[80:83], v[120:123], a[208:211]
    buffer_load_dwordx4 v14, s[32:35], s52 offen lds
    v_mfma_f32_16x16x32_bf16 a[204:207], v[76:79], v[120:123], a[204:207]
    s_add_u32 s52, s52, s56
    s_add_u32 s60, s60, 32768
    s_cmp_ge_u32 s60, 163840
    v_mfma_f32_16x16x32_bf16 a[236:239], v[76:79], v[124:127], a[236:239]
    s_cselect_b32 s60, s62, s60
    v_mfma_f32_16x16x32_bf16 a[232:235], v[72:75], v[124:127], a[232:235]
    v_mfma_f32_16x16x32_bf16 a[200:203], v[72:75], v[120:123], a[200:203]
    buffer_load_dword v41, v40, s[40:43], s87 offen
    v_mfma_f32_16x16x32_bf16 a[196:199], v[68:71], v[120:123], a[196:199]
    v_mfma_f32_16x16x32_bf16 a[228:231], v[68:71], v[124:127], a[228:231]
    buffer_atomic_add v42, v43, s[44:47], 0 offen
    v_mfma_f32_16x16x32_bf16 a[224:227], v[64:67], v[124:127], a[224:227]
    v_mfma_f32_16x16x32_bf16 a[192:195], v[64:67], v[120:123], a[192:195]
    s_waitcnt vmcnt(10) lgkmcnt(0)
    s_barrier
    v_mfma_f32_16x16x32_bf16 a[0:3], v[128:131], v[160:163], a[0:3]
    ds_read_b128 v[64:67], v4 offset:0
    s_add_u32 s59, s59, 32768
    v_mfma_f32_16x16x32_bf16 a[32:35], v[128:131], v[164:167], a[32:35]
    s_cmp_ge_u32 s59, 163840
    s_cselect_b32 s59, 65536, s59
    s_mov_b32 m0, s61
    v_mfma_f32_16x16x32_bf16 a[36:39], v[132:135], v[164:167], a[36:39]
    ds_read_b128 v[68:71], v4 offset:2048
    v_mfma_f32_16x16x32_bf16 a[4:7], v[132:135], v[160:163], a[4:7]
    buffer_load_dwordx4 v15, s[36:39], s53 offen lds
    v_mfma_f32_16x16x32_bf16 a[8:11], v[136:139], v[160:163], a[8:11]
    ds_read_b128 v[72:75], v4 offset:4096
    s_add_u32 s64, s64, 1
    v_mfma_f32_16x16x32_bf16 a[40:43], v[136:139], v[164:167], a[40:43]
    s_mov_b32 s42, 0
    s_add_u32 m0, m0, 2048
    s_add_u32 s53, s53, 32768
    v_mfma_f32_16x16x32_bf16 a[44:47], v[140:143], v[164:167], a[44:47]
    ds_read_b128 v[76:79], v4 offset:6144
    v_mfma_f32_16x16x32_bf16 a[12:15], v[140:143], v[160:163], a[12:15]
    v_mfma_f32_16x16x32_bf16 a[16:19], v[144:147], v[160:163], a[16:19]
    ds_read_b128 v[80:83], v4 offset:8192
    v_mfma_f32_16x16x32_bf16 a[48:51], v[144:147], v[164:167], a[48:51]
    v_mfma_f32_16x16x32_bf16 a[52:55], v[148:151], v[164:167], a[52:55]
    ds_read_b128 v[84:87], v4 offset:10240
    v_mfma_f32_16x16x32_bf16 a[20:23], v[148:151], v[160:163], a[20:23]
    buffer_load_dwordx4 v15, s[36:39], s53 offen lds
    v_mfma_f32_16x16x32_bf16 a[24:27], v[152:155], v[160:163], a[24:27]
    ds_read_b128 v[88:91], v4 offset:12288
    s_cmp_eq_u32 s64, s18
    v_mfma_f32_16x16x32_bf16 a[56:59], v[152:155], v[164:167], a[56:59]
    s_cselect_b64 s[40:41], s[12:13], s[40:41]
    s_cselect_b32 s42, s16, s42
    s_cselect_b32 s87, s17, s87
    v_mfma_f32_16x16x32_bf16 a[60:63], v[156:159], v[164:167], a[60:63]
    ds_read_b128 v[92:95], v4 offset:14336
    s_add_u32 m0, m0, 6144
    v_mfma_f32_16x16x32_bf16 a[28:31], v[156:159], v[160:163], a[28:31]
    s_add_u32 s53, s53, 98304
    v_mfma_f32_16x16x32_bf16 a[92:95], v[156:159], v[168:171], a[92:95]
    ds_read_b64_tr_b16 v[96:97], v6 offset:0
    v_mfma_f32_16x16x32_bf16 a[124:127], v[156:159], v[172:175], a[124:127]
    v_mfma_f32_16x16x32_bf16 a[120:123], v[152:155], v[172:175], a[120:123]
    ds_read_b64_tr_b16 v[98:99], v6 offset:2048
    v_mfma_f32_16x16x32_bf16 a[88:91], v[152:155], v[168:171], a[88:91]
    buffer_load_dwordx4 v15, s[36:39], s53 offen lds
    v_mfma_f32_16x16x32_bf16 a[84:87], v[148:151], v[168:171], a[84:87]
    ds_read_b64_tr_b16 v[100:101], v7 offset:0
    s_cmp_eq_u32 s64, 13
    v_mfma_f32_16x16x32_bf16 a[116:119], v[148:151], v[172:175], a[116:119]
    s_cselect_b64 s[40:41], s[84:85], s[40:41]
    s_cselect_b32 s42, LM_END-LM_PC, s42
    s_cselect_b32 s87, s86, s87
    v_mfma_f32_16x16x32_bf16 a[112:115], v[144:147], v[172:175], a[112:115]
    ds_read_b64_tr_b16 v[102:103], v7 offset:2048
    s_add_u32 m0, m0, 2048
    v_mfma_f32_16x16x32_bf16 a[80:83], v[144:147], v[168:171], a[80:83]
    s_add_u32 s53, s53, 32768
    v_mfma_f32_16x16x32_bf16 a[76:79], v[140:143], v[168:171], a[76:79]
    ds_read_b64_tr_b16 v[104:105], v8 offset:0
    v_mfma_f32_16x16x32_bf16 a[108:111], v[140:143], v[172:175], a[108:111]
    v_mfma_f32_16x16x32_bf16 a[104:107], v[136:139], v[172:175], a[104:107]
    ds_read_b64_tr_b16 v[106:107], v8 offset:2048
    v_mfma_f32_16x16x32_bf16 a[72:75], v[136:139], v[168:171], a[72:75]
    buffer_load_dwordx4 v15, s[36:39], s53 offen lds
    v_mfma_f32_16x16x32_bf16 a[68:71], v[132:135], v[168:171], a[68:71]
    ds_read_b64_tr_b16 v[108:109], v9 offset:0
    s_cmp_eq_u32 s64, s83
    v_mfma_f32_16x16x32_bf16 a[100:103], v[132:135], v[172:175], a[100:103]
    s_cselect_b32 s46, 256, 0
    s_add_u32 m0, m0, 6144
    s_add_u32 s53, s53, 98304
    v_mfma_f32_16x16x32_bf16 a[96:99], v[128:131], v[172:175], a[96:99]
    ds_read_b64_tr_b16 v[110:111], v9 offset:2048
    v_mfma_f32_16x16x32_bf16 a[64:67], v[128:131], v[168:171], a[64:67]
    v_mfma_f32_16x16x32_bf16 a[128:131], v[128:131], v[176:179], a[128:131]
    ds_read_b64_tr_b16 v[112:113], v10 offset:0
    v_mfma_f32_16x16x32_bf16 a[160:163], v[128:131], v[180:183], a[160:163]
    v_mfma_f32_16x16x32_bf16 a[164:167], v[132:135], v[180:183], a[164:167]
    ds_read_b64_tr_b16 v[114:115], v10 offset:2048
    v_mfma_f32_16x16x32_bf16 a[132:135], v[132:135], v[176:179], a[132:135]
    buffer_load_dwordx4 v15, s[36:39], s53 offen lds
    v_mfma_f32_16x16x32_bf16 a[136:139], v[136:139], v[176:179], a[136:139]
    ds_read_b64_tr_b16 v[116:117], v11 offset:0
    s_add_u32 m0, m0, 2048
    v_mfma_f32_16x16x32_bf16 a[168:171], v[136:139], v[180:183], a[168:171]
    s_add_u32 s53, s53, 32768
    v_mfma_f32_16x16x32_bf16 a[172:175], v[140:143], v[180:183], a[172:175]
    ds_read_b64_tr_b16 v[118:119], v11 offset:2048
    v_mfma_f32_16x16x32_bf16 a[140:143], v[140:143], v[176:179], a[140:143]
    v_mfma_f32_16x16x32_bf16 a[144:147], v[144:147], v[176:179], a[144:147]
    ds_read_b64_tr_b16 v[120:121], v12 offset:0
    v_mfma_f32_16x16x32_bf16 a[176:179], v[144:147], v[180:183], a[176:179]
    v_mfma_f32_16x16x32_bf16 a[180:183], v[148:151], v[180:183], a[180:183]
    ds_read_b64_tr_b16 v[122:123], v12 offset:2048
    v_mfma_f32_16x16x32_bf16 a[148:151], v[148:151], v[176:179], a[148:151]
    buffer_load_dwordx4 v15, s[36:39], s53 offen lds
    v_mfma_f32_16x16x32_bf16 a[152:155], v[152:155], v[176:179], a[152:155]
    ds_read_b64_tr_b16 v[124:125], v13 offset:0
    s_add_u32 m0, m0, 6144
    v_mfma_f32_16x16x32_bf16 a[184:187], v[152:155], v[180:183], a[184:187]
    s_add_u32 s53, s53, 98304
    v_mfma_f32_16x16x32_bf16 a[188:191], v[156:159], v[180:183], a[188:191]
    ds_read_b64_tr_b16 v[126:127], v13 offset:2048
    v_mfma_f32_16x16x32_bf16 a[156:159], v[156:159], v[176:179], a[156:159]
    v_mfma_f32_16x16x32_bf16 a[220:223], v[156:159], v[184:187], a[220:223]
    v_mfma_f32_16x16x32_bf16 a[252:255], v[156:159], v[188:191], a[252:255]
    buffer_load_dwordx4 v15, s[36:39], s53 offen lds
    v_mfma_f32_16x16x32_bf16 a[248:251], v[152:155], v[188:191], a[248:251]
    s_add_u32 m0, m0, 2048
    s_add_u32 s53, s53, 32768
    v_mfma_f32_16x16x32_bf16 a[216:219], v[152:155], v[184:187], a[216:219]
    v_mfma_f32_16x16x32_bf16 a[212:215], v[148:151], v[184:187], a[212:215]
    v_mfma_f32_16x16x32_bf16 a[244:247], v[148:151], v[188:191], a[244:247]
    v_mfma_f32_16x16x32_bf16 a[240:243], v[144:147], v[188:191], a[240:243]
    v_mfma_f32_16x16x32_bf16 a[208:211], v[144:147], v[184:187], a[208:211]
    buffer_load_dwordx4 v15, s[36:39], s53 offen lds
    v_mfma_f32_16x16x32_bf16 a[204:207], v[140:143], v[184:187], a[204:207]
    s_add_u32 s53, s53, 98304
    s_xor_b32 s61, s61, 32768
    s_sub_u32 s63, s63, 1
    v_mfma_f32_16x16x32_bf16 a[236:239], v[140:143], v[188:191], a[236:239]
    s_cmp_lg_u32 s63, 0
    v_mfma_f32_16x16x32_bf16 a[232:235], v[136:139], v[188:191], a[232:235]
    v_mfma_f32_16x16x32_bf16 a[200:203], v[136:139], v[184:187], a[200:203]
    v_mfma_f32_16x16x32_bf16 a[196:199], v[132:135], v[184:187], a[196:199]
    v_mfma_f32_16x16x32_bf16 a[228:231], v[132:135], v[188:191], a[228:231]
    v_mfma_f32_16x16x32_bf16 a[224:227], v[128:131], v[188:191], a[224:227]
    v_mfma_f32_16x16x32_bf16 a[192:195], v[128:131], v[184:187], a[192:195]
    s_waitcnt lgkmcnt(0)
    s_cbranch_scc1 LG_LOOP_V
    s_cmp_eq_u32 s64, 16
    s_cbranch_scc1 LG_EPI_V
    s_mov_b32 s63, 2
    s_cmp_eq_u32 s48, 0
    s_cselect_b32 s46, 256, 0
    buffer_load_dword v46, v47, s[44:47], 0 offen sc1
    s_mov_b32 s46, 0
    s_mov_b32 s32, s73
    s_mov_b32 s33, s74
    s_mov_b32 s34, s75
    s_mov_b32 s52, s68
    s_mov_b32 s54, s70
    s_mov_b32 s55, s71
    s_mov_b32 s56, s72
    v_mov_b32 v14, v16
    s_mov_b32 s36, s14
    s_mov_b32 s37, s15
    s_mov_b32 s38, 3670016
    s_mov_b32 s53, s69
    s_branch LG_LOOP_V
LG_EPI_V:
    s_mov_b32 s40, s28
    s_mov_b32 s41, s29
    s_mov_b32 s42, 268435456
    s_mov_b32 s43, 0x20000
    s_mov_b32 s46, 256
    v_cmp_le_u32 vcc, 16, v46
    s_cmp_lg_u32 s48, 0
    s_cbranch_scc1 LM_6
    s_mov_b32 s81, 65536
LM_7:
    s_nop 3
    s_cmp_eq_u64 vcc, -1
    s_cbranch_scc1 LM_6
    s_sub_u32 s81, s81, 1
    s_cmp_eq_u32 s81, 0
    s_cbranch_scc1 LM_6
    s_sleep 32
    buffer_load_dword v46, v47, s[44:47], 0 offen sc1
    s_waitcnt vmcnt(0)
    v_cmp_le_u32 vcc, 16, v46
    s_branch LM_7
LM_6:
    s_mov_b32 s68, s65
    v_add_u32 v4, 98304, v22
    v_add_u32 v5, 98304, v23
    v_add_u32 v27, 98304, v24
    v_add_u32 v28, 98304, v25
    v_add_u32 v29, 98304, v26
    ds_read_b128 v[64:67], v4 offset:0
    ds_read_b128 v[68:71], v4 offset:2048
    ds_read_b128 v[72:75], v4 offset:4096
    ds_read_b128 v[76:79], v4 offset:6144
    ds_read_b64_tr_b16 v[80:81], v6 offset:0
    ds_read_b64_tr_b16 v[82:83], v6 offset:2048
    ds_read_b64_tr_b16 v[84:85], v7 offset:0
    ds_read_b64_tr_b16 v[86:87], v7 offset:2048
    ds_read_b64_tr_b16 v[88:89], v8 offset:0
    ds_read_b64_tr_b16 v[90:91], v8 offset:2048
    ds_read_b64_tr_b16 v[92:93], v9 offset:0
    ds_read_b64_tr_b16 v[94:95], v9 offset:2048
    ds_read_b64_tr_b16 v[96:97], v10 offset:0
    ds_read_b64_tr_b16 v[98:99], v10 offset:2048
    ds_read_b64_tr_b16 v[100:101], v11 offset:0
    ds_read_b64_tr_b16 v[102:103], v11 offset:2048
    ds_read_b64_tr_b16 v[104:105], v12 offset:0
    ds_read_b64_tr_b16 v[106:107], v12 offset:2048
    ds_read_b64_tr_b16 v[108:109], v13 offset:0
    ds_read_b64_tr_b16 v[110:111], v13 offset:2048
    ds_read_b64_tr_b16 v[112:113], v27 offset:0
    ds_read_b64_tr_b16 v[114:115], v27 offset:2048
    ds_read_b64_tr_b16 v[116:117], v28 offset:0
    ds_read_b64_tr_b16 v[118:119], v28 offset:2048
    ds_read_b64_tr_b16 v[120:121], v29 offset:0
    ds_read_b64_tr_b16 v[122:123], v29 offset:2048
    v_accvgpr_read_b32 v48, a0
    v_accvgpr_read_b32 v49, a1
    v_accvgpr_read_b32 v50, a2
    v_accvgpr_read_b32 v51, a3
    v_accvgpr_read_b32 v52, a4
    v_accvgpr_read_b32 v53, a5
    v_accvgpr_read_b32 v54, a6
    v_accvgpr_read_b32 v55, a7
    v_cvt_pk_bf16_f32 v128, v48, v49
    v_cvt_pk_bf16_f32 v129, v50, v51
    v_cvt_pk_bf16_f32 v130, v52, v53
    v_cvt_pk_bf16_f32 v131, v54, v55
    v_accvgpr_read_b32 v56, a32
    v_accvgpr_read_b32 v57, a33
    v_accvgpr_read_b32 v58, a34
    v_accvgpr_read_b32 v59, a35
    v_accvgpr_read_b32 v60, a36
    v_accvgpr_read_b32 v61, a37
    v_accvgpr_read_b32 v62, a38
    v_accvgpr_read_b32 v63, a39
    v_cvt_pk_bf16_f32 v132, v56, v57
    v_cvt_pk_bf16_f32 v133, v58, v59
    v_cvt_pk_bf16_f32 v134, v60, v61
    v_cvt_pk_bf16_f32 v135, v62, v63
    buffer_store_dwordx4 v[128:131], v1, s[8:11], s65 offen offset:0 sc1
    v_accvgpr_read_b32 v48, a64
    v_accvgpr_read_b32 v49, a65
    v_accvgpr_read_b32 v50, a66
    v_accvgpr_read_b32 v51, a67
    v_accvgpr_read_b32 v52, a68
    v_accvgpr_read_b32 v53, a69
    v_accvgpr_read_b32 v54, a70
    v_accvgpr_read_b32 v55, a71
    v_cvt_pk_bf16_f32 v136, v48, v49
    v_cvt_pk_bf16_f32 v137, v50, v51
    v_cvt_pk_bf16_f32 v138, v52, v53
    v_cvt_pk_bf16_f32 v139, v54, v55
    v_accvgpr_read_b32 v56, a96
    v_accvgpr_read_b32 v57, a97
    v_accvgpr_read_b32 v58, a98
    v_accvgpr_read_b32 v59, a99
    v_accvgpr_read_b32 v60, a100
    v_accvgpr_read_b32 v61, a101
    v_accvgpr_read_b32 v62, a102
    v_accvgpr_read_b32 v63, a103
    v_cvt_pk_bf16_f32 v140, v56, v57
    v_cvt_pk_bf16_f32 v141, v58, v59
    v_cvt_pk_bf16_f32 v142, v60, v61
    v_cvt_pk_bf16_f32 v143, v62, v63
    buffer_store_dwordx4 v[132:135], v1, s[8:11], s65 offen offset:1024 sc1
    v_accvgpr_read_b32 v48, a128
    v_accvgpr_read_b32 v49, a129
    v_accvgpr_read_b32 v50, a130
    v_accvgpr_read_b32 v51, a131
    v_accvgpr_read_b32 v52, a132
    v_accvgpr_read_b32 v53, a133
    v_accvgpr_read_b32 v54, a134
    v_accvgpr_read_b32 v55, a135
    v_cvt_pk_bf16_f32 v144, v48, v49
    v_cvt_pk_bf16_f32 v145, v50, v51
    v_cvt_pk_bf16_f32 v146, v52, v53
    v_cvt_pk_bf16_f32 v147, v54, v55
    v_accvgpr_read_b32 v56, a160
    v_accvgpr_read_b32 v57, a161
    v_accvgpr_read_b32 v58, a162
    v_accvgpr_read_b32 v59, a163
    v_accvgpr_read_b32 v60, a164
    v_accvgpr_read_b32 v61, a165
    v_accvgpr_read_b32 v62, a166
    v_accvgpr_read_b32 v63, a167
    v_cvt_pk_bf16_f32 v148, v56, v57
    v_cvt_pk_bf16_f32 v149, v58, v59
    v_cvt_pk_bf16_f32 v150, v60, v61
    v_cvt_pk_bf16_f32 v151, v62, v63
    buffer_store_dwordx4 v[136:139], v1, s[8:11], s65 offen offset:2048 sc1
    v_accvgpr_read_b32 v48, a192
    v_accvgpr_read_b32 v49, a193
    v_accvgpr_read_b32 v50, a194
    v_accvgpr_read_b32 v51, a195
    v_accvgpr_read_b32 v52, a196
    v_accvgpr_read_b32 v53, a197
    v_accvgpr_read_b32 v54, a198
    v_accvgpr_read_b32 v55, a199
    v_cvt_pk_bf16_f32 v152, v48, v49
    v_cvt_pk_bf16_f32 v153, v50, v51
    v_cvt_pk_bf16_f32 v154, v52, v53
    v_cvt_pk_bf16_f32 v155, v54, v55
    v_accvgpr_read_b32 v56, a224
    v_accvgpr_read_b32 v57, a225
    v_accvgpr_read_b32 v58, a226
    v_accvgpr_read_b32 v59, a227
    v_accvgpr_read_b32 v60, a228
    v_accvgpr_read_b32 v61, a229
    v_accvgpr_read_b32 v62, a230
    v_accvgpr_read_b32 v63, a231
    v_cvt_pk_bf16_f32 v156, v56, v57
    v_cvt_pk_bf16_f32 v157, v58, v59
    v_cvt_pk_bf16_f32 v158, v60, v61
    v_cvt_pk_bf16_f32 v159, v62, v63
    buffer_store_dwordx4 v[140:143], v1, s[8:11], s65 offen offset:3072 sc1
    v_accvgpr_read_b32 v48, a8
    v_accvgpr_read_b32 v49, a9
    v_accvgpr_read_b32 v50, a10
    v_accvgpr_read_b32 v51, a11
    v_accvgpr_read_b32 v52, a12
    v_accvgpr_read_b32 v53, a13
    v_accvgpr_read_b32 v54, a14
    v_accvgpr_read_b32 v55, a15
    v_cvt_pk_bf16_f32 v160, v48, v49
    v_cvt_pk_bf16_f32 v161, v50, v51
    v_cvt_pk_bf16_f32 v162, v52, v53
    v_cvt_pk_bf16_f32 v163, v54, v55
    v_accvgpr_read_b32 v56, a40
    v_accvgpr_read_b32 v57, a41
    v_accvgpr_read_b32 v58, a42
    v_accvgpr_read_b32 v59, a43
    v_accvgpr_read_b32 v60, a44
    v_accvgpr_read_b32 v61, a45
    v_accvgpr_read_b32 v62, a46
    v_accvgpr_read_b32 v63, a47
    v_cvt_pk_bf16_f32 v164, v56, v57
    v_cvt_pk_bf16_f32 v165, v58, v59
    v_cvt_pk_bf16_f32 v166, v60, v61
    v_cvt_pk_bf16_f32 v167, v62, v63
    s_add_u32 s65, s65, s66
    buffer_store_dwordx4 v[144:147], v1, s[8:11], s65 offen offset:0 sc1
    v_accvgpr_read_b32 v48, a72
    v_accvgpr_read_b32 v49, a73
    v_accvgpr_read_b32 v50, a74
    v_accvgpr_read_b32 v51, a75
    v_accvgpr_read_b32 v52, a76
    v_accvgpr_read_b32 v53, a77
    v_accvgpr_read_b32 v54, a78
    v_accvgpr_read_b32 v55, a79
    v_cvt_pk_bf16_f32 v168, v48, v49
    v_cvt_pk_bf16_f32 v169, v50, v51
    v_cvt_pk_bf16_f32 v170, v52, v53
    v_cvt_pk_bf16_f32 v171, v54, v55
    v_accvgpr_read_b32 v56, a104
    v_accvgpr_read_b32 v57, a105
    v_accvgpr_read_b32 v58, a106
    v_accvgpr_read_b32 v59, a107
    v_accvgpr_read_b32 v60, a108
    v_accvgpr_read_b32 v61, a109
    v_accvgpr_read_b32 v62, a110
    v_accvgpr_read_b32 v63, a111
    v_cvt_pk_bf16_f32 v172, v56, v57
    v_cvt_pk_bf16_f32 v173, v58, v59
    v_cvt_pk_bf16_f32 v174, v60, v61
    v_cvt_pk_bf16_f32 v175, v62, v63
    buffer_store_dwordx4 v[148:151], v1, s[8:11], s65 offen offset:1024 sc1
    v_accvgpr_read_b32 v48, a136
    v_accvgpr_read_b32 v49, a137
    v_accvgpr_read_b32 v50, a138
    v_accvgpr_read_b32 v51, a139
    v_accvgpr_read_b32 v52, a140
    v_accvgpr_read_b32 v53, a141
    v_accvgpr_read_b32 v54, a142
    v_accvgpr_read_b32 v55, a143
    v_cvt_pk_bf16_f32 v176, v48, v49
    v_cvt_pk_bf16_f32 v177, v50, v51
    v_cvt_pk_bf16_f32 v178, v52, v53
    v_cvt_pk_bf16_f32 v179, v54, v55
    v_accvgpr_read_b32 v56, a168
    v_accvgpr_read_b32 v57, a169
    v_accvgpr_read_b32 v58, a170
    v_accvgpr_read_b32 v59, a171
    v_accvgpr_read_b32 v60, a172
    v_accvgpr_read_b32 v61, a173
    v_accvgpr_read_b32 v62, a174
    v_accvgpr_read_b32 v63, a175
    v_cvt_pk_bf16_f32 v180, v56, v57
    v_cvt_pk_bf16_f32 v181, v58, v59
    v_cvt_pk_bf16_f32 v182, v60, v61
    v_cvt_pk_bf16_f32 v183, v62, v63
    buffer_store_dwordx4 v[152:155], v1, s[8:11], s65 offen offset:2048 sc1
    v_accvgpr_read_b32 v48, a200
    v_accvgpr_read_b32 v49, a201
    v_accvgpr_read_b32 v50, a202
    v_accvgpr_read_b32 v51, a203
    v_accvgpr_read_b32 v52, a204
    v_accvgpr_read_b32 v53, a205
    v_accvgpr_read_b32 v54, a206
    v_accvgpr_read_b32 v55, a207
    v_cvt_pk_bf16_f32 v184, v48, v49
    v_cvt_pk_bf16_f32 v185, v50, v51
    v_cvt_pk_bf16_f32 v186, v52, v53
    v_cvt_pk_bf16_f32 v187, v54, v55
    v_accvgpr_read_b32 v56, a232
    v_accvgpr_read_b32 v57, a233
    v_accvgpr_read_b32 v58, a234
    v_accvgpr_read_b32 v59, a235
    v_accvgpr_read_b32 v60, a236
    v_accvgpr_read_b32 v61, a237
    v_accvgpr_read_b32 v62, a238
    v_accvgpr_read_b32 v63, a239
    v_cvt_pk_bf16_f32 v188, v56, v57
    v_cvt_pk_bf16_f32 v189, v58, v59
    v_cvt_pk_bf16_f32 v190, v60, v61
    v_cvt_pk_bf16_f32 v191, v62, v63
    buffer_store_dwordx4 v[156:159], v1, s[8:11], s65 offen offset:3072 sc1
    v_accvgpr_read_b32 v48, a16
    v_accvgpr_read_b32 v49, a17
    v_accvgpr_read_b32 v50, a18
    v_accvgpr_read_b32 v51, a19
    v_accvgpr_read_b32 v52, a20
    v_accvgpr_read_b32 v53, a21
    v_accvgpr_read_b32 v54, a22
    v_accvgpr_read_b32 v55, a23
    v_cvt_pk_bf16_f32 v192, v48, v49
    v_cvt_pk_bf16_f32 v193, v50, v51
    v_cvt_pk_bf16_f32 v194, v52, v53
    v_cvt_pk_bf16_f32 v195, v54, v55
    v_accvgpr_read_b32 v56, a48
    v_accvgpr_read_b32 v57, a49
    v_accvgpr_read_b32 v58, a50
    v_accvgpr_read_b32 v59, a51
    v_accvgpr_read_b32 v60, a52
    v_accvgpr_read_b32 v61, a53
    v_accvgpr_read_b32 v62, a54
    v_accvgpr_read_b32 v63, a55
    v_cvt_pk_bf16_f32 v196, v56, v57
    v_cvt_pk_bf16_f32 v197, v58, v59
    v_cvt_pk_bf16_f32 v198, v60, v61
    v_cvt_pk_bf16_f32 v199, v62, v63
    s_add_u32 s65, s65, s67
    buffer_store_dwordx4 v[160:163], v1, s[8:11], s65 offen offset:0 sc1
    v_accvgpr_read_b32 v48, a80
    v_accvgpr_read_b32 v49, a81
    v_accvgpr_read_b32 v50, a82
    v_accvgpr_read_b32 v51, a83
    v_accvgpr_read_b32 v52, a84
    v_accvgpr_read_b32 v53, a85
    v_accvgpr_read_b32 v54, a86
    v_accvgpr_read_b32 v55, a87
    v_cvt_pk_bf16_f32 v200, v48, v49
    v_cvt_pk_bf16_f32 v201, v50, v51
    v_cvt_pk_bf16_f32 v202, v52, v53
    v_cvt_pk_bf16_f32 v203, v54, v55
    v_accvgpr_read_b32 v56, a112
    v_accvgpr_read_b32 v57, a113
    v_accvgpr_read_b32 v58, a114
    v_accvgpr_read_b32 v59, a115
    v_accvgpr_read_b32 v60, a116
    v_accvgpr_read_b32 v61, a117
    v_accvgpr_read_b32 v62, a118
    v_accvgpr_read_b32 v63, a119
    v_cvt_pk_bf16_f32 v204, v56, v57
    v_cvt_pk_bf16_f32 v205, v58, v59
    v_cvt_pk_bf16_f32 v206, v60, v61
    v_cvt_pk_bf16_f32 v207, v62, v63
    buffer_store_dwordx4 v[164:167], v1, s[8:11], s65 offen offset:1024 sc1
    v_accvgpr_read_b32 v48, a144
    v_accvgpr_read_b32 v49, a145
    v_accvgpr_read_b32 v50, a146
    v_accvgpr_read_b32 v51, a147
    v_accvgpr_read_b32 v52, a148
    v_accvgpr_read_b32 v53, a149
    v_accvgpr_read_b32 v54, a150
    v_accvgpr_read_b32 v55, a151
    v_cvt_pk_bf16_f32 v208, v48, v49
    v_cvt_pk_bf16_f32 v209, v50, v51
    v_cvt_pk_bf16_f32 v210, v52, v53
    v_cvt_pk_bf16_f32 v211, v54, v55
    v_accvgpr_read_b32 v56, a176
    v_accvgpr_read_b32 v57, a177
    v_accvgpr_read_b32 v58, a178
    v_accvgpr_read_b32 v59, a179
    v_accvgpr_read_b32 v60, a180
    v_accvgpr_read_b32 v61, a181
    v_accvgpr_read_b32 v62, a182
    v_accvgpr_read_b32 v63, a183
    v_cvt_pk_bf16_f32 v212, v56, v57
    v_cvt_pk_bf16_f32 v213, v58, v59
    v_cvt_pk_bf16_f32 v214, v60, v61
    v_cvt_pk_bf16_f32 v215, v62, v63
    buffer_store_dwordx4 v[168:171], v1, s[8:11], s65 offen offset:2048 sc1
    v_accvgpr_read_b32 v48, a208
    v_accvgpr_read_b32 v49, a209
    v_accvgpr_read_b32 v50, a210
    v_accvgpr_read_b32 v51, a211
    v_accvgpr_read_b32 v52, a212
    v_accvgpr_read_b32 v53, a213
    v_accvgpr_read_b32 v54, a214
    v_accvgpr_read_b32 v55, a215
    v_cvt_pk_bf16_f32 v216, v48, v49
    v_cvt_pk_bf16_f32 v217, v50, v51
    v_cvt_pk_bf16_f32 v218, v52, v53
    v_cvt_pk_bf16_f32 v219, v54, v55
    v_accvgpr_read_b32 v56, a240
    v_accvgpr_read_b32 v57, a241
    v_accvgpr_read_b32 v58, a242
    v_accvgpr_read_b32 v59, a243
    v_accvgpr_read_b32 v60, a244
    v_accvgpr_read_b32 v61, a245
    v_accvgpr_read_b32 v62, a246
    v_accvgpr_read_b32 v63, a247
    v_cvt_pk_bf16_f32 v220, v56, v57
    v_cvt_pk_bf16_f32 v221, v58, v59
    v_cvt_pk_bf16_f32 v222, v60, v61
    v_cvt_pk_bf16_f32 v223, v62, v63
    buffer_store_dwordx4 v[172:175], v1, s[8:11], s65 offen offset:3072 sc1
    v_accvgpr_read_b32 v48, a24
    v_accvgpr_read_b32 v49, a25
    v_accvgpr_read_b32 v50, a26
    v_accvgpr_read_b32 v51, a27
    v_accvgpr_read_b32 v52, a28
    v_accvgpr_read_b32 v53, a29
    v_accvgpr_read_b32 v54, a30
    v_accvgpr_read_b32 v55, a31
    v_cvt_pk_bf16_f32 v224, v48, v49
    v_cvt_pk_bf16_f32 v225, v50, v51
    v_cvt_pk_bf16_f32 v226, v52, v53
    v_cvt_pk_bf16_f32 v227, v54, v55
    v_accvgpr_read_b32 v56, a56
    v_accvgpr_read_b32 v57, a57
    v_accvgpr_read_b32 v58, a58
    v_accvgpr_read_b32 v59, a59
    v_accvgpr_read_b32 v60, a60
    v_accvgpr_read_b32 v61, a61
    v_accvgpr_read_b32 v62, a62
    v_accvgpr_read_b32 v63, a63
    v_cvt_pk_bf16_f32 v228, v56, v57
    v_cvt_pk_bf16_f32 v229, v58, v59
    v_cvt_pk_bf16_f32 v230, v60, v61
    v_cvt_pk_bf16_f32 v231, v62, v63
    s_add_u32 s65, s65, s66
    buffer_store_dwordx4 v[176:179], v1, s[8:11], s65 offen offset:0 sc1
    v_accvgpr_read_b32 v48, a88
    v_accvgpr_read_b32 v49, a89
    v_accvgpr_read_b32 v50, a90
    v_accvgpr_read_b32 v51, a91
    v_accvgpr_read_b32 v52, a92
    v_accvgpr_read_b32 v53, a93
    v_accvgpr_read_b32 v54, a94
    v_accvgpr_read_b32 v55, a95
    v_cvt_pk_bf16_f32 v232, v48, v49
    v_cvt_pk_bf16_f32 v233, v50, v51
    v_cvt_pk_bf16_f32 v234, v52, v53
    v_cvt_pk_bf16_f32 v235, v54, v55
    v_accvgpr_read_b32 v56, a120
    v_accvgpr_read_b32 v57, a121
    v_accvgpr_read_b32 v58, a122
    v_accvgpr_read_b32 v59, a123
    v_accvgpr_read_b32 v60, a124
    v_accvgpr_read_b32 v61, a125
    v_accvgpr_read_b32 v62, a126
    v_accvgpr_read_b32 v63, a127
    v_cvt_pk_bf16_f32 v236, v56, v57
    v_cvt_pk_bf16_f32 v237, v58, v59
    v_cvt_pk_bf16_f32 v238, v60, v61
    v_cvt_pk_bf16_f32 v239, v62, v63
    buffer_store_dwordx4 v[180:183], v1, s[8:11], s65 offen offset:1024 sc1
    v_accvgpr_read_b32 v48, a152
    v_accvgpr_read_b32 v49, a153
    v_accvgpr_read_b32 v50, a154
    v_accvgpr_read_b32 v51, a155
    v_accvgpr_read_b32 v52, a156
    v_accvgpr_read_b32 v53, a157
    v_accvgpr_read_b32 v54, a158
    v_accvgpr_read_b32 v55, a159
    v_cvt_pk_bf16_f32 v240, v48, v49
    v_cvt_pk_bf16_f32 v241, v50, v51
    v_cvt_pk_bf16_f32 v242, v52, v53
    v_cvt_pk_bf16_f32 v243, v54, v55
    v_accvgpr_read_b32 v56, a184
    v_accvgpr_read_b32 v57, a185
    v_accvgpr_read_b32 v58, a186
    v_accvgpr_read_b32 v59, a187
    v_accvgpr_read_b32 v60, a188
    v_accvgpr_read_b32 v61, a189
    v_accvgpr_read_b32 v62, a190
    v_accvgpr_read_b32 v63, a191
    v_cvt_pk_bf16_f32 v244, v56, v57
    v_cvt_pk_bf16_f32 v245, v58, v59
    v_cvt_pk_bf16_f32 v246, v60, v61
    v_cvt_pk_bf16_f32 v247, v62, v63
    buffer_store_dwordx4 v[184:187], v1, s[8:11], s65 offen offset:2048 sc1
    v_accvgpr_read_b32 v48, a216
    v_accvgpr_read_b32 v49, a217
    v_accvgpr_read_b32 v50, a218
    v_accvgpr_read_b32 v51, a219
    v_accvgpr_read_b32 v52, a220
    v_accvgpr_read_b32 v53, a221
    v_accvgpr_read_b32 v54, a222
    v_accvgpr_read_b32 v55, a223
    v_cvt_pk_bf16_f32 v248, v48, v49
    v_cvt_pk_bf16_f32 v249, v50, v51
    v_cvt_pk_bf16_f32 v250, v52, v53
    v_cvt_pk_bf16_f32 v251, v54, v55
    v_accvgpr_read_b32 v56, a248
    v_accvgpr_read_b32 v57, a249
    v_accvgpr_read_b32 v58, a250
    v_accvgpr_read_b32 v59, a251
    v_accvgpr_read_b32 v60, a252
    v_accvgpr_read_b32 v61, a253
    v_accvgpr_read_b32 v62, a254
    v_accvgpr_read_b32 v63, a255
    v_cvt_pk_bf16_f32 v252, v56, v57
    v_cvt_pk_bf16_f32 v253, v58, v59
    v_cvt_pk_bf16_f32 v254, v60, v61
    v_cvt_pk_bf16_f32 v255, v62, v63
    buffer_store_dwordx4 v[188:191], v1, s[8:11], s65 offen offset:3072 sc1
LP_START:
    s_waitcnt lgkmcnt(0)
    v_mfma_f32_16x16x32_bf16 a[0:3], v[80:83], v[64:67], 0
    ds_read_b128 a[176:179], v5 offset:0
    s_mov_b32 m0, s60
    v_mfma_f32_16x16x32_bf16 a[16:19], v[84:87], v[64:67], 0
    ds_read_b128 a[180:183], v5 offset:2048
    v_mfma_f32_16x16x32_bf16 a[20:23], v[84:87], v[68:71], 0
    buffer_load_dwordx4 v14, s[32:35], s52 offen lds
    v_mfma_f32_16x16x32_bf16 a[4:7], v[80:83], v[68:71], 0
    ds_read_b128 a[184:187], v5 offset:4096
    s_add_u32 m0, m0, 2048
    v_mfma_f32_16x16x32_bf16 a[8:11], v[80:83], v[72:75], 0
    ds_read_b128 a[188:191], v5 offset:6144
    s_add_u32 s52, s52, s54
    v_mfma_f32_16x16x32_bf16 a[24:27], v[84:87], v[72:75], 0
    buffer_load_dwordx4 v14, s[32:35], s52 offen lds
    v_mfma_f32_16x16x32_bf16 a[28:31], v[84:87], v[76:79], 0
    ds_read_b64_tr_b16 a[192:193], v6 offset:16384
    s_add_u32 s65, s65, s67
    v_mfma_f32_16x16x32_bf16 a[12:15], v[80:83], v[76:79], 0
    ds_read_b64_tr_b16 a[194:195], v6 offset:18432
    v_mfma_f32_16x16x32_bf16 a[44:47], v[88:91], v[76:79], 0
    buffer_store_dwordx4 v[192:195], v1, s[8:11], s65 offen offset:0 sc1
    v_mfma_f32_16x16x32_bf16 a[60:63], v[92:95], v[76:79], 0
    ds_read_b64_tr_b16 a[196:197], v7 offset:16384
    s_add_u32 m0, m0, 2048
    v_mfma_f32_16x16x32_bf16 a[56:59], v[92:95], v[72:75], 0
    ds_read_b64_tr_b16 a[198:199], v7 offset:18432
    s_add_u32 s52, s52, s55
    v_mfma_f32_16x16x32_bf16 a[40:43], v[88:91], v[72:75], 0
    buffer_load_dwordx4 v14, s[32:35], s52 offen lds
    v_mfma_f32_16x16x32_bf16 a[36:39], v[88:91], v[68:71], 0
    ds_read_b64_tr_b16 a[200:201], v8 offset:16384
    s_add_u32 m0, m0, 2048
    v_mfma_f32_16x16x32_bf16 a[52:55], v[92:95], v[68:71], 0
    ds_read_b64_tr_b16 a[202:203], v8 offset:18432
    s_add_u32 s52, s52, s54
    v_mfma_f32_16x16x32_bf16 a[48:51], v[92:95], v[64:67], 0
    buffer_load_dwordx4 v14, s[32:35], s52 offen lds
    v_mfma_f32_16x16x32_bf16 a[32:35], v[88:91], v[64:67], 0
    ds_read_b64_tr_b16 a[204:205], v9 offset:16384
    v_mfma_f32_16x16x32_bf16 a[64:67], v[96:99], v[64:67], 0
    ds_read_b64_tr_b16 a[206:207], v9 offset:18432
    v_mfma_f32_16x16x32_bf16 a[80:83], v[100:103], v[64:67], 0
    buffer_store_dwordx4 v[196:199], v1, s[8:11], s65 offen offset:1024 sc1
    v_mfma_f32_16x16x32_bf16 a[84:87], v[100:103], v[68:71], 0
    ds_read_b64_tr_b16 a[208:209], v10 offset:16384
    s_add_u32 m0, m0, 2048
    v_mfma_f32_16x16x32_bf16 a[68:71], v[96:99], v[68:71], 0
    ds_read_b64_tr_b16 a[210:211], v10 offset:18432
    s_add_u32 s52, s52, s55
    v_mfma_f32_16x16x32_bf16 a[72:75], v[96:99], v[72:75], 0
    buffer_load_dwordx4 v14, s[32:35], s52 offen lds
    v_mfma_f32_16x16x32_bf16 a[88:91], v[100:103], v[72:75], 0
    ds_read_b64_tr_b16 a[212:213], v11 offset:16384
    s_add_u32 m0, m0, 2048
    v_mfma_f32_16x16x32_bf16 a[92:95], v[100:103], v[76:79], 0
    ds_read_b64_tr_b16 a[214:215], v11 offset:18432
    s_add_u32 s52, s52, s54
    v_mfma_f32_16x16x32_bf16 a[76:79], v[96:99], v[76:79], 0
    buffer_load_dwordx4 v14, s[32:35], s52 offen lds
    v_mfma_f32_16x16x32_bf16 a[108:111], v[104:107], v[76:79], 0
    ds_read_b64_tr_b16 a[216:217], v12 offset:16384
    v_mfma_f32_16x16x32_bf16 a[124:127], v[108:111], v[76:79], 0
    ds_read_b64_tr_b16 a[218:219], v12 offset:18432
    v_mfma_f32_16x16x32_bf16 a[120:123], v[108:111], v[72:75], 0
    buffer_store_dwordx4 v[200:203], v1, s[8:11], s65 offen offset:2048 sc1
    v_mfma_f32_16x16x32_bf16 a[104:107], v[104:107], v[72:75], 0
    ds_read_b64_tr_b16 a[220:221], v13 offset:16384
    s_add_u32 m0, m0, 2048
    v_mfma_f32_16x16x32_bf16 a[100:103], v[104:107], v[68:71], 0
    ds_read_b64_tr_b16 a[222:223], v13 offset:18432
    s_add_u32 s52, s52, s55
    v_mfma_f32_16x16x32_bf16 a[116:119], v[108:111], v[68:71], 0
    buffer_load_dwordx4 v14, s[32:35], s52 offen lds
    v_mfma_f32_16x16x32_bf16 a[112:115], v[108:111], v[64:67], 0
    ds_read_b64_tr_b16 a[224:225], v27 offset:8192
    s_add_u32 m0, m0, 2048
    v_mfma_f32_16x16x32_bf16 a[96:99], v[104:107], v[64:67], 0
    ds_read_b64_tr_b16 a[226:227], v27 offset:10240
    s_add_u32 s52, s52, s54
    v_mfma_f32_16x16x32_bf16 a[128:131], v[112:115], v[64:67], 0
    buffer_load_dwordx4 v14, s[32:35], s52 offen lds
    v_mfma_f32_16x16x32_bf16 a[132:135], v[112:115], v[68:71], 0
    ds_read_b64_tr_b16 a[228:229], v28 offset:8192
    v_mfma_f32_16x16x32_bf16 a[136:139], v[112:115], v[72:75], 0
    ds_read_b64_tr_b16 a[230:231], v28 offset:10240
    v_mfma_f32_16x16x32_bf16 a[140:143], v[112:115], v[76:79], 0
    buffer_store_dwordx4 v[204:207], v1, s[8:11], s65 offen offset:3072 sc1
    v_mfma_f32_16x16x32_bf16 a[144:147], v[116:119], v[64:67], 0
    ds_read_b64_tr_b16 a[232:233], v29 offset:8192
    s_add_u32 s52, s52, s56
    v_mfma_f32_16x16x32_bf16 a[148:151], v[116:119], v[68:71], 0
    ds_read_b64_tr_b16 a[234:235], v29 offset:10240
    s_add_u32 s60, s60, 32768
    v_mfma_f32_16x16x32_bf16 a[152:155], v[116:119], v[72:75], 0
    s_cmp_ge_u32 s60, 163840
    v_add_u32 v4, 131072, v22
    v_add_u32 v5, 131072, v23
    v_mfma_f32_16x16x32_bf16 a[156:159], v[116:119], v[76:79], 0
    s_cselect_b32 s60, s62, s60
    v_add_u32 v27, 131072, v24
    v_add_u32 v28, 131072, v25
    v_mfma_f32_16x16x32_bf16 a[160:163], v[64:67], v[120:123], 0
    v_add_u32 v29, 131072, v26
    v_xor_b32 v6, 0x8000, v6
    v_mfma_f32_16x16x32_bf16 a[164:167], v[68:71], v[120:123], 0
    v_xor_b32 v7, 0x8000, v7
    v_xor_b32 v8, 0x8000, v8
    v_mfma_f32_16x16x32_bf16 a[168:171], v[72:75], v[120:123], 0
    v_xor_b32 v9, 0x8000, v9
    v_xor_b32 v10, 0x8000, v10
    v_mfma_f32_16x16x32_bf16 a[172:175], v[76:79], v[120:123], 0
    v_xor_b32 v11, 0x8000, v11
    v_xor_b32 v12, 0x8000, v12
    v_xor_b32 v13, 0x8000, v13
    s_waitcnt vmcnt(12) lgkmcnt(0)
    s_barrier
    v_mfma_f32_16x16x32_bf16 a[0:3], a[192:195], a[176:179], a[0:3]
    ds_read_b128 v[64:67], v4 offset:0
    s_mov_b32 m0, s61
    v_mfma_f32_16x16x32_bf16 a[16:19], a[196:199], a[176:179], a[16:19]
    ds_read_b128 v[68:71], v4 offset:2048
    v_mfma_f32_16x16x32_bf16 a[20:23], a[196:199], a[180:183], a[20:23]
    buffer_load_dwordx4 v15, s[36:39], s53 offen lds
    v_mfma_f32_16x16x32_bf16 a[4:7], a[192:195], a[180:183], a[4:7]
    ds_read_b128 v[72:75], v4 offset:4096
    s_add_u32 m0, m0, 2048
    v_mfma_f32_16x16x32_bf16 a[8:11], a[192:195], a[184:187], a[8:11]
    ds_read_b128 v[76:79], v4 offset:6144
    s_add_u32 s53, s53, 32768
    v_mfma_f32_16x16x32_bf16 a[24:27], a[196:199], a[184:187], a[24:27]
    buffer_load_dwordx4 v15, s[36:39], s53 offen lds
    v_mfma_f32_16x16x32_bf16 a[28:31], a[196:199], a[188:191], a[28:31]
    ds_read_b64_tr_b16 v[80:81], v6 offset:0
    s_add_u32 s65, s65, s66
    v_mfma_f32_16x16x32_bf16 a[12:15], a[192:195], a[188:191], a[12:15]
    ds_read_b64_tr_b16 v[82:83], v6 offset:2048
    v_mfma_f32_16x16x32_bf16 a[44:47], a[200:203], a[188:191], a[44:47]
    buffer_store_dwordx4 v[208:211], v1, s[8:11], s65 offen offset:0 sc1
    v_mfma_f32_16x16x32_bf16 a[60:63], a[204:207], a[188:191], a[60:63]
    ds_read_b64_tr_b16 v[84:85], v7 offset:0
    s_add_u32 m0, m0, 6144
    v_mfma_f32_16x16x32_bf16 a[56:59], a[204:207], a[184:187], a[56:59]
    ds_read_b64_tr_b16 v[86:87], v7 offset:2048
    s_add_u32 s53, s53, 98304
    v_mfma_f32_16x16x32_bf16 a[40:43], a[200:203], a[184:187], a[40:43]
    buffer_load_dwordx4 v15, s[36:39], s53 offen lds
    v_mfma_f32_16x16x32_bf16 a[36:39], a[200:203], a[180:183], a[36:39]
    ds_read_b64_tr_b16 v[88:89], v8 offset:0
    s_add_u32 m0, m0, 2048
    v_mfma_f32_16x16x32_bf16 a[52:55], a[204:207], a[180:183], a[52:55]
    ds_read_b64_tr_b16 v[90:91], v8 offset:2048
    s_add_u32 s53, s53, 32768
    v_mfma_f32_16x16x32_bf16 a[48:51], a[204:207], a[176:179], a[48:51]
    buffer_load_dwordx4 v15, s[36:39], s53 offen lds
    v_mfma_f32_16x16x32_bf16 a[32:35], a[200:203], a[176:179], a[32:35]
    ds_read_b64_tr_b16 v[92:93], v9 offset:0
    v_mfma_f32_16x16x32_bf16 a[64:67], a[208:211], a[176:179], a[64:67]
    ds_read_b64_tr_b16 v[94:95], v9 offset:2048
    v_mfma_f32_16x16x32_bf16 a[80:83], a[212:215], a[176:179], a[80:83]
    buffer_store_dwordx4 v[212:215], v1, s[8:11], s65 offen offset:1024 sc1
    v_mfma_f32_16x16x32_bf16 a[84:87], a[212:215], a[180:183], a[84:87]
    ds_read_b64_tr_b16 v[96:97], v10 offset:0
    s_add_u32 m0, m0, 6144
    v_mfma_f32_16x16x32_bf16 a[68:71], a[208:211], a[180:183], a[68:71]
    ds_read_b64_tr_b16 v[98:99], v10 offset:2048
    s_add_u32 s53, s53, 98304
    v_mfma_f32_16x16x32_bf16 a[72:75], a[208:211], a[184:187], a[72:75]
    buffer_load_dwordx4 v15, s[36:39], s53 offen lds
    v_mfma_f32_16x16x32_bf16 a[88:91], a[212:215], a[184:187], a[88:91]
    ds_read_b64_tr_b16 v[100:101], v11 offset:0
    s_add_u32 m0, m0, 2048
    v_mfma_f32_16x16x32_bf16 a[92:95], a[212:215], a[188:191], a[92:95]
    ds_read_b64_tr_b16 v[102:103], v11 offset:2048
    s_add_u32 s53, s53, 32768
    v_mfma_f32_16x16x32_bf16 a[76:79], a[208:211], a[188:191], a[76:79]
    buffer_load_dwordx4 v15, s[36:39], s53 offen lds
    v_mfma_f32_16x16x32_bf16 a[108:111], a[216:219], a[188:191], a[108:111]
    ds_read_b64_tr_b16 v[104:105], v12 offset:0
    v_mfma_f32_16x16x32_bf16 a[124:127], a[220:223], a[188:191], a[124:127]
    ds_read_b64_tr_b16 v[106:107], v12 offset:2048
    v_mfma_f32_16x16x32_bf16 a[120:123], a[220:223], a[184:187], a[120:123]
    buffer_store_dwordx4 v[216:219], v1, s[8:11], s65 offen offset:2048 sc1
    v_mfma_f32_16x16x32_bf16 a[104:107], a[216:219], a[184:187], a[104:107]
    ds_read_b64_tr_b16 v[108:109], v13 offset:0
    s_add_u32 m0, m0, 6144
    v_mfma_f32_16x16x32_bf16 a[100:103], a[216:219], a[180:183], a[100:103]
    ds_read_b64_tr_b16 v[110:111], v13 offset:2048
    s_add_u32 s53, s53, 98304
    v_mfma_f32_16x16x32_bf16 a[116:119], a[220:223], a[180:183], a[116:119]
    buffer_load_dwordx4 v15, s[36:39], s53 offen lds
    v_mfma_f32_16x16x32_bf16 a[112:115], a[220:223], a[176:179], a[112:115]
    ds_read_b64_tr_b16 v[112:113], v27 offset:0
    s_add_u32 m0, m0, 2048
    v_mfma_f32_16x16x32_bf16 a[96:99], a[216:219], a[176:179], a[96:99]
    ds_read_b64_tr_b16 v[114:115], v27 offset:2048
    s_add_u32 s53, s53, 32768
    v_mfma_f32_16x16x32_bf16 a[128:131], a[224:227], a[176:179], a[128:131]
    buffer_load_dwordx4 v15, s[36:39], s53 offen lds
    v_mfma_f32_16x16x32_bf16 a[132:135], a[224:227], a[180:183], a[132:135]
    ds_read_b64_tr_b16 v[116:117], v28 offset:0
    v_mfma_f32_16x16x32_bf16 a[136:139], a[224:227], a[184:187], a[136:139]
    ds_read_b64_tr_b16 v[118:119], v28 offset:2048
    v_mfma_f32_16x16x32_bf16 a[140:143], a[224:227], a[188:191], a[140:143]
    buffer_store_dwordx4 v[220:223], v1, s[8:11], s65 offen offset:3072 sc1
    v_mfma_f32_16x16x32_bf16 a[144:147], a[228:231], a[176:179], a[144:147]
    ds_read_b64_tr_b16 v[120:121], v29 offset:0
    s_add_u32 s53, s53, 98304
    v_mfma_f32_16x16x32_bf16 a[148:151], a[228:231], a[180:183], a[148:151]
    ds_read_b64_tr_b16 v[122:123], v29 offset:2048
    s_xor_b32 s61, s61, 32768
    v_mfma_f32_16x16x32_bf16 a[152:155], a[228:231], a[184:187], a[152:155]
    v_mfma_f32_16x16x32_bf16 a[156:159], a[228:231], a[188:191], a[156:159]
    v_mfma_f32_16x16x32_bf16 a[160:163], a[176:179], a[232:235], a[160:163]
    v_mfma_f32_16x16x32_bf16 a[164:167], a[180:183], a[232:235], a[164:167]
    v_mfma_f32_16x16x32_bf16 a[168:171], a[184:187], a[232:235], a[168:171]
    v_mfma_f32_16x16x32_bf16 a[172:175], a[188:191], a[232:235], a[172:175]
    s_waitcnt lgkmcnt(0)
    v_mfma_f32_16x16x32_bf16 a[0:3], v[80:83], v[64:67], a[0:3]
    ds_read_b128 a[176:179], v5 offset:0
    s_mov_b32 m0, s60
    v_mfma_f32_16x16x32_bf16 a[16:19], v[84:87], v[64:67], a[16:19]
    ds_read_b128 a[180:183], v5 offset:2048
    v_mfma_f32_16x16x32_bf16 a[20:23], v[84:87], v[68:71], a[20:23]
    buffer_load_dwordx4 v14, s[32:35], s52 offen lds
    v_mfma_f32_16x16x32_bf16 a[4:7], v[80:83], v[68:71], a[4:7]
    ds_read_b128 a[184:187], v5 offset:4096
    s_add_u32 m0, m0, 2048
    v_mfma_f32_16x16x32_bf16 a[8:11], v[80:83], v[72:75], a[8:11]
    ds_read_b128 a[188:191], v5 offset:6144
    s_add_u32 s52, s52, s54
    v_mfma_f32_16x16x32_bf16 a[24:27], v[84:87], v[72:75], a[24:27]
    buffer_load_dwordx4 v14, s[32:35], s52 offen lds
    v_mfma_f32_16x16x32_bf16 a[28:31], v[84:87], v[76:79], a[28:31]
    ds_read_b64_tr_b16 a[192:193], v6 offset:16384
    s_add_u32 s65, s65, s67
    v_mfma_f32_16x16x32_bf16 a[12:15], v[80:83], v[76:79], a[12:15]
    ds_read_b64_tr_b16 a[194:195], v6 offset:18432
    v_mfma_f32_16x16x32_bf16 a[44:47], v[88:91], v[76:79], a[44:47]
    buffer_store_dwordx4 v[224:227], v1, s[8:11], s65 offen offset:0 sc1
    v_mfma_f32_16x16x32_bf16 a[60:63], v[92:95], v[76:79], a[60:63]
    ds_read_b64_tr_b16 a[196:197], v7 offset:16384
    s_add_u32 m0, m0, 2048
    v_mfma_f32_16x16x32_bf16 a[56:59], v[92:95], v[72:75], a[56:59]
    ds_read_b64_tr_b16 a[198:199], v7 offset:18432
    s_add_u32 s52, s52, s55
    v_mfma_f32_16x16x32_bf16 a[40:43], v[88:91], v[72:75], a[40:43]
    buffer_load_dwordx4 v14, s[32:35], s52 offen lds
    v_mfma_f32_16x16x32_bf16 a[36:39], v[88:91], v[68:71], a[36:39]
    ds_read_b64_tr_b16 a[200:201], v8 offset:16384
    s_add_u32 m0, m0, 2048
    v_mfma_f32_16x16x32_bf16 a[52:55], v[92:95], v[68:71], a[52:55]
    ds_read_b64_tr_b16 a[202:203], v8 offset:18432
    s_add_u32 s52, s52, s54
    v_mfma_f32_16x16x32_bf16 a[48:51], v[92:95], v[64:67], a[48:51]
    buffer_load_dwordx4 v14, s[32:35], s52 offen lds
    v_mfma_f32_16x16x32_bf16 a[32:35], v[88:91], v[64:67], a[32:35]
    ds_read_b64_tr_b16 a[204:205], v9 offset:16384
    v_mfma_f32_16x16x32_bf16 a[64:67], v[96:99], v[64:67], a[64:67]
    ds_read_b64_tr_b16 a[206:207], v9 offset:18432
    v_mfma_f32_16x16x32_bf16 a[80:83], v[100:103], v[64:67], a[80:83]
    buffer_store_dwordx4 v[228:231], v1, s[8:11], s65 offen offset:1024 sc1
    v_mfma_f32_16x16x32_bf16 a[84:87], v[100:103], v[68:71], a[84:87]
    ds_read_b64_tr_b16 a[208:209], v10 offset:16384
    s_add_u32 m0, m0, 2048
    v_mfma_f32_16x16x32_bf16 a[68:71], v[96:99], v[68:71], a[68:71]
    ds_read_b64_tr_b16 a[210:211], v10 offset:18432
    s_add_u32 s52, s52, s55
    v_mfma_f32_16x16x32_bf16 a[72:75], v[96:99], v[72:75], a[72:75]
    buffer_load_dwordx4 v14, s[32:35], s52 offen lds
    v_mfma_f32_16x16x32_bf16 a[88:91], v[100:103], v[72:75], a[88:91]
    ds_read_b64_tr_b16 a[212:213], v11 offset:16384
    s_add_u32 m0, m0, 2048
    v_mfma_f32_16x16x32_bf16 a[92:95], v[100:103], v[76:79], a[92:95]
    ds_read_b64_tr_b16 a[214:215], v11 offset:18432
    s_add_u32 s52, s52, s54
    v_mfma_f32_16x16x32_bf16 a[76:79], v[96:99], v[76:79], a[76:79]
    buffer_load_dwordx4 v14, s[32:35], s52 offen lds
    v_mfma_f32_16x16x32_bf16 a[108:111], v[104:107], v[76:79], a[108:111]
    ds_read_b64_tr_b16 a[216:217], v12 offset:16384
    v_mfma_f32_16x16x32_bf16 a[124:127], v[108:111], v[76:79], a[124:127]
    ds_read_b64_tr_b16 a[218:219], v12 offset:18432
    v_mfma_f32_16x16x32_bf16 a[120:123], v[108:111], v[72:75], a[120:123]
    buffer_store_dwordx4 v[232:235], v1, s[8:11], s65 offen offset:2048 sc1
    v_mfma_f32_16x16x32_bf16 a[104:107], v[104:107], v[72:75], a[104:107]
    ds_read_b64_tr_b16 a[220:221], v13 offset:16384
    s_add_u32 m0, m0, 2048
    v_mfma_f32_16x16x32_bf16 a[100:103], v[104:107], v[68:71], a[100:103]
    ds_read_b64_tr_b16 a[222:223], v13 offset:18432
    s_add_u32 s52, s52, s55
    v_mfma_f32_16x16x32_bf16 a[116:119], v[108:111], v[68:71], a[116:119]
    buffer_load_dwordx4 v14, s[32:35], s52 offen lds
    v_mfma_f32_16x16x32_bf16 a[112:115], v[108:111], v[64:67], a[112:115]
    ds_read_b64_tr_b16 a[224:225], v27 offset:8192
    s_add_u32 m0, m0, 2048
    v_mfma_f32_16x16x32_bf16 a[96:99], v[104:107], v[64:67], a[96:99]
    ds_read_b64_tr_b16 a[226:227], v27 offset:10240
    s_add_u32 s52, s52, s54
    v_mfma_f32_16x16x32_bf16 a[128:131], v[112:115], v[64:67], a[128:131]
    buffer_load_dwordx4 v14, s[32:35], s52 offen lds
    v_mfma_f32_16x16x32_bf16 a[132:135], v[112:115], v[68:71], a[132:135]
    ds_read_b64_tr_b16 a[228:229], v28 offset:8192
    v_mfma_f32_16x16x32_bf16 a[136:139], v[112:115], v[72:75], a[136:139]
    ds_read_b64_tr_b16 a[230:231], v28 offset:10240
    v_mfma_f32_16x16x32_bf16 a[140:143], v[112:115], v[76:79], a[140:143]
    buffer_store_dwordx4 v[236:239], v1, s[8:11], s65 offen offset:3072 sc1
    v_mfma_f32_16x16x32_bf16 a[144:147], v[116:119], v[64:67], a[144:147]
    ds_read_b64_tr_b16 a[232:233], v29 offset:8192
    s_add_u32 s52, s52, s56
    v_mfma_f32_16x16x32_bf16 a[148:151], v[116:119], v[68:71], a[148:151]
    ds_read_b64_tr_b16 a[234:235], v29 offset:10240
    s_add_u32 s60, s60, 32768
    v_mfma_f32_16x16x32_bf16 a[152:155], v[116:119], v[72:75], a[152:155]
    s_cmp_ge_u32 s60, 163840
    v_add_u32 v4, 65536, v22
    v_add_u32 v5, 65536, v23
    v_mfma_f32_16x16x32_bf16 a[156:159], v[116:119], v[76:79], a[156:159]
    s_cselect_b32 s60, s62, s60
    v_add_u32 v27, 65536, v24
    v_add_u32 v28, 65536, v25
    v_mfma_f32_16x16x32_bf16 a[160:163], v[64:67], v[120:123], a[160:163]
    v_add_u32 v29, 65536, v26
    v_xor_b32 v6, 0x8000, v6
    v_mfma_f32_16x16x32_bf16 a[164:167], v[68:71], v[120:123], a[164:167]
    v_xor_b32 v7, 0x8000, v7
    v_xor_b32 v8, 0x8000, v8
    v_mfma_f32_16x16x32_bf16 a[168:171], v[72:75], v[120:123], a[168:171]
    v_xor_b32 v9, 0x8000, v9
    v_xor_b32 v10, 0x8000, v10
    v_mfma_f32_16x16x32_bf16 a[172:175], v[76:79], v[120:123], a[172:175]
    v_xor_b32 v11, 0x8000, v11
    v_xor_b32 v12, 0x8000, v12
    v_xor_b32 v13, 0x8000, v13
    s_waitcnt vmcnt(12) lgkmcnt(0)
    s_barrier
    v_mfma_f32_16x16x32_bf16 a[0:3], a[192:195], a[176:179], a[0:3]
    ds_read_b128 v[64:67], v4 offset:0
    s_mov_b32 m0, s61
    v_mfma_f32_16x16x32_bf16 a[16:19], a[196:199], a[176:179], a[16:19]
    ds_read_b128 v[68:71], v4 offset:2048
    v_mfma_f32_16x16x32_bf16 a[20:23], a[196:199], a[180:183], a[20:23]
    buffer_load_dwordx4 v15, s[36:39], s53 offen lds
    v_mfma_f32_16x16x32_bf16 a[4:7], a[192:195], a[180:183], a[4:7]
    ds_read_b128 v[72:75], v4 offset:4096
    s_add_u32 m0, m0, 2048
    v_mfma_f32_16x16x32_bf16 a[8:11], a[192:195], a[184:187], a[8:11]
    ds_read_b128 v[76:79], v4 offset:6144
    s_add_u32 s53, s53, 32768
    v_mfma_f32_16x16x32_bf16 a[24:27], a[196:199], a[184:187], a[24:27]
    buffer_load_dwordx4 v15, s[36:39], s53 offen lds
    v_mfma_f32_16x16x32_bf16 a[28:31], a[196:199], a[188:191], a[28:31]
    ds_read_b64_tr_b16 v[80:81], v6 offset:0
    s_add_u32 s65, s65, s66
    v_mfma_f32_16x16x32_bf16 a[12:15], a[192:195], a[188:191], a[12:15]
    ds_read_b64_tr_b16 v[82:83], v6 offset:2048
    v_mfma_f32_16x16x32_bf16 a[44:47], a[200:203], a[188:191], a[44:47]
    buffer_store_dwordx4 v[240:243], v1, s[8:11], s65 offen offset:0 sc1
    v_mfma_f32_16x16x32_bf16 a[60:63], a[204:207], a[188:191], a[60:63]
    ds_read_b64_tr_b16 v[84:85], v7 offset:0
    s_add_u32 m0, m0, 6144
    v_mfma_f32_16x16x32_bf16 a[56:59], a[204:207], a[184:187], a[56:59]
    ds_read_b64_tr_b16 v[86:87], v7 offset:2048
    s_add_u32 s53, s53, 98304
    v_mfma_f32_16x16x32_bf16 a[40:43], a[200:203], a[184:187], a[40:43]
    buffer_load_dwordx4 v15, s[36:39], s53 offen lds
    v_mfma_f32_16x16x32_bf16 a[36:39], a[200:203], a[180:183], a[36:39]
    ds_read_b64_tr_b16 v[88:89], v8 offset:0
    s_add_u32 m0, m0, 2048
    v_mfma_f32_16x16x32_bf16 a[52:55], a[204:207], a[180:183], a[52:55]
    ds_read_b64_tr_b16 v[90:91], v8 offset:2048
    s_add_u32 s53, s53, 32768
    v_mfma_f32_16x16x32_bf16 a[48:51], a[204:207], a[176:179], a[48:51]
    buffer_load_dwordx4 v15, s[36:39], s53 offen lds
    v_mfma_f32_16x16x32_bf16 a[32:35], a[200:203], a[176:179], a[32:35]
    ds_read_b64_tr_b16 v[92:93], v9 offset:0
    v_mfma_f32_16x16x32_bf16 a[64:67], a[208:211], a[176:179], a[64:67]
    ds_read_b64_tr_b16 v[94:95], v9 offset:2048
    v_mfma_f32_16x16x32_bf16 a[80:83], a[212:215], a[176:179], a[80:83]
    buffer_store_dwordx4 v[244:247], v1, s[8:11], s65 offen offset:1024 sc1
    v_mfma_f32_16x16x32_bf16 a[84:87], a[212:215], a[180:183], a[84:87]
    ds_read_b64_tr_b16 v[96:97], v10 offset:0
    s_add_u32 m0, m0, 6144
    v_mfma_f32_16x16x32_bf16 a[68:71], a[208:211], a[180:183], a[68:71]
    ds_read_b64_tr_b16 v[98:99], v10 offset:2048
    s_add_u32 s53, s53, 98304
    v_mfma_f32_16x16x32_bf16 a[72:75], a[208:211], a[184:187], a[72:75]
    buffer_load_dwordx4 v15, s[36:39], s53 offen lds
    v_mfma_f32_16x16x32_bf16 a[88:91], a[212:215], a[184:187], a[88:91]
    ds_read_b64_tr_b16 v[100:101], v11 offset:0
    s_add_u32 m0, m0, 2048
    v_mfma_f32_16x16x32_bf16 a[92:95], a[212:215], a[188:191], a[92:95]
    ds_read_b64_tr_b16 v[102:103], v11 offset:2048
    s_add_u32 s53, s53, 32768
    v_mfma_f32_16x16x32_bf16 a[76:79], a[208:211], a[188:191], a[76:79]
    buffer_load_dwordx4 v15, s[36:39], s53 offen lds
    v_mfma_f32_16x16x32_bf16 a[108:111], a[216:219], a[188:191], a[108:111]
    ds_read_b64_tr_b16 v[104:105], v12 offset:0
    v_mfma_f32_16x16x32_bf16 a[124:127], a[220:223], a[188:191], a[124:127]
    ds_read_b64_tr_b16 v[106:107], v12 offset:2048
    v_mfma_f32_16x16x32_bf16 a[120:123], a[220:223], a[184:187], a[120:123]
    buffer_store_dwordx4 v[248:251], v1, s[8:11], s65 offen offset:2048 sc1
    v_mfma_f32_16x16x32_bf16 a[104:107], a[216:219], a[184:187], a[104:107]
    ds_read_b64_tr_b16 v[108:109], v13 offset:0
    s_add_u32 m0, m0, 6144
    v_mfma_f32_16x16x32_bf16 a[100:103], a[216:219], a[180:183], a[100:103]
    ds_read_b64_tr_b16 v[110:111], v13 offset:2048
    s_add_u32 s53, s53, 98304
    v_mfma_f32_16x16x32_bf16 a[116:119], a[220:223], a[180:183], a[116:119]
    buffer_load_dwordx4 v15, s[36:39], s53 offen lds
    v_mfma_f32_16x16x32_bf16 a[112:115], a[220:223], a[176:179], a[112:115]
    ds_read_b64_tr_b16 v[112:113], v27 offset:0
    s_add_u32 m0, m0, 2048
    v_mfma_f32_16x16x32_bf16 a[96:99], a[216:219], a[176:179], a[96:99]
    ds_read_b64_tr_b16 v[114:115], v27 offset:2048
    s_add_u32 s53, s53, 32768
    v_mfma_f32_16x16x32_bf16 a[128:131], a[224:227], a[176:179], a[128:131]
    buffer_load_dwordx4 v15, s[36:39], s53 offen lds
    v_mfma_f32_16x16x32_bf16 a[132:135], a[224:227], a[180:183], a[132:135]
    ds_read_b64_tr_b16 v[116:117], v28 offset:0
    v_mfma_f32_16x16x32_bf16 a[136:139], a[224:227], a[184:187], a[136:139]
    ds_read_b64_tr_b16 v[118:119], v28 offset:2048
    v_mfma_f32_16x16x32_bf16 a[140:143], a[224:227], a[188:191], a[140:143]
    buffer_store_dwordx4 v[252:255], v1, s[8:11], s65 offen offset:3072 sc1
    v_mfma_f32_16x16x32_bf16 a[144:147], a[228:231], a[176:179], a[144:147]
    ds_read_b64_tr_b16 v[120:121], v29 offset:0
    s_add_u32 s53, s53, 98304
    v_mfma_f32_16x16x32_bf16 a[148:151], a[228:231], a[180:183], a[148:151]
    ds_read_b64_tr_b16 v[122:123], v29 offset:2048
    s_xor_b32 s61, s61, 32768
    v_mfma_f32_16x16x32_bf16 a[152:155], a[228:231], a[184:187], a[152:155]
    v_mfma_f32_16x16x32_bf16 a[156:159], a[228:231], a[188:191], a[156:159]
    v_mfma_f32_16x16x32_bf16 a[160:163], a[176:179], a[232:235], a[160:163]
    v_mfma_f32_16x16x32_bf16 a[164:167], a[180:183], a[232:235], a[164:167]
    v_mfma_f32_16x16x32_bf16 a[168:171], a[184:187], a[232:235], a[168:171]
    v_mfma_f32_16x16x32_bf16 a[172:175], a[188:191], a[232:235], a[172:175]
    s_waitcnt lgkmcnt(0)
    v_mfma_f32_16x16x32_bf16 a[0:3], v[80:83], v[64:67], a[0:3]
    ds_read_b128 a[176:179], v5 offset:0
    s_mov_b32 m0, s60
    v_mfma_f32_16x16x32_bf16 a[16:19], v[84:87], v[64:67], a[16:19]
    ds_read_b128 a[180:183], v5 offset:2048
    v_mfma_f32_16x16x32_bf16 a[20:23], v[84:87], v[68:71], a[20:23]
    buffer_load_dwordx4 v14, s[32:35], s52 offen lds
    v_mfma_f32_16x16x32_bf16 a[4:7], v[80:83], v[68:71], a[4:7]
    ds_read_b128 a[184:187], v5 offset:4096
    s_add_u32 m0, m0, 2048
    v_mfma_f32_16x16x32_bf16 a[8:11], v[80:83], v[72:75], a[8:11]
    ds_read_b128 a[188:191], v5 offset:6144
    s_add_u32 s52, s52, s54
    v_mfma_f32_16x16x32_bf16 a[24:27], v[84:87], v[72:75], a[24:27]
    buffer_load_dwordx4 v14, s[32:35], s52 offen lds
    v_mfma_f32_16x16x32_bf16 a[28:31], v[84:87], v[76:79], a[28:31]
    ds_read_b64_tr_b16 a[192:193], v6 offset:16384
    s_add_u32 m0, m0, 2048
    v_mfma_f32_16x16x32_bf16 a[12:15], v[80:83], v[76:79], a[12:15]
    ds_read_b64_tr_b16 a[194:195], v6 offset:18432
    s_add_u32 s52, s52, s55
    v_mfma_f32_16x16x32_bf16 a[44:47], v[88:91], v[76:79], a[44:47]
    buffer_load_dwordx4 v14, s[32:35], s52 offen lds
    v_mfma_f32_16x16x32_bf16 a[60:63], v[92:95], v[76:79], a[60:63]
    ds_read_b64_tr_b16 a[196:197], v7 offset:16384
    s_add_u32 m0, m0, 2048
    v_mfma_f32_16x16x32_bf16 a[56:59], v[92:95], v[72:75], a[56:59]
    ds_read_b64_tr_b16 a[198:199], v7 offset:18432
    s_add_u32 s52, s52, s54
    v_mfma_f32_16x16x32_bf16 a[40:43], v[88:91], v[72:75], a[40:43]
    buffer_load_dwordx4 v14, s[32:35], s52 offen lds
    v_mfma_f32_16x16x32_bf16 a[36:39], v[88:91], v[68:71], a[36:39]
    ds_read_b64_tr_b16 a[200:201], v8 offset:16384
    s_add_u32 m0, m0, 2048
    v_mfma_f32_16x16x32_bf16 a[52:55], v[92:95], v[68:71], a[52:55]
    ds_read_b64_tr_b16 a[202:203], v8 offset:18432
    s_add_u32 s52, s52, s55
    v_mfma_f32_16x16x32_bf16 a[48:51], v[92:95], v[64:67], a[48:51]
    buffer_load_dwordx4 v14, s[32:35], s52 offen lds
    v_mfma_f32_16x16x32_bf16 a[32:35], v[88:91], v[64:67], a[32:35]
    ds_read_b64_tr_b16 a[204:205], v9 offset:16384
    s_add_u32 m0, m0, 2048
    v_mfma_f32_16x16x32_bf16 a[64:67], v[96:99], v[64:67], a[64:67]
    ds_read_b64_tr_b16 a[206:207], v9 offset:18432
    s_add_u32 s52, s52, s54
    v_mfma_f32_16x16x32_bf16 a[80:83], v[100:103], v[64:67], a[80:83]
    buffer_load_dwordx4 v14, s[32:35], s52 offen lds
    v_mfma_f32_16x16x32_bf16 a[84:87], v[100:103], v[68:71], a[84:87]
    ds_read_b64_tr_b16 a[208:209], v10 offset:16384
    s_add_u32 m0, m0, 2048
    v_mfma_f32_16x16x32_bf16 a[68:71], v[96:99], v[68:71], a[68:71]
    ds_read_b64_tr_b16 a[210:211], v10 offset:18432
    s_add_u32 s52, s52, s55
    v_mfma_f32_16x16x32_bf16 a[72:75], v[96:99], v[72:75], a[72:75]
    buffer_load_dwordx4 v14, s[32:35], s52 offen lds
    v_mfma_f32_16x16x32_bf16 a[88:91], v[100:103], v[72:75], a[88:91]
    ds_read_b64_tr_b16 a[212:213], v11 offset:16384
    s_add_u32 m0, m0, 2048
    v_mfma_f32_16x16x32_bf16 a[92:95], v[100:103], v[76:79], a[92:95]
    ds_read_b64_tr_b16 a[214:215], v11 offset:18432
    s_add_u32 s52, s52, s54
    v_mfma_f32_16x16x32_bf16 a[76:79], v[96:99], v[76:79], a[76:79]
    buffer_load_dwordx4 v14, s[32:35], s52 offen lds
    v_mfma_f32_16x16x32_bf16 a[108:111], v[104:107], v[76:79], a[108:111]
    ds_read_b64_tr_b16 a[216:217], v12 offset:16384
    s_add_u32 s52, s52, s56
    v_mfma_f32_16x16x32_bf16 a[124:127], v[108:111], v[76:79], a[124:127]
    ds_read_b64_tr_b16 a[218:219], v12 offset:18432
    s_add_u32 s60, s60, 32768
    v_mfma_f32_16x16x32_bf16 a[120:123], v[108:111], v[72:75], a[120:123]
    s_cmp_ge_u32 s60, 163840
    s_cselect_b32 s60, s62, s60
    v_mfma_f32_16x16x32_bf16 a[104:107], v[104:107], v[72:75], a[104:107]
    ds_read_b64_tr_b16 a[220:221], v13 offset:16384
    v_mfma_f32_16x16x32_bf16 a[100:103], v[104:107], v[68:71], a[100:103]
    ds_read_b64_tr_b16 a[222:223], v13 offset:18432
    v_mfma_f32_16x16x32_bf16 a[116:119], v[108:111], v[68:71], a[116:119]
    v_mfma_f32_16x16x32_bf16 a[112:115], v[108:111], v[64:67], a[112:115]
    ds_read_b64_tr_b16 a[224:225], v27 offset:8192
    v_mfma_f32_16x16x32_bf16 a[96:99], v[104:107], v[64:67], a[96:99]
    ds_read_b64_tr_b16 a[226:227], v27 offset:10240
    v_mfma_f32_16x16x32_bf16 a[128:131], v[112:115], v[64:67], a[128:131]
    v_mfma_f32_16x16x32_bf16 a[132:135], v[112:115], v[68:71], a[132:135]
    ds_read_b64_tr_b16 a[228:229], v28 offset:8192
    v_mfma_f32_16x16x32_bf16 a[136:139], v[112:115], v[72:75], a[136:139]
    ds_read_b64_tr_b16 a[230:231], v28 offset:10240
    v_mfma_f32_16x16x32_bf16 a[140:143], v[112:115], v[76:79], a[140:143]
    v_mfma_f32_16x16x32_bf16 a[144:147], v[116:119], v[64:67], a[144:147]
    ds_read_b64_tr_b16 a[232:233], v29 offset:8192
    v_mfma_f32_16x16x32_bf16 a[148:151], v[116:119], v[68:71], a[148:151]
    ds_read_b64_tr_b16 a[234:235], v29 offset:10240
    v_mfma_f32_16x16x32_bf16 a[152:155], v[116:119], v[72:75], a[152:155]
    v_add_u32 v4, 98304, v22
    v_add_u32 v5, 98304, v23
    v_mfma_f32_16x16x32_bf16 a[156:159], v[116:119], v[76:79], a[156:159]
    v_add_u32 v27, 98304, v24
    v_add_u32 v28, 98304, v25
    v_mfma_f32_16x16x32_bf16 a[160:163], v[64:67], v[120:123], a[160:163]
    v_add_u32 v29, 98304, v26
    v_xor_b32 v6, 0x8000, v6
    v_mfma_f32_16x16x32_bf16 a[164:167], v[68:71], v[120:123], a[164:167]
    v_xor_b32 v7, 0x8000, v7
    v_xor_b32 v8, 0x8000, v8
    v_mfma_f32_16x16x32_bf16 a[168:171], v[72:75], v[120:123], a[168:171]
    v_xor_b32 v9, 0x8000, v9
    v_xor_b32 v10, 0x8000, v10
    v_mfma_f32_16x16x32_bf16 a[172:175], v[76:79], v[120:123], a[172:175]
    v_xor_b32 v11, 0x8000, v11
    v_xor_b32 v12, 0x8000, v12
    v_xor_b32 v13, 0x8000, v13
    s_waitcnt vmcnt(8) lgkmcnt(0)
    s_barrier
    s_cmp_lg_u32 s48, 0
    s_cbranch_scc1 LSG_8
    s_cmp_lg_u32 s3, 0
    s_cbranch_scc1 LSG_8
    v_mov_b32 v46, 1
    v_lshlrev_b32 v47, 5, v0
    s_mov_b64 exec, 1
    buffer_store_dword v46, v47, s[40:43], s79 offen sc1
    s_mov_b64 exec, -1
LSG_8:
    v_mfma_f32_16x16x32_bf16 a[0:3], a[192:195], a[176:179], a[0:3]
    ds_read_b128 v[64:67], v4 offset:0
    s_mov_b32 m0, s61
    v_mfma_f32_16x16x32_bf16 a[16:19], a[196:199], a[176:179], a[16:19]
    ds_read_b128 v[68:71], v4 offset:2048
    v_mfma_f32_16x16x32_bf16 a[20:23], a[196:199], a[180:183], a[20:23]
    buffer_load_dwordx4 v15, s[36:39], s53 offen lds
    v_mfma_f32_16x16x32_bf16 a[4:7], a[192:195], a[180:183], a[4:7]
    ds_read_b128 v[72:75], v4 offset:4096
    s_add_u32 m0, m0, 2048
    v_mfma_f32_16x16x32_bf16 a[8:11], a[192:195], a[184:187], a[8:11]
    ds_read_b128 v[76:79], v4 offset:6144
    s_add_u32 s53, s53, 32768
    v_mfma_f32_16x16x32_bf16 a[24:27], a[196:199], a[184:187], a[24:27]
    buffer_load_dwordx4 v15, s[36:39], s53 offen lds
    v_mfma_f32_16x16x32_bf16 a[28:31], a[196:199], a[188:191], a[28:31]
    ds_read_b64_tr_b16 v[80:81], v6 offset:0
    s_add_u32 m0, m0, 6144
    v_mfma_f32_16x16x32_bf16 a[12:15], a[192:195], a[188:191], a[12:15]
    ds_read_b64_tr_b16 v[82:83], v6 offset:2048
    s_add_u32 s53, s53, 98304
    v_mfma_f32_16x16x32_bf16 a[44:47], a[200:203], a[188:191], a[44:47]
    buffer_load_dwordx4 v15, s[36:39], s53 offen lds
    v_mfma_f32_16x16x32_bf16 a[60:63], a[204:207], a[188:191], a[60:63]
    ds_read_b64_tr_b16 v[84:85], v7 offset:0
    s_add_u32 m0, m0, 2048
    v_mfma_f32_16x16x32_bf16 a[56:59], a[204:207], a[184:187], a[56:59]
    ds_read_b64_tr_b16 v[86:87], v7 offset:2048
    s_add_u32 s53, s53, 32768
    v_mfma_f32_16x16x32_bf16 a[40:43], a[200:203], a[184:187], a[40:43]
    buffer_load_dwordx4 v15, s[36:39], s53 offen lds
    v_mfma_f32_16x16x32_bf16 a[36:39], a[200:203], a[180:183], a[36:39]
    ds_read_b64_tr_b16 v[88:89], v8 offset:0
    s_add_u32 m0, m0, 6144
    v_mfma_f32_16x16x32_bf16 a[52:55], a[204:207], a[180:183], a[52:55]
    ds_read_b64_tr_b16 v[90:91], v8 offset:2048
    s_add_u32 s53, s53, 98304
    v_mfma_f32_16x16x32_bf16 a[48:51], a[204:207], a[176:179], a[48:51]
    buffer_load_dwordx4 v15, s[36:39], s53 offen lds
    v_mfma_f32_16x16x32_bf16 a[32:35], a[200:203], a[176:179], a[32:35]
    ds_read_b64_tr_b16 v[92:93], v9 offset:0
    s_add_u32 m0, m0, 2048
    v_mfma_f32_16x16x32_bf16 a[64:67], a[208:211], a[176:179], a[64:67]
    ds_read_b64_tr_b16 v[94:95], v9 offset:2048
    s_add_u32 s53, s53, 32768
    v_mfma_f32_16x16x32_bf16 a[80:83], a[212:215], a[176:179], a[80:83]
    buffer_load_dwordx4 v15, s[36:39], s53 offen lds
    v_mfma_f32_16x16x32_bf16 a[84:87], a[212:215], a[180:183], a[84:87]
    ds_read_b64_tr_b16 v[96:97], v10 offset:0
    s_add_u32 m0, m0, 6144
    v_mfma_f32_16x16x32_bf16 a[68:71], a[208:211], a[180:183], a[68:71]
    ds_read_b64_tr_b16 v[98:99], v10 offset:2048
    s_add_u32 s53, s53, 98304
    v_mfma_f32_16x16x32_bf16 a[72:75], a[208:211], a[184:187], a[72:75]
    buffer_load_dwordx4 v15, s[36:39], s53 offen lds
    v_mfma_f32_16x16x32_bf16 a[88:91], a[212:215], a[184:187], a[88:91]
    ds_read_b64_tr_b16 v[100:101], v11 offset:0
    s_add_u32 m0, m0, 2048
    v_mfma_f32_16x16x32_bf16 a[92:95], a[212:215], a[188:191], a[92:95]
    ds_read_b64_tr_b16 v[102:103], v11 offset:2048
    s_add_u32 s53, s53, 32768
    v_mfma_f32_16x16x32_bf16 a[76:79], a[208:211], a[188:191], a[76:79]
    buffer_load_dwordx4 v15, s[36:39], s53 offen lds
    v_mfma_f32_16x16x32_bf16 a[108:111], a[216:219], a[188:191], a[108:111]
    ds_read_b64_tr_b16 v[104:105], v12 offset:0
    s_add_u32 s53, s53, 98304
    v_mfma_f32_16x16x32_bf16 a[124:127], a[220:223], a[188:191], a[124:127]
    ds_read_b64_tr_b16 v[106:107], v12 offset:2048
    s_xor_b32 s61, s61, 32768
    v_mfma_f32_16x16x32_bf16 a[120:123], a[220:223], a[184:187], a[120:123]
    v_mfma_f32_16x16x32_bf16 a[104:107], a[216:219], a[184:187], a[104:107]
    ds_read_b64_tr_b16 v[108:109], v13 offset:0
    v_mfma_f32_16x16x32_bf16 a[100:103], a[216:219], a[180:183], a[100:103]
    ds_read_b64_tr_b16 v[110:111], v13 offset:2048
    v_mfma_f32_16x16x32_bf16 a[116:119], a[220:223], a[180:183], a[116:119]
    v_mfma_f32_16x16x32_bf16 a[112:115], a[220:223], a[176:179], a[112:115]
    ds_read_b64_tr_b16 v[112:113], v27 offset:0
    v_mfma_f32_16x16x32_bf16 a[96:99], a[216:219], a[176:179], a[96:99]
    ds_read_b64_tr_b16 v[114:115], v27 offset:2048
    v_mfma_f32_16x16x32_bf16 a[128:131], a[224:227], a[176:179], a[128:131]
    v_mfma_f32_16x16x32_bf16 a[132:135], a[224:227], a[180:183], a[132:135]
    ds_read_b64_tr_b16 v[116:117], v28 offset:0
    v_mfma_f32_16x16x32_bf16 a[136:139], a[224:227], a[184:187], a[136:139]
    ds_read_b64_tr_b16 v[118:119], v28 offset:2048
    v_mfma_f32_16x16x32_bf16 a[140:143], a[224:227], a[188:191], a[140:143]
    v_mfma_f32_16x16x32_bf16 a[144:147], a[228:231], a[176:179], a[144:147]
    ds_read_b64_tr_b16 v[120:121], v29 offset:0
    v_mfma_f32_16x16x32_bf16 a[148:151], a[228:231], a[180:183], a[148:151]
    ds_read_b64_tr_b16 v[122:123], v29 offset:2048
    v_mfma_f32_16x16x32_bf16 a[152:155], a[228:231], a[184:187], a[152:155]
    v_mfma_f32_16x16x32_bf16 a[156:159], a[228:231], a[188:191], a[156:159]
    v_mfma_f32_16x16x32_bf16 a[160:163], a[176:179], a[232:235], a[160:163]
    v_mfma_f32_16x16x32_bf16 a[164:167], a[180:183], a[232:235], a[164:167]
    v_mfma_f32_16x16x32_bf16 a[168:171], a[184:187], a[232:235], a[168:171]
    v_mfma_f32_16x16x32_bf16 a[172:175], a[188:191], a[232:235], a[172:175]
    s_waitcnt lgkmcnt(0)
    v_mfma_f32_16x16x32_bf16 a[0:3], v[80:83], v[64:67], a[0:3]
    ds_read_b128 a[176:179], v5 offset:0
    s_mov_b32 m0, s60
    v_mfma_f32_16x16x32_bf16 a[16:19], v[84:87], v[64:67], a[16:19]
    ds_read_b128 a[180:183], v5 offset:2048
    v_mfma_f32_16x16x32_bf16 a[20:23], v[84:87], v[68:71], a[20:23]
    buffer_load_dwordx4 v14, s[32:35], s52 offen lds
    v_mfma_f32_16x16x32_bf16 a[4:7], v[80:83], v[68:71], a[4:7]
    ds_read_b128 a[184:187], v5 offset:4096
    s_add_u32 m0, m0, 2048
    v_mfma_f32_16x16x32_bf16 a[8:11], v[80:83], v[72:75], a[8:11]
    ds_read_b128 a[188:191], v5 offset:6144
    s_add_u32 s52, s52, s54
    v_mfma_f32_16x16x32_bf16 a[24:27], v[84:87], v[72:75], a[24:27]
    buffer_load_dwordx4 v14, s[32:35], s52 offen lds
    v_mfma_f32_16x16x32_bf16 a[28:31], v[84:87], v[76:79], a[28:31]
    ds_read_b64_tr_b16 a[192:193], v6 offset:16384
    s_add_u32 m0, m0, 2048
    v_mfma_f32_16x16x32_bf16 a[12:15], v[80:83], v[76:79], a[12:15]
    ds_read_b64_tr_b16 a[194:195], v6 offset:18432
    s_add_u32 s52, s52, s55
    v_mfma_f32_16x16x32_bf16 a[44:47], v[88:91], v[76:79], a[44:47]
    buffer_load_dwordx4 v14, s[32:35], s52 offen lds
    v_mfma_f32_16x16x32_bf16 a[60:63], v[92:95], v[76:79], a[60:63]
    ds_read_b64_tr_b16 a[196:197], v7 offset:16384
    s_add_u32 m0, m0, 2048
    v_mfma_f32_16x16x32_bf16 a[56:59], v[92:95], v[72:75], a[56:59]
    ds_read_b64_tr_b16 a[198:199], v7 offset:18432
    s_add_u32 s52, s52, s54
    v_mfma_f32_16x16x32_bf16 a[40:43], v[88:91], v[72:75], a[40:43]
    buffer_load_dwordx4 v14, s[32:35], s52 offen lds
    v_mfma_f32_16x16x32_bf16 a[36:39], v[88:91], v[68:71], a[36:39]
    ds_read_b64_tr_b16 a[200:201], v8 offset:16384
    s_add_u32 m0, m0, 2048
    v_mfma_f32_16x16x32_bf16 a[52:55], v[92:95], v[68:71], a[52:55]
    ds_read_b64_tr_b16 a[202:203], v8 offset:18432
    s_add_u32 s52, s52, s55
    v_mfma_f32_16x16x32_bf16 a[48:51], v[92:95], v[64:67], a[48:51]
    buffer_load_dwordx4 v14, s[32:35], s52 offen lds
    v_mfma_f32_16x16x32_bf16 a[32:35], v[88:91], v[64:67], a[32:35]
    ds_read_b64_tr_b16 a[204:205], v9 offset:16384
    s_add_u32 m0, m0, 2048
    v_mfma_f32_16x16x32_bf16 a[64:67], v[96:99], v[64:67], a[64:67]
    ds_read_b64_tr_b16 a[206:207], v9 offset:18432
    s_add_u32 s52, s52, s54
    v_mfma_f32_16x16x32_bf16 a[80:83], v[100:103], v[64:67], a[80:83]
    buffer_load_dwordx4 v14, s[32:35], s52 offen lds
    v_mfma_f32_16x16x32_bf16 a[84:87], v[100:103], v[68:71], a[84:87]
    ds_read_b64_tr_b16 a[208:209], v10 offset:16384
    s_add_u32 m0, m0, 2048
    v_mfma_f32_16x16x32_bf16 a[68:71], v[96:99], v[68:71], a[68:71]
    ds_read_b64_tr_b16 a[210:211], v10 offset:18432
    s_add_u32 s52, s52, s55
    v_mfma_f32_16x16x32_bf16 a[72:75], v[96:99], v[72:75], a[72:75]
    buffer_load_dwordx4 v14, s[32:35], s52 offen lds
    v_mfma_f32_16x16x32_bf16 a[88:91], v[100:103], v[72:75], a[88:91]
    ds_read_b64_tr_b16 a[212:213], v11 offset:16384
    s_add_u32 m0, m0, 2048
    v_mfma_f32_16x16x32_bf16 a[92:95], v[100:103], v[76:79], a[92:95]
    ds_read_b64_tr_b16 a[214:215], v11 offset:18432
    s_add_u32 s52, s52, s54
    v_mfma_f32_16x16x32_bf16 a[76:79], v[96:99], v[76:79], a[76:79]
    buffer_load_dwordx4 v14, s[32:35], s52 offen lds
    v_mfma_f32_16x16x32_bf16 a[108:111], v[104:107], v[76:79], a[108:111]
    ds_read_b64_tr_b16 a[216:217], v12 offset:16384
    s_add_u32 s52, s52, s56
    v_mfma_f32_16x16x32_bf16 a[124:127], v[108:111], v[76:79], a[124:127]
    ds_read_b64_tr_b16 a[218:219], v12 offset:18432
    s_add_u32 s60, s60, 32768
    v_mfma_f32_16x16x32_bf16 a[120:123], v[108:111], v[72:75], a[120:123]
    s_cmp_ge_u32 s60, 163840
    s_cselect_b32 s60, s62, s60
    v_mfma_f32_16x16x32_bf16 a[104:107], v[104:107], v[72:75], a[104:107]
    ds_read_b64_tr_b16 a[220:221], v13 offset:16384
    v_mfma_f32_16x16x32_bf16 a[100:103], v[104:107], v[68:71], a[100:103]
    ds_read_b64_tr_b16 a[222:223], v13 offset:18432
    v_mfma_f32_16x16x32_bf16 a[116:119], v[108:111], v[68:71], a[116:119]
    v_mfma_f32_16x16x32_bf16 a[112:115], v[108:111], v[64:67], a[112:115]
    ds_read_b64_tr_b16 a[224:225], v27 offset:8192
    v_mfma_f32_16x16x32_bf16 a[96:99], v[104:107], v[64:67], a[96:99]
    ds_read_b64_tr_b16 a[226:227], v27 offset:10240
    v_mfma_f32_16x16x32_bf16 a[128:131], v[112:115], v[64:67], a[128:131]
    v_mfma_f32_16x16x32_bf16 a[132:135], v[112:115], v[68:71], a[132:135]
    ds_read_b64_tr_b16 a[228:229], v28 offset:8192
    v_mfma_f32_16x16x32_bf16 a[136:139], v[112:115], v[72:75], a[136:139]
    ds_read_b64_tr_b16 a[230:231], v28 offset:10240
    v_mfma_f32_16x16x32_bf16 a[140:143], v[112:115], v[76:79], a[140:143]
    v_mfma_f32_16x16x32_bf16 a[144:147], v[116:119], v[64:67], a[144:147]
    ds_read_b64_tr_b16 a[232:233], v29 offset:8192
    v_mfma_f32_16x16x32_bf16 a[148:151], v[116:119], v[68:71], a[148:151]
    ds_read_b64_tr_b16 a[234:235], v29 offset:10240
    v_mfma_f32_16x16x32_bf16 a[152:155], v[116:119], v[72:75], a[152:155]
    v_add_u32 v4, 131072, v22
    v_add_u32 v5, 131072, v23
    v_mfma_f32_16x16x32_bf16 a[156:159], v[116:119], v[76:79], a[156:159]
    v_add_u32 v27, 131072, v24
    v_add_u32 v28, 131072, v25
    v_mfma_f32_16x16x32_bf16 a[160:163], v[64:67], v[120:123], a[160:163]
    v_add_u32 v29, 131072, v26
    v_xor_b32 v6, 0x8000, v6
    v_mfma_f32_16x16x32_bf16 a[164:167], v[68:71], v[120:123], a[164:167]
    v_xor_b32 v7, 0x8000, v7
    v_xor_b32 v8, 0x8000, v8
    v_mfma_f32_16x16x32_bf16 a[168:171], v[72:75], v[120:123], a[168:171]
    v_xor_b32 v9, 0x8000, v9
    v_xor_b32 v10, 0x8000, v10
    v_mfma_f32_16x16x32_bf16 a[172:175], v[76:79], v[120:123], a[172:175]
    v_xor_b32 v11, 0x8000, v11
    v_xor_b32 v12, 0x8000, v12
    v_xor_b32 v13, 0x8000, v13
    s_waitcnt vmcnt(8) lgkmcnt(0)
    s_barrier
    v_mfma_f32_16x16x32_bf16 a[0:3], a[192:195], a[176:179], a[0:3]
    ds_read_b128 v[64:67], v4 offset:0
    s_mov_b32 m0, s61
    v_mfma_f32_16x16x32_bf16 a[16:19], a[196:199], a[176:179], a[16:19]
    ds_read_b128 v[68:71], v4 offset:2048
    v_mfma_f32_16x16x32_bf16 a[20:23], a[196:199], a[180:183], a[20:23]
    buffer_load_dwordx4 v15, s[36:39], s53 offen lds
    v_mfma_f32_16x16x32_bf16 a[4:7], a[192:195], a[180:183], a[4:7]
    ds_read_b128 v[72:75], v4 offset:4096
    s_add_u32 m0, m0, 2048
    v_mfma_f32_16x16x32_bf16 a[8:11], a[192:195], a[184:187], a[8:11]
    ds_read_b128 v[76:79], v4 offset:6144
    s_add_u32 s53, s53, 32768
    v_mfma_f32_16x16x32_bf16 a[24:27], a[196:199], a[184:187], a[24:27]
    buffer_load_dwordx4 v15, s[36:39], s53 offen lds
    v_mfma_f32_16x16x32_bf16 a[28:31], a[196:199], a[188:191], a[28:31]
    ds_read_b64_tr_b16 v[80:81], v6 offset:0
    s_add_u32 m0, m0, 6144
    v_mfma_f32_16x16x32_bf16 a[12:15], a[192:195], a[188:191], a[12:15]
    ds_read_b64_tr_b16 v[82:83], v6 offset:2048
    s_add_u32 s53, s53, 98304
    v_mfma_f32_16x16x32_bf16 a[44:47], a[200:203], a[188:191], a[44:47]
    buffer_load_dwordx4 v15, s[36:39], s53 offen lds
    v_mfma_f32_16x16x32_bf16 a[60:63], a[204:207], a[188:191], a[60:63]
    ds_read_b64_tr_b16 v[84:85], v7 offset:0
    s_add_u32 m0, m0, 2048
    v_mfma_f32_16x16x32_bf16 a[56:59], a[204:207], a[184:187], a[56:59]
    ds_read_b64_tr_b16 v[86:87], v7 offset:2048
    s_add_u32 s53, s53, 32768
    v_mfma_f32_16x16x32_bf16 a[40:43], a[200:203], a[184:187], a[40:43]
    buffer_load_dwordx4 v15, s[36:39], s53 offen lds
    v_mfma_f32_16x16x32_bf16 a[36:39], a[200:203], a[180:183], a[36:39]
    ds_read_b64_tr_b16 v[88:89], v8 offset:0
    s_add_u32 m0, m0, 6144
    v_mfma_f32_16x16x32_bf16 a[52:55], a[204:207], a[180:183], a[52:55]
    ds_read_b64_tr_b16 v[90:91], v8 offset:2048
    s_add_u32 s53, s53, 98304
    v_mfma_f32_16x16x32_bf16 a[48:51], a[204:207], a[176:179], a[48:51]
    buffer_load_dwordx4 v15, s[36:39], s53 offen lds
    v_mfma_f32_16x16x32_bf16 a[32:35], a[200:203], a[176:179], a[32:35]
    ds_read_b64_tr_b16 v[92:93], v9 offset:0
    s_add_u32 m0, m0, 2048
    v_mfma_f32_16x16x32_bf16 a[64:67], a[208:211], a[176:179], a[64:67]
    ds_read_b64_tr_b16 v[94:95], v9 offset:2048
    s_add_u32 s53, s53, 32768
    v_mfma_f32_16x16x32_bf16 a[80:83], a[212:215], a[176:179], a[80:83]
    buffer_load_dwordx4 v15, s[36:39], s53 offen lds
    v_mfma_f32_16x16x32_bf16 a[84:87], a[212:215], a[180:183], a[84:87]
    ds_read_b64_tr_b16 v[96:97], v10 offset:0
    s_add_u32 m0, m0, 6144
    v_mfma_f32_16x16x32_bf16 a[68:71], a[208:211], a[180:183], a[68:71]
    ds_read_b64_tr_b16 v[98:99], v10 offset:2048
    s_add_u32 s53, s53, 98304
    v_mfma_f32_16x16x32_bf16 a[72:75], a[208:211], a[184:187], a[72:75]
    buffer_load_dwordx4 v15, s[36:39], s53 offen lds
    v_mfma_f32_16x16x32_bf16 a[88:91], a[212:215], a[184:187], a[88:91]
    ds_read_b64_tr_b16 v[100:101], v11 offset:0
    s_add_u32 m0, m0, 2048
    v_mfma_f32_16x16x32_bf16 a[92:95], a[212:215], a[188:191], a[92:95]
    ds_read_b64_tr_b16 v[102:103], v11 offset:2048
    s_add_u32 s53, s53, 32768
    v_mfma_f32_16x16x32_bf16 a[76:79], a[208:211], a[188:191], a[76:79]
    buffer_load_dwordx4 v15, s[36:39], s53 offen lds
    v_mfma_f32_16x16x32_bf16 a[108:111], a[216:219], a[188:191], a[108:111]
    ds_read_b64_tr_b16 v[104:105], v12 offset:0
    s_add_u32 s53, s53, 98304
    v_mfma_f32_16x16x32_bf16 a[124:127], a[220:223], a[188:191], a[124:127]
    ds_read_b64_tr_b16 v[106:107], v12 offset:2048
    s_xor_b32 s61, s61, 32768
    v_mfma_f32_16x16x32_bf16 a[120:123], a[220:223], a[184:187], a[120:123]
    v_mfma_f32_16x16x32_bf16 a[104:107], a[216:219], a[184:187], a[104:107]
    ds_read_b64_tr_b16 v[108:109], v13 offset:0
    v_mfma_f32_16x16x32_bf16 a[100:103], a[216:219], a[180:183], a[100:103]
    ds_read_b64_tr_b16 v[110:111], v13 offset:2048
    v_mfma_f32_16x16x32_bf16 a[116:119], a[220:223], a[180:183], a[116:119]
    v_mfma_f32_16x16x32_bf16 a[112:115], a[220:223], a[176:179], a[112:115]
    ds_read_b64_tr_b16 v[112:113], v27 offset:0
    v_mfma_f32_16x16x32_bf16 a[96:99], a[216:219], a[176:179], a[96:99]
    ds_read_b64_tr_b16 v[114:115], v27 offset:2048
    v_mfma_f32_16x16x32_bf16 a[128:131], a[224:227], a[176:179], a[128:131]
    v_mfma_f32_16x16x32_bf16 a[132:135], a[224:227], a[180:183], a[132:135]
    ds_read_b64_tr_b16 v[116:117], v28 offset:0
    v_mfma_f32_16x16x32_bf16 a[136:139], a[224:227], a[184:187], a[136:139]
    ds_read_b64_tr_b16 v[118:119], v28 offset:2048
    v_mfma_f32_16x16x32_bf16 a[140:143], a[224:227], a[188:191], a[140:143]
    v_mfma_f32_16x16x32_bf16 a[144:147], a[228:231], a[176:179], a[144:147]
    ds_read_b64_tr_b16 v[120:121], v29 offset:0
    v_mfma_f32_16x16x32_bf16 a[148:151], a[228:231], a[180:183], a[148:151]
    ds_read_b64_tr_b16 v[122:123], v29 offset:2048
    v_mfma_f32_16x16x32_bf16 a[152:155], a[228:231], a[184:187], a[152:155]
    v_mfma_f32_16x16x32_bf16 a[156:159], a[228:231], a[188:191], a[156:159]
    v_mfma_f32_16x16x32_bf16 a[160:163], a[176:179], a[232:235], a[160:163]
    v_mfma_f32_16x16x32_bf16 a[164:167], a[180:183], a[232:235], a[164:167]
    v_mfma_f32_16x16x32_bf16 a[168:171], a[184:187], a[232:235], a[168:171]
    v_mfma_f32_16x16x32_bf16 a[172:175], a[188:191], a[232:235], a[172:175]
    s_waitcnt lgkmcnt(0)
    v_mfma_f32_16x16x32_bf16 a[0:3], v[80:83], v[64:67], a[0:3]
    ds_read_b128 a[176:179], v5 offset:0
    s_mov_b32 m0, s60
    v_mfma_f32_16x16x32_bf16 a[16:19], v[84:87], v[64:67], a[16:19]
    ds_read_b128 a[180:183], v5 offset:2048
    v_mfma_f32_16x16x32_bf16 a[20:23], v[84:87], v[68:71], a[20:23]
    buffer_load_dwordx4 v14, s[32:35], s52 offen lds
    v_mfma_f32_16x16x32_bf16 a[4:7], v[80:83], v[68:71], a[4:7]
    ds_read_b128 a[184:187], v5 offset:4096
    s_add_u32 m0, m0, 2048
    v_mfma_f32_16x16x32_bf16 a[8:11], v[80:83], v[72:75], a[8:11]
    ds_read_b128 a[188:191], v5 offset:6144
    s_add_u32 s52, s52, s54
    v_mfma_f32_16x16x32_bf16 a[24:27], v[84:87], v[72:75], a[24:27]
    buffer_load_dwordx4 v14, s[32:35], s52 offen lds
    v_mfma_f32_16x16x32_bf16 a[28:31], v[84:87], v[76:79], a[28:31]
    ds_read_b64_tr_b16 a[192:193], v6 offset:16384
    s_add_u32 m0, m0, 2048
    v_mfma_f32_16x16x32_bf16 a[12:15], v[80:83], v[76:79], a[12:15]
    ds_read_b64_tr_b16 a[194:195], v6 offset:18432
    s_add_u32 s52, s52, s55
    v_mfma_f32_16x16x32_bf16 a[44:47], v[88:91], v[76:79], a[44:47]
    buffer_load_dwordx4 v14, s[32:35], s52 offen lds
    v_mfma_f32_16x16x32_bf16 a[60:63], v[92:95], v[76:79], a[60:63]
    ds_read_b64_tr_b16 a[196:197], v7 offset:16384
    s_add_u32 m0, m0, 2048
    v_mfma_f32_16x16x32_bf16 a[56:59], v[92:95], v[72:75], a[56:59]
    ds_read_b64_tr_b16 a[198:199], v7 offset:18432
    s_add_u32 s52, s52, s54
    v_mfma_f32_16x16x32_bf16 a[40:43], v[88:91], v[72:75], a[40:43]
    buffer_load_dwordx4 v14, s[32:35], s52 offen lds
    v_mfma_f32_16x16x32_bf16 a[36:39], v[88:91], v[68:71], a[36:39]
    ds_read_b64_tr_b16 a[200:201], v8 offset:16384
    s_add_u32 m0, m0, 2048
    v_mfma_f32_16x16x32_bf16 a[52:55], v[92:95], v[68:71], a[52:55]
    ds_read_b64_tr_b16 a[202:203], v8 offset:18432
    s_add_u32 s52, s52, s55
    v_mfma_f32_16x16x32_bf16 a[48:51], v[92:95], v[64:67], a[48:51]
    buffer_load_dwordx4 v14, s[32:35], s52 offen lds
    v_mfma_f32_16x16x32_bf16 a[32:35], v[88:91], v[64:67], a[32:35]
    ds_read_b64_tr_b16 a[204:205], v9 offset:16384
    s_add_u32 m0, m0, 2048
    v_mfma_f32_16x16x32_bf16 a[64:67], v[96:99], v[64:67], a[64:67]
    ds_read_b64_tr_b16 a[206:207], v9 offset:18432
    s_add_u32 s52, s52, s54
    v_mfma_f32_16x16x32_bf16 a[80:83], v[100:103], v[64:67], a[80:83]
    buffer_load_dwordx4 v14, s[32:35], s52 offen lds
    v_mfma_f32_16x16x32_bf16 a[84:87], v[100:103], v[68:71], a[84:87]
    ds_read_b64_tr_b16 a[208:209], v10 offset:16384
    s_add_u32 m0, m0, 2048
    v_mfma_f32_16x16x32_bf16 a[68:71], v[96:99], v[68:71], a[68:71]
    ds_read_b64_tr_b16 a[210:211], v10 offset:18432
    s_add_u32 s52, s52, s55
    v_mfma_f32_16x16x32_bf16 a[72:75], v[96:99], v[72:75], a[72:75]
    buffer_load_dwordx4 v14, s[32:35], s52 offen lds
    v_mfma_f32_16x16x32_bf16 a[88:91], v[100:103], v[72:75], a[88:91]
    ds_read_b64_tr_b16 a[212:213], v11 offset:16384
    s_add_u32 m0, m0, 2048
    v_mfma_f32_16x16x32_bf16 a[92:95], v[100:103], v[76:79], a[92:95]
    ds_read_b64_tr_b16 a[214:215], v11 offset:18432
    s_add_u32 s52, s52, s54
    v_mfma_f32_16x16x32_bf16 a[76:79], v[96:99], v[76:79], a[76:79]
    buffer_load_dwordx4 v14, s[32:35], s52 offen lds
    v_mfma_f32_16x16x32_bf16 a[108:111], v[104:107], v[76:79], a[108:111]
    ds_read_b64_tr_b16 a[216:217], v12 offset:16384
    s_add_u32 s52, s52, s56
    v_mfma_f32_16x16x32_bf16 a[124:127], v[108:111], v[76:79], a[124:127]
    ds_read_b64_tr_b16 a[218:219], v12 offset:18432
    s_add_u32 s60, s60, 32768
    v_mfma_f32_16x16x32_bf16 a[120:123], v[108:111], v[72:75], a[120:123]
    s_cmp_ge_u32 s60, 163840
    s_cselect_b32 s60, s62, s60
    v_mfma_f32_16x16x32_bf16 a[104:107], v[104:107], v[72:75], a[104:107]
    ds_read_b64_tr_b16 a[220:221], v13 offset:16384
    v_mfma_f32_16x16x32_bf16 a[100:103], v[104:107], v[68:71], a[100:103]
    ds_read_b64_tr_b16 a[222:223], v13 offset:18432
    v_mfma_f32_16x16x32_bf16 a[116:119], v[108:111], v[68:71], a[116:119]
    v_mfma_f32_16x16x32_bf16 a[112:115], v[108:111], v[64:67], a[112:115]
    ds_read_b64_tr_b16 a[224:225], v27 offset:8192
    v_mfma_f32_16x16x32_bf16 a[96:99], v[104:107], v[64:67], a[96:99]
    ds_read_b64_tr_b16 a[226:227], v27 offset:10240
    v_mfma_f32_16x16x32_bf16 a[128:131], v[112:115], v[64:67], a[128:131]
    v_mfma_f32_16x16x32_bf16 a[132:135], v[112:115], v[68:71], a[132:135]
    ds_read_b64_tr_b16 a[228:229], v28 offset:8192
    v_mfma_f32_16x16x32_bf16 a[136:139], v[112:115], v[72:75], a[136:139]
    ds_read_b64_tr_b16 a[230:231], v28 offset:10240
    v_mfma_f32_16x16x32_bf16 a[140:143], v[112:115], v[76:79], a[140:143]
    v_mfma_f32_16x16x32_bf16 a[144:147], v[116:119], v[64:67], a[144:147]
    ds_read_b64_tr_b16 a[232:233], v29 offset:8192
    v_mfma_f32_16x16x32_bf16 a[148:151], v[116:119], v[68:71], a[148:151]
    ds_read_b64_tr_b16 a[234:235], v29 offset:10240
    v_mfma_f32_16x16x32_bf16 a[152:155], v[116:119], v[72:75], a[152:155]
    v_add_u32 v4, 65536, v22
    v_add_u32 v5, 65536, v23
    v_mfma_f32_16x16x32_bf16 a[156:159], v[116:119], v[76:79], a[156:159]
    v_add_u32 v27, 65536, v24
    v_add_u32 v28, 65536, v25
    v_mfma_f32_16x16x32_bf16 a[160:163], v[64:67], v[120:123], a[160:163]
    v_add_u32 v29, 65536, v26
    v_xor_b32 v6, 0x8000, v6
    v_mfma_f32_16x16x32_bf16 a[164:167], v[68:71], v[120:123], a[164:167]
    v_xor_b32 v7, 0x8000, v7
    v_xor_b32 v8, 0x8000, v8
    v_mfma_f32_16x16x32_bf16 a[168:171], v[72:75], v[120:123], a[168:171]
    v_xor_b32 v9, 0x8000, v9
    v_xor_b32 v10, 0x8000, v10
    v_mfma_f32_16x16x32_bf16 a[172:175], v[76:79], v[120:123], a[172:175]
    v_xor_b32 v11, 0x8000, v11
    v_xor_b32 v12, 0x8000, v12
    v_xor_b32 v13, 0x8000, v13
    s_waitcnt vmcnt(8) lgkmcnt(0)
    s_barrier
    v_mfma_f32_16x16x32_bf16 a[0:3], a[192:195], a[176:179], a[0:3]
    ds_read_b128 v[64:67], v4 offset:0
    s_mov_b32 m0, s61
    v_mfma_f32_16x16x32_bf16 a[16:19], a[196:199], a[176:179], a[16:19]
    ds_read_b128 v[68:71], v4 offset:2048
    v_mfma_f32_16x16x32_bf16 a[20:23], a[196:199], a[180:183], a[20:23]
    buffer_load_dwordx4 v15, s[36:39], s53 offen lds
    v_mfma_f32_16x16x32_bf16 a[4:7], a[192:195], a[180:183], a[4:7]
    ds_read_b128 v[72:75], v4 offset:4096
    s_add_u32 m0, m0, 2048
    v_mfma_f32_16x16x32_bf16 a[8:11], a[192:195], a[184:187], a[8:11]
    ds_read_b128 v[76:79], v4 offset:6144
    s_add_u32 s53, s53, 32768
    v_mfma_f32_16x16x32_bf16 a[24:27], a[196:199], a[184:187], a[24:27]
    buffer_load_dwordx4 v15, s[36:39], s53 offen lds
    v_mfma_f32_16x16x32_bf16 a[28:31], a[196:199], a[188:191], a[28:31]
    ds_read_b64_tr_b16 v[80:81], v6 offset:0
    s_add_u32 m0, m0, 6144
    v_mfma_f32_16x16x32_bf16 a[12:15], a[192:195], a[188:191], a[12:15]
    ds_read_b64_tr_b16 v[82:83], v6 offset:2048
    s_add_u32 s53, s53, 98304
    v_mfma_f32_16x16x32_bf16 a[44:47], a[200:203], a[188:191], a[44:47]
    buffer_load_dwordx4 v15, s[36:39], s53 offen lds
    v_mfma_f32_16x16x32_bf16 a[60:63], a[204:207], a[188:191], a[60:63]
    ds_read_b64_tr_b16 v[84:85], v7 offset:0
    s_add_u32 m0, m0, 2048
    v_mfma_f32_16x16x32_bf16 a[56:59], a[204:207], a[184:187], a[56:59]
    ds_read_b64_tr_b16 v[86:87], v7 offset:2048
    s_add_u32 s53, s53, 32768
    v_mfma_f32_16x16x32_bf16 a[40:43], a[200:203], a[184:187], a[40:43]
    buffer_load_dwordx4 v15, s[36:39], s53 offen lds
    v_mfma_f32_16x16x32_bf16 a[36:39], a[200:203], a[180:183], a[36:39]
    ds_read_b64_tr_b16 v[88:89], v8 offset:0
    s_add_u32 m0, m0, 6144
    v_mfma_f32_16x16x32_bf16 a[52:55], a[204:207], a[180:183], a[52:55]
    ds_read_b64_tr_b16 v[90:91], v8 offset:2048
    s_add_u32 s53, s53, 98304
    v_mfma_f32_16x16x32_bf16 a[48:51], a[204:207], a[176:179], a[48:51]
    buffer_load_dwordx4 v15, s[36:39], s53 offen lds
    v_mfma_f32_16x16x32_bf16 a[32:35], a[200:203], a[176:179], a[32:35]
    ds_read_b64_tr_b16 v[92:93], v9 offset:0
    s_add_u32 m0, m0, 2048
    v_mfma_f32_16x16x32_bf16 a[64:67], a[208:211], a[176:179], a[64:67]
    ds_read_b64_tr_b16 v[94:95], v9 offset:2048
    s_add_u32 s53, s53, 32768
    v_mfma_f32_16x16x32_bf16 a[80:83], a[212:215], a[176:179], a[80:83]
    buffer_load_dwordx4 v15, s[36:39], s53 offen lds
    v_mfma_f32_16x16x32_bf16 a[84:87], a[212:215], a[180:183], a[84:87]
    ds_read_b64_tr_b16 v[96:97], v10 offset:0
    s_add_u32 m0, m0, 6144
    v_mfma_f32_16x16x32_bf16 a[68:71], a[208:211], a[180:183], a[68:71]
    ds_read_b64_tr_b16 v[98:99], v10 offset:2048
    s_add_u32 s53, s53, 98304
    v_mfma_f32_16x16x32_bf16 a[72:75], a[208:211], a[184:187], a[72:75]
    buffer_load_dwordx4 v15, s[36:39], s53 offen lds
    v_mfma_f32_16x16x32_bf16 a[88:91], a[212:215], a[184:187], a[88:91]
    ds_read_b64_tr_b16 v[100:101], v11 offset:0
    s_add_u32 m0, m0, 2048
    v_mfma_f32_16x16x32_bf16 a[92:95], a[212:215], a[188:191], a[92:95]
    ds_read_b64_tr_b16 v[102:103], v11 offset:2048
    s_add_u32 s53, s53, 32768
    v_mfma_f32_16x16x32_bf16 a[76:79], a[208:211], a[188:191], a[76:79]
    buffer_load_dwordx4 v15, s[36:39], s53 offen lds
    v_mfma_f32_16x16x32_bf16 a[108:111], a[216:219], a[188:191], a[108:111]
    ds_read_b64_tr_b16 v[104:105], v12 offset:0
    s_add_u32 s53, s53, 98304
    v_mfma_f32_16x16x32_bf16 a[124:127], a[220:223], a[188:191], a[124:127]
    ds_read_b64_tr_b16 v[106:107], v12 offset:2048
    s_xor_b32 s61, s61, 32768
    v_mfma_f32_16x16x32_bf16 a[120:123], a[220:223], a[184:187], a[120:123]
    v_mfma_f32_16x16x32_bf16 a[104:107], a[216:219], a[184:187], a[104:107]
    ds_read_b64_tr_b16 v[108:109], v13 offset:0
    v_mfma_f32_16x16x32_bf16 a[100:103], a[216:219], a[180:183], a[100:103]
    ds_read_b64_tr_b16 v[110:111], v13 offset:2048
    v_mfma_f32_16x16x32_bf16 a[116:119], a[220:223], a[180:183], a[116:119]
    v_mfma_f32_16x16x32_bf16 a[112:115], a[220:223], a[176:179], a[112:115]
    ds_read_b64_tr_b16 v[112:113], v27 offset:0
    v_mfma_f32_16x16x32_bf16 a[96:99], a[216:219], a[176:179], a[96:99]
    ds_read_b64_tr_b16 v[114:115], v27 offset:2048
    v_mfma_f32_16x16x32_bf16 a[128:131], a[224:227], a[176:179], a[128:131]
    v_mfma_f32_16x16x32_bf16 a[132:135], a[224:227], a[180:183], a[132:135]
    ds_read_b64_tr_b16 v[116:117], v28 offset:0
    v_mfma_f32_16x16x32_bf16 a[136:139], a[224:227], a[184:187], a[136:139]
    ds_read_b64_tr_b16 v[118:119], v28 offset:2048
    v_mfma_f32_16x16x32_bf16 a[140:143], a[224:227], a[188:191], a[140:143]
    v_mfma_f32_16x16x32_bf16 a[144:147], a[228:231], a[176:179], a[144:147]
    ds_read_b64_tr_b16 v[120:121], v29 offset:0
    v_mfma_f32_16x16x32_bf16 a[148:151], a[228:231], a[180:183], a[148:151]
    ds_read_b64_tr_b16 v[122:123], v29 offset:2048
    v_mfma_f32_16x16x32_bf16 a[152:155], a[228:231], a[184:187], a[152:155]
    v_mfma_f32_16x16x32_bf16 a[156:159], a[228:231], a[188:191], a[156:159]
    v_mfma_f32_16x16x32_bf16 a[160:163], a[176:179], a[232:235], a[160:163]
    v_mfma_f32_16x16x32_bf16 a[164:167], a[180:183], a[232:235], a[164:167]
    v_mfma_f32_16x16x32_bf16 a[168:171], a[184:187], a[232:235], a[168:171]
    v_mfma_f32_16x16x32_bf16 a[172:175], a[188:191], a[232:235], a[172:175]
    s_waitcnt lgkmcnt(0)
    v_mfma_f32_16x16x32_bf16 a[0:3], v[80:83], v[64:67], a[0:3]
    ds_read_b128 a[176:179], v5 offset:0
    v_mfma_f32_16x16x32_bf16 a[16:19], v[84:87], v[64:67], a[16:19]
    ds_read_b128 a[180:183], v5 offset:2048
    v_mfma_f32_16x16x32_bf16 a[20:23], v[84:87], v[68:71], a[20:23]
    v_mfma_f32_16x16x32_bf16 a[4:7], v[80:83], v[68:71], a[4:7]
    ds_read_b128 a[184:187], v5 offset:4096
    v_mfma_f32_16x16x32_bf16 a[8:11], v[80:83], v[72:75], a[8:11]
    ds_read_b128 a[188:191], v5 offset:6144
    v_mfma_f32_16x16x32_bf16 a[24:27], v[84:87], v[72:75], a[24:27]
    v_mfma_f32_16x16x32_bf16 a[28:31], v[84:87], v[76:79], a[28:31]
    ds_read_b64_tr_b16 a[192:193], v6 offset:16384
    v_mfma_f32_16x16x32_bf16 a[12:15], v[80:83], v[76:79], a[12:15]
    ds_read_b64_tr_b16 a[194:195], v6 offset:18432
    v_mfma_f32_16x16x32_bf16 a[44:47], v[88:91], v[76:79], a[44:47]
    v_mfma_f32_16x16x32_bf16 a[60:63], v[92:95], v[76:79], a[60:63]
    ds_read_b64_tr_b16 a[196:197], v7 offset:16384
    v_mfma_f32_16x16x32_bf16 a[56:59], v[92:95], v[72:75], a[56:59]
    ds_read_b64_tr_b16 a[198:199], v7 offset:18432
    v_mfma_f32_16x16x32_bf16 a[40:43], v[88:91], v[72:75], a[40:43]
    v_mfma_f32_16x16x32_bf16 a[36:39], v[88:91], v[68:71], a[36:39]
    ds_read_b64_tr_b16 a[200:201], v8 offset:16384
    v_mfma_f32_16x16x32_bf16 a[52:55], v[92:95], v[68:71], a[52:55]
    ds_read_b64_tr_b16 a[202:203], v8 offset:18432
    v_mfma_f32_16x16x32_bf16 a[48:51], v[92:95], v[64:67], a[48:51]
    v_mfma_f32_16x16x32_bf16 a[32:35], v[88:91], v[64:67], a[32:35]
    ds_read_b64_tr_b16 a[204:205], v9 offset:16384
    v_mfma_f32_16x16x32_bf16 a[64:67], v[96:99], v[64:67], a[64:67]
    ds_read_b64_tr_b16 a[206:207], v9 offset:18432
    v_mfma_f32_16x16x32_bf16 a[80:83], v[100:103], v[64:67], a[80:83]
    v_mfma_f32_16x16x32_bf16 a[84:87], v[100:103], v[68:71], a[84:87]
    ds_read_b64_tr_b16 a[208:209], v10 offset:16384
    v_mfma_f32_16x16x32_bf16 a[68:71], v[96:99], v[68:71], a[68:71]
    ds_read_b64_tr_b16 a[210:211], v10 offset:18432
    v_mfma_f32_16x16x32_bf16 a[72:75], v[96:99], v[72:75], a[72:75]
    v_mfma_f32_16x16x32_bf16 a[88:91], v[100:103], v[72:75], a[88:91]
    ds_read_b64_tr_b16 a[212:213], v11 offset:16384
    v_mfma_f32_16x16x32_bf16 a[92:95], v[100:103], v[76:79], a[92:95]
    ds_read_b64_tr_b16 a[214:215], v11 offset:18432
    v_mfma_f32_16x16x32_bf16 a[76:79], v[96:99], v[76:79], a[76:79]
    v_mfma_f32_16x16x32_bf16 a[108:111], v[104:107], v[76:79], a[108:111]
    ds_read_b64_tr_b16 a[216:217], v12 offset:16384
    v_mfma_f32_16x16x32_bf16 a[124:127], v[108:111], v[76:79], a[124:127]
    ds_read_b64_tr_b16 a[218:219], v12 offset:18432
    v_mfma_f32_16x16x32_bf16 a[120:123], v[108:111], v[72:75], a[120:123]
    v_mfma_f32_16x16x32_bf16 a[104:107], v[104:107], v[72:75], a[104:107]
    ds_read_b64_tr_b16 a[220:221], v13 offset:16384
    v_mfma_f32_16x16x32_bf16 a[100:103], v[104:107], v[68:71], a[100:103]
    ds_read_b64_tr_b16 a[222:223], v13 offset:18432
    v_mfma_f32_16x16x32_bf16 a[116:119], v[108:111], v[68:71], a[116:119]
    v_mfma_f32_16x16x32_bf16 a[112:115], v[108:111], v[64:67], a[112:115]
    ds_read_b64_tr_b16 a[224:225], v27 offset:8192
    v_mfma_f32_16x16x32_bf16 a[96:99], v[104:107], v[64:67], a[96:99]
    ds_read_b64_tr_b16 a[226:227], v27 offset:10240
    v_mfma_f32_16x16x32_bf16 a[128:131], v[112:115], v[64:67], a[128:131]
    v_mfma_f32_16x16x32_bf16 a[132:135], v[112:115], v[68:71], a[132:135]
    ds_read_b64_tr_b16 a[228:229], v28 offset:8192
    v_mfma_f32_16x16x32_bf16 a[136:139], v[112:115], v[72:75], a[136:139]
    ds_read_b64_tr_b16 a[230:231], v28 offset:10240
    v_mfma_f32_16x16x32_bf16 a[140:143], v[112:115], v[76:79], a[140:143]
    v_mfma_f32_16x16x32_bf16 a[144:147], v[116:119], v[64:67], a[144:147]
    ds_read_b64_tr_b16 a[232:233], v29 offset:8192
    v_mfma_f32_16x16x32_bf16 a[148:151], v[116:119], v[68:71], a[148:151]
    ds_read_b64_tr_b16 a[234:235], v29 offset:10240
    v_mfma_f32_16x16x32_bf16 a[152:155], v[116:119], v[72:75], a[152:155]
    v_add_u32 v4, 98304, v22
    v_add_u32 v5, 98304, v23
    v_mfma_f32_16x16x32_bf16 a[156:159], v[116:119], v[76:79], a[156:159]
    v_add_u32 v27, 98304, v24
    v_add_u32 v28, 98304, v25
    v_mfma_f32_16x16x32_bf16 a[160:163], v[64:67], v[120:123], a[160:163]
    v_add_u32 v29, 98304, v26
    v_xor_b32 v6, 0x8000, v6
    v_mfma_f32_16x16x32_bf16 a[164:167], v[68:71], v[120:123], a[164:167]
    v_xor_b32 v7, 0x8000, v7
    v_xor_b32 v8, 0x8000, v8
    v_mfma_f32_16x16x32_bf16 a[168:171], v[72:75], v[120:123], a[168:171]
    v_xor_b32 v9, 0x8000, v9
    v_xor_b32 v10, 0x8000, v10
    v_mfma_f32_16x16x32_bf16 a[172:175], v[76:79], v[120:123], a[172:175]
    v_xor_b32 v11, 0x8000, v11
    v_xor_b32 v12, 0x8000, v12
    v_xor_b32 v13, 0x8000, v13
    s_waitcnt vmcnt(0) lgkmcnt(0)
    s_barrier
    v_mfma_f32_16x16x32_bf16 a[0:3], a[192:195], a[176:179], a[0:3]
    ds_read_b128 v[64:67], v4 offset:0
    v_mfma_f32_16x16x32_bf16 a[16:19], a[196:199], a[176:179], a[16:19]
    ds_read_b128 v[68:71], v4 offset:2048
    v_mfma_f32_16x16x32_bf16 a[20:23], a[196:199], a[180:183], a[20:23]
    v_mfma_f32_16x16x32_bf16 a[4:7], a[192:195], a[180:183], a[4:7]
    ds_read_b128 v[72:75], v4 offset:4096
    v_mfma_f32_16x16x32_bf16 a[8:11], a[192:195], a[184:187], a[8:11]
    ds_read_b128 v[76:79], v4 offset:6144
    v_mfma_f32_16x16x32_bf16 a[24:27], a[196:199], a[184:187], a[24:27]
    v_mfma_f32_16x16x32_bf16 a[28:31], a[196:199], a[188:191], a[28:31]
    ds_read_b64_tr_b16 v[80:81], v6 offset:0
    v_mfma_f32_16x16x32_bf16 a[12:15], a[192:195], a[188:191], a[12:15]
    ds_read_b64_tr_b16 v[82:83], v6 offset:2048
    v_mfma_f32_16x16x32_bf16 a[44:47], a[200:203], a[188:191], a[44:47]
    v_mfma_f32_16x16x32_bf16 a[60:63], a[204:207], a[188:191], a[60:63]
    ds_read_b64_tr_b16 v[84:85], v7 offset:0
    v_mfma_f32_16x16x32_bf16 a[56:59], a[204:207], a[184:187], a[56:59]
    ds_read_b64_tr_b16 v[86:87], v7 offset:2048
    v_mfma_f32_16x16x32_bf16 a[40:43], a[200:203], a[184:187], a[40:43]
    v_mfma_f32_16x16x32_bf16 a[36:39], a[200:203], a[180:183], a[36:39]
    ds_read_b64_tr_b16 v[88:89], v8 offset:0
    v_mfma_f32_16x16x32_bf16 a[52:55], a[204:207], a[180:183], a[52:55]
    ds_read_b64_tr_b16 v[90:91], v8 offset:2048
    v_mfma_f32_16x16x32_bf16 a[48:51], a[204:207], a[176:179], a[48:51]
    v_mfma_f32_16x16x32_bf16 a[32:35], a[200:203], a[176:179], a[32:35]
    ds_read_b64_tr_b16 v[92:93], v9 offset:0
    v_mfma_f32_16x16x32_bf16 a[64:67], a[208:211], a[176:179], a[64:67]
    ds_read_b64_tr_b16 v[94:95], v9 offset:2048
    v_mfma_f32_16x16x32_bf16 a[80:83], a[212:215], a[176:179], a[80:83]
    v_mfma_f32_16x16x32_bf16 a[84:87], a[212:215], a[180:183], a[84:87]
    ds_read_b64_tr_b16 v[96:97], v10 offset:0
    v_mfma_f32_16x16x32_bf16 a[68:71], a[208:211], a[180:183], a[68:71]
    ds_read_b64_tr_b16 v[98:99], v10 offset:2048
    v_mfma_f32_16x16x32_bf16 a[72:75], a[208:211], a[184:187], a[72:75]
    v_mfma_f32_16x16x32_bf16 a[88:91], a[212:215], a[184:187], a[88:91]
    ds_read_b64_tr_b16 v[100:101], v11 offset:0
    v_mfma_f32_16x16x32_bf16 a[92:95], a[212:215], a[188:191], a[92:95]
    ds_read_b64_tr_b16 v[102:103], v11 offset:2048
    v_mfma_f32_16x16x32_bf16 a[76:79], a[208:211], a[188:191], a[76:79]
    v_mfma_f32_16x16x32_bf16 a[108:111], a[216:219], a[188:191], a[108:111]
    ds_read_b64_tr_b16 v[104:105], v12 offset:0
    v_mfma_f32_16x16x32_bf16 a[124:127], a[220:223], a[188:191], a[124:127]
    ds_read_b64_tr_b16 v[106:107], v12 offset:2048
    v_mfma_f32_16x16x32_bf16 a[120:123], a[220:223], a[184:187], a[120:123]
    v_mfma_f32_16x16x32_bf16 a[104:107], a[216:219], a[184:187], a[104:107]
    ds_read_b64_tr_b16 v[108:109], v13 offset:0
    v_mfma_f32_16x16x32_bf16 a[100:103], a[216:219], a[180:183], a[100:103]
    ds_read_b64_tr_b16 v[110:111], v13 offset:2048
    v_mfma_f32_16x16x32_bf16 a[116:119], a[220:223], a[180:183], a[116:119]
    v_mfma_f32_16x16x32_bf16 a[112:115], a[220:223], a[176:179], a[112:115]
    ds_read_b64_tr_b16 v[112:113], v27 offset:0
    v_mfma_f32_16x16x32_bf16 a[96:99], a[216:219], a[176:179], a[96:99]
    ds_read_b64_tr_b16 v[114:115], v27 offset:2048
    v_mfma_f32_16x16x32_bf16 a[128:131], a[224:227], a[176:179], a[128:131]
    v_mfma_f32_16x16x32_bf16 a[132:135], a[224:227], a[180:183], a[132:135]
    ds_read_b64_tr_b16 v[116:117], v28 offset:0
    v_mfma_f32_16x16x32_bf16 a[136:139], a[224:227], a[184:187], a[136:139]
    ds_read_b64_tr_b16 v[118:119], v28 offset:2048
    v_mfma_f32_16x16x32_bf16 a[140:143], a[224:227], a[188:191], a[140:143]
    v_mfma_f32_16x16x32_bf16 a[144:147], a[228:231], a[176:179], a[144:147]
    ds_read_b64_tr_b16 v[120:121], v29 offset:0
    v_mfma_f32_16x16x32_bf16 a[148:151], a[228:231], a[180:183], a[148:151]
    ds_read_b64_tr_b16 v[122:123], v29 offset:2048
    v_mfma_f32_16x16x32_bf16 a[152:155], a[228:231], a[184:187], a[152:155]
    v_mfma_f32_16x16x32_bf16 a[156:159], a[228:231], a[188:191], a[156:159]
    v_mfma_f32_16x16x32_bf16 a[160:163], a[176:179], a[232:235], a[160:163]
    v_mfma_f32_16x16x32_bf16 a[164:167], a[180:183], a[232:235], a[164:167]
    v_mfma_f32_16x16x32_bf16 a[168:171], a[184:187], a[232:235], a[168:171]
    v_mfma_f32_16x16x32_bf16 a[172:175], a[188:191], a[232:235], a[172:175]
    s_waitcnt lgkmcnt(0)
    v_mfma_f32_16x16x32_bf16 a[0:3], v[80:83], v[64:67], a[0:3]
    ds_read_b128 a[176:179], v5 offset:0
    v_mfma_f32_16x16x32_bf16 a[16:19], v[84:87], v[64:67], a[16:19]
    ds_read_b128 a[180:183], v5 offset:2048
    v_mfma_f32_16x16x32_bf16 a[20:23], v[84:87], v[68:71], a[20:23]
    v_mfma_f32_16x16x32_bf16 a[4:7], v[80:83], v[68:71], a[4:7]
    ds_read_b128 a[184:187], v5 offset:4096
    v_mfma_f32_16x16x32_bf16 a[8:11], v[80:83], v[72:75], a[8:11]
    ds_read_b128 a[188:191], v5 offset:6144
    v_mfma_f32_16x16x32_bf16 a[24:27], v[84:87], v[72:75], a[24:27]
    v_mfma_f32_16x16x32_bf16 a[28:31], v[84:87], v[76:79], a[28:31]
    ds_read_b64_tr_b16 a[192:193], v6 offset:16384
    v_mfma_f32_16x16x32_bf16 a[12:15], v[80:83], v[76:79], a[12:15]
    ds_read_b64_tr_b16 a[194:195], v6 offset:18432
    v_mfma_f32_16x16x32_bf16 a[44:47], v[88:91], v[76:79], a[44:47]
    v_mfma_f32_16x16x32_bf16 a[60:63], v[92:95], v[76:79], a[60:63]
    ds_read_b64_tr_b16 a[196:197], v7 offset:16384
    v_mfma_f32_16x16x32_bf16 a[56:59], v[92:95], v[72:75], a[56:59]
    ds_read_b64_tr_b16 a[198:199], v7 offset:18432
    v_mfma_f32_16x16x32_bf16 a[40:43], v[88:91], v[72:75], a[40:43]
    v_mfma_f32_16x16x32_bf16 a[36:39], v[88:91], v[68:71], a[36:39]
    ds_read_b64_tr_b16 a[200:201], v8 offset:16384
    v_mfma_f32_16x16x32_bf16 a[52:55], v[92:95], v[68:71], a[52:55]
    ds_read_b64_tr_b16 a[202:203], v8 offset:18432
    v_mfma_f32_16x16x32_bf16 a[48:51], v[92:95], v[64:67], a[48:51]
    v_mfma_f32_16x16x32_bf16 a[32:35], v[88:91], v[64:67], a[32:35]
    ds_read_b64_tr_b16 a[204:205], v9 offset:16384
    v_mfma_f32_16x16x32_bf16 a[64:67], v[96:99], v[64:67], a[64:67]
    ds_read_b64_tr_b16 a[206:207], v9 offset:18432
    v_mfma_f32_16x16x32_bf16 a[80:83], v[100:103], v[64:67], a[80:83]
    v_mfma_f32_16x16x32_bf16 a[84:87], v[100:103], v[68:71], a[84:87]
    ds_read_b64_tr_b16 a[208:209], v10 offset:16384
    v_mfma_f32_16x16x32_bf16 a[68:71], v[96:99], v[68:71], a[68:71]
    ds_read_b64_tr_b16 a[210:211], v10 offset:18432
    v_mfma_f32_16x16x32_bf16 a[72:75], v[96:99], v[72:75], a[72:75]
    v_mfma_f32_16x16x32_bf16 a[88:91], v[100:103], v[72:75], a[88:91]
    ds_read_b64_tr_b16 a[212:213], v11 offset:16384
    v_mfma_f32_16x16x32_bf16 a[92:95], v[100:103], v[76:79], a[92:95]
    ds_read_b64_tr_b16 a[214:215], v11 offset:18432
    v_mfma_f32_16x16x32_bf16 a[76:79], v[96:99], v[76:79], a[76:79]
    v_mfma_f32_16x16x32_bf16 a[108:111], v[104:107], v[76:79], a[108:111]
    ds_read_b64_tr_b16 a[216:217], v12 offset:16384
    v_mfma_f32_16x16x32_bf16 a[124:127], v[108:111], v[76:79], a[124:127]
    ds_read_b64_tr_b16 a[218:219], v12 offset:18432
    v_mfma_f32_16x16x32_bf16 a[120:123], v[108:111], v[72:75], a[120:123]
    v_mfma_f32_16x16x32_bf16 a[104:107], v[104:107], v[72:75], a[104:107]
    ds_read_b64_tr_b16 a[220:221], v13 offset:16384
    v_mfma_f32_16x16x32_bf16 a[100:103], v[104:107], v[68:71], a[100:103]
    ds_read_b64_tr_b16 a[222:223], v13 offset:18432
    v_mfma_f32_16x16x32_bf16 a[116:119], v[108:111], v[68:71], a[116:119]
    v_mfma_f32_16x16x32_bf16 a[112:115], v[108:111], v[64:67], a[112:115]
    ds_read_b64_tr_b16 a[224:225], v27 offset:8192
    v_mfma_f32_16x16x32_bf16 a[96:99], v[104:107], v[64:67], a[96:99]
    ds_read_b64_tr_b16 a[226:227], v27 offset:10240
    v_mfma_f32_16x16x32_bf16 a[128:131], v[112:115], v[64:67], a[128:131]
    v_mfma_f32_16x16x32_bf16 a[132:135], v[112:115], v[68:71], a[132:135]
    ds_read_b64_tr_b16 a[228:229], v28 offset:8192
    v_mfma_f32_16x16x32_bf16 a[136:139], v[112:115], v[72:75], a[136:139]
    ds_read_b64_tr_b16 a[230:231], v28 offset:10240
    v_mfma_f32_16x16x32_bf16 a[140:143], v[112:115], v[76:79], a[140:143]
    v_mfma_f32_16x16x32_bf16 a[144:147], v[116:119], v[64:67], a[144:147]
    ds_read_b64_tr_b16 a[232:233], v29 offset:8192
    v_mfma_f32_16x16x32_bf16 a[148:151], v[116:119], v[68:71], a[148:151]
    ds_read_b64_tr_b16 a[234:235], v29 offset:10240
    v_mfma_f32_16x16x32_bf16 a[152:155], v[116:119], v[72:75], a[152:155]
    v_mfma_f32_16x16x32_bf16 a[156:159], v[116:119], v[76:79], a[156:159]
    v_mfma_f32_16x16x32_bf16 a[160:163], v[64:67], v[120:123], a[160:163]
    v_mfma_f32_16x16x32_bf16 a[164:167], v[68:71], v[120:123], a[164:167]
    v_mfma_f32_16x16x32_bf16 a[168:171], v[72:75], v[120:123], a[168:171]
    v_mfma_f32_16x16x32_bf16 a[172:175], v[76:79], v[120:123], a[172:175]
    s_waitcnt vmcnt(0) lgkmcnt(0)
    s_barrier
    s_lshl_b32 s75, s50, 8
    s_add_u32 s75, s75, 251658240
    v_min_u32 v45, 7, v0
    v_lshlrev_b32 v45, 2, v45
    buffer_load_dword v44, v45, s[40:43], s75 offen sc1
    v_mfma_f32_16x16x32_bf16 a[0:3], a[192:195], a[176:179], a[0:3]
    v_mfma_f32_16x16x32_bf16 a[16:19], a[196:199], a[176:179], a[16:19]
    v_mfma_f32_16x16x32_bf16 a[20:23], a[196:199], a[180:183], a[20:23]
    v_mfma_f32_16x16x32_bf16 a[4:7], a[192:195], a[180:183], a[4:7]
    v_mfma_f32_16x16x32_bf16 a[8:11], a[192:195], a[184:187], a[8:11]
    v_mfma_f32_16x16x32_bf16 a[24:27], a[196:199], a[184:187], a[24:27]
    v_mfma_f32_16x16x32_bf16 a[28:31], a[196:199], a[188:191], a[28:31]
    v_mfma_f32_16x16x32_bf16 a[12:15], a[192:195], a[188:191], a[12:15]
    v_mfma_f32_16x16x32_bf16 a[44:47], a[200:203], a[188:191], a[44:47]
    v_mfma_f32_16x16x32_bf16 a[60:63], a[204:207], a[188:191], a[60:63]
    v_mfma_f32_16x16x32_bf16 a[56:59], a[204:207], a[184:187], a[56:59]
    v_mfma_f32_16x16x32_bf16 a[40:43], a[200:203], a[184:187], a[40:43]
    v_mfma_f32_16x16x32_bf16 a[36:39], a[200:203], a[180:183], a[36:39]
    v_mfma_f32_16x16x32_bf16 a[52:55], a[204:207], a[180:183], a[52:55]
    v_mfma_f32_16x16x32_bf16 a[48:51], a[204:207], a[176:179], a[48:51]
    v_mfma_f32_16x16x32_bf16 a[32:35], a[200:203], a[176:179], a[32:35]
    v_mfma_f32_16x16x32_bf16 a[64:67], a[208:211], a[176:179], a[64:67]
    v_mfma_f32_16x16x32_bf16 a[80:83], a[212:215], a[176:179], a[80:83]
    v_mfma_f32_16x16x32_bf16 a[84:87], a[212:215], a[180:183], a[84:87]
    v_mfma_f32_16x16x32_bf16 a[68:71], a[208:211], a[180:183], a[68:71]
    v_mfma_f32_16x16x32_bf16 a[72:75], a[208:211], a[184:187], a[72:75]
    v_mfma_f32_16x16x32_bf16 a[88:91], a[212:215], a[184:187], a[88:91]
    v_mfma_f32_16x16x32_bf16 a[92:95], a[212:215], a[188:191], a[92:95]
    v_mfma_f32_16x16x32_bf16 a[76:79], a[208:211], a[188:191], a[76:79]
    v_mfma_f32_16x16x32_bf16 a[108:111], a[216:219], a[188:191], a[108:111]
    v_mfma_f32_16x16x32_bf16 a[124:127], a[220:223], a[188:191], a[124:127]
    v_mfma_f32_16x16x32_bf16 a[120:123], a[220:223], a[184:187], a[120:123]
    v_mfma_f32_16x16x32_bf16 a[104:107], a[216:219], a[184:187], a[104:107]
    v_mfma_f32_16x16x32_bf16 a[100:103], a[216:219], a[180:183], a[100:103]
    v_mfma_f32_16x16x32_bf16 a[116:119], a[220:223], a[180:183], a[116:119]
    v_mfma_f32_16x16x32_bf16 a[112:115], a[220:223], a[176:179], a[112:115]
    v_mfma_f32_16x16x32_bf16 a[96:99], a[216:219], a[176:179], a[96:99]
    v_mfma_f32_16x16x32_bf16 a[128:131], a[224:227], a[176:179], a[128:131]
    v_mfma_f32_16x16x32_bf16 a[132:135], a[224:227], a[180:183], a[132:135]
    v_mfma_f32_16x16x32_bf16 a[136:139], a[224:227], a[184:187], a[136:139]
    v_mfma_f32_16x16x32_bf16 a[140:143], a[224:227], a[188:191], a[140:143]
    v_mfma_f32_16x16x32_bf16 a[144:147], a[228:231], a[176:179], a[144:147]
    v_mfma_f32_16x16x32_bf16 a[148:151], a[228:231], a[180:183], a[148:151]
    v_mfma_f32_16x16x32_bf16 a[152:155], a[228:231], a[184:187], a[152:155]
    v_mfma_f32_16x16x32_bf16 a[156:159], a[228:231], a[188:191], a[156:159]
    v_mfma_f32_16x16x32_bf16 a[160:163], a[176:179], a[232:235], a[160:163]
    v_mfma_f32_16x16x32_bf16 a[164:167], a[180:183], a[232:235], a[164:167]
    v_mfma_f32_16x16x32_bf16 a[168:171], a[184:187], a[232:235], a[168:171]
    v_mfma_f32_16x16x32_bf16 a[172:175], a[188:191], a[232:235], a[172:175]
    s_waitcnt lgkmcnt(0)
    s_lshl_b32 s54, s51, 2
    s_add_u32 s52, s54, 4
    s_lshl_b32 s55, s50, 20
    s_add_u32 s56, s55, 16777216
    s_lshl_b32 s80, s52, 14
    s_add_u32 s57, s55, s80
    s_add_u32 s58, s56, s80
    s_lshl_b32 s59, s48, 12
    v_add_u32 v2, s59, v1
    s_mov_b32 s70, 0x3db8aa3b
    s_mov_b32 s71, 0x3db8aa3b
    s_waitcnt vmcnt(0)
    v_cmp_eq_u32 vcc, 1, v44
    s_nop 3
    s_cmp_eq_u64 vcc, -1
    s_cselect_b32 s74, 1, 0
    s_cbranch_scc0 LP_NOTYET
    s_add_u32 m0, s59, 0
    s_nop 0
    buffer_load_dwordx4 v2, s[40:43], s55 offen offset:0 sc1 lds
    buffer_load_dwordx4 v2, s[40:43], s55 offen offset:1024 sc1 lds
    buffer_load_dwordx4 v2, s[40:43], s55 offen offset:2048 sc1 lds
    buffer_load_dwordx4 v2, s[40:43], s55 offen offset:3072 sc1 lds
    s_add_u32 s55, s55, 16384
    s_add_u32 m0, s59, 16384
    s_nop 0
    buffer_load_dwordx4 v2, s[40:43], s56 offen offset:0 sc1 lds
    buffer_load_dwordx4 v2, s[40:43], s56 offen offset:1024 sc1 lds
    buffer_load_dwordx4 v2, s[40:43], s56 offen offset:2048 sc1 lds
    buffer_load_dwordx4 v2, s[40:43], s56 offen offset:3072 sc1 lds
    s_add_u32 s56, s56, 16384
    s_add_u32 m0, s59, 32768
    s_nop 0
    buffer_load_dwordx4 v2, s[40:43], s55 offen offset:0 sc1 lds
    buffer_load_dwordx4 v2, s[40:43], s55 offen offset:1024 sc1 lds
    buffer_load_dwordx4 v2, s[40:43], s55 offen offset:2048 sc1 lds
    buffer_load_dwordx4 v2, s[40:43], s55 offen offset:3072 sc1 lds
    s_add_u32 s55, s55, 16384
    s_add_u32 m0, s59, 49152
    s_nop 0
    buffer_load_dwordx4 v2, s[40:43], s56 offen offset:0 sc1 lds
    buffer_load_dwordx4 v2, s[40:43], s56 offen offset:1024 sc1 lds
    buffer_load_dwordx4 v2, s[40:43], s56 offen offset:2048 sc1 lds
    buffer_load_dwordx4 v2, s[40:43], s56 offen offset:3072 sc1 lds
    s_add_u32 s56, s56, 16384
    s_add_u32 m0, s59, 65536
    s_nop 0
    buffer_load_dwordx4 v2, s[40:43], s55 offen offset:0 sc1 lds
    buffer_load_dwordx4 v2, s[40:43], s55 offen offset:1024 sc1 lds
    buffer_load_dwordx4 v2, s[40:43], s55 offen offset:2048 sc1 lds
    buffer_load_dwordx4 v2, s[40:43], s55 offen offset:3072 sc1 lds
    s_add_u32 s55, s55, 16384
    s_add_u32 m0, s59, 81920
    s_nop 0
    buffer_load_dwordx4 v2, s[40:43], s56 offen offset:0 sc1 lds
    buffer_load_dwordx4 v2, s[40:43], s56 offen offset:1024 sc1 lds
    buffer_load_dwordx4 v2, s[40:43], s56 offen offset:2048 sc1 lds
    buffer_load_dwordx4 v2, s[40:43], s56 offen offset:3072 sc1 lds
    s_add_u32 s56, s56, 16384
LP_NOTYET:
    s_cmp_eq_u32 s3, 0
    s_cbranch_scc1 LP_NOLATE
    s_mov_b32 s65, s68
    buffer_store_dwordx4 v[128:131], v1, s[40:43], s65 offen offset:0 sc1
    buffer_store_dwordx4 v[132:135], v1, s[40:43], s65 offen offset:1024 sc1
    buffer_store_dwordx4 v[136:139], v1, s[40:43], s65 offen offset:2048 sc1
    buffer_store_dwordx4 v[140:143], v1, s[40:43], s65 offen offset:3072 sc1
    s_add_u32 s65, s65, s66
    buffer_store_dwordx4 v[144:147], v1, s[40:43], s65 offen offset:0 sc1
    buffer_store_dwordx4 v[148:151], v1, s[40:43], s65 offen offset:1024 sc1
    buffer_store_dwordx4 v[152:155], v1, s[40:43], s65 offen offset:2048 sc1
    buffer_store_dwordx4 v[156:159], v1, s[40:43], s65 offen offset:3072 sc1
    s_add_u32 s65, s65, s67
    buffer_store_dwordx4 v[160:163], v1, s[40:43], s65 offen offset:0 sc1
    buffer_store_dwordx4 v[164:167], v1, s[40:43], s65 offen offset:1024 sc1
    buffer_store_dwordx4 v[168:171], v1, s[40:43], s65 offen offset:2048 sc1
    buffer_store_dwordx4 v[172:175], v1, s[40:43], s65 offen offset:3072 sc1
    s_add_u32 s65, s65, s66
    buffer_store_dwordx4 v[176:179], v1, s[40:43], s65 offen offset:0 sc1
    buffer_store_dwordx4 v[180:183], v1, s[40:43], s65 offen offset:1024 sc1
    buffer_store_dwordx4 v[184:187], v1, s[40:43], s65 offen offset:2048 sc1
    buffer_store_dwordx4 v[188:191], v1, s[40:43], s65 offen offset:3072 sc1
    s_add_u32 s65, s65, s67
    buffer_store_dwordx4 v[192:195], v1, s[40:43], s65 offen offset:0 sc1
    buffer_store_dwordx4 v[196:199], v1, s[40:43], s65 offen offset:1024 sc1
    buffer_store_dwordx4 v[200:203], v1, s[40:43], s65 offen offset:2048 sc1
    buffer_store_dwordx4 v[204:207], v1, s[40:43], s65 offen offset:3072 sc1
    s_add_u32 s65, s65, s66
    buffer_store_dwordx4 v[208:211], v1, s[40:43], s65 offen offset:0 sc1
    buffer_store_dwordx4 v[212:215], v1, s[40:43], s65 offen offset:1024 sc1
    buffer_store_dwordx4 v[216:219], v1, s[40:43], s65 offen offset:2048 sc1
    buffer_store_dwordx4 v[220:223], v1, s[40:43], s65 offen offset:3072 sc1
    s_add_u32 s65, s65, s67
    buffer_store_dwordx4 v[224:227], v1, s[40:43], s65 offen offset:0 sc1
    buffer_store_dwordx4 v[228:231], v1, s[40:43], s65 offen offset:1024 sc1
    buffer_store_dwordx4 v[232:235], v1, s[40:43], s65 offen offset:2048 sc1
    buffer_store_dwordx4 v[236:239], v1, s[40:43], s65 offen offset:3072 sc1
    s_add_u32 s65, s65, s66
    buffer_store_dwordx4 v[240:243], v1, s[40:43], s65 offen offset:0 sc1
    buffer_store_dwordx4 v[244:247], v1, s[40:43], s65 offen offset:1024 sc1
    buffer_store_dwordx4 v[248:251], v1, s[40:43], s65 offen offset:2048 sc1
    buffer_store_dwordx4 v[252:255], v1, s[40:43], s65 offen offset:3072 sc1
    s_nop 1
LP_NOLATE:
    v_accvgpr_read_b32 v64, a128
    v_accvgpr_read_b32 v68, a144
    v_accvgpr_read_b32 v65, a129
    v_accvgpr_read_b32 v69, a145
    v_accvgpr_read_b32 v66, a130
    v_accvgpr_read_b32 v70, a146
    v_accvgpr_read_b32 v67, a131
    v_accvgpr_read_b32 v71, a147
    v_mul_f32 v64, s78, v64
    v_mul_f32 v68, v19, v68
    v_mul_f32 v65, s78, v65
    v_mul_f32 v69, v19, v69
    v_mul_f32 v66, s78, v66
    v_mul_f32 v70, v19, v70
    v_mul_f32 v67, s78, v67
    v_mul_f32 v71, v19, v71
    v_cvt_pk_bf16_f32 v72, v64, v65
    v_cvt_pk_bf16_f32 v73, v66, v67
    v_cvt_pk_bf16_f32 v74, v68, v69
    v_cvt_pk_bf16_f32 v75, v70, v71
    buffer_store_dwordx4 v[72:75], v17, s[40:43], s76 offen offset:0 sc1
    v_accvgpr_read_b32 v76, a132
    v_accvgpr_read_b32 v80, a148
    v_accvgpr_read_b32 v77, a133
    v_accvgpr_read_b32 v81, a149
    v_accvgpr_read_b32 v78, a134
    v_accvgpr_read_b32 v82, a150
    v_accvgpr_read_b32 v79, a135
    v_accvgpr_read_b32 v83, a151
    v_mul_f32 v76, s78, v76
    v_mul_f32 v80, v19, v80
    v_mul_f32 v77, s78, v77
    v_mul_f32 v81, v19, v81
    v_mul_f32 v78, s78, v78
    v_mul_f32 v82, v19, v82
    v_mul_f32 v79, s78, v79
    v_mul_f32 v83, v19, v83
    v_cvt_pk_bf16_f32 v84, v76, v77
    v_cvt_pk_bf16_f32 v85, v78, v79
    v_cvt_pk_bf16_f32 v86, v80, v81
    v_cvt_pk_bf16_f32 v87, v82, v83
    buffer_store_dwordx4 v[84:87], v17, s[40:43], s76 offen offset:128 sc1
    v_accvgpr_read_b32 v88, a136
    v_accvgpr_read_b32 v92, a152
    v_accvgpr_read_b32 v89, a137
    v_accvgpr_read_b32 v93, a153
    v_accvgpr_read_b32 v90, a138
    v_accvgpr_read_b32 v94, a154
    v_accvgpr_read_b32 v91, a139
    v_accvgpr_read_b32 v95, a155
    v_mul_f32 v88, s78, v88
    v_mul_f32 v92, v19, v92
    v_mul_f32 v89, s78, v89
    v_mul_f32 v93, v19, v93
    v_mul_f32 v90, s78, v90
    v_mul_f32 v94, v19, v94
    v_mul_f32 v91, s78, v91
    v_mul_f32 v95, v19, v95
    v_cvt_pk_bf16_f32 v96, v88, v89
    v_cvt_pk_bf16_f32 v97, v90, v91
    v_cvt_pk_bf16_f32 v98, v92, v93
    v_cvt_pk_bf16_f32 v99, v94, v95
    buffer_store_dwordx4 v[96:99], v17, s[40:43], s76 offen offset:2048 sc1
    v_accvgpr_read_b32 v100, a140
    v_accvgpr_read_b32 v104, a156
    v_accvgpr_read_b32 v101, a141
    v_accvgpr_read_b32 v105, a157
    v_accvgpr_read_b32 v102, a142
    v_accvgpr_read_b32 v106, a158
    v_accvgpr_read_b32 v103, a143
    v_accvgpr_read_b32 v107, a159
    v_mul_f32 v100, s78, v100
    v_mul_f32 v104, v19, v104
    v_mul_f32 v101, s78, v101
    v_mul_f32 v105, v19, v105
    v_mul_f32 v102, s78, v102
    v_mul_f32 v106, v19, v106
    v_mul_f32 v103, s78, v103
    v_mul_f32 v107, v19, v107
    v_cvt_pk_bf16_f32 v108, v100, v101
    v_cvt_pk_bf16_f32 v109, v102, v103
    v_cvt_pk_bf16_f32 v110, v104, v105
    v_cvt_pk_bf16_f32 v111, v106, v107
    buffer_store_dwordx4 v[108:111], v17, s[40:43], s76 offen offset:2176 sc1
    v_accvgpr_read_b32 v128, a160
    v_accvgpr_read_b32 v132, a164
    v_accvgpr_read_b32 v129, a161
    v_accvgpr_read_b32 v133, a165
    v_accvgpr_read_b32 v130, a162
    v_accvgpr_read_b32 v134, a166
    v_accvgpr_read_b32 v131, a163
    v_accvgpr_read_b32 v135, a167
    v_fma_f32 v128, v128, v20, v21
    v_fma_f32 v129, v129, v20, v21
    v_fma_f32 v130, v130, v20, v21
    v_fma_f32 v131, v131, v20, v21
    v_fma_f32 v132, v132, v20, v21
    v_fma_f32 v133, v133, v20, v21
    v_fma_f32 v134, v134, v20, v21
    v_fma_f32 v135, v135, v20, v21
    v_cvt_pk_bf16_f32 v136, v128, v129
    v_cvt_pk_bf16_f32 v137, v130, v131
    v_cvt_pk_bf16_f32 v138, v132, v133
    v_cvt_pk_bf16_f32 v139, v134, v135
    buffer_store_dwordx4 v[136:139], v18, s[40:43], s77 offen offset:0 sc1
    v_accvgpr_read_b32 v140, a168
    v_accvgpr_read_b32 v144, a172
    v_accvgpr_read_b32 v141, a169
    v_accvgpr_read_b32 v145, a173
    v_accvgpr_read_b32 v142, a170
    v_accvgpr_read_b32 v146, a174
    v_accvgpr_read_b32 v143, a171
    v_accvgpr_read_b32 v147, a175
    v_fma_f32 v140, v140, v20, v21
    v_fma_f32 v141, v141, v20, v21
    v_fma_f32 v142, v142, v20, v21
    v_fma_f32 v143, v143, v20, v21
    v_fma_f32 v144, v144, v20, v21
    v_fma_f32 v145, v145, v20, v21
    v_fma_f32 v146, v146, v20, v21
    v_fma_f32 v147, v147, v20, v21
    v_cvt_pk_bf16_f32 v148, v140, v141
    v_cvt_pk_bf16_f32 v149, v142, v143
    v_cvt_pk_bf16_f32 v150, v144, v145
    v_cvt_pk_bf16_f32 v151, v146, v147
    buffer_store_dwordx4 v[148:151], v18, s[40:43], s77 offen offset:2048 sc1
    v_accvgpr_read_b32 v160, a0
    v_accvgpr_read_b32 v164, a16
    v_accvgpr_read_b32 v161, a1
    v_accvgpr_read_b32 v165, a17
    v_accvgpr_read_b32 v162, a2
    v_accvgpr_read_b32 v166, a18
    v_accvgpr_read_b32 v163, a3
    v_accvgpr_read_b32 v167, a19
    v_pk_mul_f32 v[160:161], v[160:161], s[70:71]
    v_pk_mul_f32 v[162:163], v[162:163], s[70:71]
    v_pk_mul_f32 v[164:165], v[164:165], s[70:71]
    v_pk_mul_f32 v[166:167], v[166:167], s[70:71]
    v_cvt_pk_bf16_f32 v168, v160, v161
    v_cvt_pk_bf16_f32 v169, v162, v163
    v_cvt_pk_bf16_f32 v170, v164, v165
    v_cvt_pk_bf16_f32 v171, v166, v167
    ds_write_b128 v30, v[168:171] offset:0
    v_accvgpr_read_b32 v172, a32
    v_accvgpr_read_b32 v176, a48
    v_accvgpr_read_b32 v173, a33
    v_accvgpr_read_b32 v177, a49
    v_accvgpr_read_b32 v174, a34
    v_accvgpr_read_b32 v178, a50
    v_accvgpr_read_b32 v175, a35
    v_accvgpr_read_b32 v179, a51
    v_pk_mul_f32 v[172:173], v[172:173], s[70:71]
    v_pk_mul_f32 v[174:175], v[174:175], s[70:71]
    v_pk_mul_f32 v[176:177], v[176:177], s[70:71]
    v_pk_mul_f32 v[178:179], v[178:179], s[70:71]
    v_cvt_pk_bf16_f32 v180, v172, v173
    v_cvt_pk_bf16_f32 v181, v174, v175
    v_cvt_pk_bf16_f32 v182, v176, v177
    v_cvt_pk_bf16_f32 v183, v178, v179
    ds_write_b128 v30, v[180:183] offset:1024
    v_accvgpr_read_b32 v184, a64
    v_accvgpr_read_b32 v188, a80
    v_accvgpr_read_b32 v185, a65
    v_accvgpr_read_b32 v189, a81
    v_accvgpr_read_b32 v186, a66
    v_accvgpr_read_b32 v190, a82
    v_accvgpr_read_b32 v187, a67
    v_accvgpr_read_b32 v191, a83
    v_pk_mul_f32 v[184:185], v[184:185], s[70:71]
    v_pk_mul_f32 v[186:187], v[186:187], s[70:71]
    v_pk_mul_f32 v[188:189], v[188:189], s[70:71]
    v_pk_mul_f32 v[190:191], v[190:191], s[70:71]
    v_cvt_pk_bf16_f32 v192, v184, v185
    v_cvt_pk_bf16_f32 v193, v186, v187
    v_cvt_pk_bf16_f32 v194, v188, v189
    v_cvt_pk_bf16_f32 v195, v190, v191
    ds_write_b128 v30, v[192:195] offset:2048
    v_accvgpr_read_b32 v196, a96
    v_accvgpr_read_b32 v200, a112
    v_accvgpr_read_b32 v197, a97
    v_accvgpr_read_b32 v201, a113
    v_accvgpr_read_b32 v198, a98
    v_accvgpr_read_b32 v202, a114
    v_accvgpr_read_b32 v199, a99
    v_accvgpr_read_b32 v203, a115
    v_pk_mul_f32 v[196:197], v[196:197], s[70:71]
    v_pk_mul_f32 v[198:199], v[198:199], s[70:71]
    v_pk_mul_f32 v[200:201], v[200:201], s[70:71]
    v_pk_mul_f32 v[202:203], v[202:203], s[70:71]
    v_cvt_pk_bf16_f32 v204, v196, v197
    v_cvt_pk_bf16_f32 v205, v198, v199
    v_cvt_pk_bf16_f32 v206, v200, v201
    v_cvt_pk_bf16_f32 v207, v202, v203
    ds_write_b128 v30, v[204:207] offset:3072
    v_accvgpr_read_b32 v208, a4
    v_accvgpr_read_b32 v212, a20
    v_accvgpr_read_b32 v209, a5
    v_accvgpr_read_b32 v213, a21
    v_accvgpr_read_b32 v210, a6
    v_accvgpr_read_b32 v214, a22
    v_accvgpr_read_b32 v211, a7
    v_accvgpr_read_b32 v215, a23
    v_pk_mul_f32 v[208:209], v[208:209], s[70:71]
    v_pk_mul_f32 v[210:211], v[210:211], s[70:71]
    v_pk_mul_f32 v[212:213], v[212:213], s[70:71]
    v_pk_mul_f32 v[214:215], v[214:215], s[70:71]
    v_cvt_pk_bf16_f32 v216, v208, v209
    v_cvt_pk_bf16_f32 v217, v210, v211
    v_cvt_pk_bf16_f32 v218, v212, v213
    v_cvt_pk_bf16_f32 v219, v214, v215
    ds_write_b128 v30, v[216:219] offset:8192
    v_accvgpr_read_b32 v220, a36
    v_accvgpr_read_b32 v224, a52
    v_accvgpr_read_b32 v221, a37
    v_accvgpr_read_b32 v225, a53
    v_accvgpr_read_b32 v222, a38
    v_accvgpr_read_b32 v226, a54
    v_accvgpr_read_b32 v223, a39
    v_accvgpr_read_b32 v227, a55
    v_pk_mul_f32 v[220:221], v[220:221], s[70:71]
    v_pk_mul_f32 v[222:223], v[222:223], s[70:71]
    v_pk_mul_f32 v[224:225], v[224:225], s[70:71]
    v_pk_mul_f32 v[226:227], v[226:227], s[70:71]
    v_cvt_pk_bf16_f32 v228, v220, v221
    v_cvt_pk_bf16_f32 v229, v222, v223
    v_cvt_pk_bf16_f32 v230, v224, v225
    v_cvt_pk_bf16_f32 v231, v226, v227
    ds_write_b128 v30, v[228:231] offset:9216
    v_accvgpr_read_b32 v232, a68
    v_accvgpr_read_b32 v236, a84
    v_accvgpr_read_b32 v233, a69
    v_accvgpr_read_b32 v237, a85
    v_accvgpr_read_b32 v234, a70
    v_accvgpr_read_b32 v238, a86
    v_accvgpr_read_b32 v235, a71
    v_accvgpr_read_b32 v239, a87
    v_pk_mul_f32 v[232:233], v[232:233], s[70:71]
    v_pk_mul_f32 v[234:235], v[234:235], s[70:71]
    v_pk_mul_f32 v[236:237], v[236:237], s[70:71]
    v_pk_mul_f32 v[238:239], v[238:239], s[70:71]
    v_cvt_pk_bf16_f32 v240, v232, v233
    v_cvt_pk_bf16_f32 v241, v234, v235
    v_cvt_pk_bf16_f32 v242, v236, v237
    v_cvt_pk_bf16_f32 v243, v238, v239
    ds_write_b128 v30, v[240:243] offset:10240
    v_accvgpr_read_b32 v244, a100
    v_accvgpr_read_b32 v248, a116
    v_accvgpr_read_b32 v245, a101
    v_accvgpr_read_b32 v249, a117
    v_accvgpr_read_b32 v246, a102
    v_accvgpr_read_b32 v250, a118
    v_accvgpr_read_b32 v247, a103
    v_accvgpr_read_b32 v251, a119
    v_pk_mul_f32 v[244:245], v[244:245], s[70:71]
    v_pk_mul_f32 v[246:247], v[246:247], s[70:71]
    v_pk_mul_f32 v[248:249], v[248:249], s[70:71]
    v_pk_mul_f32 v[250:251], v[250:251], s[70:71]
    v_cvt_pk_bf16_f32 v252, v244, v245
    v_cvt_pk_bf16_f32 v253, v246, v247
    v_cvt_pk_bf16_f32 v254, v248, v249
    v_cvt_pk_bf16_f32 v255, v250, v251
    ds_write_b128 v30, v[252:255] offset:11264
    v_accvgpr_read_b32 v160, a8
    v_accvgpr_read_b32 v164, a24
    v_accvgpr_read_b32 v161, a9
    v_accvgpr_read_b32 v165, a25
    v_accvgpr_read_b32 v162, a10
    v_accvgpr_read_b32 v166, a26
    v_accvgpr_read_b32 v163, a11
    v_accvgpr_read_b32 v167, a27
    v_pk_mul_f32 v[160:161], v[160:161], s[70:71]
    v_pk_mul_f32 v[162:163], v[162:163], s[70:71]
    v_pk_mul_f32 v[164:165], v[164:165], s[70:71]
    v_pk_mul_f32 v[166:167], v[166:167], s[70:71]
    v_cvt_pk_bf16_f32 v168, v160, v161
    v_cvt_pk_bf16_f32 v169, v162, v163
    v_cvt_pk_bf16_f32 v170, v164, v165
    v_cvt_pk_bf16_f32 v171, v166, v167
    ds_write_b128 v30, v[168:171] offset:16384
    v_accvgpr_read_b32 v172, a40
    v_accvgpr_read_b32 v176, a56
    v_accvgpr_read_b32 v173, a41
    v_accvgpr_read_b32 v177, a57
    v_accvgpr_read_b32 v174, a42
    v_accvgpr_read_b32 v178, a58
    v_accvgpr_read_b32 v175, a43
    v_accvgpr_read_b32 v179, a59
    v_pk_mul_f32 v[172:173], v[172:173], s[70:71]
    v_pk_mul_f32 v[174:175], v[174:175], s[70:71]
    v_pk_mul_f32 v[176:177], v[176:177], s[70:71]
    v_pk_mul_f32 v[178:179], v[178:179], s[70:71]
    v_cvt_pk_bf16_f32 v180, v172, v173
    v_cvt_pk_bf16_f32 v181, v174, v175
    v_cvt_pk_bf16_f32 v182, v176, v177
    v_cvt_pk_bf16_f32 v183, v178, v179
    ds_write_b128 v30, v[180:183] offset:17408
    v_accvgpr_read_b32 v184, a72
    v_accvgpr_read_b32 v188, a88
    v_accvgpr_read_b32 v185, a73
    v_accvgpr_read_b32 v189, a89
    v_accvgpr_read_b32 v186, a74
    v_accvgpr_read_b32 v190, a90
    v_accvgpr_read_b32 v187, a75
    v_accvgpr_read_b32 v191, a91
    v_pk_mul_f32 v[184:185], v[184:185], s[70:71]
    v_pk_mul_f32 v[186:187], v[186:187], s[70:71]
    v_pk_mul_f32 v[188:189], v[188:189], s[70:71]
    v_pk_mul_f32 v[190:191], v[190:191], s[70:71]
    v_cvt_pk_bf16_f32 v192, v184, v185
    v_cvt_pk_bf16_f32 v193, v186, v187
    v_cvt_pk_bf16_f32 v194, v188, v189
    v_cvt_pk_bf16_f32 v195, v190, v191
    ds_write_b128 v30, v[192:195] offset:18432
    v_accvgpr_read_b32 v196, a104
    v_accvgpr_read_b32 v200, a120
    v_accvgpr_read_b32 v197, a105
    v_accvgpr_read_b32 v201, a121
    v_accvgpr_read_b32 v198, a106
    v_accvgpr_read_b32 v202, a122
    v_accvgpr_read_b32 v199, a107
    v_accvgpr_read_b32 v203, a123
    v_pk_mul_f32 v[196:197], v[196:197], s[70:71]
    v_pk_mul_f32 v[198:199], v[198:199], s[70:71]
    v_pk_mul_f32 v[200:201], v[200:201], s[70:71]
    v_pk_mul_f32 v[202:203], v[202:203], s[70:71]
    v_cvt_pk_bf16_f32 v204, v196, v197
    v_cvt_pk_bf16_f32 v205, v198, v199
    v_cvt_pk_bf16_f32 v206, v200, v201
    v_cvt_pk_bf16_f32 v207, v202, v203
    ds_write_b128 v30, v[204:207] offset:19456
    v_accvgpr_read_b32 v208, a12
    v_accvgpr_read_b32 v212, a28
    v_accvgpr_read_b32 v209, a13
    v_accvgpr_read_b32 v213, a29
    v_accvgpr_read_b32 v210, a14
    v_accvgpr_read_b32 v214, a30
    v_accvgpr_read_b32 v211, a15
    v_accvgpr_read_b32 v215, a31
    v_pk_mul_f32 v[208:209], v[208:209], s[70:71]
    v_pk_mul_f32 v[210:211], v[210:211], s[70:71]
    v_pk_mul_f32 v[212:213], v[212:213], s[70:71]
    v_pk_mul_f32 v[214:215], v[214:215], s[70:71]
    v_cvt_pk_bf16_f32 v216, v208, v209
    v_cvt_pk_bf16_f32 v217, v210, v211
    v_cvt_pk_bf16_f32 v218, v212, v213
    v_cvt_pk_bf16_f32 v219, v214, v215
    ds_write_b128 v30, v[216:219] offset:24576
    v_accvgpr_read_b32 v220, a44
    v_accvgpr_read_b32 v224, a60
    v_accvgpr_read_b32 v221, a45
    v_accvgpr_read_b32 v225, a61
    v_accvgpr_read_b32 v222, a46
    v_accvgpr_read_b32 v226, a62
    v_accvgpr_read_b32 v223, a47
    v_accvgpr_read_b32 v227, a63
    v_pk_mul_f32 v[220:221], v[220:221], s[70:71]
    v_pk_mul_f32 v[222:223], v[222:223], s[70:71]
    v_pk_mul_f32 v[224:225], v[224:225], s[70:71]
    v_pk_mul_f32 v[226:227], v[226:227], s[70:71]
    v_cvt_pk_bf16_f32 v228, v220, v221
    v_cvt_pk_bf16_f32 v229, v222, v223
    v_cvt_pk_bf16_f32 v230, v224, v225
    v_cvt_pk_bf16_f32 v231, v226, v227
    ds_write_b128 v30, v[228:231] offset:25600
    v_accvgpr_read_b32 v232, a76
    v_accvgpr_read_b32 v236, a92
    v_accvgpr_read_b32 v233, a77
    v_accvgpr_read_b32 v237, a93
    v_accvgpr_read_b32 v234, a78
    v_accvgpr_read_b32 v238, a94
    v_accvgpr_read_b32 v235, a79
    v_accvgpr_read_b32 v239, a95
    v_pk_mul_f32 v[232:233], v[232:233], s[70:71]
    v_pk_mul_f32 v[234:235], v[234:235], s[70:71]
    v_pk_mul_f32 v[236:237], v[236:237], s[70:71]
    v_pk_mul_f32 v[238:239], v[238:239], s[70:71]
    v_cvt_pk_bf16_f32 v240, v232, v233
    v_cvt_pk_bf16_f32 v241, v234, v235
    v_cvt_pk_bf16_f32 v242, v236, v237
    v_cvt_pk_bf16_f32 v243, v238, v239
    ds_write_b128 v30, v[240:243] offset:26624
    v_accvgpr_read_b32 v244, a108
    v_accvgpr_read_b32 v248, a124
    v_accvgpr_read_b32 v245, a109
    v_accvgpr_read_b32 v249, a125
    v_accvgpr_read_b32 v246, a110
    v_accvgpr_read_b32 v250, a126
    v_accvgpr_read_b32 v247, a111
    v_accvgpr_read_b32 v251, a127
    v_pk_mul_f32 v[244:245], v[244:245], s[70:71]
    v_pk_mul_f32 v[246:247], v[246:247], s[70:71]
    v_pk_mul_f32 v[248:249], v[248:249], s[70:71]
    v_pk_mul_f32 v[250:251], v[250:251], s[70:71]
    v_cvt_pk_bf16_f32 v252, v244, v245
    v_cvt_pk_bf16_f32 v253, v246, v247
    v_cvt_pk_bf16_f32 v254, v248, v249
    v_cvt_pk_bf16_f32 v255, v250, v251
    ds_write_b128 v30, v[252:255] offset:27648
    s_mov_b32 s36, s20
    s_mov_b32 s37, s21
    s_mov_b32 s38, 3670016
    s_mov_b32 s39, 0x20000
    v_and_b32 v16, 15, v0
    v_lshrrev_b32 v17, 4, v0
    v_lshlrev_b32 v18, 2, v17
    v_mov_b32 v20, 0xff800000
    v_add_u32 v19, 0, v18
    v_cmp_gt_u32 vcc, v19, v16
    s_nop 1
    v_cndmask_b32 v10, 0, v20, vcc
    v_add_u32 v19, 1, v18
    v_cmp_gt_u32 vcc, v19, v16
    s_nop 1
    v_cndmask_b32 v11, 0, v20, vcc
    v_add_u32 v19, 2, v18
    v_cmp_gt_u32 vcc, v19, v16
    s_nop 1
    v_cndmask_b32 v12, 0, v20, vcc
    v_add_u32 v19, 3, v18
    v_cmp_gt_u32 vcc, v19, v16
    s_nop 1
    v_cndmask_b32 v13, 0, v20, vcc
    v_bfe_u32 v19, v0, 2, 2
    v_add_u32 v19, v19, v18
    v_bfe_u32 v21, v19, 1, 2
    v_mul_u32_u24 v19, 896, v19
    v_and_b32 v22, 3, v0
    v_lshl_add_u32 v19, v22, 3, v19
    v_add_u32 v19, 131072, v19
    v_xor_b32 v22, 0, v21
    v_lshl_add_u32 v40, v22, 5, v19
    v_xor_b32 v22, 1, v21
    v_lshl_add_u32 v41, v22, 5, v19
    v_xor_b32 v22, 2, v21
    v_lshl_add_u32 v42, v22, 5, v19
    v_xor_b32 v22, 3, v21
    v_lshl_add_u32 v43, v22, 5, v19
    v_add_u32 v16, 0, v0
    v_mul_u32_u24 v17, 1171, v16
    v_lshrrev_b32 v17, 16, v17
    v_mul_u32_u24 v18, 56, v17
    v_sub_u32 v18, v16, v18
    v_bfe_u32 v19, v17, 1, 2
    v_lshlrev_b32 v19, 1, v19
    v_xor_b32 v18, v18, v19
    v_mul_u32_u24 v17, 896, v17
    v_lshl_add_u32 v17, v18, 4, v17
    v_subrev_u32 v32, 0, v17
    v_add_u32 v16, 64, v0
    v_mul_u32_u24 v17, 1171, v16
    v_lshrrev_b32 v17, 16, v17
    v_mul_u32_u24 v18, 56, v17
    v_sub_u32 v18, v16, v18
    v_bfe_u32 v19, v17, 1, 2
    v_lshlrev_b32 v19, 1, v19
    v_xor_b32 v18, v18, v19
    v_mul_u32_u24 v17, 896, v17
    v_lshl_add_u32 v17, v18, 4, v17
    v_subrev_u32 v33, 1024, v17
    v_add_u32 v16, 128, v0
    v_mul_u32_u24 v17, 1171, v16
    v_lshrrev_b32 v17, 16, v17
    v_mul_u32_u24 v18, 56, v17
    v_sub_u32 v18, v16, v18
    v_bfe_u32 v19, v17, 1, 2
    v_lshlrev_b32 v19, 1, v19
    v_xor_b32 v18, v18, v19
    v_mul_u32_u24 v17, 896, v17
    v_lshl_add_u32 v17, v18, 4, v17
    v_subrev_u32 v34, 2048, v17
    v_add_u32 v16, 192, v0
    v_mul_u32_u24 v17, 1171, v16
    v_lshrrev_b32 v17, 16, v17
    v_mul_u32_u24 v18, 56, v17
    v_sub_u32 v18, v16, v18
    v_bfe_u32 v19, v17, 1, 2
    v_lshlrev_b32 v19, 1, v19
    v_xor_b32 v18, v18, v19
    v_mul_u32_u24 v17, 896, v17
    v_lshl_add_u32 v17, v18, 4, v17
    v_subrev_u32 v35, 3072, v17
    v_add_u32 v16, 256, v0
    v_mul_u32_u24 v17, 1171, v16
    v_lshrrev_b32 v17, 16, v17
    v_mul_u32_u24 v18, 56, v17
    v_sub_u32 v18, v16, v18
    v_bfe_u32 v19, v17, 1, 2
    v_lshlrev_b32 v19, 1, v19
    v_xor_b32 v18, v18, v19
    v_mul_u32_u24 v17, 896, v17
    v_lshl_add_u32 v17, v18, 4, v17
    v_subrev_u32 v36, 0, v17
    v_add_u32 v16, 320, v0
    v_mul_u32_u24 v17, 1171, v16
    v_lshrrev_b32 v17, 16, v17
    v_mul_u32_u24 v18, 56, v17
    v_sub_u32 v18, v16, v18
    v_bfe_u32 v19, v17, 1, 2
    v_lshlrev_b32 v19, 1, v19
    v_xor_b32 v18, v18, v19
    v_mul_u32_u24 v17, 896, v17
    v_lshl_add_u32 v17, v18, 4, v17
    v_subrev_u32 v37, 1024, v17
    v_add_u32 v16, 384, v0
    v_mul_u32_u24 v17, 1171, v16
    v_lshrrev_b32 v17, 16, v17
    v_mul_u32_u24 v18, 56, v17
    v_sub_u32 v18, v16, v18
    v_bfe_u32 v19, v17, 1, 2
    v_lshlrev_b32 v19, 1, v19
    v_xor_b32 v18, v18, v19
    v_mul_u32_u24 v17, 896, v17
    v_lshl_add_u32 v17, v18, 4, v17
    v_subrev_u32 v38, 2048, v17
    s_mul_i32 s65, s50, 229376
    s_mul_i32 s69, s48, 7168
    s_add_u32 s65, s65, s69
    s_add_u32 s66, s50, 4
    s_mul_i32 s66, s66, 1835008
    s_mul_i32 s80, s51, 114688
    s_add_u32 s66, s66, s80
    s_add_u32 s66, s66, 67108864
    s_sub_u32 s67, 7, s48
    s_mul_i32 s80, s67, 14336
    s_add_u32 s71, s66, s80
    s_mul_i32 s80, s48, 14336
    s_add_u32 s66, s66, s80
    s_lshl_b32 s80, s67, 13
    s_add_u32 s80, s80, 98304
    v_add_u32 v30, s80, v1
    s_lshl_b32 s76, s51, 8
    s_lshl_b32 s80, s50, 2
    s_add_u32 s76, s76, s80
    s_add_u32 s76, s76, 251670528
    s_mov_b32 s77, 1
    s_mov_b32 s68, 268435456
    s_mov_b32 s62, 0xff800000
    s_mov_b32 s64, 1
    v_mov_b32 v96, 0
    v_mov_b32 v97, 0
    v_mov_b32 v98, 0
    v_mov_b32 v99, 0
    v_mov_b32 v100, 0
    v_mov_b32 v101, 0
    v_mov_b32 v102, 0
    v_mov_b32 v103, 0
    v_mov_b32 v104, 0
    v_mov_b32 v105, 0
    v_mov_b32 v106, 0
    v_mov_b32 v107, 0
    v_mov_b32 v108, 0
    v_mov_b32 v109, 0
    v_mov_b32 v110, 0
    v_mov_b32 v111, 0
    v_mov_b32 v6, 0
    v_mov_b32 v7, 0
    v_mov_b32 v8, 0
    v_mov_b32 v9, 0
    v_mov_b32 v14, 0
    v_mov_b32 v15, 0
    v_mov_b32 v4, v1
    v_add_u32 v3, 0x10000, v1
    s_mov_b32 s53, 0
    s_cmp_ge_u32 s53, s54
    s_cbranch_scc1 LC_9
LC_10:
    s_cmp_eq_u32 s74, 1
    s_cbranch_scc1 LP_HAVE
    s_mov_b32 s73, 65536
    buffer_load_dword v44, v45, s[40:43], s75 offen sc1
LPL_12:
    s_waitcnt vmcnt(0)
    v_cmp_eq_u32 vcc, 1, v44
    s_nop 3
    s_cmp_eq_u64 vcc, -1
    s_cbranch_scc1 LPK_11
    s_sub_u32 s73, s73, 1
    s_cmp_eq_u32 s73, 0
    s_cbranch_scc1 LPK_11
    s_sleep 8
    buffer_load_dword v44, v45, s[40:43], s75 offen sc1
    s_branch LPL_12
LPK_11:
    s_add_u32 m0, s59, 0
    s_nop 0
    buffer_load_dwordx4 v2, s[40:43], s55 offen offset:0 sc1 lds
    buffer_load_dwordx4 v2, s[40:43], s55 offen offset:1024 sc1 lds
    buffer_load_dwordx4 v2, s[40:43], s55 offen offset:2048 sc1 lds
    buffer_load_dwordx4 v2, s[40:43], s55 offen offset:3072 sc1 lds
    s_add_u32 s55, s55, 16384
    s_add_u32 m0, s59, 16384
    s_nop 0
    buffer_load_dwordx4 v2, s[40:43], s56 offen offset:0 sc1 lds
    buffer_load_dwordx4 v2, s[40:43], s56 offen offset:1024 sc1 lds
    buffer_load_dwordx4 v2, s[40:43], s56 offen offset:2048 sc1 lds
    buffer_load_dwordx4 v2, s[40:43], s56 offen offset:3072 sc1 lds
    s_add_u32 s56, s56, 16384
    s_add_u32 m0, s59, 32768
    s_nop 0
    buffer_load_dwordx4 v2, s[40:43], s55 offen offset:0 sc1 lds
    buffer_load_dwordx4 v2, s[40:43], s55 offen offset:1024 sc1 lds
    buffer_load_dwordx4 v2, s[40:43], s55 offen offset:2048 sc1 lds
    buffer_load_dwordx4 v2, s[40:43], s55 offen offset:3072 sc1 lds
    s_add_u32 s55, s55, 16384
    s_add_u32 m0, s59, 49152
    s_nop 0
    buffer_load_dwordx4 v2, s[40:43], s56 offen offset:0 sc1 lds
    buffer_load_dwordx4 v2, s[40:43], s56 offen offset:1024 sc1 lds
    buffer_load_dwordx4 v2, s[40:43], s56 offen offset:2048 sc1 lds
    buffer_load_dwordx4 v2, s[40:43], s56 offen offset:3072 sc1 lds
    s_add_u32 s56, s56, 16384
    s_add_u32 m0, s59, 65536
    s_nop 0
    buffer_load_dwordx4 v2, s[40:43], s55 offen offset:0 sc1 lds
    buffer_load_dwordx4 v2, s[40:43], s55 offen offset:1024 sc1 lds
    buffer_load_dwordx4 v2, s[40:43], s55 offen offset:2048 sc1 lds
    buffer_load_dwordx4 v2, s[40:43], s55 offen offset:3072 sc1 lds
    s_add_u32 s55, s55, 16384
    s_add_u32 m0, s59, 81920
    s_nop 0
    buffer_load_dwordx4 v2, s[40:43], s56 offen offset:0 sc1 lds
    buffer_load_dwordx4 v2, s[40:43], s56 offen offset:1024 sc1 lds
    buffer_load_dwordx4 v2, s[40:43], s56 offen offset:2048 sc1 lds
    buffer_load_dwordx4 v2, s[40:43], s56 offen offset:3072 sc1 lds
    s_add_u32 s56, s56, 16384
LP_HAVE:
    s_waitcnt vmcnt(12) lgkmcnt(0)
    s_barrier
    ds_read_b128 a[0:3], v31 offset:0
    ds_read_b128 a[4:7], v31 offset:1024
    ds_read_b128 a[8:11], v31 offset:2048
    ds_read_b128 a[12:15], v31 offset:3072
    ds_read_b128 a[16:19], v31 offset:4096
    ds_read_b128 a[20:23], v31 offset:5120
    ds_read_b128 a[24:27], v31 offset:6144
    ds_read_b128 a[28:31], v31 offset:7168
    ds_read_b128 a[32:35], v30 offset:0
    ds_read_b128 a[36:39], v30 offset:1024
    ds_read_b128 a[40:43], v30 offset:2048
    ds_read_b128 a[44:47], v30 offset:3072
    ds_read_b128 a[48:51], v30 offset:4096
    ds_read_b128 a[52:55], v30 offset:5120
    ds_read_b128 a[56:59], v30 offset:6144
    ds_read_b128 a[60:63], v30 offset:7168
    ds_read_b128 a[64:67], v4 offset:0
    ds_read_b128 a[96:99], v4 offset:8192
    ds_read_b128 a[68:71], v4 offset:1024
    ds_read_b128 a[100:103], v4 offset:9216
    ds_read_b128 a[72:75], v4 offset:2048
    ds_read_b128 a[104:107], v4 offset:10240
    ds_read_b128 a[76:79], v4 offset:3072
    ds_read_b128 a[108:111], v4 offset:11264
    ds_read_b128 a[80:83], v4 offset:4096
    ds_read_b128 a[112:115], v4 offset:12288
    ds_read_b128 a[84:87], v4 offset:5120
    ds_read_b128 a[116:119], v4 offset:13312
    ds_read_b128 a[88:91], v4 offset:6144
    ds_read_b128 a[120:123], v4 offset:14336
    ds_read_b128 a[92:95], v4 offset:7168
    ds_read_b128 a[124:127], v4 offset:15360
    v_mov_b32 v128, 0
    v_mov_b32 v129, 0
    v_mov_b32 v130, 0
    v_mov_b32 v131, 0
    v_mov_b32 v132, 0
    v_mov_b32 v133, 0
    v_mov_b32 v134, 0
    v_mov_b32 v135, 0
    v_mov_b32 v136, 0
    v_mov_b32 v137, 0
    v_mov_b32 v138, 0
    v_mov_b32 v139, 0
    v_mov_b32 v140, 0
    v_mov_b32 v141, 0
    v_mov_b32 v142, 0
    v_mov_b32 v143, 0
    v_mov_b32 v144, 0
    v_mov_b32 v145, 0
    v_mov_b32 v146, 0
    v_mov_b32 v147, 0
    v_mov_b32 v148, 0
    v_mov_b32 v149, 0
    v_mov_b32 v150, 0
    v_mov_b32 v151, 0
    s_waitcnt lgkmcnt(0)
    v_mfma_f32_16x16x32_bf16 v[64:67], a[64:67], a[0:3], v[96:99]
    ds_read_b128 a[128:131], v4 offset:16384
    v_mov_b32 v152, 0
    v_mfma_f32_16x16x32_bf16 v[68:71], a[64:67], a[32:35], v[100:103]
    v_mov_b32 v153, 0
    v_mov_b32 v154, 0
    v_mfma_f32_16x16x32_bf16 v[72:75], a[96:99], a[0:3], v[104:107]
    ds_read_b128 a[132:135], v4 offset:17408
    v_mov_b32 v155, 0
    v_mfma_f32_16x16x32_bf16 v[76:79], a[96:99], a[32:35], v[108:111]
    v_mov_b32 v156, 0
    v_mov_b32 v157, 0
    v_mfma_f32_16x16x32_bf16 v[64:67], a[68:71], a[4:7], v[64:67]
    ds_read_b128 a[136:139], v4 offset:18432
    v_mov_b32 v158, 0
    v_mfma_f32_16x16x32_bf16 v[68:71], a[68:71], a[36:39], v[68:71]
    v_mov_b32 v159, 0
    v_mov_b32 v160, 0
    v_mfma_f32_16x16x32_bf16 v[72:75], a[100:103], a[4:7], v[72:75]
    ds_read_b128 a[140:143], v4 offset:19456
    v_mov_b32 v161, 0
    v_mfma_f32_16x16x32_bf16 v[76:79], a[100:103], a[36:39], v[76:79]
    v_mov_b32 v162, 0
    v_mov_b32 v163, 0
    v_mfma_f32_16x16x32_bf16 v[64:67], a[72:75], a[8:11], v[64:67]
    ds_read_b128 a[144:147], v4 offset:20480
    v_mov_b32 v164, 0
    v_mfma_f32_16x16x32_bf16 v[68:71], a[72:75], a[40:43], v[68:71]
    v_mov_b32 v165, 0
    v_mov_b32 v166, 0
    v_mfma_f32_16x16x32_bf16 v[72:75], a[104:107], a[8:11], v[72:75]
    ds_read_b128 a[148:151], v4 offset:21504
    v_mov_b32 v167, 0
    v_mfma_f32_16x16x32_bf16 v[76:79], a[104:107], a[40:43], v[76:79]
    v_mov_b32 v168, 0
    v_mov_b32 v169, 0
    v_mfma_f32_16x16x32_bf16 v[64:67], a[76:79], a[12:15], v[64:67]
    ds_read_b128 a[152:155], v4 offset:22528
    v_mov_b32 v170, 0
    v_mfma_f32_16x16x32_bf16 v[68:71], a[76:79], a[44:47], v[68:71]
    v_mov_b32 v171, 0
    v_mov_b32 v172, 0
    v_mfma_f32_16x16x32_bf16 v[72:75], a[108:111], a[12:15], v[72:75]
    ds_read_b128 a[156:159], v4 offset:23552
    v_mov_b32 v173, 0
    v_mfma_f32_16x16x32_bf16 v[76:79], a[108:111], a[44:47], v[76:79]
    v_mov_b32 v174, 0
    v_mov_b32 v175, 0
    v_mfma_f32_16x16x32_bf16 v[64:67], a[80:83], a[16:19], v[64:67]
    ds_read_b128 a[160:163], v4 offset:24576
    v_mov_b32 v176, 0
    v_mfma_f32_16x16x32_bf16 v[68:71], a[80:83], a[48:51], v[68:71]
    v_mov_b32 v177, 0
    v_mov_b32 v178, 0
    v_mfma_f32_16x16x32_bf16 v[72:75], a[112:115], a[16:19], v[72:75]
    ds_read_b128 a[164:167], v4 offset:25600
    v_mov_b32 v179, 0
    v_mfma_f32_16x16x32_bf16 v[76:79], a[112:115], a[48:51], v[76:79]
    v_mov_b32 v180, 0
    v_mov_b32 v181, 0
    v_mfma_f32_16x16x32_bf16 v[64:67], a[84:87], a[20:23], v[64:67]
    ds_read_b128 a[168:171], v4 offset:26624
    v_mov_b32 v182, 0
    v_mfma_f32_16x16x32_bf16 v[68:71], a[84:87], a[52:55], v[68:71]
    v_mov_b32 v183, 0
    v_mov_b32 v184, 0
    v_mfma_f32_16x16x32_bf16 v[72:75], a[116:119], a[20:23], v[72:75]
    ds_read_b128 a[172:175], v4 offset:27648
    v_mov_b32 v185, 0
    v_mfma_f32_16x16x32_bf16 v[76:79], a[116:119], a[52:55], v[76:79]
    v_mov_b32 v186, 0
    v_mov_b32 v187, 0
    v_mfma_f32_16x16x32_bf16 v[64:67], a[88:91], a[24:27], v[64:67]
    ds_read_b128 a[176:179], v4 offset:28672
    v_mov_b32 v188, 0
    v_mfma_f32_16x16x32_bf16 v[68:71], a[88:91], a[56:59], v[68:71]
    v_mov_b32 v189, 0
    v_mov_b32 v190, 0
    v_mfma_f32_16x16x32_bf16 v[72:75], a[120:123], a[24:27], v[72:75]
    ds_read_b128 a[180:183], v4 offset:29696
    v_mov_b32 v191, 0
    v_mfma_f32_16x16x32_bf16 v[76:79], a[120:123], a[56:59], v[76:79]
    v_mov_b32 v192, 0
    v_mov_b32 v193, 0
    v_mfma_f32_16x16x32_bf16 v[64:67], a[92:95], a[28:31], v[64:67]
    ds_read_b128 a[184:187], v4 offset:30720
    v_mov_b32 v194, 0
    v_mfma_f32_16x16x32_bf16 v[68:71], a[92:95], a[60:63], v[68:71]
    v_mov_b32 v195, 0
    v_mov_b32 v196, 0
    v_mfma_f32_16x16x32_bf16 v[72:75], a[124:127], a[28:31], v[72:75]
    ds_read_b128 a[188:191], v4 offset:31744
    v_mov_b32 v197, 0
    v_mfma_f32_16x16x32_bf16 v[76:79], a[124:127], a[60:63], v[76:79]
    v_mov_b32 v198, 0
    v_mov_b32 v199, 0
    ds_read_b128 a[64:67], v4 offset:32768
    ds_read_b128 a[96:99], v4 offset:40960
    ds_read_b128 a[68:71], v4 offset:33792
    ds_read_b128 a[100:103], v4 offset:41984
    ds_read_b128 a[72:75], v4 offset:34816
    ds_read_b128 a[104:107], v4 offset:43008
    ds_read_b128 a[76:79], v4 offset:35840
    ds_read_b128 a[108:111], v4 offset:44032
    ds_read_b128 a[80:83], v4 offset:36864
    ds_read_b128 a[112:115], v4 offset:45056
    ds_read_b128 a[84:87], v4 offset:37888
    ds_read_b128 a[116:119], v4 offset:46080
    ds_read_b128 a[88:91], v4 offset:38912
    ds_read_b128 a[120:123], v4 offset:47104
    ds_read_b128 a[92:95], v4 offset:39936
    ds_read_b128 a[124:127], v4 offset:48128
    s_mov_b32 s53, 1
    s_cmp_ge_u32 s53, s54
    s_cbranch_scc1 LC_13
LC_14:
    s_waitcnt vmcnt(0) lgkmcnt(0)
    s_barrier
    s_lshl_b32 s84, s50, 6
    s_lshl_b32 s85, s51, 2
    s_add_u32 s84, s84, s85
    s_add_u32 s84, s84, 251666432
    s_cmp_lg_u32 s48, 0
    s_cbranch_scc1 LSG_15
    v_mov_b32 v46, 1
    v_lshlrev_b32 v47, 5, v0
    s_mov_b64 exec, 1
    buffer_store_dword v46, v47, s[40:43], s84 offen sc1
    s_mov_b64 exec, -1
LSG_15:
    s_cmp_lg_u32 s48, 0
    s_cbranch_scc1 LSG_16
    s_cmp_lg_u32 s3, 1
    s_cbranch_scc1 LSG_16
    v_mov_b32 v46, 1
    v_lshlrev_b32 v47, 5, v0
    s_mov_b64 exec, 1
    buffer_store_dword v46, v47, s[40:43], s79 offen sc1
    s_mov_b64 exec, -1
LSG_16:
    v_mfma_f32_16x16x32_bf16 v[80:83], a[64:67], a[0:3], v[96:99]
    s_add_u32 m0, s59, 98304
    v_mov_b32 v200, 0
    v_mov_b32 v201, 0
    v_mfma_f32_16x16x32_bf16 v[84:87], a[64:67], a[32:35], v[100:103]
    buffer_load_dwordx4 v2, s[40:43], s55 offen offset:0 sc1 lds
    v_mfma_f32_16x16x32_bf16 v[88:91], a[96:99], a[0:3], v[104:107]
    v_mov_b32 v202, 0
    v_mov_b32 v203, 0
    v_mfma_f32_16x16x32_bf16 v[92:95], a[96:99], a[32:35], v[108:111]
    buffer_load_dwordx4 v2, s[40:43], s55 offen offset:1024 sc1 lds
    v_mfma_f32_16x16x32_bf16 v[80:83], a[68:71], a[4:7], v[80:83]
    v_mov_b32 v204, 0
    v_mov_b32 v205, 0
    v_mfma_f32_16x16x32_bf16 v[84:87], a[68:71], a[36:39], v[84:87]
    buffer_load_dwordx4 v2, s[40:43], s55 offen offset:2048 sc1 lds
    v_mfma_f32_16x16x32_bf16 v[88:91], a[100:103], a[4:7], v[88:91]
    v_mov_b32 v206, 0
    v_mov_b32 v207, 0
    v_mfma_f32_16x16x32_bf16 v[92:95], a[100:103], a[36:39], v[92:95]
    buffer_load_dwordx4 v2, s[40:43], s55 offen offset:3072 sc1 lds
    v_mfma_f32_16x16x32_bf16 v[80:83], a[72:75], a[8:11], v[80:83]
    s_add_u32 s55, s55, 16384
    v_mov_b32 v208, 0
    v_mov_b32 v209, 0
    v_mfma_f32_16x16x32_bf16 v[84:87], a[72:75], a[40:43], v[84:87]
    s_add_u32 m0, s59, 114688
    v_mov_b32 v210, 0
    v_mov_b32 v211, 0
    v_mfma_f32_16x16x32_bf16 v[88:91], a[104:107], a[8:11], v[88:91]
    v_mov_b32 v212, 0
    v_mov_b32 v213, 0
    v_mfma_f32_16x16x32_bf16 v[92:95], a[104:107], a[40:43], v[92:95]
    buffer_load_dwordx4 v2, s[40:43], s56 offen offset:0 sc1 lds
    v_mfma_f32_16x16x32_bf16 v[80:83], a[76:79], a[12:15], v[80:83]
    v_mov_b32 v214, 0
    v_mov_b32 v215, 0
    v_mfma_f32_16x16x32_bf16 v[84:87], a[76:79], a[44:47], v[84:87]
    buffer_load_dwordx4 v2, s[40:43], s56 offen offset:1024 sc1 lds
    v_mfma_f32_16x16x32_bf16 v[88:91], a[108:111], a[12:15], v[88:91]
    v_mov_b32 v216, 0
    v_mov_b32 v217, 0
    v_mfma_f32_16x16x32_bf16 v[92:95], a[108:111], a[44:47], v[92:95]
    buffer_load_dwordx4 v2, s[40:43], s56 offen offset:2048 sc1 lds
    v_mfma_f32_16x16x32_bf16 v[80:83], a[80:83], a[16:19], v[80:83]
    v_mov_b32 v218, 0
    v_mov_b32 v219, 0
    v_mfma_f32_16x16x32_bf16 v[84:87], a[80:83], a[48:51], v[84:87]
    buffer_load_dwordx4 v2, s[40:43], s56 offen offset:3072 sc1 lds
    v_mfma_f32_16x16x32_bf16 v[88:91], a[112:115], a[16:19], v[88:91]
    s_add_u32 s56, s56, 16384
    v_mov_b32 v220, 0
    v_mov_b32 v221, 0
    v_mfma_f32_16x16x32_bf16 v[92:95], a[112:115], a[48:51], v[92:95]
    s_cmp_lt_u32 s55, s57
    v_mov_b32 v222, 0
    v_mov_b32 v223, 0
    v_mfma_f32_16x16x32_bf16 v[80:83], a[84:87], a[20:23], v[80:83]
    s_cselect_b32 s80, s55, s68
    v_mov_b32 v224, 0
    v_mov_b32 v225, 0
    v_mfma_f32_16x16x32_bf16 v[84:87], a[84:87], a[52:55], v[84:87]
    s_mov_b32 m0, s59
    v_mov_b32 v226, 0
    v_mov_b32 v227, 0
    v_mfma_f32_16x16x32_bf16 v[88:91], a[116:119], a[20:23], v[88:91]
    s_add_u32 s55, s55, 16384
    v_mov_b32 v228, 0
    v_mov_b32 v229, 0
    v_mfma_f32_16x16x32_bf16 v[92:95], a[116:119], a[52:55], v[92:95]
    buffer_load_dwordx4 v2, s[40:43], s80 offen offset:0 sc1 lds
    v_mfma_f32_16x16x32_bf16 v[80:83], a[88:91], a[24:27], v[80:83]
    v_mov_b32 v230, 0
    v_mov_b32 v231, 0
    v_mfma_f32_16x16x32_bf16 v[84:87], a[88:91], a[56:59], v[84:87]
    buffer_load_dwordx4 v2, s[40:43], s80 offen offset:1024 sc1 lds
    v_mfma_f32_16x16x32_bf16 v[88:91], a[120:123], a[24:27], v[88:91]
    v_mov_b32 v232, 0
    v_mov_b32 v233, 0
    v_mfma_f32_16x16x32_bf16 v[92:95], a[120:123], a[56:59], v[92:95]
    buffer_load_dwordx4 v2, s[40:43], s80 offen offset:2048 sc1 lds
    v_mfma_f32_16x16x32_bf16 v[80:83], a[92:95], a[28:31], v[80:83]
    v_mov_b32 v234, 0
    v_mov_b32 v235, 0
    v_mfma_f32_16x16x32_bf16 v[84:87], a[92:95], a[60:63], v[84:87]
    buffer_load_dwordx4 v2, s[40:43], s80 offen offset:3072 sc1 lds
    v_mfma_f32_16x16x32_bf16 v[88:91], a[124:127], a[28:31], v[88:91]
    v_mov_b32 v236, 0
    v_mov_b32 v237, 0
    v_mfma_f32_16x16x32_bf16 v[92:95], a[124:127], a[60:63], v[92:95]
    v_mov_b32 v238, 0
    v_mov_b32 v239, 0
    v_mov_b32 v240, 0
    v_mov_b32 v241, 0
    v_mov_b32 v242, 0
    v_mov_b32 v243, 0
    v_mov_b32 v244, 0
    v_mov_b32 v245, 0
    v_mov_b32 v246, 0
    v_mov_b32 v247, 0
    v_mov_b32 v248, 0
    v_mov_b32 v249, 0
    v_mov_b32 v250, 0
    v_mov_b32 v251, 0
    v_mov_b32 v252, 0
    v_mov_b32 v253, 0
    v_mov_b32 v254, 0
    v_mov_b32 v255, 0
    v_lshlrev_b32 v47, 7, v0
    buffer_load_dword v46, v47, s[36:39], s19 offen
    s_call_b64 s[60:61], LB_RARE0
    s_mov_b32 s53, 2
    s_lshr_b32 s72, s52, 1
    s_sub_u32 s72, s72, 2
    s_cmp_ge_u32 s51, 8
    s_cselect_b32 s63, 10, s72
    s_cselect_b32 s74, 0, 2
    s_cmp_eq_u32 s63, 0
    s_cbranch_scc1 LB_DONE
LB_LOOP:
    s_waitcnt vmcnt(16) lgkmcnt(0)
    s_barrier
    v_mfma_f32_16x16x32_bf16 v[128:131], a[128:131], v[48:51], v[128:131]
    ds_read_b128 a[64:67], v3 offset:0
    v_add_f32 v8, v8, v14
    v_mfma_f32_16x16x32_bf16 v[132:135], a[128:131], v[52:55], v[132:135]
    ds_read_b128 a[96:99], v3 offset:8192
    v_add_f32 v9, v9, v15
    v_mfma_f32_16x16x32_bf16 v[136:139], a[132:135], v[48:51], v[136:139]
    s_cmp_ge_u32 s53, s54
    v_exp_f32 v112, v80
    v_mfma_f32_16x16x32_bf16 v[140:143], a[132:135], v[52:55], v[140:143]
    ds_read_b128 a[68:71], v3 offset:1024
    s_cbranch_scc1 LC_17
LC_18:
    v_mfma_f32_16x16x32_bf16 v[144:147], a[136:139], v[48:51], v[144:147]
    ds_read_b128 a[100:103], v3 offset:9216
    s_add_u32 s53, s53, 1
    v_mfma_f32_16x16x32_bf16 v[148:151], a[136:139], v[52:55], v[148:151]
    s_cmp_lt_u32 s55, s57
    v_exp_f32 v113, v81
    v_mfma_f32_16x16x32_bf16 v[152:155], a[140:143], v[48:51], v[152:155]
    ds_read_b128 a[72:75], v3 offset:2048
    v_cvt_pk_bf16_f32 v56, v112, v113
    v_mfma_f32_16x16x32_bf16 v[156:159], a[140:143], v[52:55], v[156:159]
    ds_read_b128 a[104:107], v3 offset:10240
    v_add_f32 v14, v112, v113
    v_mfma_f32_16x16x32_bf16 v[160:163], a[144:147], v[48:51], v[160:163]
    s_cselect_b32 s80, s55, s68
    v_exp_f32 v114, v82
    v_mfma_f32_16x16x32_bf16 v[164:167], a[144:147], v[52:55], v[164:167]
    ds_read_b128 a[76:79], v3 offset:3072
    v_add_f32 v14, v14, v114
    v_mfma_f32_16x16x32_bf16 v[168:171], a[148:151], v[48:51], v[168:171]
    ds_read_b128 a[108:111], v3 offset:11264
    s_add_u32 m0, s59, 32768
    v_mfma_f32_16x16x32_bf16 v[172:175], a[148:151], v[52:55], v[172:175]
    s_add_u32 s55, s55, 16384
    v_exp_f32 v115, v83
    v_mfma_f32_16x16x32_bf16 v[176:179], a[152:155], v[48:51], v[176:179]
    ds_read_b128 a[80:83], v3 offset:4096
    v_cvt_pk_bf16_f32 v57, v114, v115
    v_mfma_f32_16x16x32_bf16 v[180:183], a[152:155], v[52:55], v[180:183]
    ds_read_b128 a[112:115], v3 offset:12288
    v_add_f32 v14, v14, v115
    v_mfma_f32_16x16x32_bf16 v[184:187], a[156:159], v[48:51], v[184:187]
    v_exp_f32 v120, v88
    v_mfma_f32_16x16x32_bf16 v[188:191], a[156:159], v[52:55], v[188:191]
    ds_read_b128 a[84:87], v3 offset:5120
    v_add_f32 v14, v14, v120
    v_mfma_f32_16x16x32_bf16 v[192:195], a[160:163], v[48:51], v[192:195]
    ds_read_b128 a[116:119], v3 offset:13312
    v_mfma_f32_16x16x32_bf16 v[196:199], a[160:163], v[52:55], v[196:199]
    v_exp_f32 v121, v89
    v_mfma_f32_16x16x32_bf16 v[200:203], a[164:167], v[48:51], v[200:203]
    ds_read_b128 a[88:91], v3 offset:6144
    v_cvt_pk_bf16_f32 v58, v120, v121
    v_mfma_f32_16x16x32_bf16 v[204:207], a[164:167], v[52:55], v[204:207]
    ds_read_b128 a[120:123], v3 offset:14336
    v_add_f32 v14, v14, v121
    v_mfma_f32_16x16x32_bf16 v[208:211], a[168:171], v[48:51], v[208:211]
    v_exp_f32 v122, v90
    v_mfma_f32_16x16x32_bf16 v[212:215], a[168:171], v[52:55], v[212:215]
    ds_read_b128 a[92:95], v3 offset:7168
    v_add_f32 v14, v14, v122
    v_mfma_f32_16x16x32_bf16 v[216:219], a[172:175], v[48:51], v[216:219]
    ds_read_b128 a[124:127], v3 offset:15360
    v_mfma_f32_16x16x32_bf16 v[220:223], a[172:175], v[52:55], v[220:223]
    v_exp_f32 v123, v91
    v_mfma_f32_16x16x32_bf16 v[224:227], a[176:179], v[48:51], v[224:227]
    buffer_load_dwordx4 v2, s[40:43], s80 offen offset:0 sc1 lds
    v_mfma_f32_16x16x32_bf16 v[228:231], a[176:179], v[52:55], v[228:231]
    v_exp_f32 v116, v84
    v_mfma_f32_16x16x32_bf16 v[232:235], a[180:183], v[48:51], v[232:235]
    buffer_load_dwordx4 v2, s[40:43], s80 offen offset:1024 sc1 lds
    v_mfma_f32_16x16x32_bf16 v[236:239], a[180:183], v[52:55], v[236:239]
    v_exp_f32 v117, v85
    v_mfma_f32_16x16x32_bf16 v[240:243], a[184:187], v[48:51], v[240:243]
    buffer_load_dwordx4 v2, s[40:43], s80 offen offset:2048 sc1 lds
    v_mfma_f32_16x16x32_bf16 v[244:247], a[184:187], v[52:55], v[244:247]
    v_exp_f32 v118, v86
    v_mfma_f32_16x16x32_bf16 v[248:251], a[188:191], v[48:51], v[248:251]
    buffer_load_dwordx4 v2, s[40:43], s80 offen offset:3072 sc1 lds
    v_mfma_f32_16x16x32_bf16 v[252:255], a[188:191], v[52:55], v[252:255]
    s_waitcnt lgkmcnt(0)
    v_mfma_f32_16x16x32_bf16 v[64:67], a[64:67], a[0:3], v[96:99]
    ds_read_b128 a[128:131], v4 offset:49152
    v_cvt_pk_bf16_f32 v59, v122, v123
    v_mfma_f32_16x16x32_bf16 v[68:71], a[64:67], a[32:35], v[100:103]
    ds_read_b128 a[132:135], v4 offset:50176
    v_add_f32 v14, v14, v123
    v_mfma_f32_16x16x32_bf16 v[72:75], a[96:99], a[0:3], v[104:107]
    s_cmp_lt_u32 s56, s58
    v_exp_f32 v119, v87
    v_mfma_f32_16x16x32_bf16 v[76:79], a[96:99], a[32:35], v[108:111]
    ds_read_b128 a[136:139], v4 offset:51200
    v_cvt_pk_bf16_f32 v60, v116, v117
    v_mfma_f32_16x16x32_bf16 v[64:67], a[68:71], a[4:7], v[64:67]
    ds_read_b128 a[140:143], v4 offset:52224
    v_cvt_pk_bf16_f32 v61, v118, v119
    v_mfma_f32_16x16x32_bf16 v[68:71], a[68:71], a[36:39], v[68:71]
    s_cselect_b32 s81, s56, s68
    v_exp_f32 v124, v92
    v_mfma_f32_16x16x32_bf16 v[72:75], a[100:103], a[4:7], v[72:75]
    ds_read_b128 a[144:147], v4 offset:53248
    v_add_f32 v15, v116, v117
    v_mfma_f32_16x16x32_bf16 v[76:79], a[100:103], a[36:39], v[76:79]
    ds_read_b128 a[148:151], v4 offset:54272
    v_add_f32 v15, v15, v118
    v_mfma_f32_16x16x32_bf16 v[64:67], a[72:75], a[8:11], v[64:67]
    s_add_u32 m0, s59, 16384
    v_exp_f32 v125, v93
    v_mfma_f32_16x16x32_bf16 v[68:71], a[72:75], a[40:43], v[68:71]
    ds_read_b128 a[152:155], v4 offset:55296
    v_add_f32 v15, v15, v119
    v_mfma_f32_16x16x32_bf16 v[72:75], a[104:107], a[8:11], v[72:75]
    ds_read_b128 a[156:159], v4 offset:56320
    v_cvt_pk_bf16_f32 v62, v124, v125
    v_mfma_f32_16x16x32_bf16 v[76:79], a[104:107], a[40:43], v[76:79]
    s_add_u32 s56, s56, 16384
    v_exp_f32 v126, v94
    v_mfma_f32_16x16x32_bf16 v[64:67], a[76:79], a[12:15], v[64:67]
    ds_read_b128 a[160:163], v4 offset:57344
    v_add_f32 v15, v15, v124
    v_mfma_f32_16x16x32_bf16 v[68:71], a[76:79], a[44:47], v[68:71]
    ds_read_b128 a[164:167], v4 offset:58368
    v_add_f32 v15, v15, v125
    v_mfma_f32_16x16x32_bf16 v[72:75], a[108:111], a[12:15], v[72:75]
    v_exp_f32 v127, v95
    v_mfma_f32_16x16x32_bf16 v[76:79], a[108:111], a[44:47], v[76:79]
    ds_read_b128 a[168:171], v4 offset:59392
    v_cvt_pk_bf16_f32 v63, v126, v127
    v_mfma_f32_16x16x32_bf16 v[64:67], a[80:83], a[16:19], v[64:67]
    ds_read_b128 a[172:175], v4 offset:60416
    v_add_f32 v15, v15, v126
    v_mfma_f32_16x16x32_bf16 v[68:71], a[80:83], a[48:51], v[68:71]
    v_add_f32 v15, v15, v127
    v_mfma_f32_16x16x32_bf16 v[72:75], a[112:115], a[16:19], v[72:75]
    ds_read_b128 a[176:179], v4 offset:61440
    v_max_f32 v24, v14, v15
    v_mfma_f32_16x16x32_bf16 v[76:79], a[112:115], a[48:51], v[76:79]
    ds_read_b128 a[180:183], v4 offset:62464
    v_cmp_ngt_f32 vcc, 2.0, v24
    v_mfma_f32_16x16x32_bf16 v[64:67], a[84:87], a[20:23], v[64:67]
    v_mfma_f32_16x16x32_bf16 v[68:71], a[84:87], a[52:55], v[68:71]
    ds_read_b128 a[184:187], v4 offset:63488
    v_mfma_f32_16x16x32_bf16 v[72:75], a[116:119], a[20:23], v[72:75]
    ds_read_b128 a[188:191], v4 offset:64512
    v_mfma_f32_16x16x32_bf16 v[76:79], a[116:119], a[52:55], v[76:79]
    v_mfma_f32_16x16x32_bf16 v[64:67], a[88:91], a[24:27], v[64:67]
    buffer_load_dwordx4 v2, s[40:43], s81 offen offset:0 sc1 lds
    v_mfma_f32_16x16x32_bf16 v[68:71], a[88:91], a[56:59], v[68:71]
    v_mfma_f32_16x16x32_bf16 v[72:75], a[120:123], a[24:27], v[72:75]
    buffer_load_dwordx4 v2, s[40:43], s81 offen offset:1024 sc1 lds
    v_mfma_f32_16x16x32_bf16 v[76:79], a[120:123], a[56:59], v[76:79]
    v_mfma_f32_16x16x32_bf16 v[64:67], a[92:95], a[28:31], v[64:67]
    buffer_load_dwordx4 v2, s[40:43], s81 offen offset:2048 sc1 lds
    v_mfma_f32_16x16x32_bf16 v[68:71], a[92:95], a[60:63], v[68:71]
    v_mfma_f32_16x16x32_bf16 v[72:75], a[124:127], a[28:31], v[72:75]
    buffer_load_dwordx4 v2, s[40:43], s81 offen offset:3072 sc1 lds
    v_mfma_f32_16x16x32_bf16 v[76:79], a[124:127], a[60:63], v[76:79]
    s_cbranch_vccnz LR_19
LR_20:
    s_waitcnt vmcnt(16) lgkmcnt(0)
    s_barrier
    v_mfma_f32_16x16x32_bf16 v[128:131], a[128:131], v[56:59], v[128:131]
    ds_read_b128 a[64:67], v3 offset:32768
    v_add_f32 v8, v8, v14
    v_mfma_f32_16x16x32_bf16 v[132:135], a[128:131], v[60:63], v[132:135]
    ds_read_b128 a[96:99], v3 offset:40960
    v_add_f32 v9, v9, v15
    v_mfma_f32_16x16x32_bf16 v[136:139], a[132:135], v[56:59], v[136:139]
    s_cmp_ge_u32 s53, s54
    v_exp_f32 v112, v64
    v_mfma_f32_16x16x32_bf16 v[140:143], a[132:135], v[60:63], v[140:143]
    ds_read_b128 a[68:71], v3 offset:33792
    s_cbranch_scc1 LC_21
LC_22:
    v_mfma_f32_16x16x32_bf16 v[144:147], a[136:139], v[56:59], v[144:147]
    ds_read_b128 a[100:103], v3 offset:41984
    s_add_u32 s53, s53, 1
    v_mfma_f32_16x16x32_bf16 v[148:151], a[136:139], v[60:63], v[148:151]
    s_cmp_lt_u32 s55, s57
    v_exp_f32 v113, v65
    v_mfma_f32_16x16x32_bf16 v[152:155], a[140:143], v[56:59], v[152:155]
    ds_read_b128 a[72:75], v3 offset:34816
    v_cvt_pk_bf16_f32 v48, v112, v113
    v_mfma_f32_16x16x32_bf16 v[156:159], a[140:143], v[60:63], v[156:159]
    ds_read_b128 a[104:107], v3 offset:43008
    v_add_f32 v14, v112, v113
    v_mfma_f32_16x16x32_bf16 v[160:163], a[144:147], v[56:59], v[160:163]
    s_cselect_b32 s80, s55, s68
    v_exp_f32 v114, v66
    v_mfma_f32_16x16x32_bf16 v[164:167], a[144:147], v[60:63], v[164:167]
    ds_read_b128 a[76:79], v3 offset:35840
    v_add_f32 v14, v14, v114
    v_mfma_f32_16x16x32_bf16 v[168:171], a[148:151], v[56:59], v[168:171]
    ds_read_b128 a[108:111], v3 offset:44032
    s_xor_b32 m0, s59, 65536
    v_mfma_f32_16x16x32_bf16 v[172:175], a[148:151], v[60:63], v[172:175]
    s_add_u32 s55, s55, 16384
    v_exp_f32 v115, v67
    v_mfma_f32_16x16x32_bf16 v[176:179], a[152:155], v[56:59], v[176:179]
    ds_read_b128 a[80:83], v3 offset:36864
    v_cvt_pk_bf16_f32 v49, v114, v115
    v_mfma_f32_16x16x32_bf16 v[180:183], a[152:155], v[60:63], v[180:183]
    ds_read_b128 a[112:115], v3 offset:45056
    v_add_f32 v14, v14, v115
    v_mfma_f32_16x16x32_bf16 v[184:187], a[156:159], v[56:59], v[184:187]
    v_exp_f32 v120, v72
    v_mfma_f32_16x16x32_bf16 v[188:191], a[156:159], v[60:63], v[188:191]
    ds_read_b128 a[84:87], v3 offset:37888
    v_add_f32 v14, v14, v120
    v_mfma_f32_16x16x32_bf16 v[192:195], a[160:163], v[56:59], v[192:195]
    ds_read_b128 a[116:119], v3 offset:46080
    v_mfma_f32_16x16x32_bf16 v[196:199], a[160:163], v[60:63], v[196:199]
    v_exp_f32 v121, v73
    v_mfma_f32_16x16x32_bf16 v[200:203], a[164:167], v[56:59], v[200:203]
    ds_read_b128 a[88:91], v3 offset:38912
    v_cvt_pk_bf16_f32 v50, v120, v121
    v_mfma_f32_16x16x32_bf16 v[204:207], a[164:167], v[60:63], v[204:207]
    ds_read_b128 a[120:123], v3 offset:47104
    v_add_f32 v14, v14, v121
    v_mfma_f32_16x16x32_bf16 v[208:211], a[168:171], v[56:59], v[208:211]
    v_exp_f32 v122, v74
    v_mfma_f32_16x16x32_bf16 v[212:215], a[168:171], v[60:63], v[212:215]
    ds_read_b128 a[92:95], v3 offset:39936
    v_add_f32 v14, v14, v122
    v_mfma_f32_16x16x32_bf16 v[216:219], a[172:175], v[56:59], v[216:219]
    ds_read_b128 a[124:127], v3 offset:48128
    v_mfma_f32_16x16x32_bf16 v[220:223], a[172:175], v[60:63], v[220:223]
    v_exp_f32 v123, v75
    v_mfma_f32_16x16x32_bf16 v[224:227], a[176:179], v[56:59], v[224:227]
    buffer_load_dwordx4 v2, s[40:43], s80 offen offset:0 sc1 lds
    v_mfma_f32_16x16x32_bf16 v[228:231], a[176:179], v[60:63], v[228:231]
    v_exp_f32 v116, v68
    v_mfma_f32_16x16x32_bf16 v[232:235], a[180:183], v[56:59], v[232:235]
    buffer_load_dwordx4 v2, s[40:43], s80 offen offset:1024 sc1 lds
    v_mfma_f32_16x16x32_bf16 v[236:239], a[180:183], v[60:63], v[236:239]
    v_exp_f32 v117, v69
    v_mfma_f32_16x16x32_bf16 v[240:243], a[184:187], v[56:59], v[240:243]
    buffer_load_dwordx4 v2, s[40:43], s80 offen offset:2048 sc1 lds
    v_mfma_f32_16x16x32_bf16 v[244:247], a[184:187], v[60:63], v[244:247]
    v_exp_f32 v118, v70
    v_mfma_f32_16x16x32_bf16 v[248:251], a[188:191], v[56:59], v[248:251]
    buffer_load_dwordx4 v2, s[40:43], s80 offen offset:3072 sc1 lds
    v_mfma_f32_16x16x32_bf16 v[252:255], a[188:191], v[60:63], v[252:255]
    s_waitcnt lgkmcnt(0)
    v_mfma_f32_16x16x32_bf16 v[80:83], a[64:67], a[0:3], v[96:99]
    ds_read_b128 a[128:131], v3 offset:16384
    v_cvt_pk_bf16_f32 v51, v122, v123
    v_mfma_f32_16x16x32_bf16 v[84:87], a[64:67], a[32:35], v[100:103]
    ds_read_b128 a[132:135], v3 offset:17408
    v_add_f32 v14, v14, v123
    v_mfma_f32_16x16x32_bf16 v[88:91], a[96:99], a[0:3], v[104:107]
    s_cmp_lt_u32 s56, s58
    v_exp_f32 v119, v71
    v_mfma_f32_16x16x32_bf16 v[92:95], a[96:99], a[32:35], v[108:111]
    ds_read_b128 a[136:139], v3 offset:18432
    v_cvt_pk_bf16_f32 v52, v116, v117
    v_mfma_f32_16x16x32_bf16 v[80:83], a[68:71], a[4:7], v[80:83]
    ds_read_b128 a[140:143], v3 offset:19456
    v_cvt_pk_bf16_f32 v53, v118, v119
    v_mfma_f32_16x16x32_bf16 v[84:87], a[68:71], a[36:39], v[84:87]
    s_cselect_b32 s81, s56, s68
    v_exp_f32 v124, v76
    v_mfma_f32_16x16x32_bf16 v[88:91], a[100:103], a[4:7], v[88:91]
    ds_read_b128 a[144:147], v3 offset:20480
    v_add_f32 v15, v116, v117
    v_mfma_f32_16x16x32_bf16 v[92:95], a[100:103], a[36:39], v[92:95]
    ds_read_b128 a[148:151], v3 offset:21504
    v_add_f32 v15, v15, v118
    v_mfma_f32_16x16x32_bf16 v[80:83], a[72:75], a[8:11], v[80:83]
    s_add_u32 m0, s59, 49152
    v_exp_f32 v125, v77
    v_mfma_f32_16x16x32_bf16 v[84:87], a[72:75], a[40:43], v[84:87]
    ds_read_b128 a[152:155], v3 offset:22528
    v_add_f32 v15, v15, v119
    v_mfma_f32_16x16x32_bf16 v[88:91], a[104:107], a[8:11], v[88:91]
    ds_read_b128 a[156:159], v3 offset:23552
    v_cvt_pk_bf16_f32 v54, v124, v125
    v_mfma_f32_16x16x32_bf16 v[92:95], a[104:107], a[40:43], v[92:95]
    s_add_u32 s56, s56, 16384
    v_exp_f32 v126, v78
    v_mfma_f32_16x16x32_bf16 v[80:83], a[76:79], a[12:15], v[80:83]
    ds_read_b128 a[160:163], v3 offset:24576
    v_add_f32 v15, v15, v124
    v_mfma_f32_16x16x32_bf16 v[84:87], a[76:79], a[44:47], v[84:87]
    ds_read_b128 a[164:167], v3 offset:25600
    v_add_f32 v15, v15, v125
    v_mfma_f32_16x16x32_bf16 v[88:91], a[108:111], a[12:15], v[88:91]
    s_xor_b32 s59, s59, 65536
    v_exp_f32 v127, v79
    v_mfma_f32_16x16x32_bf16 v[92:95], a[108:111], a[44:47], v[92:95]
    ds_read_b128 a[168:171], v3 offset:26624
    v_cvt_pk_bf16_f32 v55, v126, v127
    v_mfma_f32_16x16x32_bf16 v[80:83], a[80:83], a[16:19], v[80:83]
    ds_read_b128 a[172:175], v3 offset:27648
    v_add_f32 v15, v15, v126
    v_mfma_f32_16x16x32_bf16 v[84:87], a[80:83], a[48:51], v[84:87]
    s_sub_u32 s63, s63, 1
    v_add_f32 v15, v15, v127
    v_mfma_f32_16x16x32_bf16 v[88:91], a[112:115], a[16:19], v[88:91]
    ds_read_b128 a[176:179], v3 offset:28672
    v_max_f32 v24, v14, v15
    v_mfma_f32_16x16x32_bf16 v[92:95], a[112:115], a[48:51], v[92:95]
    ds_read_b128 a[180:183], v3 offset:29696
    v_cmp_ngt_f32 vcc, 2.0, v24
    v_mfma_f32_16x16x32_bf16 v[80:83], a[84:87], a[20:23], v[80:83]
    v_mfma_f32_16x16x32_bf16 v[84:87], a[84:87], a[52:55], v[84:87]
    ds_read_b128 a[184:187], v3 offset:30720
    v_mfma_f32_16x16x32_bf16 v[88:91], a[116:119], a[20:23], v[88:91]
    ds_read_b128 a[188:191], v3 offset:31744
    v_mfma_f32_16x16x32_bf16 v[92:95], a[116:119], a[52:55], v[92:95]
    v_mfma_f32_16x16x32_bf16 v[80:83], a[88:91], a[24:27], v[80:83]
    buffer_load_dwordx4 v2, s[40:43], s81 offen offset:0 sc1 lds
    v_mfma_f32_16x16x32_bf16 v[84:87], a[88:91], a[56:59], v[84:87]
    v_xor_b32 v4, 0x10000, v4
    v_xor_b32 v3, 0x10000, v3
    v_mfma_f32_16x16x32_bf16 v[88:91], a[120:123], a[24:27], v[88:91]
    buffer_load_dwordx4 v2, s[40:43], s81 offen offset:1024 sc1 lds
    v_mfma_f32_16x16x32_bf16 v[92:95], a[120:123], a[56:59], v[92:95]
    v_mfma_f32_16x16x32_bf16 v[80:83], a[92:95], a[28:31], v[80:83]
    buffer_load_dwordx4 v2, s[40:43], s81 offen offset:2048 sc1 lds
    v_mfma_f32_16x16x32_bf16 v[84:87], a[92:95], a[60:63], v[84:87]
    v_mfma_f32_16x16x32_bf16 v[88:91], a[124:127], a[28:31], v[88:91]
    buffer_load_dwordx4 v2, s[40:43], s81 offen offset:3072 sc1 lds
    v_mfma_f32_16x16x32_bf16 v[92:95], a[124:127], a[60:63], v[92:95]
    s_cbranch_vccnz LR_23
LR_24:
    s_cmp_lg_u32 s63, 0
    s_cbranch_scc1 LB_LOOP
    s_cmp_eq_u32 s74, 2
    s_cbranch_scc1 LB_DONE
    s_cmp_eq_u32 s74, 1
    s_cbranch_scc1 LB_EV1
    s_mov_b32 s74, 1
    s_mov_b32 s63, 2
    s_lshl_b32 s75, s50, 8
    s_add_u32 s75, s75, 251662336
    v_min_u32 v45, 7, v0
    v_lshlrev_b32 v45, 2, v45
    buffer_load_dword v44, v45, s[40:43], s75 offen sc1
    s_branch LB_LOOP
LB_EV1:
    s_mov_b32 s74, 2
    s_sub_u32 s63, s72, 12
    v_cmp_eq_u32 vcc, 1, v44
    s_nop 3
    s_cmp_eq_u64 vcc, -1
    s_cbranch_scc1 LB_LOOP
    s_mov_b32 s73, 65536
    buffer_load_dword v44, v45, s[40:43], s75 offen sc1
LPL_26:
    s_waitcnt vmcnt(0)
    v_cmp_eq_u32 vcc, 1, v44
    s_nop 3
    s_cmp_eq_u64 vcc, -1
    s_cbranch_scc1 LPK_25
    s_sub_u32 s73, s73, 1
    s_cmp_eq_u32 s73, 0
    s_cbranch_scc1 LPK_25
    s_sleep 8
    buffer_load_dword v44, v45, s[40:43], s75 offen sc1
    s_branch LPL_26
LPK_25:
    s_branch LB_LOOP
LB_DONE:
    s_cmp_gt_u32 4, s67
    s_cselect_b32 s84, 0xff800000, 0
    s_cmp_eq_u32 4, s67
    s_cselect_b32 s85, -1, 0
    s_cmp_gt_u32 5, s67
    s_cselect_b32 s86, 0xff800000, 0
    s_cmp_eq_u32 5, s67
    s_cselect_b32 s87, -1, 0
    s_waitcnt vmcnt(16) lgkmcnt(0)
    s_barrier
    v_mfma_f32_16x16x32_bf16 v[128:131], a[128:131], v[48:51], v[128:131]
    ds_read_b128 a[64:67], v3 offset:0
    v_add_f32 v8, v8, v14
    v_mfma_f32_16x16x32_bf16 v[132:135], a[128:131], v[52:55], v[132:135]
    ds_read_b128 a[96:99], v3 offset:8192
    v_add_f32 v25, s84, v7
    v_mfma_f32_16x16x32_bf16 v[136:139], a[132:135], v[48:51], v[136:139]
    v_and_b32 v100, s85, v10
    v_and_b32 v101, s85, v11
    v_mfma_f32_16x16x32_bf16 v[140:143], a[132:135], v[52:55], v[140:143]
    ds_read_b128 a[68:71], v3 offset:1024
    v_and_b32 v102, s85, v12
    v_mfma_f32_16x16x32_bf16 v[144:147], a[136:139], v[48:51], v[144:147]
    ds_read_b128 a[100:103], v3 offset:9216
    v_and_b32 v103, s85, v13
    v_mfma_f32_16x16x32_bf16 v[148:151], a[136:139], v[52:55], v[148:151]
    v_add_f32 v100, v100, v25
    v_add_f32 v101, v101, v25
    v_mfma_f32_16x16x32_bf16 v[152:155], a[140:143], v[48:51], v[152:155]
    ds_read_b128 a[72:75], v3 offset:2048
    v_add_f32 v102, v102, v25
    v_mfma_f32_16x16x32_bf16 v[156:159], a[140:143], v[52:55], v[156:159]
    ds_read_b128 a[104:107], v3 offset:10240
    v_add_f32 v103, v103, v25
    v_mfma_f32_16x16x32_bf16 v[160:163], a[144:147], v[48:51], v[160:163]
    v_exp_f32 v112, v80
    v_mfma_f32_16x16x32_bf16 v[164:167], a[144:147], v[52:55], v[164:167]
    ds_read_b128 a[76:79], v3 offset:3072
    v_add_f32 v26, s86, v7
    v_mfma_f32_16x16x32_bf16 v[168:171], a[148:151], v[48:51], v[168:171]
    ds_read_b128 a[108:111], v3 offset:11264
    v_and_b32 v108, s87, v10
    v_mfma_f32_16x16x32_bf16 v[172:175], a[148:151], v[52:55], v[172:175]
    v_exp_f32 v113, v81
    v_mfma_f32_16x16x32_bf16 v[176:179], a[152:155], v[48:51], v[176:179]
    ds_read_b128 a[80:83], v3 offset:4096
    v_and_b32 v109, s87, v11
    v_mfma_f32_16x16x32_bf16 v[180:183], a[152:155], v[52:55], v[180:183]
    ds_read_b128 a[112:115], v3 offset:12288
    v_and_b32 v110, s87, v12
    v_mfma_f32_16x16x32_bf16 v[184:187], a[156:159], v[48:51], v[184:187]
    v_exp_f32 v114, v82
    v_mfma_f32_16x16x32_bf16 v[188:191], a[156:159], v[52:55], v[188:191]
    ds_read_b128 a[84:87], v3 offset:5120
    v_and_b32 v111, s87, v13
    v_mfma_f32_16x16x32_bf16 v[192:195], a[160:163], v[48:51], v[192:195]
    ds_read_b128 a[116:119], v3 offset:13312
    v_add_f32 v108, v108, v26
    v_mfma_f32_16x16x32_bf16 v[196:199], a[160:163], v[52:55], v[196:199]
    v_exp_f32 v115, v83
    v_mfma_f32_16x16x32_bf16 v[200:203], a[164:167], v[48:51], v[200:203]
    ds_read_b128 a[88:91], v3 offset:6144
    v_add_f32 v109, v109, v26
    v_mfma_f32_16x16x32_bf16 v[204:207], a[164:167], v[52:55], v[204:207]
    ds_read_b128 a[120:123], v3 offset:14336
    v_add_f32 v110, v110, v26
    v_mfma_f32_16x16x32_bf16 v[208:211], a[168:171], v[48:51], v[208:211]
    v_exp_f32 v120, v88
    v_mfma_f32_16x16x32_bf16 v[212:215], a[168:171], v[52:55], v[212:215]
    ds_read_b128 a[92:95], v3 offset:7168
    v_add_f32 v111, v111, v26
    v_mfma_f32_16x16x32_bf16 v[216:219], a[172:175], v[48:51], v[216:219]
    ds_read_b128 a[124:127], v3 offset:15360
    v_add_f32 v9, v9, v15
    v_mfma_f32_16x16x32_bf16 v[220:223], a[172:175], v[52:55], v[220:223]
    v_exp_f32 v121, v89
    v_mfma_f32_16x16x32_bf16 v[224:227], a[176:179], v[48:51], v[224:227]
    v_exp_f32 v122, v90
    v_mfma_f32_16x16x32_bf16 v[228:231], a[176:179], v[52:55], v[228:231]
    v_exp_f32 v123, v91
    v_mfma_f32_16x16x32_bf16 v[232:235], a[180:183], v[48:51], v[232:235]
    v_exp_f32 v116, v84
    v_mfma_f32_16x16x32_bf16 v[236:239], a[180:183], v[52:55], v[236:239]
    v_exp_f32 v117, v85
    v_mfma_f32_16x16x32_bf16 v[240:243], a[184:187], v[48:51], v[240:243]
    v_exp_f32 v118, v86
    v_mfma_f32_16x16x32_bf16 v[244:247], a[184:187], v[52:55], v[244:247]
    v_exp_f32 v119, v87
    v_mfma_f32_16x16x32_bf16 v[248:251], a[188:191], v[48:51], v[248:251]
    v_exp_f32 v124, v92
    v_mfma_f32_16x16x32_bf16 v[252:255], a[188:191], v[52:55], v[252:255]
    s_waitcnt lgkmcnt(0)
    v_mfma_f32_16x16x32_bf16 v[68:71], a[64:67], a[32:35], v[100:103]
    ds_read_b128 a[128:131], v4 offset:49152
    v_cvt_pk_bf16_f32 v56, v112, v113
    v_mfma_f32_16x16x32_bf16 v[76:79], a[96:99], a[32:35], v[108:111]
    ds_read_b128 a[132:135], v4 offset:50176
    v_cvt_pk_bf16_f32 v57, v114, v115
    v_mfma_f32_16x16x32_bf16 v[68:71], a[68:71], a[36:39], v[68:71]
    ds_read_b128 a[136:139], v4 offset:51200
    v_add_f32 v14, v112, v113
    v_mfma_f32_16x16x32_bf16 v[76:79], a[100:103], a[36:39], v[76:79]
    ds_read_b128 a[140:143], v4 offset:52224
    v_add_f32 v14, v14, v114
    v_mfma_f32_16x16x32_bf16 v[68:71], a[72:75], a[40:43], v[68:71]
    ds_read_b128 a[144:147], v4 offset:53248
    v_add_f32 v14, v14, v115
    v_mfma_f32_16x16x32_bf16 v[76:79], a[104:107], a[40:43], v[76:79]
    ds_read_b128 a[148:151], v4 offset:54272
    v_cvt_pk_bf16_f32 v58, v120, v121
    v_mfma_f32_16x16x32_bf16 v[68:71], a[76:79], a[44:47], v[68:71]
    ds_read_b128 a[152:155], v4 offset:55296
    v_cvt_pk_bf16_f32 v59, v122, v123
    v_mfma_f32_16x16x32_bf16 v[76:79], a[108:111], a[44:47], v[76:79]
    ds_read_b128 a[156:159], v4 offset:56320
    v_add_f32 v14, v14, v120
    v_mfma_f32_16x16x32_bf16 v[68:71], a[80:83], a[48:51], v[68:71]
    ds_read_b128 a[160:163], v4 offset:57344
    v_add_f32 v14, v14, v121
    v_mfma_f32_16x16x32_bf16 v[76:79], a[112:115], a[48:51], v[76:79]
    ds_read_b128 a[164:167], v4 offset:58368
    v_add_f32 v14, v14, v122
    v_mfma_f32_16x16x32_bf16 v[68:71], a[84:87], a[52:55], v[68:71]
    ds_read_b128 a[168:171], v4 offset:59392
    v_add_f32 v14, v14, v123
    v_mfma_f32_16x16x32_bf16 v[76:79], a[116:119], a[52:55], v[76:79]
    ds_read_b128 a[172:175], v4 offset:60416
    v_cvt_pk_bf16_f32 v60, v116, v117
    v_mfma_f32_16x16x32_bf16 v[68:71], a[88:91], a[56:59], v[68:71]
    ds_read_b128 a[176:179], v4 offset:61440
    v_cvt_pk_bf16_f32 v61, v118, v119
    v_mfma_f32_16x16x32_bf16 v[76:79], a[120:123], a[56:59], v[76:79]
    ds_read_b128 a[180:183], v4 offset:62464
    v_add_f32 v15, v116, v117
    v_mfma_f32_16x16x32_bf16 v[68:71], a[92:95], a[60:63], v[68:71]
    ds_read_b128 a[184:187], v4 offset:63488
    v_add_f32 v15, v15, v118
    v_mfma_f32_16x16x32_bf16 v[76:79], a[124:127], a[60:63], v[76:79]
    ds_read_b128 a[188:191], v4 offset:64512
    v_add_f32 v15, v15, v119
    s_nop 0
    v_exp_f32 v125, v93
    s_nop 0
    v_exp_f32 v126, v94
    s_nop 0
    v_exp_f32 v127, v95
    s_nop 0
    v_cvt_pk_bf16_f32 v62, v124, v125
    v_cvt_pk_bf16_f32 v63, v126, v127
    v_add_f32 v15, v15, v124
    v_add_f32 v15, v15, v125
    v_add_f32 v15, v15, v126
    v_add_f32 v15, v15, v127
    v_max_f32 v24, v14, v15
    v_cmp_ngt_f32 vcc, 2.0, v24
    s_cbranch_vccnz LR_27
LR_28:
    s_and_b32 s81, s2, 3
    s_lshl_b32 s75, s81, 8
    s_add_u32 s75, s75, 251666432
    v_min_u32 v45, 63, v0
    v_lshlrev_b32 v45, 2, v45
    s_cmp_gt_u32 6, s67
    s_cselect_b32 s84, 0xff800000, 0
    s_cmp_eq_u32 6, s67
    s_cselect_b32 s85, -1, 0
    s_cmp_gt_u32 7, s67
    s_cselect_b32 s86, 0xff800000, 0
    s_cmp_eq_u32 7, s67
    s_cselect_b32 s87, -1, 0
    s_waitcnt vmcnt(8) lgkmcnt(0)
    s_barrier
    v_mfma_f32_16x16x32_bf16 v[128:131], a[128:131], v[56:59], v[128:131]
    ds_read_b128 a[64:67], v3 offset:32768
    v_add_f32 v8, v8, v14
    v_mfma_f32_16x16x32_bf16 v[132:135], a[128:131], v[60:63], v[132:135]
    ds_read_b128 a[96:99], v3 offset:40960
    v_add_f32 v25, s84, v7
    v_mfma_f32_16x16x32_bf16 v[136:139], a[132:135], v[56:59], v[136:139]
    v_and_b32 v100, s85, v10
    v_and_b32 v101, s85, v11
    v_mfma_f32_16x16x32_bf16 v[140:143], a[132:135], v[60:63], v[140:143]
    ds_read_b128 a[68:71], v3 offset:33792
    v_and_b32 v102, s85, v12
    v_mfma_f32_16x16x32_bf16 v[144:147], a[136:139], v[56:59], v[144:147]
    ds_read_b128 a[100:103], v3 offset:41984
    v_and_b32 v103, s85, v13
    v_mfma_f32_16x16x32_bf16 v[148:151], a[136:139], v[60:63], v[148:151]
    v_add_f32 v100, v100, v25
    v_add_f32 v101, v101, v25
    v_mfma_f32_16x16x32_bf16 v[152:155], a[140:143], v[56:59], v[152:155]
    ds_read_b128 a[72:75], v3 offset:34816
    v_add_f32 v102, v102, v25
    v_mfma_f32_16x16x32_bf16 v[156:159], a[140:143], v[60:63], v[156:159]
    ds_read_b128 a[104:107], v3 offset:43008
    v_add_f32 v103, v103, v25
    v_mfma_f32_16x16x32_bf16 v[160:163], a[144:147], v[56:59], v[160:163]
    v_exp_f32 v116, v68
    v_mfma_f32_16x16x32_bf16 v[164:167], a[144:147], v[60:63], v[164:167]
    ds_read_b128 a[76:79], v3 offset:35840
    v_add_f32 v26, s86, v7
    v_mfma_f32_16x16x32_bf16 v[168:171], a[148:151], v[56:59], v[168:171]
    ds_read_b128 a[108:111], v3 offset:44032
    v_and_b32 v108, s87, v10
    v_mfma_f32_16x16x32_bf16 v[172:175], a[148:151], v[60:63], v[172:175]
    v_exp_f32 v117, v69
    v_mfma_f32_16x16x32_bf16 v[176:179], a[152:155], v[56:59], v[176:179]
    ds_read_b128 a[80:83], v3 offset:36864
    v_and_b32 v109, s87, v11
    v_mfma_f32_16x16x32_bf16 v[180:183], a[152:155], v[60:63], v[180:183]
    ds_read_b128 a[112:115], v3 offset:45056
    v_and_b32 v110, s87, v12
    v_mfma_f32_16x16x32_bf16 v[184:187], a[156:159], v[56:59], v[184:187]
    v_exp_f32 v118, v70
    v_mfma_f32_16x16x32_bf16 v[188:191], a[156:159], v[60:63], v[188:191]
    ds_read_b128 a[84:87], v3 offset:37888
    v_and_b32 v111, s87, v13
    v_mfma_f32_16x16x32_bf16 v[192:195], a[160:163], v[56:59], v[192:195]
    ds_read_b128 a[116:119], v3 offset:46080
    v_add_f32 v108, v108, v26
    v_mfma_f32_16x16x32_bf16 v[196:199], a[160:163], v[60:63], v[196:199]
    v_exp_f32 v119, v71
    v_mfma_f32_16x16x32_bf16 v[200:203], a[164:167], v[56:59], v[200:203]
    ds_read_b128 a[88:91], v3 offset:38912
    v_add_f32 v109, v109, v26
    v_mfma_f32_16x16x32_bf16 v[204:207], a[164:167], v[60:63], v[204:207]
    ds_read_b128 a[120:123], v3 offset:47104
    v_add_f32 v110, v110, v26
    v_mfma_f32_16x16x32_bf16 v[208:211], a[168:171], v[56:59], v[208:211]
    v_exp_f32 v124, v76
    v_mfma_f32_16x16x32_bf16 v[212:215], a[168:171], v[60:63], v[212:215]
    ds_read_b128 a[92:95], v3 offset:39936
    v_add_f32 v111, v111, v26
    v_mfma_f32_16x16x32_bf16 v[216:219], a[172:175], v[56:59], v[216:219]
    ds_read_b128 a[124:127], v3 offset:48128
    v_add_f32 v9, v9, v15
    v_mfma_f32_16x16x32_bf16 v[220:223], a[172:175], v[60:63], v[220:223]
    v_exp_f32 v125, v77
    v_mfma_f32_16x16x32_bf16 v[224:227], a[176:179], v[56:59], v[224:227]
    v_exp_f32 v126, v78
    v_mfma_f32_16x16x32_bf16 v[228:231], a[176:179], v[60:63], v[228:231]
    v_exp_f32 v127, v79
    v_mfma_f32_16x16x32_bf16 v[232:235], a[180:183], v[56:59], v[232:235]
    buffer_load_dword v44, v45, s[40:43], s75 offen sc1
    v_mfma_f32_16x16x32_bf16 v[236:239], a[180:183], v[60:63], v[236:239]
    s_add_u32 s82, s65, 0
    v_cvt_pk_bf16_f32 v52, v116, v117
    v_cvt_pk_bf16_f32 v53, v118, v119
    v_mfma_f32_16x16x32_bf16 v[240:243], a[184:187], v[56:59], v[240:243]
    s_add_u32 m0, s69, 131072
    v_add_f32 v15, v116, v117
    v_cvt_pk_bf16_f32 v54, v124, v125
    v_mfma_f32_16x16x32_bf16 v[244:247], a[184:187], v[60:63], v[244:247]
    buffer_load_dwordx4 v32, s[36:39], s82 offen offset:0 lds
    v_mfma_f32_16x16x32_bf16 v[248:251], a[188:191], v[56:59], v[248:251]
    buffer_load_dwordx4 v33, s[36:39], s82 offen offset:1024 lds
    v_mfma_f32_16x16x32_bf16 v[252:255], a[188:191], v[60:63], v[252:255]
    s_waitcnt lgkmcnt(0)
    v_mfma_f32_16x16x32_bf16 v[84:87], a[64:67], a[32:35], v[100:103]
    ds_read_b128 a[128:131], v3 offset:16384
    v_add_f32 v15, v15, v118
    v_mfma_f32_16x16x32_bf16 v[92:95], a[96:99], a[32:35], v[108:111]
    ds_read_b128 a[132:135], v3 offset:17408
    v_add_f32 v15, v15, v119
    v_mfma_f32_16x16x32_bf16 v[84:87], a[68:71], a[36:39], v[84:87]
    ds_read_b128 a[136:139], v3 offset:18432
    v_cvt_pk_bf16_f32 v55, v126, v127
    v_mfma_f32_16x16x32_bf16 v[92:95], a[100:103], a[36:39], v[92:95]
    ds_read_b128 a[140:143], v3 offset:19456
    v_add_f32 v15, v15, v124
    v_mfma_f32_16x16x32_bf16 v[84:87], a[72:75], a[40:43], v[84:87]
    ds_read_b128 a[144:147], v3 offset:20480
    v_add_f32 v15, v15, v125
    v_mfma_f32_16x16x32_bf16 v[92:95], a[104:107], a[40:43], v[92:95]
    ds_read_b128 a[148:151], v3 offset:21504
    v_add_f32 v15, v15, v126
    v_mfma_f32_16x16x32_bf16 v[84:87], a[76:79], a[44:47], v[84:87]
    ds_read_b128 a[152:155], v3 offset:22528
    v_add_f32 v15, v15, v127
    v_mfma_f32_16x16x32_bf16 v[92:95], a[108:111], a[44:47], v[92:95]
    ds_read_b128 a[156:159], v3 offset:23552
    v_cmp_ngt_f32 vcc, 2.0, v15
    v_mfma_f32_16x16x32_bf16 v[84:87], a[80:83], a[48:51], v[84:87]
    ds_read_b128 a[160:163], v3 offset:24576
    v_mfma_f32_16x16x32_bf16 v[92:95], a[112:115], a[48:51], v[92:95]
    ds_read_b128 a[164:167], v3 offset:25600
    v_mfma_f32_16x16x32_bf16 v[84:87], a[84:87], a[52:55], v[84:87]
    ds_read_b128 a[168:171], v3 offset:26624
    v_mfma_f32_16x16x32_bf16 v[92:95], a[116:119], a[52:55], v[92:95]
    ds_read_b128 a[172:175], v3 offset:27648
    v_mfma_f32_16x16x32_bf16 v[84:87], a[88:91], a[56:59], v[84:87]
    ds_read_b128 a[176:179], v3 offset:28672
    v_mfma_f32_16x16x32_bf16 v[92:95], a[120:123], a[56:59], v[92:95]
    ds_read_b128 a[180:183], v3 offset:29696
    v_mfma_f32_16x16x32_bf16 v[84:87], a[92:95], a[60:63], v[84:87]
    ds_read_b128 a[184:187], v3 offset:30720
    v_mfma_f32_16x16x32_bf16 v[92:95], a[124:127], a[60:63], v[92:95]
    ds_read_b128 a[188:191], v3 offset:31744
    s_nop 0
    buffer_load_dwordx4 v34, s[36:39], s82 offen offset:2048 lds
    buffer_load_dwordx4 v35, s[36:39], s82 offen offset:3072 lds
    s_add_u32 m0, m0, 4096
    s_nop 0
    buffer_load_dwordx4 v36, s[36:39], s82 offen offset:0 lds
    buffer_load_dwordx4 v37, s[36:39], s82 offen offset:1024 lds
    buffer_load_dwordx4 v38, s[36:39], s82 offen offset:2048 lds
    v_xor_b32 v4, 0x10000, v4
    v_xor_b32 v3, 0x10000, v3
    s_cbranch_vccnz LR_29
LR_30:
    s_waitcnt vmcnt(8) lgkmcnt(0)
    s_barrier
    v_mfma_f32_16x16x32_bf16 v[132:135], a[128:131], v[52:55], v[132:135]
    v_add_f32 v9, v9, v15
    v_mfma_f32_16x16x32_bf16 v[140:143], a[132:135], v[52:55], v[140:143]
    v_mfma_f32_16x16x32_bf16 v[148:151], a[136:139], v[52:55], v[148:151]
    v_exp_f32 v116, v84
    v_mfma_f32_16x16x32_bf16 v[156:159], a[140:143], v[52:55], v[156:159]
    v_exp_f32 v117, v85
    v_mfma_f32_16x16x32_bf16 v[164:167], a[144:147], v[52:55], v[164:167]
    v_exp_f32 v118, v86
    v_mfma_f32_16x16x32_bf16 v[172:175], a[148:151], v[52:55], v[172:175]
    v_exp_f32 v119, v87
    v_mfma_f32_16x16x32_bf16 v[180:183], a[152:155], v[52:55], v[180:183]
    v_exp_f32 v124, v92
    v_mfma_f32_16x16x32_bf16 v[188:191], a[156:159], v[52:55], v[188:191]
    v_exp_f32 v125, v93
    v_mfma_f32_16x16x32_bf16 v[196:199], a[160:163], v[52:55], v[196:199]
    v_exp_f32 v126, v94
    v_mfma_f32_16x16x32_bf16 v[204:207], a[164:167], v[52:55], v[204:207]
    v_exp_f32 v127, v95
    v_mfma_f32_16x16x32_bf16 v[212:215], a[168:171], v[52:55], v[212:215]
    ds_read_b128 a[128:131], v4 offset:49152
    v_cvt_pk_bf16_f32 v60, v116, v117
    v_mfma_f32_16x16x32_bf16 v[220:223], a[172:175], v[52:55], v[220:223]
    ds_read_b128 a[132:135], v4 offset:50176
    v_cvt_pk_bf16_f32 v61, v118, v119
    v_mfma_f32_16x16x32_bf16 v[228:231], a[176:179], v[52:55], v[228:231]
    ds_read_b128 a[136:139], v4 offset:51200
    v_add_f32 v15, v116, v117
    v_mfma_f32_16x16x32_bf16 v[236:239], a[180:183], v[52:55], v[236:239]
    ds_read_b128 a[140:143], v4 offset:52224
    v_add_f32 v15, v15, v118
    v_mfma_f32_16x16x32_bf16 v[244:247], a[184:187], v[52:55], v[244:247]
    ds_read_b128 a[144:147], v4 offset:53248
    v_add_f32 v15, v15, v119
    v_mfma_f32_16x16x32_bf16 v[252:255], a[188:191], v[52:55], v[252:255]
    ds_read_b128 a[148:151], v4 offset:54272
    v_cvt_pk_bf16_f32 v62, v124, v125
    s_nop 0
    ds_read_b128 a[152:155], v4 offset:55296
    ds_read_b128 a[156:159], v4 offset:56320
    ds_read_b128 a[160:163], v4 offset:57344
    ds_read_b128 a[164:167], v4 offset:58368
    ds_read_b128 a[168:171], v4 offset:59392
    ds_read_b128 a[172:175], v4 offset:60416
    ds_read_b128 a[176:179], v4 offset:61440
    ds_read_b128 a[180:183], v4 offset:62464
    ds_read_b128 a[184:187], v4 offset:63488
    ds_read_b128 a[188:191], v4 offset:64512
    v_cvt_pk_bf16_f32 v63, v126, v127
    v_add_f32 v15, v15, v124
    v_add_f32 v15, v15, v125
    v_add_f32 v15, v15, v126
    v_add_f32 v15, v15, v127
    v_cmp_ngt_f32 vcc, 2.0, v15
    s_cbranch_vccnz LR_31
LR_32:
    s_waitcnt lgkmcnt(0)
    s_barrier
    v_mfma_f32_16x16x32_bf16 v[132:135], a[128:131], v[60:63], v[132:135]
    s_add_u32 s82, s65, 28672
    v_add_f32 v9, v9, v15
    s_add_u32 m0, s69, 0
    v_mfma_f32_16x16x32_bf16 v[140:143], a[132:135], v[60:63], v[140:143]
    buffer_load_dwordx4 v32, s[36:39], s82 offen offset:0 lds
    v_mfma_f32_16x16x32_bf16 v[148:151], a[136:139], v[60:63], v[148:151]
    buffer_load_dwordx4 v33, s[36:39], s82 offen offset:1024 lds
    v_mfma_f32_16x16x32_bf16 v[156:159], a[140:143], v[60:63], v[156:159]
    buffer_load_dwordx4 v34, s[36:39], s82 offen offset:2048 lds
    v_mfma_f32_16x16x32_bf16 v[164:167], a[144:147], v[60:63], v[164:167]
    buffer_load_dwordx4 v35, s[36:39], s82 offen offset:3072 lds
    v_mfma_f32_16x16x32_bf16 v[172:175], a[148:151], v[60:63], v[172:175]
    s_add_u32 m0, m0, 4096
    v_mfma_f32_16x16x32_bf16 v[180:183], a[152:155], v[60:63], v[180:183]
    buffer_load_dwordx4 v36, s[36:39], s82 offen offset:0 lds
    v_mfma_f32_16x16x32_bf16 v[188:191], a[156:159], v[60:63], v[188:191]
    buffer_load_dwordx4 v37, s[36:39], s82 offen offset:1024 lds
    v_mfma_f32_16x16x32_bf16 v[196:199], a[160:163], v[60:63], v[196:199]
    buffer_load_dwordx4 v38, s[36:39], s82 offen offset:2048 lds
    v_mfma_f32_16x16x32_bf16 v[204:207], a[164:167], v[60:63], v[204:207]
    s_add_u32 s82, s65, 57344
    s_add_u32 m0, s69, 32768
    v_mfma_f32_16x16x32_bf16 v[212:215], a[168:171], v[60:63], v[212:215]
    buffer_load_dwordx4 v32, s[36:39], s82 offen offset:0 lds
    v_mfma_f32_16x16x32_bf16 v[220:223], a[172:175], v[60:63], v[220:223]
    buffer_load_dwordx4 v33, s[36:39], s82 offen offset:1024 lds
    v_mfma_f32_16x16x32_bf16 v[228:231], a[176:179], v[60:63], v[228:231]
    buffer_load_dwordx4 v34, s[36:39], s82 offen offset:2048 lds
    v_mfma_f32_16x16x32_bf16 v[236:239], a[180:183], v[60:63], v[236:239]
    buffer_load_dwordx4 v35, s[36:39], s82 offen offset:3072 lds
    v_mfma_f32_16x16x32_bf16 v[244:247], a[184:187], v[60:63], v[244:247]
    s_add_u32 m0, m0, 4096
    v_mfma_f32_16x16x32_bf16 v[252:255], a[188:191], v[60:63], v[252:255]
    buffer_load_dwordx4 v36, s[36:39], s82 offen offset:0 lds
    buffer_load_dwordx4 v37, s[36:39], s82 offen offset:1024 lds
    buffer_load_dwordx4 v38, s[36:39], s82 offen offset:2048 lds
    s_add_u32 s82, s65, 86016
    s_add_u32 m0, s69, 65536
    s_nop 0
    buffer_load_dwordx4 v32, s[36:39], s82 offen offset:0 lds
    buffer_load_dwordx4 v33, s[36:39], s82 offen offset:1024 lds
    buffer_load_dwordx4 v34, s[36:39], s82 offen offset:2048 lds
    buffer_load_dwordx4 v35, s[36:39], s82 offen offset:3072 lds
    s_add_u32 m0, m0, 4096
    s_nop 0
    buffer_load_dwordx4 v36, s[36:39], s82 offen offset:0 lds
    buffer_load_dwordx4 v37, s[36:39], s82 offen offset:1024 lds
    buffer_load_dwordx4 v38, s[36:39], s82 offen offset:2048 lds
    s_add_u32 s82, s65, 114688
    s_add_u32 m0, s69, 98304
    s_nop 0
    buffer_load_dwordx4 v32, s[36:39], s82 offen offset:0 lds
    buffer_load_dwordx4 v33, s[36:39], s82 offen offset:1024 lds
    buffer_load_dwordx4 v34, s[36:39], s82 offen offset:2048 lds
    buffer_load_dwordx4 v35, s[36:39], s82 offen offset:3072 lds
    s_add_u32 m0, m0, 4096
    s_nop 0
    buffer_load_dwordx4 v36, s[36:39], s82 offen offset:0 lds
    buffer_load_dwordx4 v37, s[36:39], s82 offen offset:1024 lds
    buffer_load_dwordx4 v38, s[36:39], s82 offen offset:2048 lds
    s_nop 7
    v_mov_b32 v20, v8
    s_nop 1
    v_permlane32_swap_b32 v20, v8
    s_nop 1
    v_add_f32 v8, v8, v20
    v_mov_b32 v20, v8
    s_nop 1
    v_permlane16_swap_b32 v20, v8
    s_nop 1
    v_add_f32 v8, v8, v20
    v_rcp_f32 v16, v8
    s_nop 0
    v_mov_b32 v17, v16
    v_mov_b32 v20, v9
    s_nop 1
    v_permlane32_swap_b32 v20, v9
    s_nop 1
    v_add_f32 v9, v9, v20
    v_mov_b32 v20, v9
    s_nop 1
    v_permlane16_swap_b32 v20, v9
    s_nop 1
    v_add_f32 v9, v9, v20
    v_rcp_f32 v18, v9
    s_nop 0
    v_mov_b32 v19, v18
    v_pk_mul_f32 v[128:129], v[128:129], v[16:17]
    v_pk_mul_f32 v[130:131], v[130:131], v[16:17]
    v_pk_mul_f32 v[136:137], v[136:137], v[16:17]
    v_pk_mul_f32 v[138:139], v[138:139], v[16:17]
    v_cvt_pk_bf16_f32 v64, v128, v129
    v_cvt_pk_bf16_f32 v65, v130, v131
    v_cvt_pk_bf16_f32 v66, v136, v137
    v_cvt_pk_bf16_f32 v67, v138, v139
    v_pk_mul_f32 v[132:133], v[132:133], v[18:19]
    v_pk_mul_f32 v[134:135], v[134:135], v[18:19]
    v_pk_mul_f32 v[140:141], v[140:141], v[18:19]
    v_pk_mul_f32 v[142:143], v[142:143], v[18:19]
    v_cvt_pk_bf16_f32 v68, v132, v133
    v_cvt_pk_bf16_f32 v69, v134, v135
    v_cvt_pk_bf16_f32 v70, v140, v141
    v_cvt_pk_bf16_f32 v71, v142, v143
    v_pk_mul_f32 v[144:145], v[144:145], v[16:17]
    v_pk_mul_f32 v[146:147], v[146:147], v[16:17]
    v_pk_mul_f32 v[152:153], v[152:153], v[16:17]
    v_pk_mul_f32 v[154:155], v[154:155], v[16:17]
    v_cvt_pk_bf16_f32 v72, v144, v145
    v_cvt_pk_bf16_f32 v73, v146, v147
    v_cvt_pk_bf16_f32 v74, v152, v153
    v_cvt_pk_bf16_f32 v75, v154, v155
    v_pk_mul_f32 v[148:149], v[148:149], v[18:19]
    v_pk_mul_f32 v[150:151], v[150:151], v[18:19]
    v_pk_mul_f32 v[156:157], v[156:157], v[18:19]
    v_pk_mul_f32 v[158:159], v[158:159], v[18:19]
    v_cvt_pk_bf16_f32 v76, v148, v149
    v_cvt_pk_bf16_f32 v77, v150, v151
    v_cvt_pk_bf16_f32 v78, v156, v157
    v_cvt_pk_bf16_f32 v79, v158, v159
    v_pk_mul_f32 v[160:161], v[160:161], v[16:17]
    v_pk_mul_f32 v[162:163], v[162:163], v[16:17]
    v_pk_mul_f32 v[168:169], v[168:169], v[16:17]
    v_pk_mul_f32 v[170:171], v[170:171], v[16:17]
    v_cvt_pk_bf16_f32 v80, v160, v161
    v_cvt_pk_bf16_f32 v81, v162, v163
    v_cvt_pk_bf16_f32 v82, v168, v169
    v_cvt_pk_bf16_f32 v83, v170, v171
    v_pk_mul_f32 v[164:165], v[164:165], v[18:19]
    v_pk_mul_f32 v[166:167], v[166:167], v[18:19]
    v_pk_mul_f32 v[172:173], v[172:173], v[18:19]
    v_pk_mul_f32 v[174:175], v[174:175], v[18:19]
    v_cvt_pk_bf16_f32 v84, v164, v165
    v_cvt_pk_bf16_f32 v85, v166, v167
    v_cvt_pk_bf16_f32 v86, v172, v173
    v_cvt_pk_bf16_f32 v87, v174, v175
    v_pk_mul_f32 v[176:177], v[176:177], v[16:17]
    v_pk_mul_f32 v[178:179], v[178:179], v[16:17]
    v_pk_mul_f32 v[184:185], v[184:185], v[16:17]
    v_pk_mul_f32 v[186:187], v[186:187], v[16:17]
    v_cvt_pk_bf16_f32 v88, v176, v177
    v_cvt_pk_bf16_f32 v89, v178, v179
    v_cvt_pk_bf16_f32 v90, v184, v185
    v_cvt_pk_bf16_f32 v91, v186, v187
    v_pk_mul_f32 v[180:181], v[180:181], v[18:19]
    v_pk_mul_f32 v[182:183], v[182:183], v[18:19]
    v_pk_mul_f32 v[188:189], v[188:189], v[18:19]
    v_pk_mul_f32 v[190:191], v[190:191], v[18:19]
    v_cvt_pk_bf16_f32 v92, v180, v181
    v_cvt_pk_bf16_f32 v93, v182, v183
    v_cvt_pk_bf16_f32 v94, v188, v189
    v_cvt_pk_bf16_f32 v95, v190, v191
    v_pk_mul_f32 v[192:193], v[192:193], v[16:17]
    v_pk_mul_f32 v[194:195], v[194:195], v[16:17]
    v_pk_mul_f32 v[200:201], v[200:201], v[16:17]
    v_pk_mul_f32 v[202:203], v[202:203], v[16:17]
    v_cvt_pk_bf16_f32 v96, v192, v193
    v_cvt_pk_bf16_f32 v97, v194, v195
    v_cvt_pk_bf16_f32 v98, v200, v201
    v_cvt_pk_bf16_f32 v99, v202, v203
    v_pk_mul_f32 v[196:197], v[196:197], v[18:19]
    v_pk_mul_f32 v[198:199], v[198:199], v[18:19]
    v_pk_mul_f32 v[204:205], v[204:205], v[18:19]
    v_pk_mul_f32 v[206:207], v[206:207], v[18:19]
    v_cvt_pk_bf16_f32 v100, v196, v197
    v_cvt_pk_bf16_f32 v101, v198, v199
    v_cvt_pk_bf16_f32 v102, v204, v205
    v_cvt_pk_bf16_f32 v103, v206, v207
    v_pk_mul_f32 v[208:209], v[208:209], v[16:17]
    v_pk_mul_f32 v[210:211], v[210:211], v[16:17]
    v_pk_mul_f32 v[216:217], v[216:217], v[16:17]
    v_pk_mul_f32 v[218:219], v[218:219], v[16:17]
    v_cvt_pk_bf16_f32 v104, v208, v209
    v_cvt_pk_bf16_f32 v105, v210, v211
    v_cvt_pk_bf16_f32 v106, v216, v217
    v_cvt_pk_bf16_f32 v107, v218, v219
    v_pk_mul_f32 v[212:213], v[212:213], v[18:19]
    v_pk_mul_f32 v[214:215], v[214:215], v[18:19]
    v_pk_mul_f32 v[220:221], v[220:221], v[18:19]
    v_pk_mul_f32 v[222:223], v[222:223], v[18:19]
    v_cvt_pk_bf16_f32 v108, v212, v213
    v_cvt_pk_bf16_f32 v109, v214, v215
    v_cvt_pk_bf16_f32 v110, v220, v221
    v_cvt_pk_bf16_f32 v111, v222, v223
    v_pk_mul_f32 v[224:225], v[224:225], v[16:17]
    v_pk_mul_f32 v[226:227], v[226:227], v[16:17]
    v_pk_mul_f32 v[232:233], v[232:233], v[16:17]
    v_pk_mul_f32 v[234:235], v[234:235], v[16:17]
    v_cvt_pk_bf16_f32 v112, v224, v225
    v_cvt_pk_bf16_f32 v113, v226, v227
    v_cvt_pk_bf16_f32 v114, v232, v233
    v_cvt_pk_bf16_f32 v115, v234, v235
    v_pk_mul_f32 v[228:229], v[228:229], v[18:19]
    v_pk_mul_f32 v[230:231], v[230:231], v[18:19]
    v_pk_mul_f32 v[236:237], v[236:237], v[18:19]
    v_pk_mul_f32 v[238:239], v[238:239], v[18:19]
    v_cvt_pk_bf16_f32 v116, v228, v229
    v_cvt_pk_bf16_f32 v117, v230, v231
    v_cvt_pk_bf16_f32 v118, v236, v237
    v_cvt_pk_bf16_f32 v119, v238, v239
    v_pk_mul_f32 v[240:241], v[240:241], v[16:17]
    v_pk_mul_f32 v[242:243], v[242:243], v[16:17]
    v_pk_mul_f32 v[248:249], v[248:249], v[16:17]
    v_pk_mul_f32 v[250:251], v[250:251], v[16:17]
    v_cvt_pk_bf16_f32 v120, v240, v241
    v_cvt_pk_bf16_f32 v121, v242, v243
    v_cvt_pk_bf16_f32 v122, v248, v249
    v_cvt_pk_bf16_f32 v123, v250, v251
    v_pk_mul_f32 v[244:245], v[244:245], v[18:19]
    v_pk_mul_f32 v[246:247], v[246:247], v[18:19]
    v_pk_mul_f32 v[252:253], v[252:253], v[18:19]
    v_pk_mul_f32 v[254:255], v[254:255], v[18:19]
    v_cvt_pk_bf16_f32 v124, v244, v245
    v_cvt_pk_bf16_f32 v125, v246, v247
    v_cvt_pk_bf16_f32 v126, v252, v253
    v_cvt_pk_bf16_f32 v127, v254, v255
    s_waitcnt vmcnt(28)
    s_barrier
    ds_read_b64_tr_b16 v[128:129], v40 offset:0
    ds_read_b64_tr_b16 v[130:131], v40 offset:14336
    ds_read_b64_tr_b16 v[132:133], v41 offset:0
    ds_read_b64_tr_b16 v[134:135], v41 offset:14336
    ds_read_b64_tr_b16 v[136:137], v42 offset:0
    ds_read_b64_tr_b16 v[138:139], v42 offset:14336
    ds_read_b64_tr_b16 v[140:141], v43 offset:0
    ds_read_b64_tr_b16 v[142:143], v43 offset:14336
    ds_read_b64_tr_b16 v[144:145], v40 offset:128
    ds_read_b64_tr_b16 v[146:147], v40 offset:14464
    ds_read_b64_tr_b16 v[148:149], v41 offset:128
    ds_read_b64_tr_b16 v[150:151], v41 offset:14464
    ds_read_b64_tr_b16 v[152:153], v42 offset:128
    ds_read_b64_tr_b16 v[154:155], v42 offset:14464
    ds_read_b64_tr_b16 v[156:157], v43 offset:128
    ds_read_b64_tr_b16 v[158:159], v43 offset:14464
    ds_read_b64_tr_b16 v[160:161], v40 offset:256
    ds_read_b64_tr_b16 v[162:163], v40 offset:14592
    ds_read_b64_tr_b16 v[164:165], v41 offset:256
    ds_read_b64_tr_b16 v[166:167], v41 offset:14592
    ds_read_b64_tr_b16 v[168:169], v42 offset:256
    ds_read_b64_tr_b16 v[170:171], v42 offset:14592
    ds_read_b64_tr_b16 v[172:173], v43 offset:256
    ds_read_b64_tr_b16 v[174:175], v43 offset:14592
    ds_read_b64_tr_b16 v[176:177], v40 offset:384
    ds_read_b64_tr_b16 v[178:179], v40 offset:14720
    ds_read_b64_tr_b16 v[180:181], v41 offset:384
    ds_read_b64_tr_b16 v[182:183], v41 offset:14720
    v_cmp_eq_u32 vcc, 1, v44
    s_nop 3
    s_cmp_eq_u64 vcc, -1
    s_cselect_b32 s79, 1, 0
    s_waitcnt lgkmcnt(0)
    v_mfma_f32_16x16x32_bf16 a[0:3], v[128:131], v[64:67], 0
    ds_read_b64_tr_b16 v[184:185], v42 offset:384
    v_mfma_f32_16x16x32_bf16 a[4:7], v[128:131], v[68:71], 0
    ds_read_b64_tr_b16 v[186:187], v42 offset:14720
    v_mfma_f32_16x16x32_bf16 a[8:11], v[132:135], v[64:67], 0
    ds_read_b64_tr_b16 v[188:189], v43 offset:384
    v_mfma_f32_16x16x32_bf16 a[12:15], v[132:135], v[68:71], 0
    ds_read_b64_tr_b16 v[190:191], v43 offset:14720
    v_mfma_f32_16x16x32_bf16 a[16:19], v[136:139], v[64:67], 0
    ds_read_b64_tr_b16 v[192:193], v40 offset:512
    v_mfma_f32_16x16x32_bf16 a[20:23], v[136:139], v[68:71], 0
    ds_read_b64_tr_b16 v[194:195], v40 offset:14848
    v_mfma_f32_16x16x32_bf16 a[24:27], v[140:143], v[64:67], 0
    ds_read_b64_tr_b16 v[196:197], v41 offset:512
    s_waitcnt lgkmcnt(14)
    v_mfma_f32_16x16x32_bf16 a[28:31], v[140:143], v[68:71], 0
    ds_read_b64_tr_b16 v[198:199], v41 offset:14848
    v_mfma_f32_16x16x32_bf16 a[32:35], v[144:147], v[64:67], 0
    ds_read_b64_tr_b16 v[200:201], v42 offset:512
    v_mfma_f32_16x16x32_bf16 a[36:39], v[144:147], v[68:71], 0
    ds_read_b64_tr_b16 v[202:203], v42 offset:14848
    v_mfma_f32_16x16x32_bf16 a[40:43], v[148:151], v[64:67], 0
    ds_read_b64_tr_b16 v[204:205], v43 offset:512
    v_mfma_f32_16x16x32_bf16 a[44:47], v[148:151], v[68:71], 0
    ds_read_b64_tr_b16 v[206:207], v43 offset:14848
    v_mfma_f32_16x16x32_bf16 a[48:51], v[152:155], v[64:67], 0
    ds_read_b64_tr_b16 v[208:209], v40 offset:640
    v_mfma_f32_16x16x32_bf16 a[52:55], v[152:155], v[68:71], 0
    ds_read_b64_tr_b16 v[210:211], v40 offset:14976
    s_waitcnt lgkmcnt(14)
    v_mfma_f32_16x16x32_bf16 a[56:59], v[156:159], v[64:67], 0
    ds_read_b64_tr_b16 v[212:213], v41 offset:640
    v_mfma_f32_16x16x32_bf16 a[60:63], v[156:159], v[68:71], 0
    ds_read_b64_tr_b16 v[214:215], v41 offset:14976
    v_mfma_f32_16x16x32_bf16 a[64:67], v[160:163], v[64:67], 0
    ds_read_b64_tr_b16 v[216:217], v42 offset:640
    v_mfma_f32_16x16x32_bf16 a[68:71], v[160:163], v[68:71], 0
    ds_read_b64_tr_b16 v[218:219], v42 offset:14976
    v_mfma_f32_16x16x32_bf16 a[72:75], v[164:167], v[64:67], 0
    ds_read_b64_tr_b16 v[220:221], v43 offset:640
    v_mfma_f32_16x16x32_bf16 a[76:79], v[164:167], v[68:71], 0
    ds_read_b64_tr_b16 v[222:223], v43 offset:14976
    v_mfma_f32_16x16x32_bf16 a[80:83], v[168:171], v[64:67], 0
    ds_read_b64_tr_b16 v[224:225], v40 offset:768
    s_waitcnt lgkmcnt(14)
    v_mfma_f32_16x16x32_bf16 a[84:87], v[168:171], v[68:71], 0
    ds_read_b64_tr_b16 v[226:227], v40 offset:15104
    v_mfma_f32_16x16x32_bf16 a[88:91], v[172:175], v[64:67], 0
    ds_read_b64_tr_b16 v[228:229], v41 offset:768
    v_mfma_f32_16x16x32_bf16 a[92:95], v[172:175], v[68:71], 0
    ds_read_b64_tr_b16 v[230:231], v41 offset:15104
    v_mfma_f32_16x16x32_bf16 a[96:99], v[176:179], v[64:67], 0
    ds_read_b64_tr_b16 v[232:233], v42 offset:768
    v_mfma_f32_16x16x32_bf16 a[100:103], v[176:179], v[68:71], 0
    ds_read_b64_tr_b16 v[234:235], v42 offset:15104
    v_mfma_f32_16x16x32_bf16 a[104:107], v[180:183], v[64:67], 0
    ds_read_b64_tr_b16 v[236:237], v43 offset:768
    v_mfma_f32_16x16x32_bf16 a[108:111], v[180:183], v[68:71], 0
    ds_read_b64_tr_b16 v[238:239], v43 offset:15104
    v_add_u32 v40, 0xfffe0000, v40
    v_add_u32 v41, 0xfffe0000, v41
    v_add_u32 v42, 0xfffe0000, v42
    v_add_u32 v43, 0xfffe0000, v43
    s_waitcnt vmcnt(21) lgkmcnt(0)
    s_barrier
    s_add_u32 s82, s65, 143360
    s_add_u32 m0, s69, 131072
    s_nop 0
    buffer_load_dwordx4 v32, s[36:39], s82 offen offset:0 lds
    buffer_load_dwordx4 v33, s[36:39], s82 offen offset:1024 lds
    buffer_load_dwordx4 v34, s[36:39], s82 offen offset:2048 lds
    buffer_load_dwordx4 v35, s[36:39], s82 offen offset:3072 lds
    s_add_u32 m0, m0, 4096
    s_nop 0
    buffer_load_dwordx4 v36, s[36:39], s82 offen offset:0 lds
    buffer_load_dwordx4 v37, s[36:39], s82 offen offset:1024 lds
    buffer_load_dwordx4 v38, s[36:39], s82 offen offset:2048 lds
    v_mfma_f32_16x16x32_bf16 a[112:115], v[184:187], v[64:67], 0
    ds_read_b64_tr_b16 v[128:129], v40 offset:0
    v_mfma_f32_16x16x32_bf16 a[116:119], v[184:187], v[68:71], 0
    ds_read_b64_tr_b16 v[130:131], v40 offset:14336
    v_mfma_f32_16x16x32_bf16 a[120:123], v[188:191], v[64:67], 0
    ds_read_b64_tr_b16 v[132:133], v41 offset:0
    v_mfma_f32_16x16x32_bf16 a[124:127], v[188:191], v[68:71], 0
    ds_read_b64_tr_b16 v[134:135], v41 offset:14336
    v_mfma_f32_16x16x32_bf16 a[128:131], v[192:195], v[64:67], 0
    ds_read_b64_tr_b16 v[136:137], v42 offset:0
    v_mfma_f32_16x16x32_bf16 a[132:135], v[192:195], v[68:71], 0
    ds_read_b64_tr_b16 v[138:139], v42 offset:14336
    v_mfma_f32_16x16x32_bf16 a[136:139], v[196:199], v[64:67], 0
    ds_read_b64_tr_b16 v[140:141], v43 offset:0
    s_waitcnt lgkmcnt(14)
    v_mfma_f32_16x16x32_bf16 a[140:143], v[196:199], v[68:71], 0
    ds_read_b64_tr_b16 v[142:143], v43 offset:14336
    v_mfma_f32_16x16x32_bf16 a[144:147], v[200:203], v[64:67], 0
    ds_read_b64_tr_b16 v[144:145], v40 offset:128
    v_mfma_f32_16x16x32_bf16 a[148:151], v[200:203], v[68:71], 0
    ds_read_b64_tr_b16 v[146:147], v40 offset:14464
    v_mfma_f32_16x16x32_bf16 a[152:155], v[204:207], v[64:67], 0
    ds_read_b64_tr_b16 v[148:149], v41 offset:128
    v_mfma_f32_16x16x32_bf16 a[156:159], v[204:207], v[68:71], 0
    ds_read_b64_tr_b16 v[150:151], v41 offset:14464
    v_mfma_f32_16x16x32_bf16 a[160:163], v[208:211], v[64:67], 0
    ds_read_b64_tr_b16 v[152:153], v42 offset:128
    v_mfma_f32_16x16x32_bf16 a[164:167], v[208:211], v[68:71], 0
    ds_read_b64_tr_b16 v[154:155], v42 offset:14464
    s_waitcnt lgkmcnt(14)
    v_mfma_f32_16x16x32_bf16 a[168:171], v[212:215], v[64:67], 0
    ds_read_b64_tr_b16 v[156:157], v43 offset:128
    v_mfma_f32_16x16x32_bf16 a[172:175], v[212:215], v[68:71], 0
    ds_read_b64_tr_b16 v[158:159], v43 offset:14464
    v_mfma_f32_16x16x32_bf16 a[176:179], v[216:219], v[64:67], 0
    ds_read_b64_tr_b16 v[160:161], v40 offset:256
    v_mfma_f32_16x16x32_bf16 a[180:183], v[216:219], v[68:71], 0
    ds_read_b64_tr_b16 v[162:163], v40 offset:14592
    v_mfma_f32_16x16x32_bf16 a[184:187], v[220:223], v[64:67], 0
    ds_read_b64_tr_b16 v[164:165], v41 offset:256
    v_mfma_f32_16x16x32_bf16 a[188:191], v[220:223], v[68:71], 0
    ds_read_b64_tr_b16 v[166:167], v41 offset:14592
    v_mfma_f32_16x16x32_bf16 a[192:195], v[224:227], v[64:67], 0
    ds_read_b64_tr_b16 v[168:169], v42 offset:256
    s_waitcnt lgkmcnt(14)
    v_mfma_f32_16x16x32_bf16 a[196:199], v[224:227], v[68:71], 0
    ds_read_b64_tr_b16 v[170:171], v42 offset:14592
    v_mfma_f32_16x16x32_bf16 a[200:203], v[228:231], v[64:67], 0
    ds_read_b64_tr_b16 v[172:173], v43 offset:256
    v_mfma_f32_16x16x32_bf16 a[204:207], v[228:231], v[68:71], 0
    ds_read_b64_tr_b16 v[174:175], v43 offset:14592
    v_mfma_f32_16x16x32_bf16 a[208:211], v[232:235], v[64:67], 0
    ds_read_b64_tr_b16 v[176:177], v40 offset:384
    v_mfma_f32_16x16x32_bf16 a[212:215], v[232:235], v[68:71], 0
    ds_read_b64_tr_b16 v[178:179], v40 offset:14720
    v_mfma_f32_16x16x32_bf16 a[216:219], v[236:239], v[64:67], 0
    ds_read_b64_tr_b16 v[180:181], v41 offset:384
    v_mfma_f32_16x16x32_bf16 a[220:223], v[236:239], v[68:71], 0
    ds_read_b64_tr_b16 v[182:183], v41 offset:14720
    s_waitcnt lgkmcnt(14)
    v_mfma_f32_16x16x32_bf16 a[0:3], v[128:131], v[72:75], a[0:3]
    ds_read_b64_tr_b16 v[184:185], v42 offset:384
    v_mfma_f32_16x16x32_bf16 a[4:7], v[128:131], v[76:79], a[4:7]
    ds_read_b64_tr_b16 v[186:187], v42 offset:14720
    v_mfma_f32_16x16x32_bf16 a[8:11], v[132:135], v[72:75], a[8:11]
    ds_read_b64_tr_b16 v[188:189], v43 offset:384
    v_mfma_f32_16x16x32_bf16 a[12:15], v[132:135], v[76:79], a[12:15]
    ds_read_b64_tr_b16 v[190:191], v43 offset:14720
    v_mfma_f32_16x16x32_bf16 a[16:19], v[136:139], v[72:75], a[16:19]
    ds_read_b64_tr_b16 v[192:193], v40 offset:512
    v_mfma_f32_16x16x32_bf16 a[20:23], v[136:139], v[76:79], a[20:23]
    ds_read_b64_tr_b16 v[194:195], v40 offset:14848
    v_mfma_f32_16x16x32_bf16 a[24:27], v[140:143], v[72:75], a[24:27]
    ds_read_b64_tr_b16 v[196:197], v41 offset:512
    s_waitcnt lgkmcnt(14)
    v_mfma_f32_16x16x32_bf16 a[28:31], v[140:143], v[76:79], a[28:31]
    ds_read_b64_tr_b16 v[198:199], v41 offset:14848
    v_mfma_f32_16x16x32_bf16 a[32:35], v[144:147], v[72:75], a[32:35]
    ds_read_b64_tr_b16 v[200:201], v42 offset:512
    v_mfma_f32_16x16x32_bf16 a[36:39], v[144:147], v[76:79], a[36:39]
    ds_read_b64_tr_b16 v[202:203], v42 offset:14848
    v_mfma_f32_16x16x32_bf16 a[40:43], v[148:151], v[72:75], a[40:43]
    ds_read_b64_tr_b16 v[204:205], v43 offset:512
    v_mfma_f32_16x16x32_bf16 a[44:47], v[148:151], v[76:79], a[44:47]
    ds_read_b64_tr_b16 v[206:207], v43 offset:14848
    v_mfma_f32_16x16x32_bf16 a[48:51], v[152:155], v[72:75], a[48:51]
    ds_read_b64_tr_b16 v[208:209], v40 offset:640
    v_mfma_f32_16x16x32_bf16 a[52:55], v[152:155], v[76:79], a[52:55]
    ds_read_b64_tr_b16 v[210:211], v40 offset:14976
    s_waitcnt lgkmcnt(14)
    v_mfma_f32_16x16x32_bf16 a[56:59], v[156:159], v[72:75], a[56:59]
    ds_read_b64_tr_b16 v[212:213], v41 offset:640
    v_mfma_f32_16x16x32_bf16 a[60:63], v[156:159], v[76:79], a[60:63]
    ds_read_b64_tr_b16 v[214:215], v41 offset:14976
    v_mfma_f32_16x16x32_bf16 a[64:67], v[160:163], v[72:75], a[64:67]
    ds_read_b64_tr_b16 v[216:217], v42 offset:640
    v_mfma_f32_16x16x32_bf16 a[68:71], v[160:163], v[76:79], a[68:71]
    ds_read_b64_tr_b16 v[218:219], v42 offset:14976
    v_mfma_f32_16x16x32_bf16 a[72:75], v[164:167], v[72:75], a[72:75]
    ds_read_b64_tr_b16 v[220:221], v43 offset:640
    v_mfma_f32_16x16x32_bf16 a[76:79], v[164:167], v[76:79], a[76:79]
    ds_read_b64_tr_b16 v[222:223], v43 offset:14976
    v_mfma_f32_16x16x32_bf16 a[80:83], v[168:171], v[72:75], a[80:83]
    ds_read_b64_tr_b16 v[224:225], v40 offset:768
    s_waitcnt lgkmcnt(14)
    v_mfma_f32_16x16x32_bf16 a[84:87], v[168:171], v[76:79], a[84:87]
    ds_read_b64_tr_b16 v[226:227], v40 offset:15104
    v_mfma_f32_16x16x32_bf16 a[88:91], v[172:175], v[72:75], a[88:91]
    ds_read_b64_tr_b16 v[228:229], v41 offset:768
    v_mfma_f32_16x16x32_bf16 a[92:95], v[172:175], v[76:79], a[92:95]
    ds_read_b64_tr_b16 v[230:231], v41 offset:15104
    v_mfma_f32_16x16x32_bf16 a[96:99], v[176:179], v[72:75], a[96:99]
    ds_read_b64_tr_b16 v[232:233], v42 offset:768
    v_mfma_f32_16x16x32_bf16 a[100:103], v[176:179], v[76:79], a[100:103]
    ds_read_b64_tr_b16 v[234:235], v42 offset:15104
    v_mfma_f32_16x16x32_bf16 a[104:107], v[180:183], v[72:75], a[104:107]
    ds_read_b64_tr_b16 v[236:237], v43 offset:768
    v_mfma_f32_16x16x32_bf16 a[108:111], v[180:183], v[76:79], a[108:111]
    ds_read_b64_tr_b16 v[238:239], v43 offset:15104
    v_add_u32 v40, 0x8000, v40
    v_add_u32 v41, 0x8000, v41
    v_add_u32 v42, 0x8000, v42
    v_add_u32 v43, 0x8000, v43
    s_waitcnt vmcnt(21) lgkmcnt(0)
    s_barrier
    s_add_u32 s82, s65, 172032
    s_add_u32 m0, s69, 0
    s_nop 0
    buffer_load_dwordx4 v32, s[36:39], s82 offen offset:0 lds
    buffer_load_dwordx4 v33, s[36:39], s82 offen offset:1024 lds
    buffer_load_dwordx4 v34, s[36:39], s82 offen offset:2048 lds
    buffer_load_dwordx4 v35, s[36:39], s82 offen offset:3072 lds
    s_add_u32 m0, m0, 4096
    s_nop 0
    buffer_load_dwordx4 v36, s[36:39], s82 offen offset:0 lds
    buffer_load_dwordx4 v37, s[36:39], s82 offen offset:1024 lds
    buffer_load_dwordx4 v38, s[36:39], s82 offen offset:2048 lds
    v_mfma_f32_16x16x32_bf16 a[112:115], v[184:187], v[72:75], a[112:115]
    ds_read_b64_tr_b16 v[128:129], v40 offset:0
    v_mfma_f32_16x16x32_bf16 a[116:119], v[184:187], v[76:79], a[116:119]
    ds_read_b64_tr_b16 v[130:131], v40 offset:14336
    v_mfma_f32_16x16x32_bf16 a[120:123], v[188:191], v[72:75], a[120:123]
    ds_read_b64_tr_b16 v[132:133], v41 offset:0
    v_mfma_f32_16x16x32_bf16 a[124:127], v[188:191], v[76:79], a[124:127]
    ds_read_b64_tr_b16 v[134:135], v41 offset:14336
    v_mfma_f32_16x16x32_bf16 a[128:131], v[192:195], v[72:75], a[128:131]
    ds_read_b64_tr_b16 v[136:137], v42 offset:0
    v_mfma_f32_16x16x32_bf16 a[132:135], v[192:195], v[76:79], a[132:135]
    ds_read_b64_tr_b16 v[138:139], v42 offset:14336
    v_mfma_f32_16x16x32_bf16 a[136:139], v[196:199], v[72:75], a[136:139]
    ds_read_b64_tr_b16 v[140:141], v43 offset:0
    s_waitcnt lgkmcnt(14)
    v_mfma_f32_16x16x32_bf16 a[140:143], v[196:199], v[76:79], a[140:143]
    ds_read_b64_tr_b16 v[142:143], v43 offset:14336
    v_mfma_f32_16x16x32_bf16 a[144:147], v[200:203], v[72:75], a[144:147]
    ds_read_b64_tr_b16 v[144:145], v40 offset:128
    v_mfma_f32_16x16x32_bf16 a[148:151], v[200:203], v[76:79], a[148:151]
    ds_read_b64_tr_b16 v[146:147], v40 offset:14464
    v_mfma_f32_16x16x32_bf16 a[152:155], v[204:207], v[72:75], a[152:155]
    ds_read_b64_tr_b16 v[148:149], v41 offset:128
    v_mfma_f32_16x16x32_bf16 a[156:159], v[204:207], v[76:79], a[156:159]
    ds_read_b64_tr_b16 v[150:151], v41 offset:14464
    v_mfma_f32_16x16x32_bf16 a[160:163], v[208:211], v[72:75], a[160:163]
    ds_read_b64_tr_b16 v[152:153], v42 offset:128
    v_mfma_f32_16x16x32_bf16 a[164:167], v[208:211], v[76:79], a[164:167]
    ds_read_b64_tr_b16 v[154:155], v42 offset:14464
    s_waitcnt lgkmcnt(14)
    v_mfma_f32_16x16x32_bf16 a[168:171], v[212:215], v[72:75], a[168:171]
    ds_read_b64_tr_b16 v[156:157], v43 offset:128
    v_mfma_f32_16x16x32_bf16 a[172:175], v[212:215], v[76:79], a[172:175]
    ds_read_b64_tr_b16 v[158:159], v43 offset:14464
    v_mfma_f32_16x16x32_bf16 a[176:179], v[216:219], v[72:75], a[176:179]
    ds_read_b64_tr_b16 v[160:161], v40 offset:256
    v_mfma_f32_16x16x32_bf16 a[180:183], v[216:219], v[76:79], a[180:183]
    ds_read_b64_tr_b16 v[162:163], v40 offset:14592
    v_mfma_f32_16x16x32_bf16 a[184:187], v[220:223], v[72:75], a[184:187]
    ds_read_b64_tr_b16 v[164:165], v41 offset:256
    v_mfma_f32_16x16x32_bf16 a[188:191], v[220:223], v[76:79], a[188:191]
    ds_read_b64_tr_b16 v[166:167], v41 offset:14592
    v_mfma_f32_16x16x32_bf16 a[192:195], v[224:227], v[72:75], a[192:195]
    ds_read_b64_tr_b16 v[168:169], v42 offset:256
    s_waitcnt lgkmcnt(14)
    v_mfma_f32_16x16x32_bf16 a[196:199], v[224:227], v[76:79], a[196:199]
    ds_read_b64_tr_b16 v[170:171], v42 offset:14592
    v_mfma_f32_16x16x32_bf16 a[200:203], v[228:231], v[72:75], a[200:203]
    ds_read_b64_tr_b16 v[172:173], v43 offset:256
    v_mfma_f32_16x16x32_bf16 a[204:207], v[228:231], v[76:79], a[204:207]
    ds_read_b64_tr_b16 v[174:175], v43 offset:14592
    v_mfma_f32_16x16x32_bf16 a[208:211], v[232:235], v[72:75], a[208:211]
    ds_read_b64_tr_b16 v[176:177], v40 offset:384
    v_mfma_f32_16x16x32_bf16 a[212:215], v[232:235], v[76:79], a[212:215]
    ds_read_b64_tr_b16 v[178:179], v40 offset:14720
    v_mfma_f32_16x16x32_bf16 a[216:219], v[236:239], v[72:75], a[216:219]
    ds_read_b64_tr_b16 v[180:181], v41 offset:384
    v_mfma_f32_16x16x32_bf16 a[220:223], v[236:239], v[76:79], a[220:223]
    ds_read_b64_tr_b16 v[182:183], v41 offset:14720
    s_waitcnt lgkmcnt(14)
    v_mfma_f32_16x16x32_bf16 a[0:3], v[128:131], v[80:83], a[0:3]
    ds_read_b64_tr_b16 v[184:185], v42 offset:384
    v_mfma_f32_16x16x32_bf16 a[4:7], v[128:131], v[84:87], a[4:7]
    ds_read_b64_tr_b16 v[186:187], v42 offset:14720
    v_mfma_f32_16x16x32_bf16 a[8:11], v[132:135], v[80:83], a[8:11]
    ds_read_b64_tr_b16 v[188:189], v43 offset:384
    v_mfma_f32_16x16x32_bf16 a[12:15], v[132:135], v[84:87], a[12:15]
    ds_read_b64_tr_b16 v[190:191], v43 offset:14720
    v_mfma_f32_16x16x32_bf16 a[16:19], v[136:139], v[80:83], a[16:19]
    ds_read_b64_tr_b16 v[192:193], v40 offset:512
    v_mfma_f32_16x16x32_bf16 a[20:23], v[136:139], v[84:87], a[20:23]
    ds_read_b64_tr_b16 v[194:195], v40 offset:14848
    v_mfma_f32_16x16x32_bf16 a[24:27], v[140:143], v[80:83], a[24:27]
    ds_read_b64_tr_b16 v[196:197], v41 offset:512
    s_waitcnt lgkmcnt(14)
    v_mfma_f32_16x16x32_bf16 a[28:31], v[140:143], v[84:87], a[28:31]
    ds_read_b64_tr_b16 v[198:199], v41 offset:14848
    v_mfma_f32_16x16x32_bf16 a[32:35], v[144:147], v[80:83], a[32:35]
    ds_read_b64_tr_b16 v[200:201], v42 offset:512
    v_mfma_f32_16x16x32_bf16 a[36:39], v[144:147], v[84:87], a[36:39]
    ds_read_b64_tr_b16 v[202:203], v42 offset:14848
    v_mfma_f32_16x16x32_bf16 a[40:43], v[148:151], v[80:83], a[40:43]
    ds_read_b64_tr_b16 v[204:205], v43 offset:512
    v_mfma_f32_16x16x32_bf16 a[44:47], v[148:151], v[84:87], a[44:47]
    ds_read_b64_tr_b16 v[206:207], v43 offset:14848
    v_mfma_f32_16x16x32_bf16 a[48:51], v[152:155], v[80:83], a[48:51]
    ds_read_b64_tr_b16 v[208:209], v40 offset:640
    v_mfma_f32_16x16x32_bf16 a[52:55], v[152:155], v[84:87], a[52:55]
    ds_read_b64_tr_b16 v[210:211], v40 offset:14976
    s_waitcnt lgkmcnt(14)
    v_mfma_f32_16x16x32_bf16 a[56:59], v[156:159], v[80:83], a[56:59]
    ds_read_b64_tr_b16 v[212:213], v41 offset:640
    v_mfma_f32_16x16x32_bf16 a[60:63], v[156:159], v[84:87], a[60:63]
    ds_read_b64_tr_b16 v[214:215], v41 offset:14976
    v_mfma_f32_16x16x32_bf16 a[64:67], v[160:163], v[80:83], a[64:67]
    ds_read_b64_tr_b16 v[216:217], v42 offset:640
    v_mfma_f32_16x16x32_bf16 a[68:71], v[160:163], v[84:87], a[68:71]
    ds_read_b64_tr_b16 v[218:219], v42 offset:14976
    v_mfma_f32_16x16x32_bf16 a[72:75], v[164:167], v[80:83], a[72:75]
    ds_read_b64_tr_b16 v[220:221], v43 offset:640
    v_mfma_f32_16x16x32_bf16 a[76:79], v[164:167], v[84:87], a[76:79]
    ds_read_b64_tr_b16 v[222:223], v43 offset:14976
    v_mfma_f32_16x16x32_bf16 a[80:83], v[168:171], v[80:83], a[80:83]
    ds_read_b64_tr_b16 v[224:225], v40 offset:768
    s_waitcnt lgkmcnt(14)
    v_mfma_f32_16x16x32_bf16 a[84:87], v[168:171], v[84:87], a[84:87]
    ds_read_b64_tr_b16 v[226:227], v40 offset:15104
    v_mfma_f32_16x16x32_bf16 a[88:91], v[172:175], v[80:83], a[88:91]
    ds_read_b64_tr_b16 v[228:229], v41 offset:768
    v_mfma_f32_16x16x32_bf16 a[92:95], v[172:175], v[84:87], a[92:95]
    ds_read_b64_tr_b16 v[230:231], v41 offset:15104
    v_mfma_f32_16x16x32_bf16 a[96:99], v[176:179], v[80:83], a[96:99]
    ds_read_b64_tr_b16 v[232:233], v42 offset:768
    v_mfma_f32_16x16x32_bf16 a[100:103], v[176:179], v[84:87], a[100:103]
    ds_read_b64_tr_b16 v[234:235], v42 offset:15104
    v_mfma_f32_16x16x32_bf16 a[104:107], v[180:183], v[80:83], a[104:107]
    ds_read_b64_tr_b16 v[236:237], v43 offset:768
    v_mfma_f32_16x16x32_bf16 a[108:111], v[180:183], v[84:87], a[108:111]
    ds_read_b64_tr_b16 v[238:239], v43 offset:15104
    v_add_u32 v40, 0x8000, v40
    v_add_u32 v41, 0x8000, v41
    v_add_u32 v42, 0x8000, v42
    v_add_u32 v43, 0x8000, v43
    s_waitcnt vmcnt(21) lgkmcnt(0)
    s_barrier
    s_add_u32 s82, s65, 200704
    s_add_u32 m0, s69, 32768
    s_nop 0
    buffer_load_dwordx4 v32, s[36:39], s82 offen offset:0 lds
    buffer_load_dwordx4 v33, s[36:39], s82 offen offset:1024 lds
    buffer_load_dwordx4 v34, s[36:39], s82 offen offset:2048 lds
    buffer_load_dwordx4 v35, s[36:39], s82 offen offset:3072 lds
    s_add_u32 m0, m0, 4096
    s_nop 0
    buffer_load_dwordx4 v36, s[36:39], s82 offen offset:0 lds
    buffer_load_dwordx4 v37, s[36:39], s82 offen offset:1024 lds
    buffer_load_dwordx4 v38, s[36:39], s82 offen offset:2048 lds
    v_mfma_f32_16x16x32_bf16 a[112:115], v[184:187], v[80:83], a[112:115]
    ds_read_b64_tr_b16 v[128:129], v40 offset:0
    v_mfma_f32_16x16x32_bf16 a[116:119], v[184:187], v[84:87], a[116:119]
    ds_read_b64_tr_b16 v[130:131], v40 offset:14336
    v_mfma_f32_16x16x32_bf16 a[120:123], v[188:191], v[80:83], a[120:123]
    ds_read_b64_tr_b16 v[132:133], v41 offset:0
    v_mfma_f32_16x16x32_bf16 a[124:127], v[188:191], v[84:87], a[124:127]
    ds_read_b64_tr_b16 v[134:135], v41 offset:14336
    v_mfma_f32_16x16x32_bf16 a[128:131], v[192:195], v[80:83], a[128:131]
    ds_read_b64_tr_b16 v[136:137], v42 offset:0
    v_mfma_f32_16x16x32_bf16 a[132:135], v[192:195], v[84:87], a[132:135]
    ds_read_b64_tr_b16 v[138:139], v42 offset:14336
    v_mfma_f32_16x16x32_bf16 a[136:139], v[196:199], v[80:83], a[136:139]
    ds_read_b64_tr_b16 v[140:141], v43 offset:0
    s_waitcnt lgkmcnt(14)
    v_mfma_f32_16x16x32_bf16 a[140:143], v[196:199], v[84:87], a[140:143]
    ds_read_b64_tr_b16 v[142:143], v43 offset:14336
    v_mfma_f32_16x16x32_bf16 a[144:147], v[200:203], v[80:83], a[144:147]
    ds_read_b64_tr_b16 v[144:145], v40 offset:128
    v_mfma_f32_16x16x32_bf16 a[148:151], v[200:203], v[84:87], a[148:151]
    ds_read_b64_tr_b16 v[146:147], v40 offset:14464
    v_mfma_f32_16x16x32_bf16 a[152:155], v[204:207], v[80:83], a[152:155]
    ds_read_b64_tr_b16 v[148:149], v41 offset:128
    v_mfma_f32_16x16x32_bf16 a[156:159], v[204:207], v[84:87], a[156:159]
    ds_read_b64_tr_b16 v[150:151], v41 offset:14464
    v_mfma_f32_16x16x32_bf16 a[160:163], v[208:211], v[80:83], a[160:163]
    ds_read_b64_tr_b16 v[152:153], v42 offset:128
    v_mfma_f32_16x16x32_bf16 a[164:167], v[208:211], v[84:87], a[164:167]
    ds_read_b64_tr_b16 v[154:155], v42 offset:14464
    s_waitcnt lgkmcnt(14)
    v_mfma_f32_16x16x32_bf16 a[168:171], v[212:215], v[80:83], a[168:171]
    ds_read_b64_tr_b16 v[156:157], v43 offset:128
    v_mfma_f32_16x16x32_bf16 a[172:175], v[212:215], v[84:87], a[172:175]
    ds_read_b64_tr_b16 v[158:159], v43 offset:14464
    v_mfma_f32_16x16x32_bf16 a[176:179], v[216:219], v[80:83], a[176:179]
    ds_read_b64_tr_b16 v[160:161], v40 offset:256
    v_mfma_f32_16x16x32_bf16 a[180:183], v[216:219], v[84:87], a[180:183]
    ds_read_b64_tr_b16 v[162:163], v40 offset:14592
    v_mfma_f32_16x16x32_bf16 a[184:187], v[220:223], v[80:83], a[184:187]
    ds_read_b64_tr_b16 v[164:165], v41 offset:256
    v_mfma_f32_16x16x32_bf16 a[188:191], v[220:223], v[84:87], a[188:191]
    ds_read_b64_tr_b16 v[166:167], v41 offset:14592
    v_mfma_f32_16x16x32_bf16 a[192:195], v[224:227], v[80:83], a[192:195]
    ds_read_b64_tr_b16 v[168:169], v42 offset:256
    s_waitcnt lgkmcnt(14)
    v_mfma_f32_16x16x32_bf16 a[196:199], v[224:227], v[84:87], a[196:199]
    ds_read_b64_tr_b16 v[170:171], v42 offset:14592
    v_mfma_f32_16x16x32_bf16 a[200:203], v[228:231], v[80:83], a[200:203]
    ds_read_b64_tr_b16 v[172:173], v43 offset:256
    v_mfma_f32_16x16x32_bf16 a[204:207], v[228:231], v[84:87], a[204:207]
    ds_read_b64_tr_b16 v[174:175], v43 offset:14592
    v_mfma_f32_16x16x32_bf16 a[208:211], v[232:235], v[80:83], a[208:211]
    ds_read_b64_tr_b16 v[176:177], v40 offset:384
    v_mfma_f32_16x16x32_bf16 a[212:215], v[232:235], v[84:87], a[212:215]
    ds_read_b64_tr_b16 v[178:179], v40 offset:14720
    v_mfma_f32_16x16x32_bf16 a[216:219], v[236:239], v[80:83], a[216:219]
    ds_read_b64_tr_b16 v[180:181], v41 offset:384
    v_mfma_f32_16x16x32_bf16 a[220:223], v[236:239], v[84:87], a[220:223]
    ds_read_b64_tr_b16 v[182:183], v41 offset:14720
    s_waitcnt lgkmcnt(14)
    v_mfma_f32_16x16x32_bf16 a[0:3], v[128:131], v[88:91], a[0:3]
    ds_read_b64_tr_b16 v[184:185], v42 offset:384
    v_mfma_f32_16x16x32_bf16 a[4:7], v[128:131], v[92:95], a[4:7]
    ds_read_b64_tr_b16 v[186:187], v42 offset:14720
    v_mfma_f32_16x16x32_bf16 a[8:11], v[132:135], v[88:91], a[8:11]
    ds_read_b64_tr_b16 v[188:189], v43 offset:384
    v_mfma_f32_16x16x32_bf16 a[12:15], v[132:135], v[92:95], a[12:15]
    ds_read_b64_tr_b16 v[190:191], v43 offset:14720
    v_mfma_f32_16x16x32_bf16 a[16:19], v[136:139], v[88:91], a[16:19]
    ds_read_b64_tr_b16 v[192:193], v40 offset:512
    v_mfma_f32_16x16x32_bf16 a[20:23], v[136:139], v[92:95], a[20:23]
    ds_read_b64_tr_b16 v[194:195], v40 offset:14848
    v_mfma_f32_16x16x32_bf16 a[24:27], v[140:143], v[88:91], a[24:27]
    ds_read_b64_tr_b16 v[196:197], v41 offset:512
    s_waitcnt lgkmcnt(14)
    v_mfma_f32_16x16x32_bf16 a[28:31], v[140:143], v[92:95], a[28:31]
    ds_read_b64_tr_b16 v[198:199], v41 offset:14848
    v_mfma_f32_16x16x32_bf16 a[32:35], v[144:147], v[88:91], a[32:35]
    ds_read_b64_tr_b16 v[200:201], v42 offset:512
    v_mfma_f32_16x16x32_bf16 a[36:39], v[144:147], v[92:95], a[36:39]
    ds_read_b64_tr_b16 v[202:203], v42 offset:14848
    v_mfma_f32_16x16x32_bf16 a[40:43], v[148:151], v[88:91], a[40:43]
    ds_read_b64_tr_b16 v[204:205], v43 offset:512
    v_mfma_f32_16x16x32_bf16 a[44:47], v[148:151], v[92:95], a[44:47]
    ds_read_b64_tr_b16 v[206:207], v43 offset:14848
    v_mfma_f32_16x16x32_bf16 a[48:51], v[152:155], v[88:91], a[48:51]
    ds_read_b64_tr_b16 v[208:209], v40 offset:640
    v_mfma_f32_16x16x32_bf16 a[52:55], v[152:155], v[92:95], a[52:55]
    ds_read_b64_tr_b16 v[210:211], v40 offset:14976
    s_waitcnt lgkmcnt(14)
    v_mfma_f32_16x16x32_bf16 a[56:59], v[156:159], v[88:91], a[56:59]
    ds_read_b64_tr_b16 v[212:213], v41 offset:640
    v_mfma_f32_16x16x32_bf16 a[60:63], v[156:159], v[92:95], a[60:63]
    ds_read_b64_tr_b16 v[214:215], v41 offset:14976
    v_mfma_f32_16x16x32_bf16 a[64:67], v[160:163], v[88:91], a[64:67]
    ds_read_b64_tr_b16 v[216:217], v42 offset:640
    v_mfma_f32_16x16x32_bf16 a[68:71], v[160:163], v[92:95], a[68:71]
    ds_read_b64_tr_b16 v[218:219], v42 offset:14976
    v_mfma_f32_16x16x32_bf16 a[72:75], v[164:167], v[88:91], a[72:75]
    ds_read_b64_tr_b16 v[220:221], v43 offset:640
    v_mfma_f32_16x16x32_bf16 a[76:79], v[164:167], v[92:95], a[76:79]
    ds_read_b64_tr_b16 v[222:223], v43 offset:14976
    v_mfma_f32_16x16x32_bf16 a[80:83], v[168:171], v[88:91], a[80:83]
    ds_read_b64_tr_b16 v[224:225], v40 offset:768
    s_waitcnt lgkmcnt(14)
    v_mfma_f32_16x16x32_bf16 a[84:87], v[168:171], v[92:95], a[84:87]
    ds_read_b64_tr_b16 v[226:227], v40 offset:15104
    v_mfma_f32_16x16x32_bf16 a[88:91], v[172:175], v[88:91], a[88:91]
    ds_read_b64_tr_b16 v[228:229], v41 offset:768
    v_mfma_f32_16x16x32_bf16 a[92:95], v[172:175], v[92:95], a[92:95]
    ds_read_b64_tr_b16 v[230:231], v41 offset:15104
    v_mfma_f32_16x16x32_bf16 a[96:99], v[176:179], v[88:91], a[96:99]
    ds_read_b64_tr_b16 v[232:233], v42 offset:768
    v_mfma_f32_16x16x32_bf16 a[100:103], v[176:179], v[92:95], a[100:103]
    ds_read_b64_tr_b16 v[234:235], v42 offset:15104
    v_mfma_f32_16x16x32_bf16 a[104:107], v[180:183], v[88:91], a[104:107]
    ds_read_b64_tr_b16 v[236:237], v43 offset:768
    v_mfma_f32_16x16x32_bf16 a[108:111], v[180:183], v[92:95], a[108:111]
    ds_read_b64_tr_b16 v[238:239], v43 offset:15104
    v_add_u32 v40, 0x8000, v40
    v_add_u32 v41, 0x8000, v41
    v_add_u32 v42, 0x8000, v42
    v_add_u32 v43, 0x8000, v43
    s_waitcnt vmcnt(21) lgkmcnt(14)
    s_barrier
    v_mfma_f32_16x16x32_bf16 a[112:115], v[184:187], v[88:91], a[112:115]
    ds_read_b64_tr_b16 v[128:129], v40 offset:0
    v_mfma_f32_16x16x32_bf16 a[116:119], v[184:187], v[92:95], a[116:119]
    ds_read_b64_tr_b16 v[130:131], v40 offset:14336
    v_mfma_f32_16x16x32_bf16 a[120:123], v[188:191], v[88:91], a[120:123]
    ds_read_b64_tr_b16 v[132:133], v41 offset:0
    v_mfma_f32_16x16x32_bf16 a[124:127], v[188:191], v[92:95], a[124:127]
    ds_read_b64_tr_b16 v[134:135], v41 offset:14336
    v_mfma_f32_16x16x32_bf16 a[128:131], v[192:195], v[88:91], a[128:131]
    ds_read_b64_tr_b16 v[136:137], v42 offset:0
    v_mfma_f32_16x16x32_bf16 a[132:135], v[192:195], v[92:95], a[132:135]
    ds_read_b64_tr_b16 v[138:139], v42 offset:14336
    v_mfma_f32_16x16x32_bf16 a[136:139], v[196:199], v[88:91], a[136:139]
    ds_read_b64_tr_b16 v[140:141], v43 offset:0
    s_waitcnt lgkmcnt(14)
    v_mfma_f32_16x16x32_bf16 a[140:143], v[196:199], v[92:95], a[140:143]
    ds_read_b64_tr_b16 v[142:143], v43 offset:14336
    v_mfma_f32_16x16x32_bf16 a[144:147], v[200:203], v[88:91], a[144:147]
    ds_read_b64_tr_b16 v[144:145], v40 offset:128
    v_mfma_f32_16x16x32_bf16 a[148:151], v[200:203], v[92:95], a[148:151]
    ds_read_b64_tr_b16 v[146:147], v40 offset:14464
    v_mfma_f32_16x16x32_bf16 a[152:155], v[204:207], v[88:91], a[152:155]
    ds_read_b64_tr_b16 v[148:149], v41 offset:128
    v_mfma_f32_16x16x32_bf16 a[156:159], v[204:207], v[92:95], a[156:159]
    ds_read_b64_tr_b16 v[150:151], v41 offset:14464
    v_mfma_f32_16x16x32_bf16 a[160:163], v[208:211], v[88:91], a[160:163]
    ds_read_b64_tr_b16 v[152:153], v42 offset:128
    v_mfma_f32_16x16x32_bf16 a[164:167], v[208:211], v[92:95], a[164:167]
    ds_read_b64_tr_b16 v[154:155], v42 offset:14464
    s_waitcnt lgkmcnt(14)
    v_mfma_f32_16x16x32_bf16 a[168:171], v[212:215], v[88:91], a[168:171]
    ds_read_b64_tr_b16 v[156:157], v43 offset:128
    v_mfma_f32_16x16x32_bf16 a[172:175], v[212:215], v[92:95], a[172:175]
    ds_read_b64_tr_b16 v[158:159], v43 offset:14464
    v_mfma_f32_16x16x32_bf16 a[176:179], v[216:219], v[88:91], a[176:179]
    ds_read_b64_tr_b16 v[160:161], v40 offset:256
    v_mfma_f32_16x16x32_bf16 a[180:183], v[216:219], v[92:95], a[180:183]
    ds_read_b64_tr_b16 v[162:163], v40 offset:14592
    v_mfma_f32_16x16x32_bf16 a[184:187], v[220:223], v[88:91], a[184:187]
    ds_read_b64_tr_b16 v[164:165], v41 offset:256
    v_mfma_f32_16x16x32_bf16 a[188:191], v[220:223], v[92:95], a[188:191]
    ds_read_b64_tr_b16 v[166:167], v41 offset:14592
    v_mfma_f32_16x16x32_bf16 a[192:195], v[224:227], v[88:91], a[192:195]
    ds_read_b64_tr_b16 v[168:169], v42 offset:256
    s_waitcnt lgkmcnt(14)
    v_mfma_f32_16x16x32_bf16 a[196:199], v[224:227], v[92:95], a[196:199]
    ds_read_b64_tr_b16 v[170:171], v42 offset:14592
    v_mfma_f32_16x16x32_bf16 a[200:203], v[228:231], v[88:91], a[200:203]
    ds_read_b64_tr_b16 v[172:173], v43 offset:256
    v_mfma_f32_16x16x32_bf16 a[204:207], v[228:231], v[92:95], a[204:207]
    ds_read_b64_tr_b16 v[174:175], v43 offset:14592
    v_mfma_f32_16x16x32_bf16 a[208:211], v[232:235], v[88:91], a[208:211]
    ds_read_b64_tr_b16 v[176:177], v40 offset:384
    v_mfma_f32_16x16x32_bf16 a[212:215], v[232:235], v[92:95], a[212:215]
    ds_read_b64_tr_b16 v[178:179], v40 offset:14720
    v_mfma_f32_16x16x32_bf16 a[216:219], v[236:239], v[88:91], a[216:219]
    ds_read_b64_tr_b16 v[180:181], v41 offset:384
    v_mfma_f32_16x16x32_bf16 a[220:223], v[236:239], v[92:95], a[220:223]
    ds_read_b64_tr_b16 v[182:183], v41 offset:14720
    v_add_u32 v40, 0x8000, v40
    v_add_u32 v41, 0x8000, v41
    v_add_u32 v42, 0x8000, v42
    v_add_u32 v43, 0x8000, v43
    s_waitcnt vmcnt(14) lgkmcnt(14)
    s_barrier
    v_mfma_f32_16x16x32_bf16 a[0:3], v[128:131], v[96:99], a[0:3]
    ds_read_b64_tr_b16 v[184:185], v40 offset:0
    v_mfma_f32_16x16x32_bf16 a[4:7], v[128:131], v[100:103], a[4:7]
    ds_read_b64_tr_b16 v[186:187], v40 offset:14336
    v_mfma_f32_16x16x32_bf16 a[8:11], v[132:135], v[96:99], a[8:11]
    ds_read_b64_tr_b16 v[188:189], v41 offset:0
    v_mfma_f32_16x16x32_bf16 a[12:15], v[132:135], v[100:103], a[12:15]
    ds_read_b64_tr_b16 v[190:191], v41 offset:14336
    v_mfma_f32_16x16x32_bf16 a[16:19], v[136:139], v[96:99], a[16:19]
    ds_read_b64_tr_b16 v[192:193], v42 offset:0
    v_mfma_f32_16x16x32_bf16 a[20:23], v[136:139], v[100:103], a[20:23]
    ds_read_b64_tr_b16 v[194:195], v42 offset:14336
    v_mfma_f32_16x16x32_bf16 a[24:27], v[140:143], v[96:99], a[24:27]
    ds_read_b64_tr_b16 v[196:197], v43 offset:0
    s_waitcnt lgkmcnt(14)
    v_mfma_f32_16x16x32_bf16 a[28:31], v[140:143], v[100:103], a[28:31]
    ds_read_b64_tr_b16 v[198:199], v43 offset:14336
    v_mfma_f32_16x16x32_bf16 a[32:35], v[144:147], v[96:99], a[32:35]
    ds_read_b64_tr_b16 v[200:201], v40 offset:128
    v_mfma_f32_16x16x32_bf16 a[36:39], v[144:147], v[100:103], a[36:39]
    ds_read_b64_tr_b16 v[202:203], v40 offset:14464
    v_mfma_f32_16x16x32_bf16 a[40:43], v[148:151], v[96:99], a[40:43]
    ds_read_b64_tr_b16 v[204:205], v41 offset:128
    v_mfma_f32_16x16x32_bf16 a[44:47], v[148:151], v[100:103], a[44:47]
    ds_read_b64_tr_b16 v[206:207], v41 offset:14464
    v_mfma_f32_16x16x32_bf16 a[48:51], v[152:155], v[96:99], a[48:51]
    ds_read_b64_tr_b16 v[208:209], v42 offset:128
    v_mfma_f32_16x16x32_bf16 a[52:55], v[152:155], v[100:103], a[52:55]
    ds_read_b64_tr_b16 v[210:211], v42 offset:14464
    s_waitcnt lgkmcnt(14)
    v_mfma_f32_16x16x32_bf16 a[56:59], v[156:159], v[96:99], a[56:59]
    ds_read_b64_tr_b16 v[212:213], v43 offset:128
    v_mfma_f32_16x16x32_bf16 a[60:63], v[156:159], v[100:103], a[60:63]
    ds_read_b64_tr_b16 v[214:215], v43 offset:14464
    v_mfma_f32_16x16x32_bf16 a[64:67], v[160:163], v[96:99], a[64:67]
    ds_read_b64_tr_b16 v[216:217], v40 offset:256
    v_mfma_f32_16x16x32_bf16 a[68:71], v[160:163], v[100:103], a[68:71]
    ds_read_b64_tr_b16 v[218:219], v40 offset:14592
    v_mfma_f32_16x16x32_bf16 a[72:75], v[164:167], v[96:99], a[72:75]
    ds_read_b64_tr_b16 v[220:221], v41 offset:256
    v_mfma_f32_16x16x32_bf16 a[76:79], v[164:167], v[100:103], a[76:79]
    ds_read_b64_tr_b16 v[222:223], v41 offset:14592
    v_mfma_f32_16x16x32_bf16 a[80:83], v[168:171], v[96:99], a[80:83]
    ds_read_b64_tr_b16 v[224:225], v42 offset:256
    s_waitcnt lgkmcnt(14)
    v_mfma_f32_16x16x32_bf16 a[84:87], v[168:171], v[100:103], a[84:87]
    ds_read_b64_tr_b16 v[226:227], v42 offset:14592
    v_mfma_f32_16x16x32_bf16 a[88:91], v[172:175], v[96:99], a[88:91]
    ds_read_b64_tr_b16 v[228:229], v43 offset:256
    v_mfma_f32_16x16x32_bf16 a[92:95], v[172:175], v[100:103], a[92:95]
    ds_read_b64_tr_b16 v[230:231], v43 offset:14592
    v_mfma_f32_16x16x32_bf16 a[96:99], v[176:179], v[96:99], a[96:99]
    ds_read_b64_tr_b16 v[232:233], v40 offset:384
    v_mfma_f32_16x16x32_bf16 a[100:103], v[176:179], v[100:103], a[100:103]
    ds_read_b64_tr_b16 v[234:235], v40 offset:14720
    v_mfma_f32_16x16x32_bf16 a[104:107], v[180:183], v[96:99], a[104:107]
    ds_read_b64_tr_b16 v[236:237], v41 offset:384
    v_mfma_f32_16x16x32_bf16 a[108:111], v[180:183], v[100:103], a[108:111]
    ds_read_b64_tr_b16 v[238:239], v41 offset:14720
    v_add_u32 v40, 0xfffe0000, v40
    v_add_u32 v41, 0xfffe0000, v41
    v_add_u32 v42, 0xfffe0000, v42
    v_add_u32 v43, 0xfffe0000, v43
    s_waitcnt vmcnt(7) lgkmcnt(14)
    s_barrier
    v_mfma_f32_16x16x32_bf16 a[0:3], v[184:187], v[104:107], a[0:3]
    ds_read_b64_tr_b16 v[128:129], v40 offset:0
    v_mfma_f32_16x16x32_bf16 a[4:7], v[184:187], v[108:111], a[4:7]
    ds_read_b64_tr_b16 v[130:131], v40 offset:14336
    v_mfma_f32_16x16x32_bf16 a[8:11], v[188:191], v[104:107], a[8:11]
    ds_read_b64_tr_b16 v[132:133], v41 offset:0
    v_mfma_f32_16x16x32_bf16 a[12:15], v[188:191], v[108:111], a[12:15]
    ds_read_b64_tr_b16 v[134:135], v41 offset:14336
    v_mfma_f32_16x16x32_bf16 a[16:19], v[192:195], v[104:107], a[16:19]
    ds_read_b64_tr_b16 v[136:137], v42 offset:0
    v_mfma_f32_16x16x32_bf16 a[20:23], v[192:195], v[108:111], a[20:23]
    ds_read_b64_tr_b16 v[138:139], v42 offset:14336
    v_mfma_f32_16x16x32_bf16 a[24:27], v[196:199], v[104:107], a[24:27]
    ds_read_b64_tr_b16 v[140:141], v43 offset:0
    s_waitcnt lgkmcnt(14)
    v_mfma_f32_16x16x32_bf16 a[28:31], v[196:199], v[108:111], a[28:31]
    ds_read_b64_tr_b16 v[142:143], v43 offset:14336
    v_mfma_f32_16x16x32_bf16 a[32:35], v[200:203], v[104:107], a[32:35]
    ds_read_b64_tr_b16 v[144:145], v40 offset:128
    v_mfma_f32_16x16x32_bf16 a[36:39], v[200:203], v[108:111], a[36:39]
    ds_read_b64_tr_b16 v[146:147], v40 offset:14464
    v_mfma_f32_16x16x32_bf16 a[40:43], v[204:207], v[104:107], a[40:43]
    ds_read_b64_tr_b16 v[148:149], v41 offset:128
    v_mfma_f32_16x16x32_bf16 a[44:47], v[204:207], v[108:111], a[44:47]
    ds_read_b64_tr_b16 v[150:151], v41 offset:14464
    v_mfma_f32_16x16x32_bf16 a[48:51], v[208:211], v[104:107], a[48:51]
    ds_read_b64_tr_b16 v[152:153], v42 offset:128
    v_mfma_f32_16x16x32_bf16 a[52:55], v[208:211], v[108:111], a[52:55]
    ds_read_b64_tr_b16 v[154:155], v42 offset:14464
    s_waitcnt lgkmcnt(14)
    v_mfma_f32_16x16x32_bf16 a[56:59], v[212:215], v[104:107], a[56:59]
    ds_read_b64_tr_b16 v[156:157], v43 offset:128
    v_mfma_f32_16x16x32_bf16 a[60:63], v[212:215], v[108:111], a[60:63]
    ds_read_b64_tr_b16 v[158:159], v43 offset:14464
    v_mfma_f32_16x16x32_bf16 a[64:67], v[216:219], v[104:107], a[64:67]
    ds_read_b64_tr_b16 v[160:161], v40 offset:256
    v_mfma_f32_16x16x32_bf16 a[68:71], v[216:219], v[108:111], a[68:71]
    ds_read_b64_tr_b16 v[162:163], v40 offset:14592
    v_mfma_f32_16x16x32_bf16 a[72:75], v[220:223], v[104:107], a[72:75]
    ds_read_b64_tr_b16 v[164:165], v41 offset:256
    v_mfma_f32_16x16x32_bf16 a[76:79], v[220:223], v[108:111], a[76:79]
    ds_read_b64_tr_b16 v[166:167], v41 offset:14592
    v_mfma_f32_16x16x32_bf16 a[80:83], v[224:227], v[104:107], a[80:83]
    ds_read_b64_tr_b16 v[168:169], v42 offset:256
    s_waitcnt lgkmcnt(14)
    v_mfma_f32_16x16x32_bf16 a[84:87], v[224:227], v[108:111], a[84:87]
    ds_read_b64_tr_b16 v[170:171], v42 offset:14592
    v_mfma_f32_16x16x32_bf16 a[88:91], v[228:231], v[104:107], a[88:91]
    ds_read_b64_tr_b16 v[172:173], v43 offset:256
    v_mfma_f32_16x16x32_bf16 a[92:95], v[228:231], v[108:111], a[92:95]
    ds_read_b64_tr_b16 v[174:175], v43 offset:14592
    v_mfma_f32_16x16x32_bf16 a[96:99], v[232:235], v[104:107], a[96:99]
    ds_read_b64_tr_b16 v[176:177], v40 offset:384
    v_mfma_f32_16x16x32_bf16 a[100:103], v[232:235], v[108:111], a[100:103]
    ds_read_b64_tr_b16 v[178:179], v40 offset:14720
    v_mfma_f32_16x16x32_bf16 a[104:107], v[236:239], v[104:107], a[104:107]
    ds_read_b64_tr_b16 v[180:181], v41 offset:384
    v_mfma_f32_16x16x32_bf16 a[108:111], v[236:239], v[108:111], a[108:111]
    ds_read_b64_tr_b16 v[182:183], v41 offset:14720
    v_add_u32 v40, 0x8000, v40
    v_add_u32 v41, 0x8000, v41
    v_add_u32 v42, 0x8000, v42
    v_add_u32 v43, 0x8000, v43
    s_waitcnt vmcnt(0) lgkmcnt(14)
    s_barrier
    v_mfma_f32_16x16x32_bf16 a[0:3], v[128:131], v[112:115], a[0:3]
    ds_read_b64_tr_b16 v[184:185], v40 offset:0
    v_mfma_f32_16x16x32_bf16 a[4:7], v[128:131], v[116:119], a[4:7]
    ds_read_b64_tr_b16 v[186:187], v40 offset:14336
    v_mfma_f32_16x16x32_bf16 a[8:11], v[132:135], v[112:115], a[8:11]
    ds_read_b64_tr_b16 v[188:189], v41 offset:0
    v_mfma_f32_16x16x32_bf16 a[12:15], v[132:135], v[116:119], a[12:15]
    ds_read_b64_tr_b16 v[190:191], v41 offset:14336
    v_mfma_f32_16x16x32_bf16 a[16:19], v[136:139], v[112:115], a[16:19]
    ds_read_b64_tr_b16 v[192:193], v42 offset:0
    v_mfma_f32_16x16x32_bf16 a[20:23], v[136:139], v[116:119], a[20:23]
    ds_read_b64_tr_b16 v[194:195], v42 offset:14336
    v_mfma_f32_16x16x32_bf16 a[24:27], v[140:143], v[112:115], a[24:27]
    ds_read_b64_tr_b16 v[196:197], v43 offset:0
    s_waitcnt lgkmcnt(14)
    v_mfma_f32_16x16x32_bf16 a[28:31], v[140:143], v[116:119], a[28:31]
    ds_read_b64_tr_b16 v[198:199], v43 offset:14336
    v_mfma_f32_16x16x32_bf16 a[32:35], v[144:147], v[112:115], a[32:35]
    ds_read_b64_tr_b16 v[200:201], v40 offset:128
    v_mfma_f32_16x16x32_bf16 a[36:39], v[144:147], v[116:119], a[36:39]
    ds_read_b64_tr_b16 v[202:203], v40 offset:14464
    v_mfma_f32_16x16x32_bf16 a[40:43], v[148:151], v[112:115], a[40:43]
    ds_read_b64_tr_b16 v[204:205], v41 offset:128
    v_mfma_f32_16x16x32_bf16 a[44:47], v[148:151], v[116:119], a[44:47]
    ds_read_b64_tr_b16 v[206:207], v41 offset:14464
    v_mfma_f32_16x16x32_bf16 a[48:51], v[152:155], v[112:115], a[48:51]
    ds_read_b64_tr_b16 v[208:209], v42 offset:128
    v_mfma_f32_16x16x32_bf16 a[52:55], v[152:155], v[116:119], a[52:55]
    ds_read_b64_tr_b16 v[210:211], v42 offset:14464
    s_waitcnt lgkmcnt(14)
    v_mfma_f32_16x16x32_bf16 a[56:59], v[156:159], v[112:115], a[56:59]
    ds_read_b64_tr_b16 v[212:213], v43 offset:128
    v_mfma_f32_16x16x32_bf16 a[60:63], v[156:159], v[116:119], a[60:63]
    ds_read_b64_tr_b16 v[214:215], v43 offset:14464
    v_mfma_f32_16x16x32_bf16 a[64:67], v[160:163], v[112:115], a[64:67]
    ds_read_b64_tr_b16 v[216:217], v40 offset:256
    v_mfma_f32_16x16x32_bf16 a[68:71], v[160:163], v[116:119], a[68:71]
    ds_read_b64_tr_b16 v[218:219], v40 offset:14592
    v_mfma_f32_16x16x32_bf16 a[72:75], v[164:167], v[112:115], a[72:75]
    ds_read_b64_tr_b16 v[220:221], v41 offset:256
    v_mfma_f32_16x16x32_bf16 a[76:79], v[164:167], v[116:119], a[76:79]
    ds_read_b64_tr_b16 v[222:223], v41 offset:14592
    v_mfma_f32_16x16x32_bf16 a[80:83], v[168:171], v[112:115], a[80:83]
    ds_read_b64_tr_b16 v[224:225], v42 offset:256
    s_waitcnt lgkmcnt(14)
    v_mfma_f32_16x16x32_bf16 a[84:87], v[168:171], v[116:119], a[84:87]
    ds_read_b64_tr_b16 v[226:227], v42 offset:14592
    v_mfma_f32_16x16x32_bf16 a[88:91], v[172:175], v[112:115], a[88:91]
    ds_read_b64_tr_b16 v[228:229], v43 offset:256
    v_mfma_f32_16x16x32_bf16 a[92:95], v[172:175], v[116:119], a[92:95]
    ds_read_b64_tr_b16 v[230:231], v43 offset:14592
    v_mfma_f32_16x16x32_bf16 a[96:99], v[176:179], v[112:115], a[96:99]
    ds_read_b64_tr_b16 v[232:233], v40 offset:384
    v_mfma_f32_16x16x32_bf16 a[100:103], v[176:179], v[116:119], a[100:103]
    ds_read_b64_tr_b16 v[234:235], v40 offset:14720
    v_mfma_f32_16x16x32_bf16 a[104:107], v[180:183], v[112:115], a[104:107]
    ds_read_b64_tr_b16 v[236:237], v41 offset:384
    v_mfma_f32_16x16x32_bf16 a[108:111], v[180:183], v[116:119], a[108:111]
    ds_read_b64_tr_b16 v[238:239], v41 offset:14720
    v_add_u32 v40, 0x10000, v40
    v_add_u32 v41, 0x10000, v41
    v_add_u32 v42, 0x10000, v42
    v_add_u32 v43, 0x10000, v43
    s_waitcnt lgkmcnt(14)
    v_mfma_f32_16x16x32_bf16 a[0:3], v[184:187], v[120:123], a[0:3]
    ds_read_b64_tr_b16 v[128:129], v42 offset:384
    v_mfma_f32_16x16x32_bf16 a[4:7], v[184:187], v[124:127], a[4:7]
    ds_read_b64_tr_b16 v[130:131], v42 offset:14720
    v_mfma_f32_16x16x32_bf16 a[8:11], v[188:191], v[120:123], a[8:11]
    ds_read_b64_tr_b16 v[132:133], v43 offset:384
    v_mfma_f32_16x16x32_bf16 a[12:15], v[188:191], v[124:127], a[12:15]
    ds_read_b64_tr_b16 v[134:135], v43 offset:14720
    v_mfma_f32_16x16x32_bf16 a[16:19], v[192:195], v[120:123], a[16:19]
    ds_read_b64_tr_b16 v[136:137], v40 offset:512
    v_mfma_f32_16x16x32_bf16 a[20:23], v[192:195], v[124:127], a[20:23]
    ds_read_b64_tr_b16 v[138:139], v40 offset:14848
    v_mfma_f32_16x16x32_bf16 a[24:27], v[196:199], v[120:123], a[24:27]
    ds_read_b64_tr_b16 v[140:141], v41 offset:512
    s_waitcnt lgkmcnt(14)
    v_mfma_f32_16x16x32_bf16 a[28:31], v[196:199], v[124:127], a[28:31]
    ds_read_b64_tr_b16 v[142:143], v41 offset:14848
    v_mfma_f32_16x16x32_bf16 a[32:35], v[200:203], v[120:123], a[32:35]
    ds_read_b64_tr_b16 v[144:145], v42 offset:512
    v_mfma_f32_16x16x32_bf16 a[36:39], v[200:203], v[124:127], a[36:39]
    ds_read_b64_tr_b16 v[146:147], v42 offset:14848
    v_mfma_f32_16x16x32_bf16 a[40:43], v[204:207], v[120:123], a[40:43]
    ds_read_b64_tr_b16 v[148:149], v43 offset:512
    v_mfma_f32_16x16x32_bf16 a[44:47], v[204:207], v[124:127], a[44:47]
    ds_read_b64_tr_b16 v[150:151], v43 offset:14848
    v_mfma_f32_16x16x32_bf16 a[48:51], v[208:211], v[120:123], a[48:51]
    ds_read_b64_tr_b16 v[152:153], v40 offset:640
    v_mfma_f32_16x16x32_bf16 a[52:55], v[208:211], v[124:127], a[52:55]
    ds_read_b64_tr_b16 v[154:155], v40 offset:14976
    s_waitcnt lgkmcnt(14)
    v_mfma_f32_16x16x32_bf16 a[56:59], v[212:215], v[120:123], a[56:59]
    ds_read_b64_tr_b16 v[156:157], v41 offset:640
    v_mfma_f32_16x16x32_bf16 a[60:63], v[212:215], v[124:127], a[60:63]
    ds_read_b64_tr_b16 v[158:159], v41 offset:14976
    v_mfma_f32_16x16x32_bf16 a[64:67], v[216:219], v[120:123], a[64:67]
    ds_read_b64_tr_b16 v[160:161], v42 offset:640
    v_mfma_f32_16x16x32_bf16 a[68:71], v[216:219], v[124:127], a[68:71]
    ds_read_b64_tr_b16 v[162:163], v42 offset:14976
    v_mfma_f32_16x16x32_bf16 a[72:75], v[220:223], v[120:123], a[72:75]
    ds_read_b64_tr_b16 v[164:165], v43 offset:640
    v_mfma_f32_16x16x32_bf16 a[76:79], v[220:223], v[124:127], a[76:79]
    ds_read_b64_tr_b16 v[166:167], v43 offset:14976
    v_mfma_f32_16x16x32_bf16 a[80:83], v[224:227], v[120:123], a[80:83]
    ds_read_b64_tr_b16 v[168:169], v40 offset:768
    s_waitcnt lgkmcnt(14)
    v_mfma_f32_16x16x32_bf16 a[84:87], v[224:227], v[124:127], a[84:87]
    ds_read_b64_tr_b16 v[170:171], v40 offset:15104
    v_mfma_f32_16x16x32_bf16 a[88:91], v[228:231], v[120:123], a[88:91]
    ds_read_b64_tr_b16 v[172:173], v41 offset:768
    v_mfma_f32_16x16x32_bf16 a[92:95], v[228:231], v[124:127], a[92:95]
    ds_read_b64_tr_b16 v[174:175], v41 offset:15104
    v_mfma_f32_16x16x32_bf16 a[96:99], v[232:235], v[120:123], a[96:99]
    ds_read_b64_tr_b16 v[176:177], v42 offset:768
    v_mfma_f32_16x16x32_bf16 a[100:103], v[232:235], v[124:127], a[100:103]
    ds_read_b64_tr_b16 v[178:179], v42 offset:15104
    v_mfma_f32_16x16x32_bf16 a[104:107], v[236:239], v[120:123], a[104:107]
    ds_read_b64_tr_b16 v[180:181], v43 offset:768
    v_mfma_f32_16x16x32_bf16 a[108:111], v[236:239], v[124:127], a[108:111]
    ds_read_b64_tr_b16 v[182:183], v43 offset:15104
    v_add_u32 v40, 0x8000, v40
    v_add_u32 v41, 0x8000, v41
    v_add_u32 v42, 0x8000, v42
    v_add_u32 v43, 0x8000, v43
    s_waitcnt lgkmcnt(14)
    s_mov_b32 s49, 1
    s_cmp_lg_u32 s48, 0
    s_cbranch_scc1 LPO_33
    s_and_b32 s87, s2, 7
    s_lshl_b32 s87, s87, 5
    v_mov_b32 v5, 1
    v_mov_b32 v47, 0
    s_mov_b64 exec, 1
    buffer_atomic_add v5, v47, s[44:47], s87 offen offset:4 sc0
    s_mov_b64 exec, -1
LPO_33:
    v_mfma_f32_16x16x32_bf16 a[112:115], v[128:131], v[96:99], a[112:115]
    ds_read_b64_tr_b16 v[184:185], v42 offset:384
    v_mfma_f32_16x16x32_bf16 a[116:119], v[128:131], v[100:103], a[116:119]
    ds_read_b64_tr_b16 v[186:187], v42 offset:14720
    v_mfma_f32_16x16x32_bf16 a[120:123], v[132:135], v[96:99], a[120:123]
    ds_read_b64_tr_b16 v[188:189], v43 offset:384
    v_mfma_f32_16x16x32_bf16 a[124:127], v[132:135], v[100:103], a[124:127]
    ds_read_b64_tr_b16 v[190:191], v43 offset:14720
    v_accvgpr_read_b32 v64, a0
    v_mfma_f32_16x16x32_bf16 a[128:131], v[136:139], v[96:99], a[128:131]
    ds_read_b64_tr_b16 v[192:193], v40 offset:512
    v_accvgpr_read_b32 v65, a1
    v_mfma_f32_16x16x32_bf16 a[132:135], v[136:139], v[100:103], a[132:135]
    ds_read_b64_tr_b16 v[194:195], v40 offset:14848
    v_accvgpr_read_b32 v66, a2
    v_mfma_f32_16x16x32_bf16 a[136:139], v[140:143], v[96:99], a[136:139]
    ds_read_b64_tr_b16 v[196:197], v41 offset:512
    v_accvgpr_read_b32 v67, a3
    s_waitcnt lgkmcnt(14)
    v_mfma_f32_16x16x32_bf16 a[140:143], v[140:143], v[100:103], a[140:143]
    ds_read_b64_tr_b16 v[198:199], v41 offset:14848
    v_accvgpr_read_b32 v68, a8
    v_mfma_f32_16x16x32_bf16 a[144:147], v[144:147], v[96:99], a[144:147]
    ds_read_b64_tr_b16 v[200:201], v42 offset:512
    v_accvgpr_read_b32 v69, a9
    v_mfma_f32_16x16x32_bf16 a[148:151], v[144:147], v[100:103], a[148:151]
    ds_read_b64_tr_b16 v[202:203], v42 offset:14848
    v_accvgpr_read_b32 v70, a10
    v_mfma_f32_16x16x32_bf16 a[152:155], v[148:151], v[96:99], a[152:155]
    ds_read_b64_tr_b16 v[204:205], v43 offset:512
    v_accvgpr_read_b32 v71, a11
    v_mfma_f32_16x16x32_bf16 a[156:159], v[148:151], v[100:103], a[156:159]
    ds_read_b64_tr_b16 v[206:207], v43 offset:14848
    v_cvt_pk_bf16_f32 v72, v64, v65
    v_mfma_f32_16x16x32_bf16 a[160:163], v[152:155], v[96:99], a[160:163]
    ds_read_b64_tr_b16 v[208:209], v40 offset:640
    v_cvt_pk_bf16_f32 v73, v66, v67
    v_mfma_f32_16x16x32_bf16 a[164:167], v[152:155], v[100:103], a[164:167]
    ds_read_b64_tr_b16 v[210:211], v40 offset:14976
    v_cvt_pk_bf16_f32 v74, v68, v69
    s_waitcnt lgkmcnt(14)
    v_mfma_f32_16x16x32_bf16 a[168:171], v[156:159], v[96:99], a[168:171]
    ds_read_b64_tr_b16 v[212:213], v41 offset:640
    v_cvt_pk_bf16_f32 v75, v70, v71
    v_mfma_f32_16x16x32_bf16 a[172:175], v[156:159], v[100:103], a[172:175]
    ds_read_b64_tr_b16 v[214:215], v41 offset:14976
    s_add_u32 s80, s66, 0
    buffer_store_dwordx4 v[72:75], v1, s[40:43], s80 offen offset:0 sc1
    v_mfma_f32_16x16x32_bf16 a[176:179], v[160:163], v[96:99], a[176:179]
    ds_read_b64_tr_b16 v[216:217], v42 offset:640
    v_accvgpr_read_b32 v76, a16
    v_mfma_f32_16x16x32_bf16 a[180:183], v[160:163], v[100:103], a[180:183]
    ds_read_b64_tr_b16 v[218:219], v42 offset:14976
    v_accvgpr_read_b32 v77, a17
    v_mfma_f32_16x16x32_bf16 a[184:187], v[164:167], v[96:99], a[184:187]
    ds_read_b64_tr_b16 v[220:221], v43 offset:640
    v_accvgpr_read_b32 v78, a18
    v_mfma_f32_16x16x32_bf16 a[188:191], v[164:167], v[100:103], a[188:191]
    ds_read_b64_tr_b16 v[222:223], v43 offset:14976
    v_accvgpr_read_b32 v79, a19
    v_mfma_f32_16x16x32_bf16 a[192:195], v[168:171], v[96:99], a[192:195]
    ds_read_b64_tr_b16 v[224:225], v40 offset:768
    v_accvgpr_read_b32 v80, a24
    s_waitcnt lgkmcnt(14)
    v_mfma_f32_16x16x32_bf16 a[196:199], v[168:171], v[100:103], a[196:199]
    ds_read_b64_tr_b16 v[226:227], v40 offset:15104
    v_accvgpr_read_b32 v81, a25
    v_mfma_f32_16x16x32_bf16 a[200:203], v[172:175], v[96:99], a[200:203]
    ds_read_b64_tr_b16 v[228:229], v41 offset:768
    v_accvgpr_read_b32 v82, a26
    v_mfma_f32_16x16x32_bf16 a[204:207], v[172:175], v[100:103], a[204:207]
    ds_read_b64_tr_b16 v[230:231], v41 offset:15104
    v_accvgpr_read_b32 v83, a27
    v_mfma_f32_16x16x32_bf16 a[208:211], v[176:179], v[96:99], a[208:211]
    ds_read_b64_tr_b16 v[232:233], v42 offset:768
    v_cvt_pk_bf16_f32 v84, v76, v77
    v_mfma_f32_16x16x32_bf16 a[212:215], v[176:179], v[100:103], a[212:215]
    ds_read_b64_tr_b16 v[234:235], v42 offset:15104
    v_cvt_pk_bf16_f32 v85, v78, v79
    v_mfma_f32_16x16x32_bf16 a[216:219], v[180:183], v[96:99], a[216:219]
    ds_read_b64_tr_b16 v[236:237], v43 offset:768
    v_cvt_pk_bf16_f32 v86, v80, v81
    v_mfma_f32_16x16x32_bf16 a[220:223], v[180:183], v[100:103], a[220:223]
    ds_read_b64_tr_b16 v[238:239], v43 offset:15104
    v_cvt_pk_bf16_f32 v87, v82, v83
    v_add_u32 v40, 0xfffe0000, v40
    v_add_u32 v41, 0xfffe0000, v41
    v_add_u32 v42, 0xfffe0000, v42
    v_add_u32 v43, 0xfffe0000, v43
    s_waitcnt lgkmcnt(14)
    v_mfma_f32_16x16x32_bf16 a[112:115], v[184:187], v[104:107], a[112:115]
    ds_read_b64_tr_b16 v[128:129], v42 offset:384
    buffer_store_dwordx4 v[84:87], v1, s[40:43], s80 offen offset:1024 sc1
    v_mfma_f32_16x16x32_bf16 a[116:119], v[184:187], v[108:111], a[116:119]
    ds_read_b64_tr_b16 v[130:131], v42 offset:14720
    v_accvgpr_read_b32 v64, a32
    v_mfma_f32_16x16x32_bf16 a[120:123], v[188:191], v[104:107], a[120:123]
    ds_read_b64_tr_b16 v[132:133], v43 offset:384
    v_accvgpr_read_b32 v65, a33
    v_mfma_f32_16x16x32_bf16 a[124:127], v[188:191], v[108:111], a[124:127]
    ds_read_b64_tr_b16 v[134:135], v43 offset:14720
    v_accvgpr_read_b32 v66, a34
    v_mfma_f32_16x16x32_bf16 a[128:131], v[192:195], v[104:107], a[128:131]
    ds_read_b64_tr_b16 v[136:137], v40 offset:512
    v_accvgpr_read_b32 v67, a35
    v_mfma_f32_16x16x32_bf16 a[132:135], v[192:195], v[108:111], a[132:135]
    ds_read_b64_tr_b16 v[138:139], v40 offset:14848
    v_accvgpr_read_b32 v68, a40
    v_mfma_f32_16x16x32_bf16 a[136:139], v[196:199], v[104:107], a[136:139]
    ds_read_b64_tr_b16 v[140:141], v41 offset:512
    v_accvgpr_read_b32 v69, a41
    s_waitcnt lgkmcnt(14)
    v_mfma_f32_16x16x32_bf16 a[140:143], v[196:199], v[108:111], a[140:143]
    ds_read_b64_tr_b16 v[142:143], v41 offset:14848
    v_accvgpr_read_b32 v70, a42
    v_mfma_f32_16x16x32_bf16 a[144:147], v[200:203], v[104:107], a[144:147]
    ds_read_b64_tr_b16 v[144:145], v42 offset:512
    v_accvgpr_read_b32 v71, a43
    v_mfma_f32_16x16x32_bf16 a[148:151], v[200:203], v[108:111], a[148:151]
    ds_read_b64_tr_b16 v[146:147], v42 offset:14848
    v_cvt_pk_bf16_f32 v72, v64, v65
    v_mfma_f32_16x16x32_bf16 a[152:155], v[204:207], v[104:107], a[152:155]
    ds_read_b64_tr_b16 v[148:149], v43 offset:512
    v_cvt_pk_bf16_f32 v73, v66, v67
    v_mfma_f32_16x16x32_bf16 a[156:159], v[204:207], v[108:111], a[156:159]
    ds_read_b64_tr_b16 v[150:151], v43 offset:14848
    v_cvt_pk_bf16_f32 v74, v68, v69
    v_mfma_f32_16x16x32_bf16 a[160:163], v[208:211], v[104:107], a[160:163]
    ds_read_b64_tr_b16 v[152:153], v40 offset:640
    v_cvt_pk_bf16_f32 v75, v70, v71
    v_mfma_f32_16x16x32_bf16 a[164:167], v[208:211], v[108:111], a[164:167]
    ds_read_b64_tr_b16 v[154:155], v40 offset:14976
    buffer_store_dwordx4 v[72:75], v1, s[40:43], s80 offen offset:2048 sc1
    s_waitcnt lgkmcnt(14)
    v_mfma_f32_16x16x32_bf16 a[168:171], v[212:215], v[104:107], a[168:171]
    ds_read_b64_tr_b16 v[156:157], v41 offset:640
    v_accvgpr_read_b32 v76, a48
    v_mfma_f32_16x16x32_bf16 a[172:175], v[212:215], v[108:111], a[172:175]
    ds_read_b64_tr_b16 v[158:159], v41 offset:14976
    v_accvgpr_read_b32 v77, a49
    v_mfma_f32_16x16x32_bf16 a[176:179], v[216:219], v[104:107], a[176:179]
    ds_read_b64_tr_b16 v[160:161], v42 offset:640
    v_accvgpr_read_b32 v78, a50
    v_mfma_f32_16x16x32_bf16 a[180:183], v[216:219], v[108:111], a[180:183]
    ds_read_b64_tr_b16 v[162:163], v42 offset:14976
    v_accvgpr_read_b32 v79, a51
    v_mfma_f32_16x16x32_bf16 a[184:187], v[220:223], v[104:107], a[184:187]
    ds_read_b64_tr_b16 v[164:165], v43 offset:640
    v_accvgpr_read_b32 v80, a56
    v_mfma_f32_16x16x32_bf16 a[188:191], v[220:223], v[108:111], a[188:191]
    ds_read_b64_tr_b16 v[166:167], v43 offset:14976
    v_accvgpr_read_b32 v81, a57
    v_mfma_f32_16x16x32_bf16 a[192:195], v[224:227], v[104:107], a[192:195]
    ds_read_b64_tr_b16 v[168:169], v40 offset:768
    v_accvgpr_read_b32 v82, a58
    s_waitcnt lgkmcnt(14)
    v_mfma_f32_16x16x32_bf16 a[196:199], v[224:227], v[108:111], a[196:199]
    ds_read_b64_tr_b16 v[170:171], v40 offset:15104
    v_accvgpr_read_b32 v83, a59
    v_mfma_f32_16x16x32_bf16 a[200:203], v[228:231], v[104:107], a[200:203]
    ds_read_b64_tr_b16 v[172:173], v41 offset:768
    v_cvt_pk_bf16_f32 v84, v76, v77
    v_mfma_f32_16x16x32_bf16 a[204:207], v[228:231], v[108:111], a[204:207]
    ds_read_b64_tr_b16 v[174:175], v41 offset:15104
    v_cvt_pk_bf16_f32 v85, v78, v79
    v_mfma_f32_16x16x32_bf16 a[208:211], v[232:235], v[104:107], a[208:211]
    ds_read_b64_tr_b16 v[176:177], v42 offset:768
    v_cvt_pk_bf16_f32 v86, v80, v81
    v_mfma_f32_16x16x32_bf16 a[212:215], v[232:235], v[108:111], a[212:215]
    ds_read_b64_tr_b16 v[178:179], v42 offset:15104
    v_cvt_pk_bf16_f32 v87, v82, v83
    v_mfma_f32_16x16x32_bf16 a[216:219], v[236:239], v[104:107], a[216:219]
    ds_read_b64_tr_b16 v[180:181], v43 offset:768
    buffer_store_dwordx4 v[84:87], v1, s[40:43], s80 offen offset:3072 sc1
    v_mfma_f32_16x16x32_bf16 a[220:223], v[236:239], v[108:111], a[220:223]
    ds_read_b64_tr_b16 v[182:183], v43 offset:15104
    v_accvgpr_read_b32 v64, a64
    v_add_u32 v40, 0x8000, v40
    v_add_u32 v41, 0x8000, v41
    v_add_u32 v42, 0x8000, v42
    v_add_u32 v43, 0x8000, v43
    s_waitcnt lgkmcnt(14)
    v_mfma_f32_16x16x32_bf16 a[112:115], v[128:131], v[112:115], a[112:115]
    ds_read_b64_tr_b16 v[184:185], v42 offset:384
    v_accvgpr_read_b32 v65, a65
    v_mfma_f32_16x16x32_bf16 a[116:119], v[128:131], v[116:119], a[116:119]
    ds_read_b64_tr_b16 v[186:187], v42 offset:14720
    v_accvgpr_read_b32 v66, a66
    v_mfma_f32_16x16x32_bf16 a[120:123], v[132:135], v[112:115], a[120:123]
    ds_read_b64_tr_b16 v[188:189], v43 offset:384
    v_accvgpr_read_b32 v67, a67
    v_mfma_f32_16x16x32_bf16 a[124:127], v[132:135], v[116:119], a[124:127]
    ds_read_b64_tr_b16 v[190:191], v43 offset:14720
    v_accvgpr_read_b32 v68, a72
    v_mfma_f32_16x16x32_bf16 a[128:131], v[136:139], v[112:115], a[128:131]
    ds_read_b64_tr_b16 v[192:193], v40 offset:512
    v_accvgpr_read_b32 v69, a73
    v_mfma_f32_16x16x32_bf16 a[132:135], v[136:139], v[116:119], a[132:135]
    ds_read_b64_tr_b16 v[194:195], v40 offset:14848
    v_accvgpr_read_b32 v70, a74
    v_mfma_f32_16x16x32_bf16 a[136:139], v[140:143], v[112:115], a[136:139]
    ds_read_b64_tr_b16 v[196:197], v41 offset:512
    v_accvgpr_read_b32 v71, a75
    s_waitcnt lgkmcnt(14)
    v_mfma_f32_16x16x32_bf16 a[140:143], v[140:143], v[116:119], a[140:143]
    ds_read_b64_tr_b16 v[198:199], v41 offset:14848
    v_cvt_pk_bf16_f32 v72, v64, v65
    v_mfma_f32_16x16x32_bf16 a[144:147], v[144:147], v[112:115], a[144:147]
    ds_read_b64_tr_b16 v[200:201], v42 offset:512
    v_cvt_pk_bf16_f32 v73, v66, v67
    v_mfma_f32_16x16x32_bf16 a[148:151], v[144:147], v[116:119], a[148:151]
    ds_read_b64_tr_b16 v[202:203], v42 offset:14848
    v_cvt_pk_bf16_f32 v74, v68, v69
    v_mfma_f32_16x16x32_bf16 a[152:155], v[148:151], v[112:115], a[152:155]
    ds_read_b64_tr_b16 v[204:205], v43 offset:512
    v_cvt_pk_bf16_f32 v75, v70, v71
    v_mfma_f32_16x16x32_bf16 a[156:159], v[148:151], v[116:119], a[156:159]
    ds_read_b64_tr_b16 v[206:207], v43 offset:14848
    s_add_u32 s80, s66, 4096
    buffer_store_dwordx4 v[72:75], v1, s[40:43], s80 offen offset:0 sc1
    v_mfma_f32_16x16x32_bf16 a[160:163], v[152:155], v[112:115], a[160:163]
    ds_read_b64_tr_b16 v[208:209], v40 offset:640
    v_accvgpr_read_b32 v76, a80
    v_mfma_f32_16x16x32_bf16 a[164:167], v[152:155], v[116:119], a[164:167]
    ds_read_b64_tr_b16 v[210:211], v40 offset:14976
    v_accvgpr_read_b32 v77, a81
    s_waitcnt lgkmcnt(14)
    v_mfma_f32_16x16x32_bf16 a[168:171], v[156:159], v[112:115], a[168:171]
    ds_read_b64_tr_b16 v[212:213], v41 offset:640
    v_accvgpr_read_b32 v78, a82
    v_mfma_f32_16x16x32_bf16 a[172:175], v[156:159], v[116:119], a[172:175]
    ds_read_b64_tr_b16 v[214:215], v41 offset:14976
    v_accvgpr_read_b32 v79, a83
    v_mfma_f32_16x16x32_bf16 a[176:179], v[160:163], v[112:115], a[176:179]
    ds_read_b64_tr_b16 v[216:217], v42 offset:640
    v_accvgpr_read_b32 v80, a88
    v_mfma_f32_16x16x32_bf16 a[180:183], v[160:163], v[116:119], a[180:183]
    ds_read_b64_tr_b16 v[218:219], v42 offset:14976
    v_accvgpr_read_b32 v81, a89
    v_mfma_f32_16x16x32_bf16 a[184:187], v[164:167], v[112:115], a[184:187]
    ds_read_b64_tr_b16 v[220:221], v43 offset:640
    v_accvgpr_read_b32 v82, a90
    v_mfma_f32_16x16x32_bf16 a[188:191], v[164:167], v[116:119], a[188:191]
    ds_read_b64_tr_b16 v[222:223], v43 offset:14976
    v_accvgpr_read_b32 v83, a91
    v_mfma_f32_16x16x32_bf16 a[192:195], v[168:171], v[112:115], a[192:195]
    ds_read_b64_tr_b16 v[224:225], v40 offset:768
    v_cvt_pk_bf16_f32 v84, v76, v77
    s_waitcnt lgkmcnt(14)
    v_mfma_f32_16x16x32_bf16 a[196:199], v[168:171], v[116:119], a[196:199]
    ds_read_b64_tr_b16 v[226:227], v40 offset:15104
    v_cvt_pk_bf16_f32 v85, v78, v79
    v_mfma_f32_16x16x32_bf16 a[200:203], v[172:175], v[112:115], a[200:203]
    ds_read_b64_tr_b16 v[228:229], v41 offset:768
    v_cvt_pk_bf16_f32 v86, v80, v81
    v_mfma_f32_16x16x32_bf16 a[204:207], v[172:175], v[116:119], a[204:207]
    ds_read_b64_tr_b16 v[230:231], v41 offset:15104
    v_cvt_pk_bf16_f32 v87, v82, v83
    v_mfma_f32_16x16x32_bf16 a[208:211], v[176:179], v[112:115], a[208:211]
    ds_read_b64_tr_b16 v[232:233], v42 offset:768
    buffer_store_dwordx4 v[84:87], v1, s[40:43], s80 offen offset:1024 sc1
    v_mfma_f32_16x16x32_bf16 a[212:215], v[176:179], v[116:119], a[212:215]
    ds_read_b64_tr_b16 v[234:235], v42 offset:15104
    v_accvgpr_read_b32 v64, a96
    v_mfma_f32_16x16x32_bf16 a[216:219], v[180:183], v[112:115], a[216:219]
    ds_read_b64_tr_b16 v[236:237], v43 offset:768
    v_accvgpr_read_b32 v65, a97
    v_mfma_f32_16x16x32_bf16 a[220:223], v[180:183], v[116:119], a[220:223]
    ds_read_b64_tr_b16 v[238:239], v43 offset:15104
    v_accvgpr_read_b32 v66, a98
    s_waitcnt lgkmcnt(14)
    v_mfma_f32_16x16x32_bf16 a[112:115], v[184:187], v[120:123], a[112:115]
    v_accvgpr_read_b32 v67, a99
    v_accvgpr_read_b32 v68, a104
    v_mfma_f32_16x16x32_bf16 a[116:119], v[184:187], v[124:127], a[116:119]
    v_accvgpr_read_b32 v69, a105
    v_accvgpr_read_b32 v70, a106
    v_mfma_f32_16x16x32_bf16 a[120:123], v[188:191], v[120:123], a[120:123]
    v_accvgpr_read_b32 v71, a107
    v_cvt_pk_bf16_f32 v72, v64, v65
    v_mfma_f32_16x16x32_bf16 a[124:127], v[188:191], v[124:127], a[124:127]
    v_cvt_pk_bf16_f32 v73, v66, v67
    v_cvt_pk_bf16_f32 v74, v68, v69
    v_mfma_f32_16x16x32_bf16 a[128:131], v[192:195], v[120:123], a[128:131]
    v_cvt_pk_bf16_f32 v75, v70, v71
    v_accvgpr_read_b32 v76, a4
    v_mfma_f32_16x16x32_bf16 a[132:135], v[192:195], v[124:127], a[132:135]
    buffer_store_dwordx4 v[72:75], v1, s[40:43], s80 offen offset:2048 sc1
    v_accvgpr_read_b32 v77, a5
    v_mfma_f32_16x16x32_bf16 a[136:139], v[196:199], v[120:123], a[136:139]
    v_accvgpr_read_b32 v78, a6
    v_accvgpr_read_b32 v79, a7
    v_mfma_f32_16x16x32_bf16 a[140:143], v[196:199], v[124:127], a[140:143]
    v_accvgpr_read_b32 v80, a12
    v_accvgpr_read_b32 v81, a13
    v_mfma_f32_16x16x32_bf16 a[144:147], v[200:203], v[120:123], a[144:147]
    v_accvgpr_read_b32 v82, a14
    v_accvgpr_read_b32 v83, a15
    v_mfma_f32_16x16x32_bf16 a[148:151], v[200:203], v[124:127], a[148:151]
    v_cvt_pk_bf16_f32 v84, v76, v77
    v_cvt_pk_bf16_f32 v85, v78, v79
    v_mfma_f32_16x16x32_bf16 a[152:155], v[204:207], v[120:123], a[152:155]
    v_cvt_pk_bf16_f32 v86, v80, v81
    v_cvt_pk_bf16_f32 v87, v82, v83
    v_mfma_f32_16x16x32_bf16 a[156:159], v[204:207], v[124:127], a[156:159]
    s_add_u32 s80, s71, 0
    buffer_store_dwordx4 v[84:87], v1, s[40:43], s80 offen offset:0 sc1
    v_accvgpr_read_b32 v64, a20
    s_waitcnt lgkmcnt(0)
    v_mfma_f32_16x16x32_bf16 a[160:163], v[208:211], v[120:123], a[160:163]
    v_accvgpr_read_b32 v65, a21
    v_accvgpr_read_b32 v66, a22
    v_mfma_f32_16x16x32_bf16 a[164:167], v[208:211], v[124:127], a[164:167]
    v_accvgpr_read_b32 v67, a23
    v_accvgpr_read_b32 v68, a28
    v_mfma_f32_16x16x32_bf16 a[168:171], v[212:215], v[120:123], a[168:171]
    v_accvgpr_read_b32 v69, a29
    v_accvgpr_read_b32 v70, a30
    v_mfma_f32_16x16x32_bf16 a[172:175], v[212:215], v[124:127], a[172:175]
    v_accvgpr_read_b32 v71, a31
    v_cvt_pk_bf16_f32 v72, v64, v65
    v_mfma_f32_16x16x32_bf16 a[176:179], v[216:219], v[120:123], a[176:179]
    v_cvt_pk_bf16_f32 v73, v66, v67
    v_cvt_pk_bf16_f32 v74, v68, v69
    v_mfma_f32_16x16x32_bf16 a[180:183], v[216:219], v[124:127], a[180:183]
    v_cvt_pk_bf16_f32 v75, v70, v71
    v_accvgpr_read_b32 v76, a36
    v_mfma_f32_16x16x32_bf16 a[184:187], v[220:223], v[120:123], a[184:187]
    buffer_store_dwordx4 v[72:75], v1, s[40:43], s80 offen offset:1024 sc1
    v_accvgpr_read_b32 v77, a37
    v_mfma_f32_16x16x32_bf16 a[188:191], v[220:223], v[124:127], a[188:191]
    v_accvgpr_read_b32 v78, a38
    v_accvgpr_read_b32 v79, a39
    v_mfma_f32_16x16x32_bf16 a[192:195], v[224:227], v[120:123], a[192:195]
    v_accvgpr_read_b32 v80, a44
    v_accvgpr_read_b32 v81, a45
    v_mfma_f32_16x16x32_bf16 a[196:199], v[224:227], v[124:127], a[196:199]
    v_accvgpr_read_b32 v82, a46
    v_accvgpr_read_b32 v83, a47
    v_mfma_f32_16x16x32_bf16 a[200:203], v[228:231], v[120:123], a[200:203]
    v_cvt_pk_bf16_f32 v84, v76, v77
    v_cvt_pk_bf16_f32 v85, v78, v79
    v_mfma_f32_16x16x32_bf16 a[204:207], v[228:231], v[124:127], a[204:207]
    v_cvt_pk_bf16_f32 v86, v80, v81
    v_cvt_pk_bf16_f32 v87, v82, v83
    v_mfma_f32_16x16x32_bf16 a[208:211], v[232:235], v[120:123], a[208:211]
    buffer_store_dwordx4 v[84:87], v1, s[40:43], s80 offen offset:2048 sc1
    v_accvgpr_read_b32 v64, a52
    v_mfma_f32_16x16x32_bf16 a[212:215], v[232:235], v[124:127], a[212:215]
    v_accvgpr_read_b32 v65, a53
    v_accvgpr_read_b32 v66, a54
    v_mfma_f32_16x16x32_bf16 a[216:219], v[236:239], v[120:123], a[216:219]
    v_accvgpr_read_b32 v67, a55
    v_accvgpr_read_b32 v68, a60
    v_mfma_f32_16x16x32_bf16 a[220:223], v[236:239], v[124:127], a[220:223]
    v_accvgpr_read_b32 v69, a61
    v_accvgpr_read_b32 v70, a62
    v_accvgpr_read_b32 v71, a63
    v_cvt_pk_bf16_f32 v72, v64, v65
    v_cvt_pk_bf16_f32 v73, v66, v67
    v_cvt_pk_bf16_f32 v74, v68, v69
    v_cvt_pk_bf16_f32 v75, v70, v71
    buffer_store_dwordx4 v[72:75], v1, s[40:43], s80 offen offset:3072 sc1
    v_accvgpr_read_b32 v76, a68
    v_accvgpr_read_b32 v77, a69
    v_accvgpr_read_b32 v78, a70
    v_accvgpr_read_b32 v79, a71
    v_accvgpr_read_b32 v80, a76
    v_accvgpr_read_b32 v81, a77
    v_accvgpr_read_b32 v82, a78
    v_accvgpr_read_b32 v83, a79
    v_cvt_pk_bf16_f32 v84, v76, v77
    v_cvt_pk_bf16_f32 v85, v78, v79
    v_cvt_pk_bf16_f32 v86, v80, v81
    v_cvt_pk_bf16_f32 v87, v82, v83
    s_add_u32 s80, s71, 4096
    buffer_store_dwordx4 v[84:87], v1, s[40:43], s80 offen offset:0 sc1
    v_accvgpr_read_b32 v64, a84
    v_accvgpr_read_b32 v65, a85
    v_accvgpr_read_b32 v66, a86
    v_accvgpr_read_b32 v67, a87
    v_accvgpr_read_b32 v68, a92
    v_accvgpr_read_b32 v69, a93
    v_accvgpr_read_b32 v70, a94
    v_accvgpr_read_b32 v71, a95
    v_cvt_pk_bf16_f32 v72, v64, v65
    v_cvt_pk_bf16_f32 v73, v66, v67
    v_cvt_pk_bf16_f32 v74, v68, v69
    v_cvt_pk_bf16_f32 v75, v70, v71
    buffer_store_dwordx4 v[72:75], v1, s[40:43], s80 offen offset:1024 sc1
    v_accvgpr_read_b32 v76, a100
    v_accvgpr_read_b32 v77, a101
    v_accvgpr_read_b32 v78, a102
    v_accvgpr_read_b32 v79, a103
    v_accvgpr_read_b32 v80, a108
    v_accvgpr_read_b32 v81, a109
    v_accvgpr_read_b32 v82, a110
    v_accvgpr_read_b32 v83, a111
    v_cvt_pk_bf16_f32 v84, v76, v77
    v_cvt_pk_bf16_f32 v85, v78, v79
    v_cvt_pk_bf16_f32 v86, v80, v81
    v_cvt_pk_bf16_f32 v87, v82, v83
    buffer_store_dwordx4 v[84:87], v1, s[40:43], s80 offen offset:2048 sc1
    s_nop 7
    v_accvgpr_read_b32 v128, a112
    v_accvgpr_read_b32 v129, a113
    v_accvgpr_read_b32 v130, a114
    v_accvgpr_read_b32 v131, a115
    v_accvgpr_read_b32 v132, a120
    v_accvgpr_read_b32 v133, a121
    v_accvgpr_read_b32 v134, a122
    v_accvgpr_read_b32 v135, a123
    v_cvt_pk_bf16_f32 v136, v128, v129
    v_cvt_pk_bf16_f32 v137, v130, v131
    v_cvt_pk_bf16_f32 v138, v132, v133
    v_cvt_pk_bf16_f32 v139, v134, v135
    s_add_u32 s80, s66, 4096
    buffer_store_dwordx4 v[136:139], v1, s[40:43], s80 offen offset:3072 sc1
    v_accvgpr_read_b32 v140, a128
    v_accvgpr_read_b32 v141, a129
    v_accvgpr_read_b32 v142, a130
    v_accvgpr_read_b32 v143, a131
    v_accvgpr_read_b32 v144, a136
    v_accvgpr_read_b32 v145, a137
    v_accvgpr_read_b32 v146, a138
    v_accvgpr_read_b32 v147, a139
    v_cvt_pk_bf16_f32 v148, v140, v141
    v_cvt_pk_bf16_f32 v149, v142, v143
    v_cvt_pk_bf16_f32 v150, v144, v145
    v_cvt_pk_bf16_f32 v151, v146, v147
    s_add_u32 s80, s66, 8192
    buffer_store_dwordx4 v[148:151], v1, s[40:43], s80 offen offset:0 sc1
    v_accvgpr_read_b32 v152, a144
    v_accvgpr_read_b32 v153, a145
    v_accvgpr_read_b32 v154, a146
    v_accvgpr_read_b32 v155, a147
    v_accvgpr_read_b32 v156, a152
    v_accvgpr_read_b32 v157, a153
    v_accvgpr_read_b32 v158, a154
    v_accvgpr_read_b32 v159, a155
    v_cvt_pk_bf16_f32 v160, v152, v153
    v_cvt_pk_bf16_f32 v161, v154, v155
    v_cvt_pk_bf16_f32 v162, v156, v157
    v_cvt_pk_bf16_f32 v163, v158, v159
    buffer_store_dwordx4 v[160:163], v1, s[40:43], s80 offen offset:1024 sc1
    v_accvgpr_read_b32 v164, a160
    v_accvgpr_read_b32 v165, a161
    v_accvgpr_read_b32 v166, a162
    v_accvgpr_read_b32 v167, a163
    v_accvgpr_read_b32 v168, a168
    v_accvgpr_read_b32 v169, a169
    v_accvgpr_read_b32 v170, a170
    v_accvgpr_read_b32 v171, a171
    v_cvt_pk_bf16_f32 v172, v164, v165
    v_cvt_pk_bf16_f32 v173, v166, v167
    v_cvt_pk_bf16_f32 v174, v168, v169
    v_cvt_pk_bf16_f32 v175, v170, v171
    buffer_store_dwordx4 v[172:175], v1, s[40:43], s80 offen offset:2048 sc1
    v_accvgpr_read_b32 v176, a176
    v_accvgpr_read_b32 v177, a177
    v_accvgpr_read_b32 v178, a178
    v_accvgpr_read_b32 v179, a179
    v_accvgpr_read_b32 v180, a184
    v_accvgpr_read_b32 v181, a185
    v_accvgpr_read_b32 v182, a186
    v_accvgpr_read_b32 v183, a187
    v_cvt_pk_bf16_f32 v184, v176, v177
    v_cvt_pk_bf16_f32 v185, v178, v179
    v_cvt_pk_bf16_f32 v186, v180, v181
    v_cvt_pk_bf16_f32 v187, v182, v183
    buffer_store_dwordx4 v[184:187], v1, s[40:43], s80 offen offset:3072 sc1
    v_accvgpr_read_b32 v188, a192
    v_accvgpr_read_b32 v189, a193
    v_accvgpr_read_b32 v190, a194
    v_accvgpr_read_b32 v191, a195
    v_accvgpr_read_b32 v192, a200
    v_accvgpr_read_b32 v193, a201
    v_accvgpr_read_b32 v194, a202
    v_accvgpr_read_b32 v195, a203
    v_cvt_pk_bf16_f32 v196, v188, v189
    v_cvt_pk_bf16_f32 v197, v190, v191
    v_cvt_pk_bf16_f32 v198, v192, v193
    v_cvt_pk_bf16_f32 v199, v194, v195
    s_add_u32 s80, s66, 12288
    buffer_store_dwordx4 v[196:199], v1, s[40:43], s80 offen offset:0 sc1
    v_accvgpr_read_b32 v200, a208
    v_accvgpr_read_b32 v201, a209
    v_accvgpr_read_b32 v202, a210
    v_accvgpr_read_b32 v203, a211
    v_accvgpr_read_b32 v204, a216
    v_accvgpr_read_b32 v205, a217
    v_accvgpr_read_b32 v206, a218
    v_accvgpr_read_b32 v207, a219
    v_cvt_pk_bf16_f32 v208, v200, v201
    v_cvt_pk_bf16_f32 v209, v202, v203
    v_cvt_pk_bf16_f32 v210, v204, v205
    v_cvt_pk_bf16_f32 v211, v206, v207
    buffer_store_dwordx4 v[208:211], v1, s[40:43], s80 offen offset:1024 sc1
    v_accvgpr_read_b32 v212, a116
    v_accvgpr_read_b32 v213, a117
    v_accvgpr_read_b32 v214, a118
    v_accvgpr_read_b32 v215, a119
    v_accvgpr_read_b32 v216, a124
    v_accvgpr_read_b32 v217, a125
    v_accvgpr_read_b32 v218, a126
    v_accvgpr_read_b32 v219, a127
    v_cvt_pk_bf16_f32 v220, v212, v213
    v_cvt_pk_bf16_f32 v221, v214, v215
    v_cvt_pk_bf16_f32 v222, v216, v217
    v_cvt_pk_bf16_f32 v223, v218, v219
    s_add_u32 s80, s71, 4096
    buffer_store_dwordx4 v[220:223], v1, s[40:43], s80 offen offset:3072 sc1
    v_accvgpr_read_b32 v128, a132
    v_accvgpr_read_b32 v129, a133
    v_accvgpr_read_b32 v130, a134
    v_accvgpr_read_b32 v131, a135
    v_accvgpr_read_b32 v132, a140
    v_accvgpr_read_b32 v133, a141
    v_accvgpr_read_b32 v134, a142
    v_accvgpr_read_b32 v135, a143
    v_cvt_pk_bf16_f32 v136, v128, v129
    v_cvt_pk_bf16_f32 v137, v130, v131
    v_cvt_pk_bf16_f32 v138, v132, v133
    v_cvt_pk_bf16_f32 v139, v134, v135
    s_add_u32 s80, s71, 8192
    buffer_store_dwordx4 v[136:139], v1, s[40:43], s80 offen offset:0 sc1
    v_accvgpr_read_b32 v140, a148
    v_accvgpr_read_b32 v141, a149
    v_accvgpr_read_b32 v142, a150
    v_accvgpr_read_b32 v143, a151
    v_accvgpr_read_b32 v144, a156
    v_accvgpr_read_b32 v145, a157
    v_accvgpr_read_b32 v146, a158
    v_accvgpr_read_b32 v147, a159
    v_cvt_pk_bf16_f32 v148, v140, v141
    v_cvt_pk_bf16_f32 v149, v142, v143
    v_cvt_pk_bf16_f32 v150, v144, v145
    v_cvt_pk_bf16_f32 v151, v146, v147
    buffer_store_dwordx4 v[148:151], v1, s[40:43], s80 offen offset:1024 sc1
    v_accvgpr_read_b32 v152, a164
    v_accvgpr_read_b32 v153, a165
    v_accvgpr_read_b32 v154, a166
    v_accvgpr_read_b32 v155, a167
    v_accvgpr_read_b32 v156, a172
    v_accvgpr_read_b32 v157, a173
    v_accvgpr_read_b32 v158, a174
    v_accvgpr_read_b32 v159, a175
    v_cvt_pk_bf16_f32 v160, v152, v153
    v_cvt_pk_bf16_f32 v161, v154, v155
    v_cvt_pk_bf16_f32 v162, v156, v157
    v_cvt_pk_bf16_f32 v163, v158, v159
    buffer_store_dwordx4 v[160:163], v1, s[40:43], s80 offen offset:2048 sc1
    v_accvgpr_read_b32 v164, a180
    v_accvgpr_read_b32 v165, a181
    v_accvgpr_read_b32 v166, a182
    v_accvgpr_read_b32 v167, a183
    v_accvgpr_read_b32 v168, a188
    v_accvgpr_read_b32 v169, a189
    v_accvgpr_read_b32 v170, a190
    v_accvgpr_read_b32 v171, a191
    v_cvt_pk_bf16_f32 v172, v164, v165
    v_cvt_pk_bf16_f32 v173, v166, v167
    v_cvt_pk_bf16_f32 v174, v168, v169
    v_cvt_pk_bf16_f32 v175, v170, v171
    buffer_store_dwordx4 v[172:175], v1, s[40:43], s80 offen offset:3072 sc1
    v_accvgpr_read_b32 v176, a196
    v_accvgpr_read_b32 v177, a197
    v_accvgpr_read_b32 v178, a198
    v_accvgpr_read_b32 v179, a199
    v_accvgpr_read_b32 v180, a204
    v_accvgpr_read_b32 v181, a205
    v_accvgpr_read_b32 v182, a206
    v_accvgpr_read_b32 v183, a207
    v_cvt_pk_bf16_f32 v184, v176, v177
    v_cvt_pk_bf16_f32 v185, v178, v179
    v_cvt_pk_bf16_f32 v186, v180, v181
    v_cvt_pk_bf16_f32 v187, v182, v183
    s_add_u32 s80, s71, 12288
    buffer_store_dwordx4 v[184:187], v1, s[40:43], s80 offen offset:0 sc1
    v_accvgpr_read_b32 v188, a212
    v_accvgpr_read_b32 v189, a213
    v_accvgpr_read_b32 v190, a214
    v_accvgpr_read_b32 v191, a215
    v_accvgpr_read_b32 v192, a220
    v_accvgpr_read_b32 v193, a221
    v_accvgpr_read_b32 v194, a222
    v_accvgpr_read_b32 v195, a223
    v_cvt_pk_bf16_f32 v196, v188, v189
    v_cvt_pk_bf16_f32 v197, v190, v191
    v_cvt_pk_bf16_f32 v198, v192, v193
    v_cvt_pk_bf16_f32 v199, v194, v195
    buffer_store_dwordx4 v[196:199], v1, s[40:43], s80 offen offset:1024 sc1
LQ_NEXT:
    s_cmp_eq_u32 s49, 1
    s_cbranch_scc1 LQ_34
    s_mov_b32 s49, 1
    s_cmp_lg_u32 s48, 0
    s_cbranch_scc1 LPO_35
    s_and_b32 s87, s2, 7
    s_lshl_b32 s87, s87, 5
    v_mov_b32 v5, 1
    v_mov_b32 v47, 0
    s_mov_b64 exec, 1
    buffer_atomic_add v5, v47, s[44:47], s87 offen offset:4 sc0
    s_mov_b64 exec, -1
LPO_35:
    s_waitcnt vmcnt(0)
LQ_34:
    s_mov_b32 s49, 0
    s_cmp_lg_u32 s48, 0
    s_cbranch_scc1 LQ_36
    s_waitcnt vmcnt(14)
    v_mov_b32 v45, 163824
    s_mov_b64 exec, 1
    ds_write_b32 v45, v5
    s_mov_b64 exec, -1
LQ_36:
    s_waitcnt lgkmcnt(0)
    s_barrier
    v_mov_b32 v45, 163824
    ds_read_b32 v44, v45
    s_mov_b32 s12, s76
    s_mov_b32 s13, s77
    s_waitcnt lgkmcnt(0)
    v_readfirstlane_b32 s72, v44
    s_nop 3
    s_cmp_lt_u32 s72, 24
    s_cbranch_scc1 LQ_AITEM
    s_cmp_eq_u32 s12, 0
    s_cbranch_scc1 LQ_37
    s_waitcnt vmcnt(0)
LQ_37:
    s_barrier
    s_cmp_eq_u32 s12, 0
    s_cbranch_scc1 LQ_38
    s_cmp_lg_u32 s48, 0
    s_cbranch_scc1 LSG_39
    v_mov_b32 v46, 1
    v_lshlrev_b32 v47, 5, v0
    s_mov_b64 exec, 1
    s_mov_b32 exec_lo, s13
    buffer_store_dword v46, v47, s[40:43], s12 offen sc1
    s_mov_b64 exec, -1
LSG_39:
LQ_38:
    s_branch LQ_RED
LQ_AITEM:
    s_and_b32 s81, s2, 3
    s_cmp_eq_u32 s79, 1
    s_cbranch_scc1 LAQ_40
    s_lshl_b32 s75, s81, 8
    s_add_u32 s75, s75, 251666432
    v_min_u32 v45, 63, v0
    v_lshlrev_b32 v45, 2, v45
    buffer_load_dword v44, v45, s[40:43], s75 offen sc1
    s_mov_b32 s73, 65536
LPL_42:
    s_waitcnt vmcnt(0)
    v_cmp_eq_u32 vcc, 1, v44
    s_nop 3
    s_cmp_eq_u64 vcc, -1
    s_cbranch_scc1 LPK_41
    s_sub_u32 s73, s73, 1
    s_cmp_eq_u32 s73, 0
    s_cbranch_scc1 LPK_41
    s_sleep 8
    buffer_load_dword v44, v45, s[40:43], s75 offen sc1
    s_branch LPL_42
LPK_41:
    s_mov_b32 s79, 1
LAQ_40:
    s_cmp_ge_u32 s72, 12
    s_cselect_b32 s52, 1, 0
    s_cselect_b32 s82, 12, 0
    s_cselect_b32 s83, 12, 0
    s_cmp_ge_u32 s72, 16
    s_cselect_b32 s52, 2, s52
    s_cselect_b32 s82, 16, s82
    s_cselect_b32 s83, 14, s83
    s_sub_u32 s82, s72, s82
    s_lshl_b32 s85, 1, s52
    s_sub_u32 s85, s85, 1
    s_and_b32 s86, s82, s85
    s_lshr_b32 s82, s82, s52
    s_add_u32 s82, s82, s83
    s_sub_u32 s84, 2, s52
    s_lshl_b32 s83, s86, s84
    s_lshr_b32 s84, s48, s52
    s_add_u32 s83, s83, s84
    s_and_b32 s84, s48, s85
    s_sub_u32 s85, 17, s52
    s_lshl_b32 s84, s84, s85
    s_lshr_b32 s63, 16, s52
    s_lshr_b32 s85, 131072, s52
    s_sub_u32 s85, s85, 2048
    s_cmp_ge_u32 s52, 1
    s_cselect_b32 s78, 1.0, 0
    s_cselect_b32 s74, 1024, 0
    s_cselect_b32 s77, 5, 15
    s_cmp_ge_u32 s52, 2
    s_cselect_b32 s53, 1.0, 0
    s_cselect_b32 s54, 2048, 0
    s_cselect_b32 s77, 1, s77
    s_bfe_u32 s80, s2, 0x10002
    s_lshl_b32 s80, s80, 4
    s_add_u32 s82, s82, s80
    s_lshl_b32 s80, s81, 2
    s_add_u32 s83, s83, s80
    s_mul_i32 s65, s83, 25088
    s_lshl_b32 s83, s83, 17
    s_add_u32 s55, s83, s84
    s_add_u32 s56, s55, 54525952
    s_add_u32 s55, s55, 52428800
    s_add_u32 s57, s55, s85
    s_add_u32 s58, s56, s85
    s_lshl_b32 s84, s82, 12
    s_add_u32 s84, s84, s83
    s_add_u32 s84, s84, 50331648
    buffer_load_dwordx4 a[0:3], v1, s[40:43], s84 offen offset:0 sc1
    buffer_load_dwordx4 a[4:7], v1, s[40:43], s84 offen offset:1024 sc1
    buffer_load_dwordx4 a[8:11], v1, s[40:43], s84 offen offset:2048 sc1
    buffer_load_dwordx4 a[12:15], v1, s[40:43], s84 offen offset:3072 sc1
    buffer_load_dwordx4 a[16:19], v1, s[40:43], s55 offen offset:0 sc1
    buffer_load_dwordx4 a[20:23], v1, s[40:43], s55 offen offset:1024 sc1
    s_add_u32 s55, s55, 2048
    s_min_u32 s55, s55, s57
    buffer_load_dwordx4 a[24:27], v1, s[40:43], s55 offen offset:0 sc1
    buffer_load_dwordx4 a[28:31], v1, s[40:43], s55 offen offset:1024 sc1
    s_add_u32 s55, s55, 2048
    s_min_u32 s55, s55, s57
    buffer_load_dwordx4 a[32:35], v1, s[40:43], s55 offen offset:0 sc1
    buffer_load_dwordx4 a[36:39], v1, s[40:43], s55 offen offset:1024 sc1
    s_add_u32 s55, s55, 2048
    s_min_u32 s55, s55, s57
    buffer_load_dwordx4 a[48:51], v1, s[40:43], s56 offen offset:0 sc1
    buffer_load_dwordx4 a[52:55], v1, s[40:43], s56 offen offset:1024 sc1
    s_add_u32 s56, s56, 2048
    s_min_u32 s56, s56, s58
    buffer_load_dwordx4 a[40:43], v1, s[40:43], s55 offen offset:0 sc1
    buffer_load_dwordx4 a[44:47], v1, s[40:43], s55 offen offset:1024 sc1
    s_add_u32 s55, s55, 2048
    s_min_u32 s55, s55, s57
    buffer_load_dwordx4 a[56:59], v1, s[40:43], s56 offen offset:0 sc1
    buffer_load_dwordx4 a[60:63], v1, s[40:43], s56 offen offset:1024 sc1
    s_add_u32 s56, s56, 2048
    s_min_u32 s56, s56, s58
    s_mov_b32 s36, s30
    s_mov_b32 s37, s31
    s_mov_b32 s38, 401408
    s_mov_b32 s39, 0x20000
    s_lshr_b32 s76, s82, 1
    s_lshl_b32 s76, s76, 8
    s_and_b32 s83, s82, 1
    s_lshl_b32 s83, s83, 2
    s_add_u32 s83, s83, s81
    s_lshl_b32 s80, s86, 3
    s_add_u32 s83, s83, s80
    s_lshl_b32 s83, s83, 2
    s_add_u32 s76, s76, s83
    s_add_u32 s76, s76, 251670592
    s_lshl_b32 s80, s86, 2
    s_add_u32 s80, s80, 16
    s_cmp_eq_u32 s86, 0
    s_cselect_b32 s80, 0, s80
    s_add_u32 s80, s80, s81
    s_mul_i32 s66, s80, 1835008
    s_lshl_b32 s83, s82, 2
    s_add_u32 s83, s83, s48
    s_mul_i32 s83, s83, 14336
    s_add_u32 s66, s66, s83
    s_add_u32 s66, s66, 67108864
    s_mul_i32 s69, s48, 28672
    s_mov_b32 s67, 0x40004000
    s_mov_b32 s62, 0xff800000
    s_mov_b32 s64, 1
    v_mov_b32 v128, 0
    v_mov_b32 v160, 0
    v_mov_b32 v96, 0
    v_mov_b32 v129, 0
    v_mov_b32 v161, 0
    v_mov_b32 v97, 0
    v_mov_b32 v130, 0
    v_mov_b32 v162, 0
    v_mov_b32 v98, 0
    v_mov_b32 v131, 0
    v_mov_b32 v163, 0
    v_mov_b32 v99, 0
    v_mov_b32 v132, 0
    v_mov_b32 v164, 0
    v_mov_b32 v100, 0
    v_mov_b32 v133, 0
    v_mov_b32 v165, 0
    v_mov_b32 v101, 0
    v_mov_b32 v134, 0
    v_mov_b32 v166, 0
    v_mov_b32 v102, 0
    v_mov_b32 v135, 0
    v_mov_b32 v167, 0
    v_mov_b32 v103, 0
    v_mov_b32 v136, 0
    v_mov_b32 v168, 0
    v_mov_b32 v104, 0
    v_mov_b32 v137, 0
    v_mov_b32 v169, 0
    v_mov_b32 v105, 0
    v_mov_b32 v138, 0
    v_mov_b32 v170, 0
    v_mov_b32 v106, 0
    v_mov_b32 v139, 0
    v_mov_b32 v171, 0
    v_mov_b32 v107, 0
    v_mov_b32 v140, 0
    v_mov_b32 v172, 0
    v_mov_b32 v108, 0
    v_mov_b32 v141, 0
    v_mov_b32 v173, 0
    v_mov_b32 v109, 0
    v_mov_b32 v142, 0
    v_mov_b32 v174, 0
    v_mov_b32 v110, 0
    v_mov_b32 v143, 0
    v_mov_b32 v175, 0
    v_mov_b32 v111, 0
    v_mov_b32 v144, 0
    v_mov_b32 v176, 0
    v_mov_b32 v112, 0
    v_mov_b32 v145, 0
    v_mov_b32 v177, 0
    v_mov_b32 v113, 0
    v_mov_b32 v146, 0
    v_mov_b32 v178, 0
    v_mov_b32 v114, 0
    v_mov_b32 v147, 0
    v_mov_b32 v179, 0
    v_mov_b32 v115, 0
    v_mov_b32 v148, 0
    v_mov_b32 v180, 0
    v_mov_b32 v116, 0
    v_mov_b32 v149, 0
    v_mov_b32 v181, 0
    v_mov_b32 v117, 0
    v_mov_b32 v150, 0
    v_mov_b32 v182, 0
    v_mov_b32 v118, 0
    v_mov_b32 v151, 0
    v_mov_b32 v183, 0
    v_mov_b32 v119, 0
    v_mov_b32 v152, 0
    v_mov_b32 v184, 0
    v_mov_b32 v120, 0
    v_mov_b32 v153, 0
    v_mov_b32 v185, 0
    v_mov_b32 v121, 0
    v_mov_b32 v154, 0
    v_mov_b32 v186, 0
    v_mov_b32 v122, 0
    v_mov_b32 v155, 0
    v_mov_b32 v187, 0
    v_mov_b32 v123, 0
    v_mov_b32 v156, 0
    v_mov_b32 v188, 0
    v_mov_b32 v124, 0
    v_mov_b32 v157, 0
    v_mov_b32 v189, 0
    v_mov_b32 v125, 0
    v_mov_b32 v158, 0
    v_mov_b32 v190, 0
    v_mov_b32 v126, 0
    v_mov_b32 v159, 0
    v_mov_b32 v191, 0
    v_mov_b32 v127, 0
    v_mov_b32 v208, 0
    v_mov_b32 v209, 0
    v_mov_b32 v210, 0
    v_mov_b32 v211, 0
    v_mov_b32 v212, 0
    v_mov_b32 v213, 0
    v_mov_b32 v214, 0
    v_mov_b32 v215, 0
    v_mov_b32 v216, 0
    v_mov_b32 v217, 0
    v_mov_b32 v218, 0
    v_mov_b32 v219, 0
    v_mov_b32 v220, 0
    v_mov_b32 v221, 0
    v_mov_b32 v222, 0
    v_mov_b32 v223, 0
    v_accvgpr_write_b32 a72, 0
    v_accvgpr_write_b32 a73, 0
    v_accvgpr_write_b32 a74, 0
    v_accvgpr_write_b32 a75, 0
    v_accvgpr_write_b32 a76, 0
    v_accvgpr_write_b32 a77, 0
    v_accvgpr_write_b32 a78, 0
    v_accvgpr_write_b32 a79, 0
    v_bfe_u32 v16, v0, 3, 1
    v_lshlrev_b32 v16, 10, v16
    v_lshrrev_b32 v17, 5, v0
    v_lshl_add_u32 v16, v17, 8, v16
    v_bfe_u32 v17, v0, 4, 1
    v_lshl_add_u32 v16, v17, 7, v16
    v_and_b32 v17, 7, v0
    v_lshl_add_u32 v16, v17, 4, v16
    s_lshl_b32 s85, s48, 12
    s_add_u32 s85, s85, 114688
    v_add_u32 v2, s85, v16
    v_bfe_u32 v16, v0, 2, 3
    v_bfe_u32 v18, v16, 1, 2
    v_lshrrev_b32 v17, 5, v0
    v_lshl_add_u32 v16, v17, 4, v16
    v_mul_u32_u24 v16, 896, v16
    v_and_b32 v17, 3, v0
    v_lshl_add_u32 v16, v17, 3, v16
    v_xor_b32 v17, 0, v18
    v_lshl_add_u32 v40, v17, 5, v16
    v_xor_b32 v17, 1, v18
    v_lshl_add_u32 v41, v17, 5, v16
    v_xor_b32 v17, 2, v18
    v_lshl_add_u32 v42, v17, 5, v16
    v_xor_b32 v17, 3, v18
    v_lshl_add_u32 v43, v17, 5, v16
    s_waitcnt vmcnt(10)
    s_barrier
    s_cmp_lg_u32 s48, 0
    s_cbranch_scc1 LSG_43
    v_mov_b32 v46, 1
    v_lshlrev_b32 v47, 5, v0
    s_mov_b64 exec, 1
    s_mov_b32 exec_lo, s13
    buffer_store_dword v46, v47, s[40:43], s12 offen sc1
    s_mov_b64 exec, -1
LSG_43:
    v_mfma_f32_32x32x16_bf16 v[64:79], a[16:19], a[0:3], v[128:143]
    v_mfma_f32_32x32x16_bf16 v[80:95], a[16:19], a[8:11], v[144:159]
    v_mfma_f32_32x32x16_bf16 v[64:79], a[20:23], a[4:7], v[64:79]
    v_mfma_f32_32x32x16_bf16 v[80:95], a[20:23], a[12:15], v[80:95]
    buffer_load_dwordx4 a[64:67], v1, s[40:43], s56 offen offset:0 sc1
    buffer_load_dwordx4 a[68:71], v1, s[40:43], s56 offen offset:1024 sc1
    s_add_u32 s56, s56, 2048
    s_min_u32 s56, s56, s58
    buffer_load_dwordx4 a[16:19], v1, s[40:43], s55 offen offset:0 sc1
    buffer_load_dwordx4 a[20:23], v1, s[40:43], s55 offen offset:1024 sc1
    s_mov_b32 m0, s69
    s_add_u32 s69, s69, 7168
    buffer_load_dwordx4 v32, s[36:39], s65 offen offset:0 lds
    buffer_load_dwordx4 v33, s[36:39], s65 offen offset:1024 lds
    buffer_load_dwordx4 v34, s[36:39], s65 offen offset:2048 lds
    buffer_load_dwordx4 v35, s[36:39], s65 offen offset:3072 lds
    s_add_u32 m0, m0, 4096
    s_nop 0
    buffer_load_dwordx4 v36, s[36:39], s65 offen offset:0 lds
    buffer_load_dwordx4 v37, s[36:39], s65 offen offset:1024 lds
    buffer_load_dwordx4 v38, s[36:39], s65 offen offset:2048 lds
    s_add_u32 s65, s65, 7168
    s_call_b64 s[60:61], LA_RARE0
LA_FLOOP:
    v_exp_f32_e64 v224, v64 clamp
    s_waitcnt vmcnt(12)
    v_mfma_f32_32x32x16_bf16 v[160:175], a[72:75], v[208:211], v[160:175]
    s_add_u32 s55, s55, 2048
    v_exp_f32_e64 v225, v65 clamp
    v_exp_f32_e64 v226, v66 clamp
    v_exp_f32_e64 v227, v67 clamp
    v_exp_f32_e64 v228, v68 clamp
    v_cvt_pk_bf16_f32 v192, v224, v225
    v_mfma_f32_32x32x16_bf16 v[176:191], a[72:75], v[216:219], v[176:191]
    s_min_u32 s55, s55, s57
    v_exp_f32_e64 v229, v69 clamp
    v_exp_f32_e64 v230, v70 clamp
    v_cvt_pk_bf16_f32 v193, v226, v227
    v_exp_f32_e64 v231, v71 clamp
    v_exp_f32_e64 v232, v72 clamp
    v_cvt_pk_bf16_f32 v194, v228, v229
    v_mfma_f32_32x32x16_bf16 v[160:175], a[76:79], v[212:215], v[160:175]
    buffer_load_dwordx4 a[72:75], v1, s[40:43], s56 offen offset:0 sc1
    v_exp_f32_e64 v233, v73 clamp
    v_exp_f32_e64 v234, v74 clamp
    v_cvt_pk_bf16_f32 v195, v230, v231
    v_exp_f32_e64 v235, v75 clamp
    v_exp_f32_e64 v236, v76 clamp
    v_mfma_f32_32x32x16_bf16 v[176:191], a[76:79], v[220:223], v[176:191]
    buffer_load_dwordx4 a[76:79], v1, s[40:43], s56 offen offset:1024 sc1
    v_cvt_pk_bf16_f32 v196, v232, v233
    v_exp_f32_e64 v237, v77 clamp
    v_exp_f32_e64 v238, v78 clamp
    v_cvt_pk_bf16_f32 v197, v234, v235
    v_exp_f32_e64 v239, v79 clamp
    v_exp_f32_e64 v224, v80 clamp
    v_mfma_f32_32x32x16_bf16 v[96:111], a[24:27], a[0:3], v[128:143]
    s_add_u32 s56, s56, 2048
    v_cvt_pk_bf16_f32 v198, v236, v237
    v_exp_f32_e64 v225, v81 clamp
    v_exp_f32_e64 v226, v82 clamp
    v_cvt_pk_bf16_f32 v199, v238, v239
    v_exp_f32_e64 v227, v83 clamp
    v_mfma_f32_32x32x16_bf16 v[112:127], a[24:27], a[8:11], v[144:159]
    s_min_u32 s56, s56, s58
    v_exp_f32_e64 v228, v84 clamp
    v_cvt_pk_bf16_f32 v200, v224, v225
    v_exp_f32_e64 v229, v85 clamp
    v_exp_f32_e64 v230, v86 clamp
    v_cvt_pk_bf16_f32 v201, v226, v227
    v_exp_f32_e64 v231, v87 clamp
    v_mfma_f32_32x32x16_bf16 v[96:111], a[28:31], a[4:7], v[96:111]
    buffer_load_dwordx4 a[24:27], v1, s[40:43], s55 offen offset:0 sc1
    v_exp_f32_e64 v232, v88 clamp
    v_cvt_pk_bf16_f32 v202, v228, v229
    v_exp_f32_e64 v233, v89 clamp
    v_exp_f32_e64 v234, v90 clamp
    v_cvt_pk_bf16_f32 v203, v230, v231
    v_exp_f32_e64 v235, v91 clamp
    v_mfma_f32_32x32x16_bf16 v[112:127], a[28:31], a[12:15], v[112:127]
    buffer_load_dwordx4 a[28:31], v1, s[40:43], s55 offen offset:1024 sc1
    v_exp_f32_e64 v236, v92 clamp
    v_cvt_pk_bf16_f32 v204, v232, v233
    v_exp_f32_e64 v237, v93 clamp
    v_exp_f32_e64 v238, v94 clamp
    v_cvt_pk_bf16_f32 v205, v234, v235
    v_exp_f32_e64 v239, v95 clamp
    v_cvt_pk_bf16_f32 v206, v236, v237
    v_cvt_pk_bf16_f32 v207, v238, v239
    v_exp_f32_e64 v224, v96 clamp
    s_waitcnt vmcnt(12)
    v_mfma_f32_32x32x16_bf16 v[160:175], a[48:51], v[192:195], v[160:175]
    s_add_u32 s55, s55, 2048
    v_exp_f32_e64 v225, v97 clamp
    v_exp_f32_e64 v226, v98 clamp
    v_exp_f32_e64 v227, v99 clamp
    v_exp_f32_e64 v228, v100 clamp
    v_cvt_pk_bf16_f32 v208, v224, v225
    v_mfma_f32_32x32x16_bf16 v[176:191], a[48:51], v[200:203], v[176:191]
    s_min_u32 s55, s55, s57
    v_exp_f32_e64 v229, v101 clamp
    v_exp_f32_e64 v230, v102 clamp
    v_cvt_pk_bf16_f32 v209, v226, v227
    v_exp_f32_e64 v231, v103 clamp
    v_exp_f32_e64 v232, v104 clamp
    v_cvt_pk_bf16_f32 v210, v228, v229
    v_mfma_f32_32x32x16_bf16 v[160:175], a[52:55], v[196:199], v[160:175]
    buffer_load_dwordx4 a[48:51], v1, s[40:43], s56 offen offset:0 sc1
    v_exp_f32_e64 v233, v105 clamp
    v_exp_f32_e64 v234, v106 clamp
    v_cvt_pk_bf16_f32 v211, v230, v231
    v_exp_f32_e64 v235, v107 clamp
    v_exp_f32_e64 v236, v108 clamp
    v_mfma_f32_32x32x16_bf16 v[176:191], a[52:55], v[204:207], v[176:191]
    buffer_load_dwordx4 a[52:55], v1, s[40:43], s56 offen offset:1024 sc1
    v_cvt_pk_bf16_f32 v212, v232, v233
    v_exp_f32_e64 v237, v109 clamp
    v_exp_f32_e64 v238, v110 clamp
    v_cvt_pk_bf16_f32 v213, v234, v235
    v_exp_f32_e64 v239, v111 clamp
    v_exp_f32_e64 v224, v112 clamp
    v_mfma_f32_32x32x16_bf16 v[64:79], a[32:35], a[0:3], v[128:143]
    s_add_u32 s56, s56, 2048
    v_cvt_pk_bf16_f32 v214, v236, v237
    v_exp_f32_e64 v225, v113 clamp
    v_exp_f32_e64 v226, v114 clamp
    v_cvt_pk_bf16_f32 v215, v238, v239
    v_exp_f32_e64 v227, v115 clamp
    v_mfma_f32_32x32x16_bf16 v[80:95], a[32:35], a[8:11], v[144:159]
    s_min_u32 s56, s56, s58
    v_exp_f32_e64 v228, v116 clamp
    v_cvt_pk_bf16_f32 v216, v224, v225
    v_exp_f32_e64 v229, v117 clamp
    v_exp_f32_e64 v230, v118 clamp
    v_cvt_pk_bf16_f32 v217, v226, v227
    v_exp_f32_e64 v231, v119 clamp
    v_mfma_f32_32x32x16_bf16 v[64:79], a[36:39], a[4:7], v[64:79]
    buffer_load_dwordx4 a[32:35], v1, s[40:43], s55 offen offset:0 sc1
    v_exp_f32_e64 v232, v120 clamp
    v_cvt_pk_bf16_f32 v218, v228, v229
    v_exp_f32_e64 v233, v121 clamp
    v_exp_f32_e64 v234, v122 clamp
    v_cvt_pk_bf16_f32 v219, v230, v231
    v_exp_f32_e64 v235, v123 clamp
    v_mfma_f32_32x32x16_bf16 v[80:95], a[36:39], a[12:15], v[80:95]
    buffer_load_dwordx4 a[36:39], v1, s[40:43], s55 offen offset:1024 sc1
    v_exp_f32_e64 v236, v124 clamp
    v_cvt_pk_bf16_f32 v220, v232, v233
    v_exp_f32_e64 v237, v125 clamp
    v_exp_f32_e64 v238, v126 clamp
    v_cvt_pk_bf16_f32 v221, v234, v235
    v_exp_f32_e64 v239, v127 clamp
    v_cvt_pk_bf16_f32 v222, v236, v237
    v_cvt_pk_bf16_f32 v223, v238, v239
    v_exp_f32_e64 v224, v64 clamp
    s_waitcnt vmcnt(12)
    v_mfma_f32_32x32x16_bf16 v[160:175], a[56:59], v[208:211], v[160:175]
    s_add_u32 s55, s55, 2048
    v_exp_f32_e64 v225, v65 clamp
    v_exp_f32_e64 v226, v66 clamp
    v_exp_f32_e64 v227, v67 clamp
    v_exp_f32_e64 v228, v68 clamp
    v_cvt_pk_bf16_f32 v192, v224, v225
    v_mfma_f32_32x32x16_bf16 v[176:191], a[56:59], v[216:219], v[176:191]
    s_min_u32 s55, s55, s57
    v_exp_f32_e64 v229, v69 clamp
    v_exp_f32_e64 v230, v70 clamp
    v_cvt_pk_bf16_f32 v193, v226, v227
    v_exp_f32_e64 v231, v71 clamp
    v_exp_f32_e64 v232, v72 clamp
    v_cvt_pk_bf16_f32 v194, v228, v229
    v_mfma_f32_32x32x16_bf16 v[160:175], a[60:63], v[212:215], v[160:175]
    buffer_load_dwordx4 a[56:59], v1, s[40:43], s56 offen offset:0 sc1
    v_exp_f32_e64 v233, v73 clamp
    v_exp_f32_e64 v234, v74 clamp
    v_cvt_pk_bf16_f32 v195, v230, v231
    v_exp_f32_e64 v235, v75 clamp
    v_exp_f32_e64 v236, v76 clamp
    v_mfma_f32_32x32x16_bf16 v[176:191], a[60:63], v[220:223], v[176:191]
    buffer_load_dwordx4 a[60:63], v1, s[40:43], s56 offen offset:1024 sc1
    v_cvt_pk_bf16_f32 v196, v232, v233
    v_exp_f32_e64 v237, v77 clamp
    v_exp_f32_e64 v238, v78 clamp
    v_cvt_pk_bf16_f32 v197, v234, v235
    v_exp_f32_e64 v239, v79 clamp
    v_exp_f32_e64 v224, v80 clamp
    v_mfma_f32_32x32x16_bf16 v[96:111], a[40:43], a[0:3], v[128:143]
    s_add_u32 s56, s56, 2048
    v_cvt_pk_bf16_f32 v198, v236, v237
    v_exp_f32_e64 v225, v81 clamp
    v_exp_f32_e64 v226, v82 clamp
    v_cvt_pk_bf16_f32 v199, v238, v239
    v_exp_f32_e64 v227, v83 clamp
    v_mfma_f32_32x32x16_bf16 v[112:127], a[40:43], a[8:11], v[144:159]
    s_min_u32 s56, s56, s58
    v_exp_f32_e64 v228, v84 clamp
    v_cvt_pk_bf16_f32 v200, v224, v225
    v_exp_f32_e64 v229, v85 clamp
    v_exp_f32_e64 v230, v86 clamp
    v_cvt_pk_bf16_f32 v201, v226, v227
    v_exp_f32_e64 v231, v87 clamp
    v_mfma_f32_32x32x16_bf16 v[96:111], a[44:47], a[4:7], v[96:111]
    buffer_load_dwordx4 a[40:43], v1, s[40:43], s55 offen offset:0 sc1
    v_exp_f32_e64 v232, v88 clamp
    v_cvt_pk_bf16_f32 v202, v228, v229
    v_exp_f32_e64 v233, v89 clamp
    v_exp_f32_e64 v234, v90 clamp
    v_cvt_pk_bf16_f32 v203, v230, v231
    v_exp_f32_e64 v235, v91 clamp
    v_mfma_f32_32x32x16_bf16 v[112:127], a[44:47], a[12:15], v[112:127]
    buffer_load_dwordx4 a[44:47], v1, s[40:43], s55 offen offset:1024 sc1
    v_exp_f32_e64 v236, v92 clamp
    v_cvt_pk_bf16_f32 v204, v232, v233
    v_exp_f32_e64 v237, v93 clamp
    v_exp_f32_e64 v238, v94 clamp
    v_cvt_pk_bf16_f32 v205, v234, v235
    v_exp_f32_e64 v239, v95 clamp
    v_cvt_pk_bf16_f32 v206, v236, v237
    v_cvt_pk_bf16_f32 v207, v238, v239
    v_exp_f32_e64 v224, v96 clamp
    s_waitcnt vmcnt(12)
    v_mfma_f32_32x32x16_bf16 v[160:175], a[64:67], v[192:195], v[160:175]
    s_add_u32 s55, s55, 2048
    v_exp_f32_e64 v225, v97 clamp
    v_exp_f32_e64 v226, v98 clamp
    v_exp_f32_e64 v227, v99 clamp
    v_exp_f32_e64 v228, v100 clamp
    v_cvt_pk_bf16_f32 v208, v224, v225
    v_mfma_f32_32x32x16_bf16 v[176:191], a[64:67], v[200:203], v[176:191]
    s_min_u32 s55, s55, s57
    v_exp_f32_e64 v229, v101 clamp
    v_exp_f32_e64 v230, v102 clamp
    v_cvt_pk_bf16_f32 v209, v226, v227
    v_exp_f32_e64 v231, v103 clamp
    v_exp_f32_e64 v232, v104 clamp
    v_cvt_pk_bf16_f32 v210, v228, v229
    v_mfma_f32_32x32x16_bf16 v[160:175], a[68:71], v[196:199], v[160:175]
    buffer_load_dwordx4 a[64:67], v1, s[40:43], s56 offen offset:0 sc1
    v_exp_f32_e64 v233, v105 clamp
    v_exp_f32_e64 v234, v106 clamp
    v_cvt_pk_bf16_f32 v211, v230, v231
    v_exp_f32_e64 v235, v107 clamp
    v_exp_f32_e64 v236, v108 clamp
    v_mfma_f32_32x32x16_bf16 v[176:191], a[68:71], v[204:207], v[176:191]
    buffer_load_dwordx4 a[68:71], v1, s[40:43], s56 offen offset:1024 sc1
    v_cvt_pk_bf16_f32 v212, v232, v233
    v_exp_f32_e64 v237, v109 clamp
    v_exp_f32_e64 v238, v110 clamp
    v_cvt_pk_bf16_f32 v213, v234, v235
    v_exp_f32_e64 v239, v111 clamp
    v_exp_f32_e64 v224, v112 clamp
    v_mfma_f32_32x32x16_bf16 v[64:79], a[16:19], a[0:3], v[128:143]
    s_add_u32 s56, s56, 2048
    v_cvt_pk_bf16_f32 v214, v236, v237
    v_exp_f32_e64 v225, v113 clamp
    v_exp_f32_e64 v226, v114 clamp
    v_cvt_pk_bf16_f32 v215, v238, v239
    v_exp_f32_e64 v227, v115 clamp
    v_mfma_f32_32x32x16_bf16 v[80:95], a[16:19], a[8:11], v[144:159]
    s_min_u32 s56, s56, s58
    v_exp_f32_e64 v228, v116 clamp
    v_cvt_pk_bf16_f32 v216, v224, v225
    v_exp_f32_e64 v229, v117 clamp
    v_exp_f32_e64 v230, v118 clamp
    v_cvt_pk_bf16_f32 v217, v226, v227
    v_exp_f32_e64 v231, v119 clamp
    v_mfma_f32_32x32x16_bf16 v[64:79], a[20:23], a[4:7], v[64:79]
    buffer_load_dwordx4 a[16:19], v1, s[40:43], s55 offen offset:0 sc1
    v_exp_f32_e64 v232, v120 clamp
    v_cvt_pk_bf16_f32 v218, v228, v229
    v_exp_f32_e64 v233, v121 clamp
    v_exp_f32_e64 v234, v122 clamp
    v_cvt_pk_bf16_f32 v219, v230, v231
    v_exp_f32_e64 v235, v123 clamp
    v_mfma_f32_32x32x16_bf16 v[80:95], a[20:23], a[12:15], v[80:95]
    buffer_load_dwordx4 a[20:23], v1, s[40:43], s55 offen offset:1024 sc1
    v_exp_f32_e64 v236, v124 clamp
    v_cvt_pk_bf16_f32 v220, v232, v233
    v_exp_f32_e64 v237, v125 clamp
    v_exp_f32_e64 v238, v126 clamp
    v_cvt_pk_bf16_f32 v221, v234, v235
    v_exp_f32_e64 v239, v127 clamp
    v_cvt_pk_bf16_f32 v222, v236, v237
    v_cvt_pk_bf16_f32 v223, v238, v239
    s_sub_u32 s63, s63, 1
    s_cmp_gt_u32 s63, 3
    s_cbranch_scc1 LA_FLOOP
    s_cmp_eq_u32 s63, 0
    s_cbranch_scc1 LA_FFIN
    s_mov_b32 m0, s69
    s_add_u32 s69, s69, 7168
    buffer_load_dwordx4 v32, s[36:39], s65 offen offset:0 lds
    buffer_load_dwordx4 v33, s[36:39], s65 offen offset:1024 lds
    buffer_load_dwordx4 v34, s[36:39], s65 offen offset:2048 lds
    buffer_load_dwordx4 v35, s[36:39], s65 offen offset:3072 lds
    s_add_u32 m0, m0, 4096
    s_nop 0
    buffer_load_dwordx4 v36, s[36:39], s65 offen offset:0 lds
    buffer_load_dwordx4 v37, s[36:39], s65 offen offset:1024 lds
    buffer_load_dwordx4 v38, s[36:39], s65 offen offset:2048 lds
    s_add_u32 s65, s65, 7168
    s_branch LA_FLOOP
LA_FFIN:
    s_waitcnt vmcnt(12)
    v_mfma_f32_32x32x16_bf16 v[160:175], a[72:75], v[208:211], v[160:175]
    v_mfma_f32_32x32x16_bf16 v[176:191], a[72:75], v[216:219], v[176:191]
    v_mfma_f32_32x32x16_bf16 v[160:175], a[76:79], v[212:215], v[160:175]
    v_mfma_f32_32x32x16_bf16 v[176:191], a[76:79], v[220:223], v[176:191]
    s_nop 7
    s_nop 7
    v_max_f32 v16, v172, v188
    v_cmp_ngt_f32 vcc, 0.5, v16
    s_nop 3
    s_cmp_lg_u32 vcc_hi, 0
    s_cbranch_scc1 LA_REDO
LA_EPI:
    v_cmp_gt_u32 vcc, 32, v0
    s_nop 7
    s_nop 7
    v_mov_b32 v16, v172
    v_mov_b32 v25, v172
    v_mov_b32 v24, v128
    s_nop 0
    v_permlane32_swap_b32 v16, v25
    v_mov_b32 v16, v188
    v_mov_b32 v27, v188
    v_mov_b32 v26, v144
    s_nop 0
    v_permlane32_swap_b32 v16, v27
    s_lshl_b32 s85, s48, 10
    s_add_u32 s85, s85, 131072
    v_add_u32 v16, s85, v1
    ds_write_b128 v16, v[24:27]
    v_xor_b32 v17, s74, v16
    v_xor_b32 v18, s54, v16
    v_xor_b32 v19, s54, v17
    s_waitcnt lgkmcnt(0)
    s_barrier
    ds_read_b128 v[100:103], v17
    ds_read_b128 v[104:107], v18
    ds_read_b128 v[108:111], v19
    s_waitcnt lgkmcnt(0)
    v_min_f32 v16, v24, v100
    v_min3_f32 v16, v16, v104, v108
    v_sub_f32 v100, v16, v100
    v_exp_f32 v100, v100
    v_mul_f32 v101, s78, v101
    v_sub_f32 v104, v16, v104
    v_exp_f32 v104, v104
    v_mul_f32 v105, s53, v105
    v_sub_f32 v108, v16, v108
    v_exp_f32 v108, v108
    v_mul_f32 v109, s53, v109
    v_sub_f32 v16, v16, v24
    v_exp_f32 v16, v16
    s_nop 0
    v_mul_f32 v25, v25, v16
    v_fma_f32 v25, v100, v101, v25
    v_fma_f32 v25, v104, v105, v25
    v_fma_f32 v25, v108, v109, v25
    v_rcp_f32 v18, v25
    s_nop 0
    v_mul_f32 v18, v18, v16
    v_cndmask_b32 v19, 0, v18, vcc
    v_mul_f32 v160, v160, v18
    v_mul_f32 v161, v161, v18
    v_mul_f32 v162, v162, v18
    v_mul_f32 v163, v163, v18
    v_mul_f32 v164, v164, v18
    v_mul_f32 v165, v165, v18
    v_mul_f32 v166, v166, v18
    v_mul_f32 v167, v167, v18
    v_mul_f32 v168, v168, v18
    v_mul_f32 v169, v169, v18
    v_mul_f32 v170, v170, v18
    v_mul_f32 v171, v171, v18
    v_mul_f32 v172, v172, v19
    v_mul_f32 v173, v173, v19
    v_mul_f32 v174, v174, v19
    v_mul_f32 v175, v175, v19
    v_cvt_pk_bf16_f32 v64, v160, v161
    v_cvt_pk_bf16_f32 v65, v162, v163
    v_cvt_pk_bf16_f32 v66, v164, v165
    v_cvt_pk_bf16_f32 v67, v166, v167
    ds_write_b128 v2, v[64:67] offset:0
    v_cvt_pk_bf16_f32 v68, v168, v169
    v_cvt_pk_bf16_f32 v69, v170, v171
    v_cvt_pk_bf16_f32 v70, v172, v173
    v_cvt_pk_bf16_f32 v71, v174, v175
    ds_write_b128 v2, v[68:71] offset:512
    v_min_f32 v16, v26, v102
    v_min3_f32 v16, v16, v106, v110
    v_sub_f32 v102, v16, v102
    v_exp_f32 v102, v102
    v_mul_f32 v103, s78, v103
    v_sub_f32 v106, v16, v106
    v_exp_f32 v106, v106
    v_mul_f32 v107, s53, v107
    v_sub_f32 v110, v16, v110
    v_exp_f32 v110, v110
    v_mul_f32 v111, s53, v111
    v_sub_f32 v16, v16, v26
    v_exp_f32 v16, v16
    s_nop 0
    v_mul_f32 v27, v27, v16
    v_fma_f32 v27, v102, v103, v27
    v_fma_f32 v27, v106, v107, v27
    v_fma_f32 v27, v110, v111, v27
    v_rcp_f32 v18, v27
    s_nop 0
    v_mul_f32 v18, v18, v16
    v_cndmask_b32 v19, 0, v18, vcc
    v_mul_f32 v176, v176, v18
    v_mul_f32 v177, v177, v18
    v_mul_f32 v178, v178, v18
    v_mul_f32 v179, v179, v18
    v_mul_f32 v180, v180, v18
    v_mul_f32 v181, v181, v18
    v_mul_f32 v182, v182, v18
    v_mul_f32 v183, v183, v18
    v_mul_f32 v184, v184, v18
    v_mul_f32 v185, v185, v18
    v_mul_f32 v186, v186, v18
    v_mul_f32 v187, v187, v18
    v_mul_f32 v188, v188, v19
    v_mul_f32 v189, v189, v19
    v_mul_f32 v190, v190, v19
    v_mul_f32 v191, v191, v19
    v_cvt_pk_bf16_f32 v72, v176, v177
    v_cvt_pk_bf16_f32 v73, v178, v179
    v_cvt_pk_bf16_f32 v74, v180, v181
    v_cvt_pk_bf16_f32 v75, v182, v183
    ds_write_b128 v2, v[72:75] offset:2048
    v_cvt_pk_bf16_f32 v76, v184, v185
    v_cvt_pk_bf16_f32 v77, v186, v187
    v_cvt_pk_bf16_f32 v78, v188, v189
    v_cvt_pk_bf16_f32 v79, v190, v191
    ds_write_b128 v2, v[76:79] offset:2560
    s_waitcnt vmcnt(0) lgkmcnt(0)
    s_barrier
    s_lshl_b32 s85, s48, 10
    s_add_u32 s85, s85, 114688
    v_add_u32 v16, s85, v1
    ds_read_b128 v[96:99], v16 offset:0
    ds_read_b128 v[100:103], v16 offset:4096
    ds_read_b128 v[104:107], v16 offset:8192
    ds_read_b128 v[108:111], v16 offset:12288
    ds_read_b64_tr_b16 v[128:129], v40 offset:0
    ds_read_b64_tr_b16 v[130:131], v40 offset:7168
    ds_read_b64_tr_b16 v[132:133], v41 offset:0
    ds_read_b64_tr_b16 v[134:135], v41 offset:7168
    ds_read_b64_tr_b16 v[136:137], v42 offset:0
    ds_read_b64_tr_b16 v[138:139], v42 offset:7168
    ds_read_b64_tr_b16 v[140:141], v43 offset:0
    ds_read_b64_tr_b16 v[142:143], v43 offset:7168
    ds_read_b64_tr_b16 v[144:145], v40 offset:128
    ds_read_b64_tr_b16 v[146:147], v40 offset:7296
    ds_read_b64_tr_b16 v[148:149], v41 offset:128
    ds_read_b64_tr_b16 v[150:151], v41 offset:7296
    ds_read_b64_tr_b16 v[152:153], v42 offset:128
    ds_read_b64_tr_b16 v[154:155], v42 offset:7296
    ds_read_b64_tr_b16 v[156:157], v43 offset:128
    ds_read_b64_tr_b16 v[158:159], v43 offset:7296
    ds_read_b64_tr_b16 v[160:161], v40 offset:256
    ds_read_b64_tr_b16 v[162:163], v40 offset:7424
    ds_read_b64_tr_b16 v[164:165], v41 offset:256
    ds_read_b64_tr_b16 v[166:167], v41 offset:7424
    ds_read_b64_tr_b16 v[168:169], v42 offset:256
    ds_read_b64_tr_b16 v[170:171], v42 offset:7424
    ds_read_b64_tr_b16 v[172:173], v43 offset:256
    ds_read_b64_tr_b16 v[174:175], v43 offset:7424
    ds_read_b64_tr_b16 v[176:177], v40 offset:384
    ds_read_b64_tr_b16 v[178:179], v40 offset:7552
    ds_read_b64_tr_b16 v[180:181], v41 offset:384
    ds_read_b64_tr_b16 v[182:183], v41 offset:7552
    ds_read_b64_tr_b16 v[184:185], v42 offset:384
    ds_read_b64_tr_b16 v[186:187], v42 offset:7552
    ds_read_b64_tr_b16 v[188:189], v43 offset:384
    ds_read_b64_tr_b16 v[190:191], v43 offset:7552
    ds_read_b64_tr_b16 v[192:193], v40 offset:512
    ds_read_b64_tr_b16 v[194:195], v40 offset:7680
    ds_read_b64_tr_b16 v[196:197], v41 offset:512
    ds_read_b64_tr_b16 v[198:199], v41 offset:7680
    ds_read_b64_tr_b16 v[200:201], v42 offset:512
    ds_read_b64_tr_b16 v[202:203], v42 offset:7680
    ds_read_b64_tr_b16 v[204:205], v43 offset:512
    ds_read_b64_tr_b16 v[206:207], v43 offset:7680
    ds_read_b64_tr_b16 v[208:209], v40 offset:640
    ds_read_b64_tr_b16 v[210:211], v40 offset:7808
    s_waitcnt lgkmcnt(14)
    v_mfma_f32_16x16x32_bf16 a[0:3], v[128:131], v[96:99], 0
    ds_read_b64_tr_b16 v[212:213], v41 offset:640
    v_mfma_f32_16x16x32_bf16 a[4:7], v[132:135], v[96:99], 0
    ds_read_b64_tr_b16 v[214:215], v41 offset:7808
    v_mfma_f32_16x16x32_bf16 a[8:11], v[136:139], v[96:99], 0
    ds_read_b64_tr_b16 v[216:217], v42 offset:640
    v_mfma_f32_16x16x32_bf16 a[12:15], v[140:143], v[96:99], 0
    ds_read_b64_tr_b16 v[218:219], v42 offset:7808
    v_mfma_f32_16x16x32_bf16 a[16:19], v[144:147], v[96:99], 0
    ds_read_b64_tr_b16 v[220:221], v43 offset:640
    v_mfma_f32_16x16x32_bf16 a[20:23], v[148:151], v[96:99], 0
    ds_read_b64_tr_b16 v[222:223], v43 offset:7808
    v_mfma_f32_16x16x32_bf16 a[24:27], v[152:155], v[96:99], 0
    ds_read_b64_tr_b16 v[224:225], v40 offset:768
    v_mfma_f32_16x16x32_bf16 a[28:31], v[156:159], v[96:99], 0
    ds_read_b64_tr_b16 v[226:227], v40 offset:7936
    v_mfma_f32_16x16x32_bf16 a[32:35], v[160:163], v[96:99], 0
    ds_read_b64_tr_b16 v[228:229], v41 offset:768
    v_mfma_f32_16x16x32_bf16 a[36:39], v[164:167], v[96:99], 0
    ds_read_b64_tr_b16 v[230:231], v41 offset:7936
    v_mfma_f32_16x16x32_bf16 a[40:43], v[168:171], v[96:99], 0
    ds_read_b64_tr_b16 v[232:233], v42 offset:768
    v_mfma_f32_16x16x32_bf16 a[44:47], v[172:175], v[96:99], 0
    ds_read_b64_tr_b16 v[234:235], v42 offset:7936
    v_mfma_f32_16x16x32_bf16 a[48:51], v[176:179], v[96:99], 0
    ds_read_b64_tr_b16 v[236:237], v43 offset:768
    v_mfma_f32_16x16x32_bf16 a[52:55], v[180:183], v[96:99], 0
    ds_read_b64_tr_b16 v[238:239], v43 offset:7936
    ds_read_b64_tr_b16 v[128:129], v40 offset:28672
    ds_read_b64_tr_b16 v[130:131], v40 offset:35840
    ds_read_b64_tr_b16 v[132:133], v41 offset:28672
    ds_read_b64_tr_b16 v[134:135], v41 offset:35840
    ds_read_b64_tr_b16 v[136:137], v42 offset:28672
    ds_read_b64_tr_b16 v[138:139], v42 offset:35840
    ds_read_b64_tr_b16 v[140:141], v43 offset:28672
    ds_read_b64_tr_b16 v[142:143], v43 offset:35840
    ds_read_b64_tr_b16 v[144:145], v40 offset:28800
    ds_read_b64_tr_b16 v[146:147], v40 offset:35968
    ds_read_b64_tr_b16 v[148:149], v41 offset:28800
    ds_read_b64_tr_b16 v[150:151], v41 offset:35968
    ds_read_b64_tr_b16 v[152:153], v42 offset:28800
    ds_read_b64_tr_b16 v[154:155], v42 offset:35968
    s_waitcnt lgkmcnt(14)
    v_mfma_f32_16x16x32_bf16 a[56:59], v[184:187], v[96:99], 0
    ds_read_b64_tr_b16 v[156:157], v43 offset:28800
    v_mfma_f32_16x16x32_bf16 a[60:63], v[188:191], v[96:99], 0
    ds_read_b64_tr_b16 v[158:159], v43 offset:35968
    v_mfma_f32_16x16x32_bf16 a[64:67], v[192:195], v[96:99], 0
    ds_read_b64_tr_b16 v[160:161], v40 offset:28928
    v_mfma_f32_16x16x32_bf16 a[68:71], v[196:199], v[96:99], 0
    ds_read_b64_tr_b16 v[162:163], v40 offset:36096
    v_mfma_f32_16x16x32_bf16 a[72:75], v[200:203], v[96:99], 0
    ds_read_b64_tr_b16 v[164:165], v41 offset:28928
    v_mfma_f32_16x16x32_bf16 a[76:79], v[204:207], v[96:99], 0
    ds_read_b64_tr_b16 v[166:167], v41 offset:36096
    v_mfma_f32_16x16x32_bf16 a[80:83], v[208:211], v[96:99], 0
    ds_read_b64_tr_b16 v[168:169], v42 offset:28928
    v_mfma_f32_16x16x32_bf16 a[84:87], v[212:215], v[96:99], 0
    ds_read_b64_tr_b16 v[170:171], v42 offset:36096
    v_mfma_f32_16x16x32_bf16 a[88:91], v[216:219], v[96:99], 0
    ds_read_b64_tr_b16 v[172:173], v43 offset:28928
    v_mfma_f32_16x16x32_bf16 a[92:95], v[220:223], v[96:99], 0
    ds_read_b64_tr_b16 v[174:175], v43 offset:36096
    v_mfma_f32_16x16x32_bf16 a[96:99], v[224:227], v[96:99], 0
    ds_read_b64_tr_b16 v[176:177], v40 offset:29056
    v_mfma_f32_16x16x32_bf16 a[100:103], v[228:231], v[96:99], 0
    ds_read_b64_tr_b16 v[178:179], v40 offset:36224
    v_mfma_f32_16x16x32_bf16 a[104:107], v[232:235], v[96:99], 0
    ds_read_b64_tr_b16 v[180:181], v41 offset:29056
    v_mfma_f32_16x16x32_bf16 a[108:111], v[236:239], v[96:99], 0
    ds_read_b64_tr_b16 v[182:183], v41 offset:36224
    ds_read_b64_tr_b16 v[184:185], v42 offset:29056
    ds_read_b64_tr_b16 v[186:187], v42 offset:36224
    ds_read_b64_tr_b16 v[188:189], v43 offset:29056
    ds_read_b64_tr_b16 v[190:191], v43 offset:36224
    ds_read_b64_tr_b16 v[192:193], v40 offset:29184
    ds_read_b64_tr_b16 v[194:195], v40 offset:36352
    ds_read_b64_tr_b16 v[196:197], v41 offset:29184
    ds_read_b64_tr_b16 v[198:199], v41 offset:36352
    ds_read_b64_tr_b16 v[200:201], v42 offset:29184
    ds_read_b64_tr_b16 v[202:203], v42 offset:36352
    ds_read_b64_tr_b16 v[204:205], v43 offset:29184
    ds_read_b64_tr_b16 v[206:207], v43 offset:36352
    ds_read_b64_tr_b16 v[208:209], v40 offset:29312
    ds_read_b64_tr_b16 v[210:211], v40 offset:36480
    s_waitcnt lgkmcnt(14)
    v_mfma_f32_16x16x32_bf16 a[0:3], v[128:131], v[100:103], a[0:3]
    ds_read_b64_tr_b16 v[212:213], v41 offset:29312
    v_mfma_f32_16x16x32_bf16 a[4:7], v[132:135], v[100:103], a[4:7]
    ds_read_b64_tr_b16 v[214:215], v41 offset:36480
    v_mfma_f32_16x16x32_bf16 a[8:11], v[136:139], v[100:103], a[8:11]
    ds_read_b64_tr_b16 v[216:217], v42 offset:29312
    v_mfma_f32_16x16x32_bf16 a[12:15], v[140:143], v[100:103], a[12:15]
    ds_read_b64_tr_b16 v[218:219], v42 offset:36480
    v_mfma_f32_16x16x32_bf16 a[16:19], v[144:147], v[100:103], a[16:19]
    ds_read_b64_tr_b16 v[220:221], v43 offset:29312
    v_mfma_f32_16x16x32_bf16 a[20:23], v[148:151], v[100:103], a[20:23]
    ds_read_b64_tr_b16 v[222:223], v43 offset:36480
    v_mfma_f32_16x16x32_bf16 a[24:27], v[152:155], v[100:103], a[24:27]
    ds_read_b64_tr_b16 v[224:225], v40 offset:29440
    v_mfma_f32_16x16x32_bf16 a[28:31], v[156:159], v[100:103], a[28:31]
    ds_read_b64_tr_b16 v[226:227], v40 offset:36608
    v_mfma_f32_16x16x32_bf16 a[32:35], v[160:163], v[100:103], a[32:35]
    ds_read_b64_tr_b16 v[228:229], v41 offset:29440
    v_mfma_f32_16x16x32_bf16 a[36:39], v[164:167], v[100:103], a[36:39]
    ds_read_b64_tr_b16 v[230:231], v41 offset:36608
    v_mfma_f32_16x16x32_bf16 a[40:43], v[168:171], v[100:103], a[40:43]
    ds_read_b64_tr_b16 v[232:233], v42 offset:29440
    v_mfma_f32_16x16x32_bf16 a[44:47], v[172:175], v[100:103], a[44:47]
    ds_read_b64_tr_b16 v[234:235], v42 offset:36608
    v_mfma_f32_16x16x32_bf16 a[48:51], v[176:179], v[100:103], a[48:51]
    ds_read_b64_tr_b16 v[236:237], v43 offset:29440
    v_mfma_f32_16x16x32_bf16 a[52:55], v[180:183], v[100:103], a[52:55]
    ds_read_b64_tr_b16 v[238:239], v43 offset:36608
    v_add_u32 v40, 57344, v40
    v_add_u32 v41, 57344, v41
    v_add_u32 v42, 57344, v42
    v_add_u32 v43, 57344, v43
    ds_read_b64_tr_b16 v[128:129], v40 offset:0
    ds_read_b64_tr_b16 v[130:131], v40 offset:7168
    ds_read_b64_tr_b16 v[132:133], v41 offset:0
    ds_read_b64_tr_b16 v[134:135], v41 offset:7168
    ds_read_b64_tr_b16 v[136:137], v42 offset:0
    ds_read_b64_tr_b16 v[138:139], v42 offset:7168
    ds_read_b64_tr_b16 v[140:141], v43 offset:0
    ds_read_b64_tr_b16 v[142:143], v43 offset:7168
    ds_read_b64_tr_b16 v[144:145], v40 offset:128
    ds_read_b64_tr_b16 v[146:147], v40 offset:7296
    ds_read_b64_tr_b16 v[148:149], v41 offset:128
    ds_read_b64_tr_b16 v[150:151], v41 offset:7296
    ds_read_b64_tr_b16 v[152:153], v42 offset:128
    ds_read_b64_tr_b16 v[154:155], v42 offset:7296
    s_waitcnt lgkmcnt(14)
    v_mfma_f32_16x16x32_bf16 a[56:59], v[184:187], v[100:103], a[56:59]
    ds_read_b64_tr_b16 v[156:157], v43 offset:128
    v_mfma_f32_16x16x32_bf16 a[60:63], v[188:191], v[100:103], a[60:63]
    ds_read_b64_tr_b16 v[158:159], v43 offset:7296
    v_mfma_f32_16x16x32_bf16 a[64:67], v[192:195], v[100:103], a[64:67]
    ds_read_b64_tr_b16 v[160:161], v40 offset:256
    v_mfma_f32_16x16x32_bf16 a[68:71], v[196:199], v[100:103], a[68:71]
    ds_read_b64_tr_b16 v[162:163], v40 offset:7424
    v_mfma_f32_16x16x32_bf16 a[72:75], v[200:203], v[100:103], a[72:75]
    ds_read_b64_tr_b16 v[164:165], v41 offset:256
    v_mfma_f32_16x16x32_bf16 a[76:79], v[204:207], v[100:103], a[76:79]
    ds_read_b64_tr_b16 v[166:167], v41 offset:7424
    v_mfma_f32_16x16x32_bf16 a[80:83], v[208:211], v[100:103], a[80:83]
    ds_read_b64_tr_b16 v[168:169], v42 offset:256
    v_mfma_f32_16x16x32_bf16 a[84:87], v[212:215], v[100:103], a[84:87]
    ds_read_b64_tr_b16 v[170:171], v42 offset:7424
    v_mfma_f32_16x16x32_bf16 a[88:91], v[216:219], v[100:103], a[88:91]
    ds_read_b64_tr_b16 v[172:173], v43 offset:256
    v_mfma_f32_16x16x32_bf16 a[92:95], v[220:223], v[100:103], a[92:95]
    ds_read_b64_tr_b16 v[174:175], v43 offset:7424
    v_mfma_f32_16x16x32_bf16 a[96:99], v[224:227], v[100:103], a[96:99]
    ds_read_b64_tr_b16 v[176:177], v40 offset:384
    v_mfma_f32_16x16x32_bf16 a[100:103], v[228:231], v[100:103], a[100:103]
    ds_read_b64_tr_b16 v[178:179], v40 offset:7552
    v_mfma_f32_16x16x32_bf16 a[104:107], v[232:235], v[100:103], a[104:107]
    ds_read_b64_tr_b16 v[180:181], v41 offset:384
    v_mfma_f32_16x16x32_bf16 a[108:111], v[236:239], v[100:103], a[108:111]
    ds_read_b64_tr_b16 v[182:183], v41 offset:7552
    ds_read_b64_tr_b16 v[184:185], v42 offset:384
    ds_read_b64_tr_b16 v[186:187], v42 offset:7552
    ds_read_b64_tr_b16 v[188:189], v43 offset:384
    ds_read_b64_tr_b16 v[190:191], v43 offset:7552
    ds_read_b64_tr_b16 v[192:193], v40 offset:512
    ds_read_b64_tr_b16 v[194:195], v40 offset:7680
    ds_read_b64_tr_b16 v[196:197], v41 offset:512
    ds_read_b64_tr_b16 v[198:199], v41 offset:7680
    ds_read_b64_tr_b16 v[200:201], v42 offset:512
    ds_read_b64_tr_b16 v[202:203], v42 offset:7680
    ds_read_b64_tr_b16 v[204:205], v43 offset:512
    ds_read_b64_tr_b16 v[206:207], v43 offset:7680
    ds_read_b64_tr_b16 v[208:209], v40 offset:640
    ds_read_b64_tr_b16 v[210:211], v40 offset:7808
    s_waitcnt lgkmcnt(14)
    v_mfma_f32_16x16x32_bf16 a[0:3], v[128:131], v[104:107], a[0:3]
    ds_read_b64_tr_b16 v[212:213], v41 offset:640
    v_mfma_f32_16x16x32_bf16 a[4:7], v[132:135], v[104:107], a[4:7]
    ds_read_b64_tr_b16 v[214:215], v41 offset:7808
    v_mfma_f32_16x16x32_bf16 a[8:11], v[136:139], v[104:107], a[8:11]
    ds_read_b64_tr_b16 v[216:217], v42 offset:640
    v_mfma_f32_16x16x32_bf16 a[12:15], v[140:143], v[104:107], a[12:15]
    ds_read_b64_tr_b16 v[218:219], v42 offset:7808
    v_mfma_f32_16x16x32_bf16 a[16:19], v[144:147], v[104:107], a[16:19]
    ds_read_b64_tr_b16 v[220:221], v43 offset:640
    v_mfma_f32_16x16x32_bf16 a[20:23], v[148:151], v[104:107], a[20:23]
    ds_read_b64_tr_b16 v[222:223], v43 offset:7808
    v_mfma_f32_16x16x32_bf16 a[24:27], v[152:155], v[104:107], a[24:27]
    ds_read_b64_tr_b16 v[224:225], v40 offset:768
    v_mfma_f32_16x16x32_bf16 a[28:31], v[156:159], v[104:107], a[28:31]
    ds_read_b64_tr_b16 v[226:227], v40 offset:7936
    v_mfma_f32_16x16x32_bf16 a[32:35], v[160:163], v[104:107], a[32:35]
    ds_read_b64_tr_b16 v[228:229], v41 offset:768
    v_mfma_f32_16x16x32_bf16 a[36:39], v[164:167], v[104:107], a[36:39]
    ds_read_b64_tr_b16 v[230:231], v41 offset:7936
    v_mfma_f32_16x16x32_bf16 a[40:43], v[168:171], v[104:107], a[40:43]
    ds_read_b64_tr_b16 v[232:233], v42 offset:768
    v_mfma_f32_16x16x32_bf16 a[44:47], v[172:175], v[104:107], a[44:47]
    ds_read_b64_tr_b16 v[234:235], v42 offset:7936
    v_mfma_f32_16x16x32_bf16 a[48:51], v[176:179], v[104:107], a[48:51]
    ds_read_b64_tr_b16 v[236:237], v43 offset:768
    v_mfma_f32_16x16x32_bf16 a[52:55], v[180:183], v[104:107], a[52:55]
    ds_read_b64_tr_b16 v[238:239], v43 offset:7936
    ds_read_b64_tr_b16 v[128:129], v40 offset:28672
    ds_read_b64_tr_b16 v[130:131], v40 offset:35840
    ds_read_b64_tr_b16 v[132:133], v41 offset:28672
    ds_read_b64_tr_b16 v[134:135], v41 offset:35840
    ds_read_b64_tr_b16 v[136:137], v42 offset:28672
    ds_read_b64_tr_b16 v[138:139], v42 offset:35840
    ds_read_b64_tr_b16 v[140:141], v43 offset:28672
    ds_read_b64_tr_b16 v[142:143], v43 offset:35840
    ds_read_b64_tr_b16 v[144:145], v40 offset:28800
    ds_read_b64_tr_b16 v[146:147], v40 offset:35968
    ds_read_b64_tr_b16 v[148:149], v41 offset:28800
    ds_read_b64_tr_b16 v[150:151], v41 offset:35968
    ds_read_b64_tr_b16 v[152:153], v42 offset:28800
    ds_read_b64_tr_b16 v[154:155], v42 offset:35968
    s_waitcnt lgkmcnt(14)
    v_mfma_f32_16x16x32_bf16 a[56:59], v[184:187], v[104:107], a[56:59]
    ds_read_b64_tr_b16 v[156:157], v43 offset:28800
    v_mfma_f32_16x16x32_bf16 a[60:63], v[188:191], v[104:107], a[60:63]
    ds_read_b64_tr_b16 v[158:159], v43 offset:35968
    v_mfma_f32_16x16x32_bf16 a[64:67], v[192:195], v[104:107], a[64:67]
    ds_read_b64_tr_b16 v[160:161], v40 offset:28928
    v_mfma_f32_16x16x32_bf16 a[68:71], v[196:199], v[104:107], a[68:71]
    ds_read_b64_tr_b16 v[162:163], v40 offset:36096
    v_mfma_f32_16x16x32_bf16 a[72:75], v[200:203], v[104:107], a[72:75]
    ds_read_b64_tr_b16 v[164:165], v41 offset:28928
    v_mfma_f32_16x16x32_bf16 a[76:79], v[204:207], v[104:107], a[76:79]
    ds_read_b64_tr_b16 v[166:167], v41 offset:36096
    v_mfma_f32_16x16x32_bf16 a[80:83], v[208:211], v[104:107], a[80:83]
    ds_read_b64_tr_b16 v[168:169], v42 offset:28928
    v_mfma_f32_16x16x32_bf16 a[84:87], v[212:215], v[104:107], a[84:87]
    ds_read_b64_tr_b16 v[170:171], v42 offset:36096
    v_mfma_f32_16x16x32_bf16 a[88:91], v[216:219], v[104:107], a[88:91]
    ds_read_b64_tr_b16 v[172:173], v43 offset:28928
    v_mfma_f32_16x16x32_bf16 a[92:95], v[220:223], v[104:107], a[92:95]
    ds_read_b64_tr_b16 v[174:175], v43 offset:36096
    v_mfma_f32_16x16x32_bf16 a[96:99], v[224:227], v[104:107], a[96:99]
    ds_read_b64_tr_b16 v[176:177], v40 offset:29056
    v_mfma_f32_16x16x32_bf16 a[100:103], v[228:231], v[104:107], a[100:103]
    ds_read_b64_tr_b16 v[178:179], v40 offset:36224
    v_mfma_f32_16x16x32_bf16 a[104:107], v[232:235], v[104:107], a[104:107]
    ds_read_b64_tr_b16 v[180:181], v41 offset:29056
    v_mfma_f32_16x16x32_bf16 a[108:111], v[236:239], v[104:107], a[108:111]
    ds_read_b64_tr_b16 v[182:183], v41 offset:36224
    ds_read_b64_tr_b16 v[184:185], v42 offset:29056
    ds_read_b64_tr_b16 v[186:187], v42 offset:36224
    ds_read_b64_tr_b16 v[188:189], v43 offset:29056
    ds_read_b64_tr_b16 v[190:191], v43 offset:36224
    ds_read_b64_tr_b16 v[192:193], v40 offset:29184
    ds_read_b64_tr_b16 v[194:195], v40 offset:36352
    ds_read_b64_tr_b16 v[196:197], v41 offset:29184
    ds_read_b64_tr_b16 v[198:199], v41 offset:36352
    ds_read_b64_tr_b16 v[200:201], v42 offset:29184
    ds_read_b64_tr_b16 v[202:203], v42 offset:36352
    ds_read_b64_tr_b16 v[204:205], v43 offset:29184
    ds_read_b64_tr_b16 v[206:207], v43 offset:36352
    ds_read_b64_tr_b16 v[208:209], v40 offset:29312
    ds_read_b64_tr_b16 v[210:211], v40 offset:36480
    s_waitcnt lgkmcnt(14)
    v_mfma_f32_16x16x32_bf16 a[0:3], v[128:131], v[108:111], a[0:3]
    ds_read_b64_tr_b16 v[212:213], v41 offset:29312
    v_mfma_f32_16x16x32_bf16 a[4:7], v[132:135], v[108:111], a[4:7]
    ds_read_b64_tr_b16 v[214:215], v41 offset:36480
    v_mfma_f32_16x16x32_bf16 a[8:11], v[136:139], v[108:111], a[8:11]
    ds_read_b64_tr_b16 v[216:217], v42 offset:29312
    v_mfma_f32_16x16x32_bf16 a[12:15], v[140:143], v[108:111], a[12:15]
    ds_read_b64_tr_b16 v[218:219], v42 offset:36480
    v_mfma_f32_16x16x32_bf16 a[16:19], v[144:147], v[108:111], a[16:19]
    ds_read_b64_tr_b16 v[220:221], v43 offset:29312
    v_mfma_f32_16x16x32_bf16 a[20:23], v[148:151], v[108:111], a[20:23]
    ds_read_b64_tr_b16 v[222:223], v43 offset:36480
    v_mfma_f32_16x16x32_bf16 a[24:27], v[152:155], v[108:111], a[24:27]
    ds_read_b64_tr_b16 v[224:225], v40 offset:29440
    v_mfma_f32_16x16x32_bf16 a[28:31], v[156:159], v[108:111], a[28:31]
    ds_read_b64_tr_b16 v[226:227], v40 offset:36608
    v_mfma_f32_16x16x32_bf16 a[32:35], v[160:163], v[108:111], a[32:35]
    ds_read_b64_tr_b16 v[228:229], v41 offset:29440
    v_mfma_f32_16x16x32_bf16 a[36:39], v[164:167], v[108:111], a[36:39]
    ds_read_b64_tr_b16 v[230:231], v41 offset:36608
    v_mfma_f32_16x16x32_bf16 a[40:43], v[168:171], v[108:111], a[40:43]
    ds_read_b64_tr_b16 v[232:233], v42 offset:29440
    v_mfma_f32_16x16x32_bf16 a[44:47], v[172:175], v[108:111], a[44:47]
    ds_read_b64_tr_b16 v[234:235], v42 offset:36608
    v_mfma_f32_16x16x32_bf16 a[48:51], v[176:179], v[108:111], a[48:51]
    ds_read_b64_tr_b16 v[236:237], v43 offset:29440
    v_mfma_f32_16x16x32_bf16 a[52:55], v[180:183], v[108:111], a[52:55]
    ds_read_b64_tr_b16 v[238:239], v43 offset:36608
    s_waitcnt lgkmcnt(0)
    v_mfma_f32_16x16x32_bf16 a[56:59], v[184:187], v[108:111], a[56:59]
    v_mfma_f32_16x16x32_bf16 a[60:63], v[188:191], v[108:111], a[60:63]
    v_mfma_f32_16x16x32_bf16 a[64:67], v[192:195], v[108:111], a[64:67]
    v_mfma_f32_16x16x32_bf16 a[68:71], v[196:199], v[108:111], a[68:71]
    v_mfma_f32_16x16x32_bf16 a[72:75], v[200:203], v[108:111], a[72:75]
    v_mfma_f32_16x16x32_bf16 a[76:79], v[204:207], v[108:111], a[76:79]
    v_mfma_f32_16x16x32_bf16 a[80:83], v[208:211], v[108:111], a[80:83]
    v_mfma_f32_16x16x32_bf16 a[84:87], v[212:215], v[108:111], a[84:87]
    v_mfma_f32_16x16x32_bf16 a[88:91], v[216:219], v[108:111], a[88:91]
    v_mfma_f32_16x16x32_bf16 a[92:95], v[220:223], v[108:111], a[92:95]
    v_mfma_f32_16x16x32_bf16 a[96:99], v[224:227], v[108:111], a[96:99]
    v_mfma_f32_16x16x32_bf16 a[100:103], v[228:231], v[108:111], a[100:103]
    v_mfma_f32_16x16x32_bf16 a[104:107], v[232:235], v[108:111], a[104:107]
    v_mfma_f32_16x16x32_bf16 a[108:111], v[236:239], v[108:111], a[108:111]
    s_mov_b32 s49, 1
    s_cmp_lg_u32 s48, 0
    s_cbranch_scc1 LPO_44
    s_and_b32 s87, s2, 7
    s_lshl_b32 s87, s87, 5
    v_mov_b32 v5, 1
    v_mov_b32 v47, 0
    s_mov_b64 exec, 1
    buffer_atomic_add v5, v47, s[44:47], s87 offen offset:4 sc0
    s_mov_b64 exec, -1
LPO_44:
    s_nop 7
    v_accvgpr_read_b32 v128, a0
    v_accvgpr_read_b32 v129, a1
    v_accvgpr_read_b32 v130, a2
    v_accvgpr_read_b32 v131, a3
    v_accvgpr_read_b32 v132, a4
    v_accvgpr_read_b32 v133, a5
    v_accvgpr_read_b32 v134, a6
    v_accvgpr_read_b32 v135, a7
    v_cvt_pk_bf16_f32 v136, v128, v129
    v_cvt_pk_bf16_f32 v137, v130, v131
    v_cvt_pk_bf16_f32 v138, v132, v133
    v_cvt_pk_bf16_f32 v139, v134, v135
    s_add_u32 s80, s66, 0
    buffer_store_dwordx4 v[136:139], v1, s[40:43], s80 offen offset:0 sc1
    v_accvgpr_read_b32 v140, a8
    v_accvgpr_read_b32 v141, a9
    v_accvgpr_read_b32 v142, a10
    v_accvgpr_read_b32 v143, a11
    v_accvgpr_read_b32 v144, a12
    v_accvgpr_read_b32 v145, a13
    v_accvgpr_read_b32 v146, a14
    v_accvgpr_read_b32 v147, a15
    v_cvt_pk_bf16_f32 v148, v140, v141
    v_cvt_pk_bf16_f32 v149, v142, v143
    v_cvt_pk_bf16_f32 v150, v144, v145
    v_cvt_pk_bf16_f32 v151, v146, v147
    buffer_store_dwordx4 v[148:151], v1, s[40:43], s80 offen offset:1024 sc1
    v_accvgpr_read_b32 v152, a16
    v_accvgpr_read_b32 v153, a17
    v_accvgpr_read_b32 v154, a18
    v_accvgpr_read_b32 v155, a19
    v_accvgpr_read_b32 v156, a20
    v_accvgpr_read_b32 v157, a21
    v_accvgpr_read_b32 v158, a22
    v_accvgpr_read_b32 v159, a23
    v_cvt_pk_bf16_f32 v160, v152, v153
    v_cvt_pk_bf16_f32 v161, v154, v155
    v_cvt_pk_bf16_f32 v162, v156, v157
    v_cvt_pk_bf16_f32 v163, v158, v159
    buffer_store_dwordx4 v[160:163], v1, s[40:43], s80 offen offset:2048 sc1
    v_accvgpr_read_b32 v164, a24
    v_accvgpr_read_b32 v165, a25
    v_accvgpr_read_b32 v166, a26
    v_accvgpr_read_b32 v167, a27
    v_accvgpr_read_b32 v168, a28
    v_accvgpr_read_b32 v169, a29
    v_accvgpr_read_b32 v170, a30
    v_accvgpr_read_b32 v171, a31
    v_cvt_pk_bf16_f32 v172, v164, v165
    v_cvt_pk_bf16_f32 v173, v166, v167
    v_cvt_pk_bf16_f32 v174, v168, v169
    v_cvt_pk_bf16_f32 v175, v170, v171
    buffer_store_dwordx4 v[172:175], v1, s[40:43], s80 offen offset:3072 sc1
    v_accvgpr_read_b32 v176, a32
    v_accvgpr_read_b32 v177, a33
    v_accvgpr_read_b32 v178, a34
    v_accvgpr_read_b32 v179, a35
    v_accvgpr_read_b32 v180, a36
    v_accvgpr_read_b32 v181, a37
    v_accvgpr_read_b32 v182, a38
    v_accvgpr_read_b32 v183, a39
    v_cvt_pk_bf16_f32 v184, v176, v177
    v_cvt_pk_bf16_f32 v185, v178, v179
    v_cvt_pk_bf16_f32 v186, v180, v181
    v_cvt_pk_bf16_f32 v187, v182, v183
    s_add_u32 s80, s66, 4096
    buffer_store_dwordx4 v[184:187], v1, s[40:43], s80 offen offset:0 sc1
    v_accvgpr_read_b32 v188, a40
    v_accvgpr_read_b32 v189, a41
    v_accvgpr_read_b32 v190, a42
    v_accvgpr_read_b32 v191, a43
    v_accvgpr_read_b32 v192, a44
    v_accvgpr_read_b32 v193, a45
    v_accvgpr_read_b32 v194, a46
    v_accvgpr_read_b32 v195, a47
    v_cvt_pk_bf16_f32 v196, v188, v189
    v_cvt_pk_bf16_f32 v197, v190, v191
    v_cvt_pk_bf16_f32 v198, v192, v193
    v_cvt_pk_bf16_f32 v199, v194, v195
    buffer_store_dwordx4 v[196:199], v1, s[40:43], s80 offen offset:1024 sc1
    v_accvgpr_read_b32 v200, a48
    v_accvgpr_read_b32 v201, a49
    v_accvgpr_read_b32 v202, a50
    v_accvgpr_read_b32 v203, a51
    v_accvgpr_read_b32 v204, a52
    v_accvgpr_read_b32 v205, a53
    v_accvgpr_read_b32 v206, a54
    v_accvgpr_read_b32 v207, a55
    v_cvt_pk_bf16_f32 v208, v200, v201
    v_cvt_pk_bf16_f32 v209, v202, v203
    v_cvt_pk_bf16_f32 v210, v204, v205
    v_cvt_pk_bf16_f32 v211, v206, v207
    buffer_store_dwordx4 v[208:211], v1, s[40:43], s80 offen offset:2048 sc1
    v_accvgpr_read_b32 v212, a56
    v_accvgpr_read_b32 v213, a57
    v_accvgpr_read_b32 v214, a58
    v_accvgpr_read_b32 v215, a59
    v_accvgpr_read_b32 v216, a60
    v_accvgpr_read_b32 v217, a61
    v_accvgpr_read_b32 v218, a62
    v_accvgpr_read_b32 v219, a63
    v_cvt_pk_bf16_f32 v220, v212, v213
    v_cvt_pk_bf16_f32 v221, v214, v215
    v_cvt_pk_bf16_f32 v222, v216, v217
    v_cvt_pk_bf16_f32 v223, v218, v219
    buffer_store_dwordx4 v[220:223], v1, s[40:43], s80 offen offset:3072 sc1
    v_accvgpr_read_b32 v128, a64
    v_accvgpr_read_b32 v129, a65
    v_accvgpr_read_b32 v130, a66
    v_accvgpr_read_b32 v131, a67
    v_accvgpr_read_b32 v132, a68
    v_accvgpr_read_b32 v133, a69
    v_accvgpr_read_b32 v134, a70
    v_accvgpr_read_b32 v135, a71
    v_cvt_pk_bf16_f32 v136, v128, v129
    v_cvt_pk_bf16_f32 v137, v130, v131
    v_cvt_pk_bf16_f32 v138, v132, v133
    v_cvt_pk_bf16_f32 v139, v134, v135
    s_add_u32 s80, s66, 8192
    buffer_store_dwordx4 v[136:139], v1, s[40:43], s80 offen offset:0 sc1
    v_accvgpr_read_b32 v140, a72
    v_accvgpr_read_b32 v141, a73
    v_accvgpr_read_b32 v142, a74
    v_accvgpr_read_b32 v143, a75
    v_accvgpr_read_b32 v144, a76
    v_accvgpr_read_b32 v145, a77
    v_accvgpr_read_b32 v146, a78
    v_accvgpr_read_b32 v147, a79
    v_cvt_pk_bf16_f32 v148, v140, v141
    v_cvt_pk_bf16_f32 v149, v142, v143
    v_cvt_pk_bf16_f32 v150, v144, v145
    v_cvt_pk_bf16_f32 v151, v146, v147
    buffer_store_dwordx4 v[148:151], v1, s[40:43], s80 offen offset:1024 sc1
    v_accvgpr_read_b32 v152, a80
    v_accvgpr_read_b32 v153, a81
    v_accvgpr_read_b32 v154, a82
    v_accvgpr_read_b32 v155, a83
    v_accvgpr_read_b32 v156, a84
    v_accvgpr_read_b32 v157, a85
    v_accvgpr_read_b32 v158, a86
    v_accvgpr_read_b32 v159, a87
    v_cvt_pk_bf16_f32 v160, v152, v153
    v_cvt_pk_bf16_f32 v161, v154, v155
    v_cvt_pk_bf16_f32 v162, v156, v157
    v_cvt_pk_bf16_f32 v163, v158, v159
    buffer_store_dwordx4 v[160:163], v1, s[40:43], s80 offen offset:2048 sc1
    v_accvgpr_read_b32 v164, a88
    v_accvgpr_read_b32 v165, a89
    v_accvgpr_read_b32 v166, a90
    v_accvgpr_read_b32 v167, a91
    v_accvgpr_read_b32 v168, a92
    v_accvgpr_read_b32 v169, a93
    v_accvgpr_read_b32 v170, a94
    v_accvgpr_read_b32 v171, a95
    v_cvt_pk_bf16_f32 v172, v164, v165
    v_cvt_pk_bf16_f32 v173, v166, v167
    v_cvt_pk_bf16_f32 v174, v168, v169
    v_cvt_pk_bf16_f32 v175, v170, v171
    buffer_store_dwordx4 v[172:175], v1, s[40:43], s80 offen offset:3072 sc1
    v_accvgpr_read_b32 v176, a96
    v_accvgpr_read_b32 v177, a97
    v_accvgpr_read_b32 v178, a98
    v_accvgpr_read_b32 v179, a99
    v_accvgpr_read_b32 v180, a100
    v_accvgpr_read_b32 v181, a101
    v_accvgpr_read_b32 v182, a102
    v_accvgpr_read_b32 v183, a103
    v_cvt_pk_bf16_f32 v184, v176, v177
    v_cvt_pk_bf16_f32 v185, v178, v179
    v_cvt_pk_bf16_f32 v186, v180, v181
    v_cvt_pk_bf16_f32 v187, v182, v183
    s_add_u32 s80, s66, 12288
    buffer_store_dwordx4 v[184:187], v1, s[40:43], s80 offen offset:0 sc1
    v_accvgpr_read_b32 v188, a104
    v_accvgpr_read_b32 v189, a105
    v_accvgpr_read_b32 v190, a106
    v_accvgpr_read_b32 v191, a107
    v_accvgpr_read_b32 v192, a108
    v_accvgpr_read_b32 v193, a109
    v_accvgpr_read_b32 v194, a110
    v_accvgpr_read_b32 v195, a111
    v_cvt_pk_bf16_f32 v196, v188, v189
    v_cvt_pk_bf16_f32 v197, v190, v191
    v_cvt_pk_bf16_f32 v198, v192, v193
    v_cvt_pk_bf16_f32 v199, v194, v195
    buffer_store_dwordx4 v[196:199], v1, s[40:43], s80 offen offset:1024 sc1
    s_branch LQ_NEXT
LQ_RED:
    s_mov_b32 s76, 0
    s_mov_b32 s64, 0
    s_sub_u32 s74, s72, 24
    s_cmp_ge_u32 s74, 56
    s_cbranch_scc1 LM_FIN
    s_branch LQ_RLOOP
    s_sub_u32 s72, s72, 24
    s_cmp_ge_u32 s72, 24
    s_cbranch_scc1 LM_FIN
    s_add_u32 s74, s72, 16
    s_cmp_lt_u32 s72, 16
    s_cselect_b32 s74, s72, s74
    s_mov_b32 s64, 0
LQ_RLOOP:
    s_lshl_b32 s80, s74, 3
    s_and_b32 s81, s2, 7
    s_add_u32 s80, s80, s81
    s_mul_i32 s81, s80, 2341
    s_lshr_b32 s81, s81, 16
    s_mul_i32 s82, s81, 28
    s_sub_u32 s82, s80, s82
    s_lshr_b32 s83, s81, 1
    s_and_b32 s81, s81, 1
    s_lshl_b32 s81, s81, 3
    s_add_u32 s81, s81, s83
    s_cmp_eq_u32 s64, 1
    s_cbranch_scc1 LRP_45
    s_lshl_b32 s75, s81, 8
    s_add_u32 s75, s75, 251670528
    v_min_u32 v45, 47, v0
    v_lshlrev_b32 v45, 2, v45
    buffer_load_dword v44, v45, s[40:43], s75 offen sc1
    s_branch LRP_46
LRP_45:
    s_mov_b32 s75, s62
    v_mov_b32 v44, v46
LRP_46:
    s_mul_i32 s83, s82, 37
    s_lshr_b32 s83, s83, 8
    s_mul_i32 s84, s83, 7
    s_sub_u32 s82, s82, s84
    s_lshl_b32 s82, s82, 1
    s_lshl_b32 s81, s81, 3
    s_and_b32 s84, s48, 1
    s_add_u32 s82, s82, s84
    s_lshl_b32 s83, s83, 1
    s_add_u32 s81, s81, s83
    s_lshr_b32 s83, s48, 1
    s_add_u32 s81, s81, s83
    s_mul_i32 s55, s81, 14336
    s_lshl_b32 s83, s82, 10
    s_add_u32 s55, s55, s83
    s_add_u32 s55, s55, 67108864
    s_lshl_b32 s56, s81, 6
    s_add_u32 s56, s56, 252706816
    s_mul_i32 s57, s81, 14336
    s_lshl_b32 s83, s82, 6
    s_add_u32 s57, s57, s83
    s_bfe_u32 s83, s81, 0x40002
    s_mov_b32 s36, s24
    s_mov_b32 s37, s25
    s_mov_b32 s38, 1835008
    s_mov_b32 s39, 0x20000
    v_and_b32 v16, 15, v0
    v_lshrrev_b32 v17, 4, v0
    v_lshlrev_b32 v18, 2, v16
    v_mul_u32_u24 v19, 896, v16
    v_lshl_add_u32 v19, v17, 3, v19
    s_mov_b32 s70, 0x00003f80
    s_mov_b32 s71, 0x3f800000
    s_bfe_u32 s84, s81, 0x10002
    s_lshl_b32 s84, s84, 2
    s_mov_b64 s[52:53], 0
    s_mov_b32 s85, 0x0f0f0f00
    s_cmp_ge_u32 s83, 12
    s_cselect_b32 s85, 0x0f0f0000, s85
    s_cmp_ge_u32 s83, 14
    s_cselect_b32 s53, 0, s85
    s_mov_b32 s73, 65536
    s_cmp_eq_u32 s64, 1
    s_cbranch_scc1 LRA_49
LRL_47:
    s_waitcnt vmcnt(0)
LRA_49:
    v_cmp_eq_u32 vcc, 1, v44
    s_nop 3
    s_and_b32 s60, vcc_lo, 0xffff
    s_lshr_b64 s[58:59], vcc, 16
    s_lshr_b32 s58, s58, s84
    s_and_b32 s61, s58, 0x0f0f0f0f
    s_or_b64 s[58:59], s[52:53], s[60:61]
    s_cmp_eq_u32 s58, 0xffff
    s_cselect_b32 s85, s59, 0
    s_cmp_eq_u32 s85, 0x0f0f0f0f
    s_cbranch_scc1 LRD_51
    s_and_b32 s85, s73, 65535
    s_cbranch_scc1 LRK_50
LRD_51:
    s_andn2_b64 s[58:59], s[60:61], s[52:53]
    s_or_b64 s[52:53], s[52:53], s[60:61]
    s_bitcmp1_b32 s59, 0
    s_cbranch_scc0 LRS_52
    s_add_u32 s85, s55, 0
    buffer_load_dwordx4 v[96:99], v1, s[40:43], s85 offen sc1
LRS_52:
    s_bitcmp1_b32 s59, 1
    s_cbranch_scc0 LRS_53
    s_add_u32 s85, s55, 1835008
    buffer_load_dwordx4 v[100:103], v1, s[40:43], s85 offen sc1
LRS_53:
    s_bitcmp1_b32 s59, 2
    s_cbranch_scc0 LRS_54
    s_add_u32 s85, s55, 3670016
    buffer_load_dwordx4 v[104:107], v1, s[40:43], s85 offen sc1
LRS_54:
    s_bitcmp1_b32 s59, 3
    s_cbranch_scc0 LRS_55
    s_add_u32 s85, s55, 5505024
    buffer_load_dwordx4 v[108:111], v1, s[40:43], s85 offen sc1
LRS_55:
    s_bitcmp1_b32 s58, 0
    s_cbranch_scc0 LRS_56
    s_add_u32 s85, s55, 7340032
    buffer_load_dwordx4 v[112:115], v1, s[40:43], s85 offen sc1
LRS_56:
    s_bitcmp1_b32 s58, 1
    s_cbranch_scc0 LRS_57
    s_add_u32 s85, s55, 9175040
    buffer_load_dwordx4 v[116:119], v1, s[40:43], s85 offen sc1
LRS_57:
    s_bitcmp1_b32 s58, 2
    s_cbranch_scc0 LRS_58
    s_add_u32 s85, s55, 11010048
    buffer_load_dwordx4 v[120:123], v1, s[40:43], s85 offen sc1
LRS_58:
    s_bitcmp1_b32 s58, 3
    s_cbranch_scc0 LRS_59
    s_add_u32 s85, s55, 12845056
    buffer_load_dwordx4 v[124:127], v1, s[40:43], s85 offen sc1
LRS_59:
    s_bitcmp1_b32 s58, 4
    s_cbranch_scc0 LRS_60
    s_add_u32 s85, s55, 14680064
    buffer_load_dwordx4 v[128:131], v1, s[40:43], s85 offen sc1
LRS_60:
    s_bitcmp1_b32 s58, 5
    s_cbranch_scc0 LRS_61
    s_add_u32 s85, s55, 16515072
    buffer_load_dwordx4 v[132:135], v1, s[40:43], s85 offen sc1
LRS_61:
    s_bitcmp1_b32 s58, 6
    s_cbranch_scc0 LRS_62
    s_add_u32 s85, s55, 18350080
    buffer_load_dwordx4 v[136:139], v1, s[40:43], s85 offen sc1
LRS_62:
    s_bitcmp1_b32 s58, 7
    s_cbranch_scc0 LRS_63
    s_add_u32 s85, s55, 20185088
    buffer_load_dwordx4 v[140:143], v1, s[40:43], s85 offen sc1
LRS_63:
    s_bitcmp1_b32 s58, 8
    s_cbranch_scc0 LRS_64
    s_add_u32 s85, s55, 22020096
    buffer_load_dwordx4 v[144:147], v1, s[40:43], s85 offen sc1
LRS_64:
    s_bitcmp1_b32 s58, 9
    s_cbranch_scc0 LRS_65
    s_add_u32 s85, s55, 23855104
    buffer_load_dwordx4 v[148:151], v1, s[40:43], s85 offen sc1
LRS_65:
    s_bitcmp1_b32 s58, 10
    s_cbranch_scc0 LRS_66
    s_add_u32 s85, s55, 25690112
    buffer_load_dwordx4 v[152:155], v1, s[40:43], s85 offen sc1
LRS_66:
    s_bitcmp1_b32 s58, 11
    s_cbranch_scc0 LRS_67
    s_add_u32 s85, s55, 27525120
    buffer_load_dwordx4 v[156:159], v1, s[40:43], s85 offen sc1
LRS_67:
    s_bitcmp1_b32 s58, 12
    s_cbranch_scc0 LRS_68
    s_add_u32 s85, s55, 29360128
    buffer_load_dwordx4 v[160:163], v1, s[40:43], s85 offen sc1
LRS_68:
    s_bitcmp1_b32 s58, 13
    s_cbranch_scc0 LRS_69
    s_add_u32 s85, s55, 31195136
    buffer_load_dwordx4 v[164:167], v1, s[40:43], s85 offen sc1
LRS_69:
    s_bitcmp1_b32 s58, 14
    s_cbranch_scc0 LRS_70
    s_add_u32 s85, s55, 33030144
    buffer_load_dwordx4 v[168:171], v1, s[40:43], s85 offen sc1
LRS_70:
    s_bitcmp1_b32 s58, 15
    s_cbranch_scc0 LRS_71
    s_add_u32 s85, s55, 34865152
    buffer_load_dwordx4 v[172:175], v1, s[40:43], s85 offen sc1
LRS_71:
    s_bitcmp1_b32 s59, 8
    s_cbranch_scc0 LRS_72
    s_add_u32 s85, s55, 36700160
    buffer_load_dwordx4 v[176:179], v1, s[40:43], s85 offen sc1
LRS_72:
    s_bitcmp1_b32 s59, 9
    s_cbranch_scc0 LRS_73
    s_add_u32 s85, s55, 38535168
    buffer_load_dwordx4 v[180:183], v1, s[40:43], s85 offen sc1
LRS_73:
    s_bitcmp1_b32 s59, 10
    s_cbranch_scc0 LRS_74
    s_add_u32 s85, s55, 40370176
    buffer_load_dwordx4 v[184:187], v1, s[40:43], s85 offen sc1
LRS_74:
    s_bitcmp1_b32 s59, 11
    s_cbranch_scc0 LRS_75
    s_add_u32 s85, s55, 42205184
    buffer_load_dwordx4 v[188:191], v1, s[40:43], s85 offen sc1
LRS_75:
    s_bitcmp1_b32 s59, 16
    s_cbranch_scc0 LRS_76
    s_add_u32 s85, s55, 44040192
    buffer_load_dwordx4 v[192:195], v1, s[40:43], s85 offen sc1
LRS_76:
    s_bitcmp1_b32 s59, 17
    s_cbranch_scc0 LRS_77
    s_add_u32 s85, s55, 45875200
    buffer_load_dwordx4 v[196:199], v1, s[40:43], s85 offen sc1
LRS_77:
    s_bitcmp1_b32 s59, 18
    s_cbranch_scc0 LRS_78
    s_add_u32 s85, s55, 47710208
    buffer_load_dwordx4 v[200:203], v1, s[40:43], s85 offen sc1
LRS_78:
    s_bitcmp1_b32 s59, 19
    s_cbranch_scc0 LRS_79
    s_add_u32 s85, s55, 49545216
    buffer_load_dwordx4 v[204:207], v1, s[40:43], s85 offen sc1
LRS_79:
    s_bitcmp1_b32 s59, 24
    s_cbranch_scc0 LRS_80
    s_add_u32 s85, s55, 51380224
    buffer_load_dwordx4 v[208:211], v1, s[40:43], s85 offen sc1
LRS_80:
    s_bitcmp1_b32 s59, 25
    s_cbranch_scc0 LRS_81
    s_add_u32 s85, s55, 53215232
    buffer_load_dwordx4 v[212:215], v1, s[40:43], s85 offen sc1
LRS_81:
    s_bitcmp1_b32 s59, 26
    s_cbranch_scc0 LRS_82
    s_add_u32 s85, s55, 55050240
    buffer_load_dwordx4 v[216:219], v1, s[40:43], s85 offen sc1
LRS_82:
    s_bitcmp1_b32 s59, 27
    s_cbranch_scc0 LRS_83
    s_add_u32 s85, s55, 56885248
    buffer_load_dwordx4 v[220:223], v1, s[40:43], s85 offen sc1
LRS_83:
    s_cmp_eq_u32 s52, 0xffff
    s_cselect_b32 s85, s53, 0
    s_cmp_eq_u32 s85, 0x0f0f0f0f
    s_cbranch_scc1 LRF_48
LRK_50:
    s_sub_u32 s73, s73, 1
    s_cmp_eq_u32 s73, 0
    s_cbranch_scc1 LRF_48
    s_sleep 8
    buffer_load_dword v44, v45, s[40:43], s75 offen sc1
    s_branch LRL_47
LRF_48:
    buffer_load_dword v20, v18, s[40:43], s56 offen sc1
    s_mov_b32 s49, 1
    s_cmp_lg_u32 s48, 0
    s_cbranch_scc1 LPO_84
    s_and_b32 s87, s2, 7
    s_lshl_b32 s87, s87, 5
    v_mov_b32 v5, 1
    v_mov_b32 v47, 0
    s_mov_b64 exec, 1
    buffer_atomic_add v5, v47, s[44:47], s87 offen offset:4 sc0
    s_mov_b64 exec, -1
LPO_84:
    s_waitcnt vmcnt(0)
    v_sub_f32 v21, 1.0, v20
    v_cvt_pk_bf16_f32 v21, v21, v21
    v_lshlrev_b32 v21, 16, v21
    v_dot2_f32_bf16 v64, v96, s70, 0
    v_dot2_f32_bf16 v65, v96, s71, 0
    v_dot2_f32_bf16 v66, v97, s70, 0
    v_dot2_f32_bf16 v67, v97, s71, 0
    v_dot2_f32_bf16 v68, v98, s70, 0
    v_dot2_f32_bf16 v69, v98, s71, 0
    v_dot2_f32_bf16 v70, v99, s70, 0
    v_dot2_f32_bf16 v71, v99, s71, 0
    v_dot2_f32_bf16 v64, v100, s70, v64
    v_dot2_f32_bf16 v65, v100, s71, v65
    v_dot2_f32_bf16 v66, v101, s70, v66
    v_dot2_f32_bf16 v67, v101, s71, v67
    v_dot2_f32_bf16 v68, v102, s70, v68
    v_dot2_f32_bf16 v69, v102, s71, v69
    v_dot2_f32_bf16 v70, v103, s70, v70
    v_dot2_f32_bf16 v71, v103, s71, v71
    v_dot2_f32_bf16 v64, v104, s70, v64
    v_dot2_f32_bf16 v65, v104, s71, v65
    v_dot2_f32_bf16 v66, v105, s70, v66
    v_dot2_f32_bf16 v67, v105, s71, v67
    v_dot2_f32_bf16 v68, v106, s70, v68
    v_dot2_f32_bf16 v69, v106, s71, v69
    v_dot2_f32_bf16 v70, v107, s70, v70
    v_dot2_f32_bf16 v71, v107, s71, v71
    v_dot2_f32_bf16 v64, v108, s70, v64
    v_dot2_f32_bf16 v65, v108, s71, v65
    v_dot2_f32_bf16 v66, v109, s70, v66
    v_dot2_f32_bf16 v67, v109, s71, v67
    v_dot2_f32_bf16 v68, v110, s70, v68
    v_dot2_f32_bf16 v69, v110, s71, v69
    v_dot2_f32_bf16 v70, v111, s70, v70
    v_dot2_f32_bf16 v71, v111, s71, v71
    v_dot2_f32_bf16 v72, v112, s70, 0
    v_dot2_f32_bf16 v73, v112, s71, 0
    v_dot2_f32_bf16 v74, v113, s70, 0
    v_dot2_f32_bf16 v75, v113, s71, 0
    v_dot2_f32_bf16 v76, v114, s70, 0
    v_dot2_f32_bf16 v77, v114, s71, 0
    v_dot2_f32_bf16 v78, v115, s70, 0
    v_dot2_f32_bf16 v79, v115, s71, 0
    v_dot2_f32_bf16 v72, v116, s70, v72
    v_dot2_f32_bf16 v73, v116, s71, v73
    v_dot2_f32_bf16 v74, v117, s70, v74
    v_dot2_f32_bf16 v75, v117, s71, v75
    v_dot2_f32_bf16 v76, v118, s70, v76
    v_dot2_f32_bf16 v77, v118, s71, v77
    v_dot2_f32_bf16 v78, v119, s70, v78
    v_dot2_f32_bf16 v79, v119, s71, v79
    v_dot2_f32_bf16 v72, v120, s70, v72
    v_dot2_f32_bf16 v73, v120, s71, v73
    v_dot2_f32_bf16 v74, v121, s70, v74
    v_dot2_f32_bf16 v75, v121, s71, v75
    v_dot2_f32_bf16 v76, v122, s70, v76
    v_dot2_f32_bf16 v77, v122, s71, v77
    v_dot2_f32_bf16 v78, v123, s70, v78
    v_dot2_f32_bf16 v79, v123, s71, v79
    v_dot2_f32_bf16 v72, v124, s70, v72
    v_dot2_f32_bf16 v73, v124, s71, v73
    v_dot2_f32_bf16 v74, v125, s70, v74
    v_dot2_f32_bf16 v75, v125, s71, v75
    v_dot2_f32_bf16 v76, v126, s70, v76
    v_dot2_f32_bf16 v77, v126, s71, v77
    v_dot2_f32_bf16 v78, v127, s70, v78
    v_dot2_f32_bf16 v79, v127, s71, v79
    v_dot2_f32_bf16 v72, v128, s70, v72
    v_dot2_f32_bf16 v73, v128, s71, v73
    v_dot2_f32_bf16 v74, v129, s70, v74
    v_dot2_f32_bf16 v75, v129, s71, v75
    v_dot2_f32_bf16 v76, v130, s70, v76
    v_dot2_f32_bf16 v77, v130, s71, v77
    v_dot2_f32_bf16 v78, v131, s70, v78
    v_dot2_f32_bf16 v79, v131, s71, v79
    v_dot2_f32_bf16 v72, v132, s70, v72
    v_dot2_f32_bf16 v73, v132, s71, v73
    v_dot2_f32_bf16 v74, v133, s70, v74
    v_dot2_f32_bf16 v75, v133, s71, v75
    v_dot2_f32_bf16 v76, v134, s70, v76
    v_dot2_f32_bf16 v77, v134, s71, v77
    v_dot2_f32_bf16 v78, v135, s70, v78
    v_dot2_f32_bf16 v79, v135, s71, v79
    v_dot2_f32_bf16 v72, v136, s70, v72
    v_dot2_f32_bf16 v73, v136, s71, v73
    v_dot2_f32_bf16 v74, v137, s70, v74
    v_dot2_f32_bf16 v75, v137, s71, v75
    v_dot2_f32_bf16 v76, v138, s70, v76
    v_dot2_f32_bf16 v77, v138, s71, v77
    v_dot2_f32_bf16 v78, v139, s70, v78
    v_dot2_f32_bf16 v79, v139, s71, v79
    v_dot2_f32_bf16 v72, v140, s70, v72
    v_dot2_f32_bf16 v73, v140, s71, v73
    v_dot2_f32_bf16 v74, v141, s70, v74
    v_dot2_f32_bf16 v75, v141, s71, v75
    v_dot2_f32_bf16 v76, v142, s70, v76
    v_dot2_f32_bf16 v77, v142, s71, v77
    v_dot2_f32_bf16 v78, v143, s70, v78
    v_dot2_f32_bf16 v79, v143, s71, v79
    v_dot2_f32_bf16 v72, v144, s70, v72
    v_dot2_f32_bf16 v73, v144, s71, v73
    v_dot2_f32_bf16 v74, v145, s70, v74
    v_dot2_f32_bf16 v75, v145, s71, v75
    v_dot2_f32_bf16 v76, v146, s70, v76
    v_dot2_f32_bf16 v77, v146, s71, v77
    v_dot2_f32_bf16 v78, v147, s70, v78
    v_dot2_f32_bf16 v79, v147, s71, v79
    v_dot2_f32_bf16 v72, v148, s70, v72
    v_dot2_f32_bf16 v73, v148, s71, v73
    v_dot2_f32_bf16 v74, v149, s70, v74
    v_dot2_f32_bf16 v75, v149, s71, v75
    v_dot2_f32_bf16 v76, v150, s70, v76
    v_dot2_f32_bf16 v77, v150, s71, v77
    v_dot2_f32_bf16 v78, v151, s70, v78
    v_dot2_f32_bf16 v79, v151, s71, v79
    v_dot2_f32_bf16 v72, v152, s70, v72
    v_dot2_f32_bf16 v73, v152, s71, v73
    v_dot2_f32_bf16 v74, v153, s70, v74
    v_dot2_f32_bf16 v75, v153, s71, v75
    v_dot2_f32_bf16 v76, v154, s70, v76
    v_dot2_f32_bf16 v77, v154, s71, v77
    v_dot2_f32_bf16 v78, v155, s70, v78
    v_dot2_f32_bf16 v79, v155, s71, v79
    v_dot2_f32_bf16 v72, v156, s70, v72
    v_dot2_f32_bf16 v73, v156, s71, v73
    v_dot2_f32_bf16 v74, v157, s70, v74
    v_dot2_f32_bf16 v75, v157, s71, v75
    v_dot2_f32_bf16 v76, v158, s70, v76
    v_dot2_f32_bf16 v77, v158, s71, v77
    v_dot2_f32_bf16 v78, v159, s70, v78
    v_dot2_f32_bf16 v79, v159, s71, v79
    v_dot2_f32_bf16 v72, v160, s70, v72
    v_dot2_f32_bf16 v73, v160, s71, v73
    v_dot2_f32_bf16 v74, v161, s70, v74
    v_dot2_f32_bf16 v75, v161, s71, v75
    v_dot2_f32_bf16 v76, v162, s70, v76
    v_dot2_f32_bf16 v77, v162, s71, v77
    v_dot2_f32_bf16 v78, v163, s70, v78
    v_dot2_f32_bf16 v79, v163, s71, v79
    v_dot2_f32_bf16 v72, v164, s70, v72
    v_dot2_f32_bf16 v73, v164, s71, v73
    v_dot2_f32_bf16 v74, v165, s70, v74
    v_dot2_f32_bf16 v75, v165, s71, v75
    v_dot2_f32_bf16 v76, v166, s70, v76
    v_dot2_f32_bf16 v77, v166, s71, v77
    v_dot2_f32_bf16 v78, v167, s70, v78
    v_dot2_f32_bf16 v79, v167, s71, v79
    v_dot2_f32_bf16 v72, v168, s70, v72
    v_dot2_f32_bf16 v73, v168, s71, v73
    v_dot2_f32_bf16 v74, v169, s70, v74
    v_dot2_f32_bf16 v75, v169, s71, v75
    v_dot2_f32_bf16 v76, v170, s70, v76
    v_dot2_f32_bf16 v77, v170, s71, v77
    v_dot2_f32_bf16 v78, v171, s70, v78
    v_dot2_f32_bf16 v79, v171, s71, v79
    v_dot2_f32_bf16 v72, v172, s70, v72
    v_dot2_f32_bf16 v73, v172, s71, v73
    v_dot2_f32_bf16 v74, v173, s70, v74
    v_dot2_f32_bf16 v75, v173, s71, v75
    v_dot2_f32_bf16 v76, v174, s70, v76
    v_dot2_f32_bf16 v77, v174, s71, v77
    v_dot2_f32_bf16 v78, v175, s70, v78
    v_dot2_f32_bf16 v79, v175, s71, v79
    s_cmp_lt_u32 s83, 12
    s_cbranch_scc1 LRU_85
    v_dot2_f32_bf16 v64, v176, s70, v64
    v_dot2_f32_bf16 v65, v176, s71, v65
    v_dot2_f32_bf16 v66, v177, s70, v66
    v_dot2_f32_bf16 v67, v177, s71, v67
    v_dot2_f32_bf16 v68, v178, s70, v68
    v_dot2_f32_bf16 v69, v178, s71, v69
    v_dot2_f32_bf16 v70, v179, s70, v70
    v_dot2_f32_bf16 v71, v179, s71, v71
    v_dot2_f32_bf16 v64, v180, s70, v64
    v_dot2_f32_bf16 v65, v180, s71, v65
    v_dot2_f32_bf16 v66, v181, s70, v66
    v_dot2_f32_bf16 v67, v181, s71, v67
    v_dot2_f32_bf16 v68, v182, s70, v68
    v_dot2_f32_bf16 v69, v182, s71, v69
    v_dot2_f32_bf16 v70, v183, s70, v70
    v_dot2_f32_bf16 v71, v183, s71, v71
    v_dot2_f32_bf16 v64, v184, s70, v64
    v_dot2_f32_bf16 v65, v184, s71, v65
    v_dot2_f32_bf16 v66, v185, s70, v66
    v_dot2_f32_bf16 v67, v185, s71, v67
    v_dot2_f32_bf16 v68, v186, s70, v68
    v_dot2_f32_bf16 v69, v186, s71, v69
    v_dot2_f32_bf16 v70, v187, s70, v70
    v_dot2_f32_bf16 v71, v187, s71, v71
    v_dot2_f32_bf16 v64, v188, s70, v64
    v_dot2_f32_bf16 v65, v188, s71, v65
    v_dot2_f32_bf16 v66, v189, s70, v66
    v_dot2_f32_bf16 v67, v189, s71, v67
    v_dot2_f32_bf16 v68, v190, s70, v68
    v_dot2_f32_bf16 v69, v190, s71, v69
    v_dot2_f32_bf16 v70, v191, s70, v70
    v_dot2_f32_bf16 v71, v191, s71, v71
    s_cmp_lt_u32 s83, 14
    s_cbranch_scc1 LRU_85
    v_dot2_f32_bf16 v64, v192, s70, v64
    v_dot2_f32_bf16 v65, v192, s71, v65
    v_dot2_f32_bf16 v66, v193, s70, v66
    v_dot2_f32_bf16 v67, v193, s71, v67
    v_dot2_f32_bf16 v68, v194, s70, v68
    v_dot2_f32_bf16 v69, v194, s71, v69
    v_dot2_f32_bf16 v70, v195, s70, v70
    v_dot2_f32_bf16 v71, v195, s71, v71
    v_dot2_f32_bf16 v64, v196, s70, v64
    v_dot2_f32_bf16 v65, v196, s71, v65
    v_dot2_f32_bf16 v66, v197, s70, v66
    v_dot2_f32_bf16 v67, v197, s71, v67
    v_dot2_f32_bf16 v68, v198, s70, v68
    v_dot2_f32_bf16 v69, v198, s71, v69
    v_dot2_f32_bf16 v70, v199, s70, v70
    v_dot2_f32_bf16 v71, v199, s71, v71
    v_dot2_f32_bf16 v64, v200, s70, v64
    v_dot2_f32_bf16 v65, v200, s71, v65
    v_dot2_f32_bf16 v66, v201, s70, v66
    v_dot2_f32_bf16 v67, v201, s71, v67
    v_dot2_f32_bf16 v68, v202, s70, v68
    v_dot2_f32_bf16 v69, v202, s71, v69
    v_dot2_f32_bf16 v70, v203, s70, v70
    v_dot2_f32_bf16 v71, v203, s71, v71
    v_dot2_f32_bf16 v64, v204, s70, v64
    v_dot2_f32_bf16 v65, v204, s71, v65
    v_dot2_f32_bf16 v66, v205, s70, v66
    v_dot2_f32_bf16 v67, v205, s71, v67
    v_dot2_f32_bf16 v68, v206, s70, v68
    v_dot2_f32_bf16 v69, v206, s71, v69
    v_dot2_f32_bf16 v70, v207, s70, v70
    v_dot2_f32_bf16 v71, v207, s71, v71
    v_dot2_f32_bf16 v64, v208, s70, v64
    v_dot2_f32_bf16 v65, v208, s71, v65
    v_dot2_f32_bf16 v66, v209, s70, v66
    v_dot2_f32_bf16 v67, v209, s71, v67
    v_dot2_f32_bf16 v68, v210, s70, v68
    v_dot2_f32_bf16 v69, v210, s71, v69
    v_dot2_f32_bf16 v70, v211, s70, v70
    v_dot2_f32_bf16 v71, v211, s71, v71
    v_dot2_f32_bf16 v64, v212, s70, v64
    v_dot2_f32_bf16 v65, v212, s71, v65
    v_dot2_f32_bf16 v66, v213, s70, v66
    v_dot2_f32_bf16 v67, v213, s71, v67
    v_dot2_f32_bf16 v68, v214, s70, v68
    v_dot2_f32_bf16 v69, v214, s71, v69
    v_dot2_f32_bf16 v70, v215, s70, v70
    v_dot2_f32_bf16 v71, v215, s71, v71
    v_dot2_f32_bf16 v64, v216, s70, v64
    v_dot2_f32_bf16 v65, v216, s71, v65
    v_dot2_f32_bf16 v66, v217, s70, v66
    v_dot2_f32_bf16 v67, v217, s71, v67
    v_dot2_f32_bf16 v68, v218, s70, v68
    v_dot2_f32_bf16 v69, v218, s71, v69
    v_dot2_f32_bf16 v70, v219, s70, v70
    v_dot2_f32_bf16 v71, v219, s71, v71
    v_dot2_f32_bf16 v64, v220, s70, v64
    v_dot2_f32_bf16 v65, v220, s71, v65
    v_dot2_f32_bf16 v66, v221, s70, v66
    v_dot2_f32_bf16 v67, v221, s71, v67
    v_dot2_f32_bf16 v68, v222, s70, v68
    v_dot2_f32_bf16 v69, v222, s71, v69
    v_dot2_f32_bf16 v70, v223, s70, v70
    v_dot2_f32_bf16 v71, v223, s71, v71
LRU_85:
    s_nop 3
    v_cvt_pk_bf16_f32 v22, v64, v65
    v_lshlrev_b32 v64, 16, v22
    v_and_b32 v65, 0xffff0000, v22
    v_mul_f32 v64, v20, v64
    v_mul_f32 v65, v20, v65
    v_cvt_pk_bf16_f32 v22, v64, v65
    v_lshlrev_b32 v64, 16, v22
    v_and_b32 v65, 0xffff0000, v22
    v_cvt_pk_bf16_f32 v22, v72, v73
    v_lshlrev_b32 v72, 16, v22
    v_and_b32 v73, 0xffff0000, v22
    v_mul_f32 v72, v21, v72
    v_mul_f32 v73, v21, v73
    v_cvt_pk_bf16_f32 v22, v72, v73
    v_lshlrev_b32 v72, 16, v22
    v_and_b32 v73, 0xffff0000, v22
    v_add_f32 v64, v64, v72
    v_add_f32 v65, v65, v73
    v_cvt_pk_bf16_f32 v48, v64, v65
    v_cvt_pk_bf16_f32 v22, v66, v67
    v_lshlrev_b32 v66, 16, v22
    v_and_b32 v67, 0xffff0000, v22
    v_mul_f32 v66, v20, v66
    v_mul_f32 v67, v20, v67
    v_cvt_pk_bf16_f32 v22, v66, v67
    v_lshlrev_b32 v66, 16, v22
    v_and_b32 v67, 0xffff0000, v22
    v_cvt_pk_bf16_f32 v22, v74, v75
    v_lshlrev_b32 v74, 16, v22
    v_and_b32 v75, 0xffff0000, v22
    v_mul_f32 v74, v21, v74
    v_mul_f32 v75, v21, v75
    v_cvt_pk_bf16_f32 v22, v74, v75
    v_lshlrev_b32 v74, 16, v22
    v_and_b32 v75, 0xffff0000, v22
    v_add_f32 v66, v66, v74
    v_add_f32 v67, v67, v75
    v_cvt_pk_bf16_f32 v49, v66, v67
    v_cvt_pk_bf16_f32 v22, v68, v69
    v_lshlrev_b32 v68, 16, v22
    v_and_b32 v69, 0xffff0000, v22
    v_mul_f32 v68, v20, v68
    v_mul_f32 v69, v20, v69
    v_cvt_pk_bf16_f32 v22, v68, v69
    v_lshlrev_b32 v68, 16, v22
    v_and_b32 v69, 0xffff0000, v22
    v_cvt_pk_bf16_f32 v22, v76, v77
    v_lshlrev_b32 v76, 16, v22
    v_and_b32 v77, 0xffff0000, v22
    v_mul_f32 v76, v21, v76
    v_mul_f32 v77, v21, v77
    v_cvt_pk_bf16_f32 v22, v76, v77
    v_lshlrev_b32 v76, 16, v22
    v_and_b32 v77, 0xffff0000, v22
    v_add_f32 v68, v68, v76
    v_add_f32 v69, v69, v77
    v_cvt_pk_bf16_f32 v50, v68, v69
    v_cvt_pk_bf16_f32 v22, v70, v71
    v_lshlrev_b32 v70, 16, v22
    v_and_b32 v71, 0xffff0000, v22
    v_mul_f32 v70, v20, v70
    v_mul_f32 v71, v20, v71
    v_cvt_pk_bf16_f32 v22, v70, v71
    v_lshlrev_b32 v70, 16, v22
    v_and_b32 v71, 0xffff0000, v22
    v_cvt_pk_bf16_f32 v22, v78, v79
    v_lshlrev_b32 v78, 16, v22
    v_and_b32 v79, 0xffff0000, v22
    v_mul_f32 v78, v21, v78
    v_mul_f32 v79, v21, v79
    v_cvt_pk_bf16_f32 v22, v78, v79
    v_lshlrev_b32 v78, 16, v22
    v_and_b32 v79, 0xffff0000, v22
    v_add_f32 v70, v70, v78
    v_add_f32 v71, v71, v79
    v_cvt_pk_bf16_f32 v51, v70, v71
    buffer_store_dwordx2 v[48:49], v19, s[36:39], s57 offen offset:0
    buffer_store_dwordx2 v[50:51], v19, s[36:39], s57 offen offset:32
    s_branch LQ_NEXT
    s_cmp_ge_u32 s74, 32
    s_cbranch_scc1 LM_FIN
    s_mov_b32 s74, s63
    s_branch LQ_RLOOP
LA_REDO:
    s_waitcnt vmcnt(0)
    s_lshr_b32 s63, 16, s52
    s_lshr_b32 s85, 131072, s52
    s_sub_u32 s85, s85, 2048
    s_sub_u32 s55, s57, s85
    s_sub_u32 s56, s58, s85
    buffer_load_dwordx4 a[16:19], v1, s[40:43], s55 offen offset:0 sc1
    buffer_load_dwordx4 a[20:23], v1, s[40:43], s55 offen offset:1024 sc1
    s_add_u32 s55, s55, 2048
    s_min_u32 s55, s55, s57
    buffer_load_dwordx4 a[24:27], v1, s[40:43], s55 offen offset:0 sc1
    buffer_load_dwordx4 a[28:31], v1, s[40:43], s55 offen offset:1024 sc1
    s_add_u32 s55, s55, 2048
    s_min_u32 s55, s55, s57
    buffer_load_dwordx4 a[32:35], v1, s[40:43], s55 offen offset:0 sc1
    buffer_load_dwordx4 a[36:39], v1, s[40:43], s55 offen offset:1024 sc1
    s_add_u32 s55, s55, 2048
    s_min_u32 s55, s55, s57
    buffer_load_dwordx4 a[48:51], v1, s[40:43], s56 offen offset:0 sc1
    buffer_load_dwordx4 a[52:55], v1, s[40:43], s56 offen offset:1024 sc1
    s_add_u32 s56, s56, 2048
    s_min_u32 s56, s56, s58
    buffer_load_dwordx4 a[40:43], v1, s[40:43], s55 offen offset:0 sc1
    buffer_load_dwordx4 a[44:47], v1, s[40:43], s55 offen offset:1024 sc1
    s_add_u32 s55, s55, 2048
    s_min_u32 s55, s55, s57
    buffer_load_dwordx4 a[56:59], v1, s[40:43], s56 offen offset:0 sc1
    buffer_load_dwordx4 a[60:63], v1, s[40:43], s56 offen offset:1024 sc1
    s_add_u32 s56, s56, 2048
    s_min_u32 s56, s56, s58
    s_mov_b32 s62, 0xff800000
    s_mov_b32 s64, 1
    v_mov_b32 v128, 0
    v_mov_b32 v160, 0
    v_mov_b32 v96, 0
    v_mov_b32 v129, 0
    v_mov_b32 v161, 0
    v_mov_b32 v97, 0
    v_mov_b32 v130, 0
    v_mov_b32 v162, 0
    v_mov_b32 v98, 0
    v_mov_b32 v131, 0
    v_mov_b32 v163, 0
    v_mov_b32 v99, 0
    v_mov_b32 v132, 0
    v_mov_b32 v164, 0
    v_mov_b32 v100, 0
    v_mov_b32 v133, 0
    v_mov_b32 v165, 0
    v_mov_b32 v101, 0
    v_mov_b32 v134, 0
    v_mov_b32 v166, 0
    v_mov_b32 v102, 0
    v_mov_b32 v135, 0
    v_mov_b32 v167, 0
    v_mov_b32 v103, 0
    v_mov_b32 v136, 0
    v_mov_b32 v168, 0
    v_mov_b32 v104, 0
    v_mov_b32 v137, 0
    v_mov_b32 v169, 0
    v_mov_b32 v105, 0
    v_mov_b32 v138, 0
    v_mov_b32 v170, 0
    v_mov_b32 v106, 0
    v_mov_b32 v139, 0
    v_mov_b32 v171, 0
    v_mov_b32 v107, 0
    v_mov_b32 v140, 0
    v_mov_b32 v172, 0
    v_mov_b32 v108, 0
    v_mov_b32 v141, 0
    v_mov_b32 v173, 0
    v_mov_b32 v109, 0
    v_mov_b32 v142, 0
    v_mov_b32 v174, 0
    v_mov_b32 v110, 0
    v_mov_b32 v143, 0
    v_mov_b32 v175, 0
    v_mov_b32 v111, 0
    v_mov_b32 v144, 0
    v_mov_b32 v176, 0
    v_mov_b32 v112, 0
    v_mov_b32 v145, 0
    v_mov_b32 v177, 0
    v_mov_b32 v113, 0
    v_mov_b32 v146, 0
    v_mov_b32 v178, 0
    v_mov_b32 v114, 0
    v_mov_b32 v147, 0
    v_mov_b32 v179, 0
    v_mov_b32 v115, 0
    v_mov_b32 v148, 0
    v_mov_b32 v180, 0
    v_mov_b32 v116, 0
    v_mov_b32 v149, 0
    v_mov_b32 v181, 0
    v_mov_b32 v117, 0
    v_mov_b32 v150, 0
    v_mov_b32 v182, 0
    v_mov_b32 v118, 0
    v_mov_b32 v151, 0
    v_mov_b32 v183, 0
    v_mov_b32 v119, 0
    v_mov_b32 v152, 0
    v_mov_b32 v184, 0
    v_mov_b32 v120, 0
    v_mov_b32 v153, 0
    v_mov_b32 v185, 0
    v_mov_b32 v121, 0
    v_mov_b32 v154, 0
    v_mov_b32 v186, 0
    v_mov_b32 v122, 0
    v_mov_b32 v155, 0
    v_mov_b32 v187, 0
    v_mov_b32 v123, 0
    v_mov_b32 v156, 0
    v_mov_b32 v188, 0
    v_mov_b32 v124, 0
    v_mov_b32 v157, 0
    v_mov_b32 v189, 0
    v_mov_b32 v125, 0
    v_mov_b32 v158, 0
    v_mov_b32 v190, 0
    v_mov_b32 v126, 0
    v_mov_b32 v159, 0
    v_mov_b32 v191, 0
    v_mov_b32 v127, 0
    v_mov_b32 v208, 0
    v_mov_b32 v209, 0
    v_mov_b32 v210, 0
    v_mov_b32 v211, 0
    v_mov_b32 v212, 0
    v_mov_b32 v213, 0
    v_mov_b32 v214, 0
    v_mov_b32 v215, 0
    v_mov_b32 v216, 0
    v_mov_b32 v217, 0
    v_mov_b32 v218, 0
    v_mov_b32 v219, 0
    v_mov_b32 v220, 0
    v_mov_b32 v221, 0
    v_mov_b32 v222, 0
    v_mov_b32 v223, 0
    v_accvgpr_write_b32 a72, 0
    v_accvgpr_write_b32 a73, 0
    v_accvgpr_write_b32 a74, 0
    v_accvgpr_write_b32 a75, 0
    v_accvgpr_write_b32 a76, 0
    v_accvgpr_write_b32 a77, 0
    v_accvgpr_write_b32 a78, 0
    v_accvgpr_write_b32 a79, 0
    s_waitcnt vmcnt(10)
    v_mfma_f32_32x32x16_bf16 v[64:79], a[16:19], a[0:3], v[128:143]
    v_mfma_f32_32x32x16_bf16 v[80:95], a[16:19], a[8:11], v[144:159]
    v_mfma_f32_32x32x16_bf16 v[64:79], a[20:23], a[4:7], v[64:79]
    v_mfma_f32_32x32x16_bf16 v[80:95], a[20:23], a[12:15], v[80:95]
    buffer_load_dwordx4 a[16:19], v1, s[40:43], s55 offen offset:0 sc1
    buffer_load_dwordx4 a[20:23], v1, s[40:43], s55 offen offset:1024 sc1
    s_add_u32 s55, s55, 2048
    s_min_u32 s55, s55, s57
    buffer_load_dwordx4 a[64:67], v1, s[40:43], s56 offen offset:0 sc1
    buffer_load_dwordx4 a[68:71], v1, s[40:43], s56 offen offset:1024 sc1
    s_add_u32 s56, s56, 2048
    s_min_u32 s56, s56, s58
    s_call_b64 s[60:61], LA_RARE0
LA_LOOP:
    s_waitcnt vmcnt(12)
    v_mfma_f32_32x32x16_bf16 v[96:111], a[24:27], a[0:3], v[128:143]
    v_exp_f32 v224, v64
    v_exp_f32 v225, v65
    v_exp_f32 v226, v66
    v_exp_f32 v227, v67
    v_exp_f32 v228, v68
    v_cvt_pk_bf16_f32 v192, v224, v225
    v_exp_f32 v229, v69
    v_mfma_f32_32x32x16_bf16 v[112:127], a[24:27], a[8:11], v[144:159]
    v_exp_f32 v230, v70
    v_cvt_pk_bf16_f32 v193, v226, v227
    v_exp_f32 v231, v71
    v_exp_f32 v232, v72
    v_cvt_pk_bf16_f32 v194, v228, v229
    v_exp_f32 v233, v73
    v_or_b32 v14, v192, v193
    v_mfma_f32_32x32x16_bf16 v[96:111], a[28:31], a[4:7], v[96:111]
    v_exp_f32 v234, v74
    v_cvt_pk_bf16_f32 v195, v230, v231
    v_exp_f32 v235, v75
    v_exp_f32 v236, v76
    v_cvt_pk_bf16_f32 v196, v232, v233
    v_exp_f32 v237, v77
    v_or3_b32 v14, v14, v194, v195
    v_mfma_f32_32x32x16_bf16 v[112:127], a[28:31], a[12:15], v[112:127]
    buffer_load_dwordx4 a[24:27], v1, s[40:43], s55 offen offset:0 sc1
    v_exp_f32 v238, v78
    v_cvt_pk_bf16_f32 v197, v234, v235
    v_exp_f32 v239, v79
    v_exp_f32 v224, v80
    v_cvt_pk_bf16_f32 v198, v236, v237
    v_exp_f32 v225, v81
    v_or3_b32 v14, v14, v196, v197
    v_exp_f32 v226, v82
    v_mfma_f32_32x32x16_bf16 v[160:175], a[72:75], v[208:211], v[160:175]
    buffer_load_dwordx4 a[28:31], v1, s[40:43], s55 offen offset:1024 sc1
    v_cvt_pk_bf16_f32 v199, v238, v239
    v_exp_f32 v227, v83
    v_exp_f32 v228, v84
    v_cvt_pk_bf16_f32 v200, v224, v225
    v_exp_f32 v229, v85
    v_or3_b32 v14, v14, v198, v199
    v_exp_f32 v230, v86
    v_mfma_f32_32x32x16_bf16 v[176:191], a[72:75], v[216:219], v[176:191]
    s_add_u32 s55, s55, 2048
    v_cvt_pk_bf16_f32 v201, v226, v227
    v_exp_f32 v231, v87
    v_exp_f32 v232, v88
    v_cvt_pk_bf16_f32 v202, v228, v229
    v_exp_f32 v233, v89
    v_or3_b32 v14, v14, v200, v201
    v_exp_f32 v234, v90
    v_mfma_f32_32x32x16_bf16 v[160:175], a[76:79], v[212:215], v[160:175]
    s_min_u32 s55, s55, s57
    v_cvt_pk_bf16_f32 v203, v230, v231
    v_exp_f32 v235, v91
    v_exp_f32 v236, v92
    v_cvt_pk_bf16_f32 v204, v232, v233
    v_exp_f32 v237, v93
    v_or3_b32 v14, v14, v202, v203
    v_exp_f32 v238, v94
    v_cvt_pk_bf16_f32 v205, v234, v235
    v_mfma_f32_32x32x16_bf16 v[176:191], a[76:79], v[220:223], v[176:191]
    buffer_load_dwordx4 a[72:75], v1, s[40:43], s56 offen offset:0 sc1
    v_exp_f32 v239, v95
    v_cvt_pk_bf16_f32 v206, v236, v237
    v_or3_b32 v14, v14, v204, v205
    v_cvt_pk_bf16_f32 v207, v238, v239
    buffer_load_dwordx4 a[76:79], v1, s[40:43], s56 offen offset:1024 sc1
    v_or3_b32 v14, v14, v206, v207
    v_and_b32 v14, s67, v14
    s_add_u32 s56, s56, 2048
    v_cmp_ne_u32 vcc, 0, v14
    s_min_u32 s56, s56, s58
    s_cbranch_vccnz LR_86
LR_87:
    s_waitcnt vmcnt(12)
    v_mfma_f32_32x32x16_bf16 v[64:79], a[32:35], a[0:3], v[128:143]
    v_exp_f32 v224, v96
    v_exp_f32 v225, v97
    v_exp_f32 v226, v98
    v_exp_f32 v227, v99
    v_exp_f32 v228, v100
    v_cvt_pk_bf16_f32 v208, v224, v225
    v_exp_f32 v229, v101
    v_mfma_f32_32x32x16_bf16 v[80:95], a[32:35], a[8:11], v[144:159]
    v_exp_f32 v230, v102
    v_cvt_pk_bf16_f32 v209, v226, v227
    v_exp_f32 v231, v103
    v_exp_f32 v232, v104
    v_cvt_pk_bf16_f32 v210, v228, v229
    v_exp_f32 v233, v105
    v_or_b32 v14, v208, v209
    v_mfma_f32_32x32x16_bf16 v[64:79], a[36:39], a[4:7], v[64:79]
    v_exp_f32 v234, v106
    v_cvt_pk_bf16_f32 v211, v230, v231
    v_exp_f32 v235, v107
    v_exp_f32 v236, v108
    v_cvt_pk_bf16_f32 v212, v232, v233
    v_exp_f32 v237, v109
    v_or3_b32 v14, v14, v210, v211
    v_mfma_f32_32x32x16_bf16 v[80:95], a[36:39], a[12:15], v[80:95]
    buffer_load_dwordx4 a[32:35], v1, s[40:43], s55 offen offset:0 sc1
    v_exp_f32 v238, v110
    v_cvt_pk_bf16_f32 v213, v234, v235
    v_exp_f32 v239, v111
    v_exp_f32 v224, v112
    v_cvt_pk_bf16_f32 v214, v236, v237
    v_exp_f32 v225, v113
    v_or3_b32 v14, v14, v212, v213
    v_exp_f32 v226, v114
    v_mfma_f32_32x32x16_bf16 v[160:175], a[48:51], v[192:195], v[160:175]
    buffer_load_dwordx4 a[36:39], v1, s[40:43], s55 offen offset:1024 sc1
    v_cvt_pk_bf16_f32 v215, v238, v239
    v_exp_f32 v227, v115
    v_exp_f32 v228, v116
    v_cvt_pk_bf16_f32 v216, v224, v225
    v_exp_f32 v229, v117
    v_or3_b32 v14, v14, v214, v215
    v_exp_f32 v230, v118
    v_mfma_f32_32x32x16_bf16 v[176:191], a[48:51], v[200:203], v[176:191]
    s_add_u32 s55, s55, 2048
    v_cvt_pk_bf16_f32 v217, v226, v227
    v_exp_f32 v231, v119
    v_exp_f32 v232, v120
    v_cvt_pk_bf16_f32 v218, v228, v229
    v_exp_f32 v233, v121
    v_or3_b32 v14, v14, v216, v217
    v_exp_f32 v234, v122
    v_mfma_f32_32x32x16_bf16 v[160:175], a[52:55], v[196:199], v[160:175]
    s_min_u32 s55, s55, s57
    v_cvt_pk_bf16_f32 v219, v230, v231
    v_exp_f32 v235, v123
    v_exp_f32 v236, v124
    v_cvt_pk_bf16_f32 v220, v232, v233
    v_exp_f32 v237, v125
    v_or3_b32 v14, v14, v218, v219
    v_exp_f32 v238, v126
    v_cvt_pk_bf16_f32 v221, v234, v235
    v_mfma_f32_32x32x16_bf16 v[176:191], a[52:55], v[204:207], v[176:191]
    buffer_load_dwordx4 a[48:51], v1, s[40:43], s56 offen offset:0 sc1
    v_exp_f32 v239, v127
    v_cvt_pk_bf16_f32 v222, v236, v237
    v_or3_b32 v14, v14, v220, v221
    v_cvt_pk_bf16_f32 v223, v238, v239
    buffer_load_dwordx4 a[52:55], v1, s[40:43], s56 offen offset:1024 sc1
    v_or3_b32 v14, v14, v222, v223
    v_and_b32 v14, s67, v14
    s_add_u32 s56, s56, 2048
    v_cmp_ne_u32 vcc, 0, v14
    s_min_u32 s56, s56, s58
    s_cbranch_vccnz LR_88
LR_89:
    s_waitcnt vmcnt(12)
    v_mfma_f32_32x32x16_bf16 v[96:111], a[40:43], a[0:3], v[128:143]
    v_exp_f32 v224, v64
    v_exp_f32 v225, v65
    v_exp_f32 v226, v66
    v_exp_f32 v227, v67
    v_exp_f32 v228, v68
    v_cvt_pk_bf16_f32 v192, v224, v225
    v_exp_f32 v229, v69
    v_mfma_f32_32x32x16_bf16 v[112:127], a[40:43], a[8:11], v[144:159]
    v_exp_f32 v230, v70
    v_cvt_pk_bf16_f32 v193, v226, v227
    v_exp_f32 v231, v71
    v_exp_f32 v232, v72
    v_cvt_pk_bf16_f32 v194, v228, v229
    v_exp_f32 v233, v73
    v_or_b32 v14, v192, v193
    v_mfma_f32_32x32x16_bf16 v[96:111], a[44:47], a[4:7], v[96:111]
    v_exp_f32 v234, v74
    v_cvt_pk_bf16_f32 v195, v230, v231
    v_exp_f32 v235, v75
    v_exp_f32 v236, v76
    v_cvt_pk_bf16_f32 v196, v232, v233
    v_exp_f32 v237, v77
    v_or3_b32 v14, v14, v194, v195
    v_mfma_f32_32x32x16_bf16 v[112:127], a[44:47], a[12:15], v[112:127]
    buffer_load_dwordx4 a[40:43], v1, s[40:43], s55 offen offset:0 sc1
    v_exp_f32 v238, v78
    v_cvt_pk_bf16_f32 v197, v234, v235
    v_exp_f32 v239, v79
    v_exp_f32 v224, v80
    v_cvt_pk_bf16_f32 v198, v236, v237
    v_exp_f32 v225, v81
    v_or3_b32 v14, v14, v196, v197
    v_exp_f32 v226, v82
    v_mfma_f32_32x32x16_bf16 v[160:175], a[56:59], v[208:211], v[160:175]
    buffer_load_dwordx4 a[44:47], v1, s[40:43], s55 offen offset:1024 sc1
    v_cvt_pk_bf16_f32 v199, v238, v239
    v_exp_f32 v227, v83
    v_exp_f32 v228, v84
    v_cvt_pk_bf16_f32 v200, v224, v225
    v_exp_f32 v229, v85
    v_or3_b32 v14, v14, v198, v199
    v_exp_f32 v230, v86
    v_mfma_f32_32x32x16_bf16 v[176:191], a[56:59], v[216:219], v[176:191]
    s_add_u32 s55, s55, 2048
    v_cvt_pk_bf16_f32 v201, v226, v227
    v_exp_f32 v231, v87
    v_exp_f32 v232, v88
    v_cvt_pk_bf16_f32 v202, v228, v229
    v_exp_f32 v233, v89
    v_or3_b32 v14, v14, v200, v201
    v_exp_f32 v234, v90
    v_mfma_f32_32x32x16_bf16 v[160:175], a[60:63], v[212:215], v[160:175]
    s_min_u32 s55, s55, s57
    v_cvt_pk_bf16_f32 v203, v230, v231
    v_exp_f32 v235, v91
    v_exp_f32 v236, v92
    v_cvt_pk_bf16_f32 v204, v232, v233
    v_exp_f32 v237, v93
    v_or3_b32 v14, v14, v202, v203
    v_exp_f32 v238, v94
    v_cvt_pk_bf16_f32 v205, v234, v235
    v_mfma_f32_32x32x16_bf16 v[176:191], a[60:63], v[220:223], v[176:191]
    buffer_load_dwordx4 a[56:59], v1, s[40:43], s56 offen offset:0 sc1
    v_exp_f32 v239, v95
    v_cvt_pk_bf16_f32 v206, v236, v237
    v_or3_b32 v14, v14, v204, v205
    v_cvt_pk_bf16_f32 v207, v238, v239
    buffer_load_dwordx4 a[60:63], v1, s[40:43], s56 offen offset:1024 sc1
    v_or3_b32 v14, v14, v206, v207
    v_and_b32 v14, s67, v14
    s_add_u32 s56, s56, 2048
    v_cmp_ne_u32 vcc, 0, v14
    s_min_u32 s56, s56, s58
    s_cbranch_vccnz LR_90
LR_91:
    s_waitcnt vmcnt(12)
    v_mfma_f32_32x32x16_bf16 v[64:79], a[16:19], a[0:3], v[128:143]
    v_exp_f32 v224, v96
    v_exp_f32 v225, v97
    v_exp_f32 v226, v98
    v_exp_f32 v227, v99
    v_exp_f32 v228, v100
    v_cvt_pk_bf16_f32 v208, v224, v225
    v_exp_f32 v229, v101
    v_mfma_f32_32x32x16_bf16 v[80:95], a[16:19], a[8:11], v[144:159]
    v_exp_f32 v230, v102
    v_cvt_pk_bf16_f32 v209, v226, v227
    v_exp_f32 v231, v103
    v_exp_f32 v232, v104
    v_cvt_pk_bf16_f32 v210, v228, v229
    v_exp_f32 v233, v105
    v_or_b32 v14, v208, v209
    v_mfma_f32_32x32x16_bf16 v[64:79], a[20:23], a[4:7], v[64:79]
    v_exp_f32 v234, v106
    v_cvt_pk_bf16_f32 v211, v230, v231
    v_exp_f32 v235, v107
    v_exp_f32 v236, v108
    v_cvt_pk_bf16_f32 v212, v232, v233
    v_exp_f32 v237, v109
    v_or3_b32 v14, v14, v210, v211
    v_mfma_f32_32x32x16_bf16 v[80:95], a[20:23], a[12:15], v[80:95]
    buffer_load_dwordx4 a[16:19], v1, s[40:43], s55 offen offset:0 sc1
    v_exp_f32 v238, v110
    v_cvt_pk_bf16_f32 v213, v234, v235
    v_exp_f32 v239, v111
    v_exp_f32 v224, v112
    v_cvt_pk_bf16_f32 v214, v236, v237
    v_exp_f32 v225, v113
    v_or3_b32 v14, v14, v212, v213
    v_exp_f32 v226, v114
    v_mfma_f32_32x32x16_bf16 v[160:175], a[64:67], v[192:195], v[160:175]
    buffer_load_dwordx4 a[20:23], v1, s[40:43], s55 offen offset:1024 sc1
    v_cvt_pk_bf16_f32 v215, v238, v239
    v_exp_f32 v227, v115
    v_exp_f32 v228, v116
    v_cvt_pk_bf16_f32 v216, v224, v225
    v_exp_f32 v229, v117
    v_or3_b32 v14, v14, v214, v215
    v_exp_f32 v230, v118
    v_mfma_f32_32x32x16_bf16 v[176:191], a[64:67], v[200:203], v[176:191]
    s_add_u32 s55, s55, 2048
    v_cvt_pk_bf16_f32 v217, v226, v227
    v_exp_f32 v231, v119
    v_exp_f32 v232, v120
    v_cvt_pk_bf16_f32 v218, v228, v229
    v_exp_f32 v233, v121
    v_or3_b32 v14, v14, v216, v217
    v_exp_f32 v234, v122
    v_mfma_f32_32x32x16_bf16 v[160:175], a[68:71], v[196:199], v[160:175]
    s_min_u32 s55, s55, s57
    v_cvt_pk_bf16_f32 v219, v230, v231
    v_exp_f32 v235, v123
    v_exp_f32 v236, v124
    v_cvt_pk_bf16_f32 v220, v232, v233
    v_exp_f32 v237, v125
    v_or3_b32 v14, v14, v218, v219
    v_exp_f32 v238, v126
    v_cvt_pk_bf16_f32 v221, v234, v235
    v_mfma_f32_32x32x16_bf16 v[176:191], a[68:71], v[204:207], v[176:191]
    buffer_load_dwordx4 a[64:67], v1, s[40:43], s56 offen offset:0 sc1
    v_exp_f32 v239, v127
    v_cvt_pk_bf16_f32 v222, v236, v237
    v_or3_b32 v14, v14, v220, v221
    v_cvt_pk_bf16_f32 v223, v238, v239
    buffer_load_dwordx4 a[68:71], v1, s[40:43], s56 offen offset:1024 sc1
    v_or3_b32 v14, v14, v222, v223
    v_and_b32 v14, s67, v14
    s_add_u32 s56, s56, 2048
    v_cmp_ne_u32 vcc, 0, v14
    s_min_u32 s56, s56, s58
    s_cbranch_vccnz LR_92
LR_93:
    s_sub_u32 s63, s63, 1
    s_cmp_lg_u32 s63, 0
    s_cbranch_scc1 LA_LOOP
    s_waitcnt vmcnt(12)
    v_mfma_f32_32x32x16_bf16 v[160:175], a[72:75], v[208:211], v[160:175]
    v_mfma_f32_32x32x16_bf16 v[176:191], a[72:75], v[216:219], v[176:191]
    v_mfma_f32_32x32x16_bf16 v[160:175], a[76:79], v[212:215], v[160:175]
    v_mfma_f32_32x32x16_bf16 v[176:191], a[76:79], v[220:223], v[176:191]
    s_branch LA_EPI
LC_9:
    s_sub_u32 s82, s53, s54
    s_lshl_b32 s82, s82, 1
    s_add_u32 s83, s82, 1
    s_cmp_gt_u32 s82, s48
    s_cselect_b32 s84, 0xff800000, 0
    s_cmp_eq_u32 s82, s48
    s_cselect_b32 s85, -1, 0
    s_cmp_gt_u32 s83, s48
    s_cselect_b32 s86, 0xff800000, 0
    s_cmp_eq_u32 s83, s48
    s_cselect_b32 s87, -1, 0
    v_add_f32 v25, s84, v6
    v_and_b32 v96, s85, v10
    v_and_b32 v97, s85, v11
    v_and_b32 v98, s85, v12
    v_and_b32 v99, s85, v13
    v_add_f32 v96, v96, v25
    v_add_f32 v97, v97, v25
    v_add_f32 v98, v98, v25
    v_add_f32 v99, v99, v25
    v_add_f32 v26, s86, v6
    v_and_b32 v104, s87, v10
    v_and_b32 v105, s87, v11
    v_and_b32 v106, s87, v12
    v_and_b32 v107, s87, v13
    v_add_f32 v104, v104, v26
    v_add_f32 v105, v105, v26
    v_add_f32 v106, v106, v26
    v_add_f32 v107, v107, v26
    s_branch LC_10
LC_13:
    s_sub_u32 s82, s53, s54
    s_lshl_b32 s82, s82, 1
    s_add_u32 s83, s82, 1
    s_cmp_gt_u32 s82, s48
    s_cselect_b32 s84, 0xff800000, 0
    s_cmp_eq_u32 s82, s48
    s_cselect_b32 s85, -1, 0
    s_cmp_gt_u32 s83, s48
    s_cselect_b32 s86, 0xff800000, 0
    s_cmp_eq_u32 s83, s48
    s_cselect_b32 s87, -1, 0
    v_add_f32 v25, s84, v6
    v_and_b32 v96, s85, v10
    v_and_b32 v97, s85, v11
    v_and_b32 v98, s85, v12
    v_and_b32 v99, s85, v13
    v_add_f32 v96, v96, v25
    v_add_f32 v97, v97, v25
    v_add_f32 v98, v98, v25
    v_add_f32 v99, v99, v25
    v_add_f32 v26, s86, v6
    v_and_b32 v104, s87, v10
    v_and_b32 v105, s87, v11
    v_and_b32 v106, s87, v12
    v_and_b32 v107, s87, v13
    v_add_f32 v104, v104, v26
    v_add_f32 v105, v105, v26
    v_add_f32 v106, v106, v26
    v_add_f32 v107, v107, v26
    s_branch LC_14
LC_17:
    s_sub_u32 s82, s53, s54
    s_lshl_b32 s82, s82, 1
    s_add_u32 s83, s82, 1
    s_cmp_gt_u32 s82, s48
    s_cselect_b32 s84, 0xff800000, 0
    s_cmp_eq_u32 s82, s48
    s_cselect_b32 s85, -1, 0
    s_cmp_gt_u32 s83, s48
    s_cselect_b32 s86, 0xff800000, 0
    s_cmp_eq_u32 s83, s48
    s_cselect_b32 s87, -1, 0
    v_add_f32 v25, s84, v6
    v_and_b32 v96, s85, v10
    v_and_b32 v97, s85, v11
    v_and_b32 v98, s85, v12
    v_and_b32 v99, s85, v13
    v_add_f32 v96, v96, v25
    v_add_f32 v97, v97, v25
    v_add_f32 v98, v98, v25
    v_add_f32 v99, v99, v25
    v_add_f32 v26, s86, v6
    v_and_b32 v104, s87, v10
    v_and_b32 v105, s87, v11
    v_and_b32 v106, s87, v12
    v_and_b32 v107, s87, v13
    v_add_f32 v104, v104, v26
    v_add_f32 v105, v105, v26
    v_add_f32 v106, v106, v26
    v_add_f32 v107, v107, v26
    s_branch LC_18
LR_19:
    s_call_b64 s[60:61], LB_RARE1
    s_branch LR_20
LC_21:
    s_sub_u32 s82, s53, s54
    s_lshl_b32 s82, s82, 1
    s_add_u32 s83, s82, 1
    s_cmp_gt_u32 s82, s48
    s_cselect_b32 s84, 0xff800000, 0
    s_cmp_eq_u32 s82, s48
    s_cselect_b32 s85, -1, 0
    s_cmp_gt_u32 s83, s48
    s_cselect_b32 s86, 0xff800000, 0
    s_cmp_eq_u32 s83, s48
    s_cselect_b32 s87, -1, 0
    v_add_f32 v25, s84, v6
    v_and_b32 v96, s85, v10
    v_and_b32 v97, s85, v11
    v_and_b32 v98, s85, v12
    v_and_b32 v99, s85, v13
    v_add_f32 v96, v96, v25
    v_add_f32 v97, v97, v25
    v_add_f32 v98, v98, v25
    v_add_f32 v99, v99, v25
    v_add_f32 v26, s86, v6
    v_and_b32 v104, s87, v10
    v_and_b32 v105, s87, v11
    v_and_b32 v106, s87, v12
    v_and_b32 v107, s87, v13
    v_add_f32 v104, v104, v26
    v_add_f32 v105, v105, v26
    v_add_f32 v106, v106, v26
    v_add_f32 v107, v107, v26
    s_branch LC_22
LR_23:
    s_call_b64 s[60:61], LB_RARE0
    s_branch LR_24
LR_27:
    s_call_b64 s[60:61], LB_RARE1
    s_branch LR_28
LR_29:
    v_mov_b32 v64, 0xff800000
    v_mov_b32 v65, 0xff800000
    v_mov_b32 v66, 0xff800000
    v_mov_b32 v67, 0xff800000
    v_mov_b32 v72, 0xff800000
    v_mov_b32 v73, 0xff800000
    v_mov_b32 v74, 0xff800000
    v_mov_b32 v75, 0xff800000
    s_call_b64 s[60:61], LB_RARE0
    s_branch LR_30
LR_31:
    v_mov_b32 v80, 0xff800000
    v_mov_b32 v81, 0xff800000
    v_mov_b32 v82, 0xff800000
    v_mov_b32 v83, 0xff800000
    v_mov_b32 v88, 0xff800000
    v_mov_b32 v89, 0xff800000
    v_mov_b32 v90, 0xff800000
    v_mov_b32 v91, 0xff800000
    s_call_b64 s[60:61], LB_RARE1
    s_branch LR_32
LR_86:
    s_call_b64 s[60:61], LA_RARE0
    s_branch LR_87
LR_88:
    s_call_b64 s[60:61], LA_RARE1
    s_branch LR_89
LR_90:
    s_call_b64 s[60:61], LA_RARE0
    s_branch LR_91
LR_92:
    s_call_b64 s[60:61], LA_RARE1
    s_branch LR_93
LB_RARE0:
    s_nop 7
    s_nop 7
    v_max3_f32 v16, v64, v65, v66
    v_max3_f32 v16, v16, v67, v72
    v_max3_f32 v16, v16, v73, v74
    v_max_f32 v16, v16, v75
    v_mov_b32 v20, v16
    s_nop 1
    v_permlane32_swap_b32 v20, v16
    s_nop 1
    v_max_f32 v16, v16, v20
    v_mov_b32 v20, v16
    s_nop 1
    v_permlane16_swap_b32 v20, v16
    s_nop 1
    v_max_f32 v16, v16, v20
    v_add_f32 v16, 0x42000000, v16
    v_max_f32 v16, s62, v16
    v_max_f32 v18, 0, v16
    v_exp_f32 v18, -v18
    v_sub_f32 v64, v64, v16
    v_sub_f32 v80, v80, v16
    v_sub_f32 v96, v96, v16
    v_sub_f32 v65, v65, v16
    v_sub_f32 v81, v81, v16
    v_sub_f32 v97, v97, v16
    v_sub_f32 v66, v66, v16
    v_sub_f32 v82, v82, v16
    v_sub_f32 v98, v98, v16
    v_sub_f32 v67, v67, v16
    v_sub_f32 v83, v83, v16
    v_sub_f32 v99, v99, v16
    v_sub_f32 v72, v72, v16
    v_sub_f32 v88, v88, v16
    v_sub_f32 v104, v104, v16
    v_sub_f32 v73, v73, v16
    v_sub_f32 v89, v89, v16
    v_sub_f32 v105, v105, v16
    v_sub_f32 v74, v74, v16
    v_sub_f32 v90, v90, v16
    v_sub_f32 v106, v106, v16
    v_sub_f32 v75, v75, v16
    v_sub_f32 v91, v91, v16
    v_sub_f32 v107, v107, v16
    v_sub_f32 v6, v6, v16
    v_mul_f32 v8, v8, v18
    v_max3_f32 v17, v68, v69, v70
    v_max3_f32 v17, v17, v71, v76
    v_max3_f32 v17, v17, v77, v78
    v_max_f32 v17, v17, v79
    v_mov_b32 v20, v17
    s_nop 1
    v_permlane32_swap_b32 v20, v17
    s_nop 1
    v_max_f32 v17, v17, v20
    v_mov_b32 v20, v17
    s_nop 1
    v_permlane16_swap_b32 v20, v17
    s_nop 1
    v_max_f32 v17, v17, v20
    v_add_f32 v17, 0x42000000, v17
    v_max_f32 v17, s62, v17
    v_max_f32 v19, 0, v17
    v_exp_f32 v19, -v19
    v_sub_f32 v68, v68, v17
    v_sub_f32 v84, v84, v17
    v_sub_f32 v100, v100, v17
    v_sub_f32 v69, v69, v17
    v_sub_f32 v85, v85, v17
    v_sub_f32 v101, v101, v17
    v_sub_f32 v70, v70, v17
    v_sub_f32 v86, v86, v17
    v_sub_f32 v102, v102, v17
    v_sub_f32 v71, v71, v17
    v_sub_f32 v87, v87, v17
    v_sub_f32 v103, v103, v17
    v_sub_f32 v76, v76, v17
    v_sub_f32 v92, v92, v17
    v_sub_f32 v108, v108, v17
    v_sub_f32 v77, v77, v17
    v_sub_f32 v93, v93, v17
    v_sub_f32 v109, v109, v17
    v_sub_f32 v78, v78, v17
    v_sub_f32 v94, v94, v17
    v_sub_f32 v110, v110, v17
    v_sub_f32 v79, v79, v17
    v_sub_f32 v95, v95, v17
    v_sub_f32 v111, v111, v17
    v_sub_f32 v7, v7, v17
    v_mul_f32 v9, v9, v19
    s_cmp_eq_u32 s64, 1
    s_cbranch_scc1 LRS_94
    v_mul_f32 v128, v128, v18
    v_mul_f32 v129, v129, v18
    v_mul_f32 v130, v130, v18
    v_mul_f32 v131, v131, v18
    v_mul_f32 v132, v132, v19
    v_mul_f32 v133, v133, v19
    v_mul_f32 v134, v134, v19
    v_mul_f32 v135, v135, v19
    v_mul_f32 v136, v136, v18
    v_mul_f32 v137, v137, v18
    v_mul_f32 v138, v138, v18
    v_mul_f32 v139, v139, v18
    v_mul_f32 v140, v140, v19
    v_mul_f32 v141, v141, v19
    v_mul_f32 v142, v142, v19
    v_mul_f32 v143, v143, v19
    v_mul_f32 v144, v144, v18
    v_mul_f32 v145, v145, v18
    v_mul_f32 v146, v146, v18
    v_mul_f32 v147, v147, v18
    v_mul_f32 v148, v148, v19
    v_mul_f32 v149, v149, v19
    v_mul_f32 v150, v150, v19
    v_mul_f32 v151, v151, v19
    v_mul_f32 v152, v152, v18
    v_mul_f32 v153, v153, v18
    v_mul_f32 v154, v154, v18
    v_mul_f32 v155, v155, v18
    v_mul_f32 v156, v156, v19
    v_mul_f32 v157, v157, v19
    v_mul_f32 v158, v158, v19
    v_mul_f32 v159, v159, v19
    v_mul_f32 v160, v160, v18
    v_mul_f32 v161, v161, v18
    v_mul_f32 v162, v162, v18
    v_mul_f32 v163, v163, v18
    v_mul_f32 v164, v164, v19
    v_mul_f32 v165, v165, v19
    v_mul_f32 v166, v166, v19
    v_mul_f32 v167, v167, v19
    v_mul_f32 v168, v168, v18
    v_mul_f32 v169, v169, v18
    v_mul_f32 v170, v170, v18
    v_mul_f32 v171, v171, v18
    v_mul_f32 v172, v172, v19
    v_mul_f32 v173, v173, v19
    v_mul_f32 v174, v174, v19
    v_mul_f32 v175, v175, v19
    v_mul_f32 v176, v176, v18
    v_mul_f32 v177, v177, v18
    v_mul_f32 v178, v178, v18
    v_mul_f32 v179, v179, v18
    v_mul_f32 v180, v180, v19
    v_mul_f32 v181, v181, v19
    v_mul_f32 v182, v182, v19
    v_mul_f32 v183, v183, v19
    v_mul_f32 v184, v184, v18
    v_mul_f32 v185, v185, v18
    v_mul_f32 v186, v186, v18
    v_mul_f32 v187, v187, v18
    v_mul_f32 v188, v188, v19
    v_mul_f32 v189, v189, v19
    v_mul_f32 v190, v190, v19
    v_mul_f32 v191, v191, v19
    v_mul_f32 v192, v192, v18
    v_mul_f32 v193, v193, v18
    v_mul_f32 v194, v194, v18
    v_mul_f32 v195, v195, v18
    v_mul_f32 v196, v196, v19
    v_mul_f32 v197, v197, v19
    v_mul_f32 v198, v198, v19
    v_mul_f32 v199, v199, v19
    v_mul_f32 v200, v200, v18
    v_mul_f32 v201, v201, v18
    v_mul_f32 v202, v202, v18
    v_mul_f32 v203, v203, v18
    v_mul_f32 v204, v204, v19
    v_mul_f32 v205, v205, v19
    v_mul_f32 v206, v206, v19
    v_mul_f32 v207, v207, v19
    v_mul_f32 v208, v208, v18
    v_mul_f32 v209, v209, v18
    v_mul_f32 v210, v210, v18
    v_mul_f32 v211, v211, v18
    v_mul_f32 v212, v212, v19
    v_mul_f32 v213, v213, v19
    v_mul_f32 v214, v214, v19
    v_mul_f32 v215, v215, v19
    v_mul_f32 v216, v216, v18
    v_mul_f32 v217, v217, v18
    v_mul_f32 v218, v218, v18
    v_mul_f32 v219, v219, v18
    v_mul_f32 v220, v220, v19
    v_mul_f32 v221, v221, v19
    v_mul_f32 v222, v222, v19
    v_mul_f32 v223, v223, v19
    v_mul_f32 v224, v224, v18
    v_mul_f32 v225, v225, v18
    v_mul_f32 v226, v226, v18
    v_mul_f32 v227, v227, v18
    v_mul_f32 v228, v228, v19
    v_mul_f32 v229, v229, v19
    v_mul_f32 v230, v230, v19
    v_mul_f32 v231, v231, v19
    v_mul_f32 v232, v232, v18
    v_mul_f32 v233, v233, v18
    v_mul_f32 v234, v234, v18
    v_mul_f32 v235, v235, v18
    v_mul_f32 v236, v236, v19
    v_mul_f32 v237, v237, v19
    v_mul_f32 v238, v238, v19
    v_mul_f32 v239, v239, v19
    v_mul_f32 v240, v240, v18
    v_mul_f32 v241, v241, v18
    v_mul_f32 v242, v242, v18
    v_mul_f32 v243, v243, v18
    v_mul_f32 v244, v244, v19
    v_mul_f32 v245, v245, v19
    v_mul_f32 v246, v246, v19
    v_mul_f32 v247, v247, v19
    v_mul_f32 v248, v248, v18
    v_mul_f32 v249, v249, v18
    v_mul_f32 v250, v250, v18
    v_mul_f32 v251, v251, v18
    v_mul_f32 v252, v252, v19
    v_mul_f32 v253, v253, v19
    v_mul_f32 v254, v254, v19
    v_mul_f32 v255, v255, v19
LRS_94:
    s_mov_b32 s64, 0
    s_mov_b32 s62, 0
    v_exp_f32 v112, v64
    v_exp_f32 v113, v65
    v_exp_f32 v114, v66
    v_exp_f32 v115, v67
    v_exp_f32 v120, v72
    v_exp_f32 v121, v73
    v_exp_f32 v122, v74
    v_exp_f32 v123, v75
    v_exp_f32 v116, v68
    v_exp_f32 v117, v69
    v_exp_f32 v118, v70
    v_exp_f32 v119, v71
    v_exp_f32 v124, v76
    v_exp_f32 v125, v77
    v_exp_f32 v126, v78
    v_exp_f32 v127, v79
    s_nop 0
    v_cvt_pk_bf16_f32 v48, v112, v113
    v_cvt_pk_bf16_f32 v49, v114, v115
    v_add_f32 v14, v112, v113
    v_add_f32 v14, v14, v114
    v_add_f32 v14, v14, v115
    v_cvt_pk_bf16_f32 v50, v120, v121
    v_cvt_pk_bf16_f32 v51, v122, v123
    v_add_f32 v14, v14, v120
    v_add_f32 v14, v14, v121
    v_add_f32 v14, v14, v122
    v_add_f32 v14, v14, v123
    v_cvt_pk_bf16_f32 v52, v116, v117
    v_cvt_pk_bf16_f32 v53, v118, v119
    v_add_f32 v15, v116, v117
    v_add_f32 v15, v15, v118
    v_add_f32 v15, v15, v119
    v_cvt_pk_bf16_f32 v54, v124, v125
    v_cvt_pk_bf16_f32 v55, v126, v127
    v_add_f32 v15, v15, v124
    v_add_f32 v15, v15, v125
    v_add_f32 v15, v15, v126
    v_add_f32 v15, v15, v127
    v_max_f32 v24, v14, v15
    v_cmp_ngt_f32 vcc, 2.0, v24
    s_nop 1
    s_setpc_b64 s[60:61]
LB_RARE1:
    s_nop 7
    s_nop 7
    v_max3_f32 v16, v80, v81, v82
    v_max3_f32 v16, v16, v83, v88
    v_max3_f32 v16, v16, v89, v90
    v_max_f32 v16, v16, v91
    v_mov_b32 v20, v16
    s_nop 1
    v_permlane32_swap_b32 v20, v16
    s_nop 1
    v_max_f32 v16, v16, v20
    v_mov_b32 v20, v16
    s_nop 1
    v_permlane16_swap_b32 v20, v16
    s_nop 1
    v_max_f32 v16, v16, v20
    v_add_f32 v16, 0x42000000, v16
    v_max_f32 v16, s62, v16
    v_max_f32 v18, 0, v16
    v_exp_f32 v18, -v18
    v_sub_f32 v80, v80, v16
    v_sub_f32 v64, v64, v16
    v_sub_f32 v96, v96, v16
    v_sub_f32 v81, v81, v16
    v_sub_f32 v65, v65, v16
    v_sub_f32 v97, v97, v16
    v_sub_f32 v82, v82, v16
    v_sub_f32 v66, v66, v16
    v_sub_f32 v98, v98, v16
    v_sub_f32 v83, v83, v16
    v_sub_f32 v67, v67, v16
    v_sub_f32 v99, v99, v16
    v_sub_f32 v88, v88, v16
    v_sub_f32 v72, v72, v16
    v_sub_f32 v104, v104, v16
    v_sub_f32 v89, v89, v16
    v_sub_f32 v73, v73, v16
    v_sub_f32 v105, v105, v16
    v_sub_f32 v90, v90, v16
    v_sub_f32 v74, v74, v16
    v_sub_f32 v106, v106, v16
    v_sub_f32 v91, v91, v16
    v_sub_f32 v75, v75, v16
    v_sub_f32 v107, v107, v16
    v_sub_f32 v6, v6, v16
    v_mul_f32 v8, v8, v18
    v_max3_f32 v17, v84, v85, v86
    v_max3_f32 v17, v17, v87, v92
    v_max3_f32 v17, v17, v93, v94
    v_max_f32 v17, v17, v95
    v_mov_b32 v20, v17
    s_nop 1
    v_permlane32_swap_b32 v20, v17
    s_nop 1
    v_max_f32 v17, v17, v20
    v_mov_b32 v20, v17
    s_nop 1
    v_permlane16_swap_b32 v20, v17
    s_nop 1
    v_max_f32 v17, v17, v20
    v_add_f32 v17, 0x42000000, v17
    v_max_f32 v17, s62, v17
    v_max_f32 v19, 0, v17
    v_exp_f32 v19, -v19
    v_sub_f32 v84, v84, v17
    v_sub_f32 v68, v68, v17
    v_sub_f32 v100, v100, v17
    v_sub_f32 v85, v85, v17
    v_sub_f32 v69, v69, v17
    v_sub_f32 v101, v101, v17
    v_sub_f32 v86, v86, v17
    v_sub_f32 v70, v70, v17
    v_sub_f32 v102, v102, v17
    v_sub_f32 v87, v87, v17
    v_sub_f32 v71, v71, v17
    v_sub_f32 v103, v103, v17
    v_sub_f32 v92, v92, v17
    v_sub_f32 v76, v76, v17
    v_sub_f32 v108, v108, v17
    v_sub_f32 v93, v93, v17
    v_sub_f32 v77, v77, v17
    v_sub_f32 v109, v109, v17
    v_sub_f32 v94, v94, v17
    v_sub_f32 v78, v78, v17
    v_sub_f32 v110, v110, v17
    v_sub_f32 v95, v95, v17
    v_sub_f32 v79, v79, v17
    v_sub_f32 v111, v111, v17
    v_sub_f32 v7, v7, v17
    v_mul_f32 v9, v9, v19
    s_cmp_eq_u32 s64, 1
    s_cbranch_scc1 LRS_95
    v_mul_f32 v128, v128, v18
    v_mul_f32 v129, v129, v18
    v_mul_f32 v130, v130, v18
    v_mul_f32 v131, v131, v18
    v_mul_f32 v132, v132, v19
    v_mul_f32 v133, v133, v19
    v_mul_f32 v134, v134, v19
    v_mul_f32 v135, v135, v19
    v_mul_f32 v136, v136, v18
    v_mul_f32 v137, v137, v18
    v_mul_f32 v138, v138, v18
    v_mul_f32 v139, v139, v18
    v_mul_f32 v140, v140, v19
    v_mul_f32 v141, v141, v19
    v_mul_f32 v142, v142, v19
    v_mul_f32 v143, v143, v19
    v_mul_f32 v144, v144, v18
    v_mul_f32 v145, v145, v18
    v_mul_f32 v146, v146, v18
    v_mul_f32 v147, v147, v18
    v_mul_f32 v148, v148, v19
    v_mul_f32 v149, v149, v19
    v_mul_f32 v150, v150, v19
    v_mul_f32 v151, v151, v19
    v_mul_f32 v152, v152, v18
    v_mul_f32 v153, v153, v18
    v_mul_f32 v154, v154, v18
    v_mul_f32 v155, v155, v18
    v_mul_f32 v156, v156, v19
    v_mul_f32 v157, v157, v19
    v_mul_f32 v158, v158, v19
    v_mul_f32 v159, v159, v19
    v_mul_f32 v160, v160, v18
    v_mul_f32 v161, v161, v18
    v_mul_f32 v162, v162, v18
    v_mul_f32 v163, v163, v18
    v_mul_f32 v164, v164, v19
    v_mul_f32 v165, v165, v19
    v_mul_f32 v166, v166, v19
    v_mul_f32 v167, v167, v19
    v_mul_f32 v168, v168, v18
    v_mul_f32 v169, v169, v18
    v_mul_f32 v170, v170, v18
    v_mul_f32 v171, v171, v18
    v_mul_f32 v172, v172, v19
    v_mul_f32 v173, v173, v19
    v_mul_f32 v174, v174, v19
    v_mul_f32 v175, v175, v19
    v_mul_f32 v176, v176, v18
    v_mul_f32 v177, v177, v18
    v_mul_f32 v178, v178, v18
    v_mul_f32 v179, v179, v18
    v_mul_f32 v180, v180, v19
    v_mul_f32 v181, v181, v19
    v_mul_f32 v182, v182, v19
    v_mul_f32 v183, v183, v19
    v_mul_f32 v184, v184, v18
    v_mul_f32 v185, v185, v18
    v_mul_f32 v186, v186, v18
    v_mul_f32 v187, v187, v18
    v_mul_f32 v188, v188, v19
    v_mul_f32 v189, v189, v19
    v_mul_f32 v190, v190, v19
    v_mul_f32 v191, v191, v19
    v_mul_f32 v192, v192, v18
    v_mul_f32 v193, v193, v18
    v_mul_f32 v194, v194, v18
    v_mul_f32 v195, v195, v18
    v_mul_f32 v196, v196, v19
    v_mul_f32 v197, v197, v19
    v_mul_f32 v198, v198, v19
    v_mul_f32 v199, v199, v19
    v_mul_f32 v200, v200, v18
    v_mul_f32 v201, v201, v18
    v_mul_f32 v202, v202, v18
    v_mul_f32 v203, v203, v18
    v_mul_f32 v204, v204, v19
    v_mul_f32 v205, v205, v19
    v_mul_f32 v206, v206, v19
    v_mul_f32 v207, v207, v19
    v_mul_f32 v208, v208, v18
    v_mul_f32 v209, v209, v18
    v_mul_f32 v210, v210, v18
    v_mul_f32 v211, v211, v18
    v_mul_f32 v212, v212, v19
    v_mul_f32 v213, v213, v19
    v_mul_f32 v214, v214, v19
    v_mul_f32 v215, v215, v19
    v_mul_f32 v216, v216, v18
    v_mul_f32 v217, v217, v18
    v_mul_f32 v218, v218, v18
    v_mul_f32 v219, v219, v18
    v_mul_f32 v220, v220, v19
    v_mul_f32 v221, v221, v19
    v_mul_f32 v222, v222, v19
    v_mul_f32 v223, v223, v19
    v_mul_f32 v224, v224, v18
    v_mul_f32 v225, v225, v18
    v_mul_f32 v226, v226, v18
    v_mul_f32 v227, v227, v18
    v_mul_f32 v228, v228, v19
    v_mul_f32 v229, v229, v19
    v_mul_f32 v230, v230, v19
    v_mul_f32 v231, v231, v19
    v_mul_f32 v232, v232, v18
    v_mul_f32 v233, v233, v18
    v_mul_f32 v234, v234, v18
    v_mul_f32 v235, v235, v18
    v_mul_f32 v236, v236, v19
    v_mul_f32 v237, v237, v19
    v_mul_f32 v238, v238, v19
    v_mul_f32 v239, v239, v19
    v_mul_f32 v240, v240, v18
    v_mul_f32 v241, v241, v18
    v_mul_f32 v242, v242, v18
    v_mul_f32 v243, v243, v18
    v_mul_f32 v244, v244, v19
    v_mul_f32 v245, v245, v19
    v_mul_f32 v246, v246, v19
    v_mul_f32 v247, v247, v19
    v_mul_f32 v248, v248, v18
    v_mul_f32 v249, v249, v18
    v_mul_f32 v250, v250, v18
    v_mul_f32 v251, v251, v18
    v_mul_f32 v252, v252, v19
    v_mul_f32 v253, v253, v19
    v_mul_f32 v254, v254, v19
    v_mul_f32 v255, v255, v19
LRS_95:
    s_mov_b32 s64, 0
    s_mov_b32 s62, 0
    v_exp_f32 v112, v80
    v_exp_f32 v113, v81
    v_exp_f32 v114, v82
    v_exp_f32 v115, v83
    v_exp_f32 v120, v88
    v_exp_f32 v121, v89
    v_exp_f32 v122, v90
    v_exp_f32 v123, v91
    v_exp_f32 v116, v84
    v_exp_f32 v117, v85
    v_exp_f32 v118, v86
    v_exp_f32 v119, v87
    v_exp_f32 v124, v92
    v_exp_f32 v125, v93
    v_exp_f32 v126, v94
    v_exp_f32 v127, v95
    s_nop 0
    v_cvt_pk_bf16_f32 v56, v112, v113
    v_cvt_pk_bf16_f32 v57, v114, v115
    v_add_f32 v14, v112, v113
    v_add_f32 v14, v14, v114
    v_add_f32 v14, v14, v115
    v_cvt_pk_bf16_f32 v58, v120, v121
    v_cvt_pk_bf16_f32 v59, v122, v123
    v_add_f32 v14, v14, v120
    v_add_f32 v14, v14, v121
    v_add_f32 v14, v14, v122
    v_add_f32 v14, v14, v123
    v_cvt_pk_bf16_f32 v60, v116, v117
    v_cvt_pk_bf16_f32 v61, v118, v119
    v_add_f32 v15, v116, v117
    v_add_f32 v15, v15, v118
    v_add_f32 v15, v15, v119
    v_cvt_pk_bf16_f32 v62, v124, v125
    v_cvt_pk_bf16_f32 v63, v126, v127
    v_add_f32 v15, v15, v124
    v_add_f32 v15, v15, v125
    v_add_f32 v15, v15, v126
    v_add_f32 v15, v15, v127
    v_max_f32 v24, v14, v15
    v_cmp_ngt_f32 vcc, 2.0, v24
    s_nop 1
    s_setpc_b64 s[60:61]
LA_RARE0:
    s_nop 7
    s_nop 7
    v_max3_f32 v16, v64, v65, v66
    v_max3_f32 v16, v16, v67, v68
    v_max3_f32 v16, v16, v69, v70
    v_max3_f32 v16, v16, v71, v72
    v_max3_f32 v16, v16, v73, v74
    v_max3_f32 v16, v16, v75, v76
    v_max3_f32 v16, v16, v77, v78
    v_max_f32 v16, v16, v79
    v_mov_b32 v20, v16
    s_nop 1
    v_permlane32_swap_b32 v20, v16
    s_nop 1
    v_max_f32 v16, v16, v20
    v_add_f32 v16, 0x42000000, v16
    v_max_f32 v16, s62, v16
    v_max_f32 v18, 0, v16
    v_exp_f32 v18, -v18
    v_sub_f32 v64, v64, v16
    v_sub_f32 v96, v96, v16
    v_sub_f32 v128, v128, v16
    v_mul_f32 v160, v160, v18
    v_sub_f32 v65, v65, v16
    v_sub_f32 v97, v97, v16
    v_sub_f32 v129, v129, v16
    v_mul_f32 v161, v161, v18
    v_sub_f32 v66, v66, v16
    v_sub_f32 v98, v98, v16
    v_sub_f32 v130, v130, v16
    v_mul_f32 v162, v162, v18
    v_sub_f32 v67, v67, v16
    v_sub_f32 v99, v99, v16
    v_sub_f32 v131, v131, v16
    v_mul_f32 v163, v163, v18
    v_sub_f32 v68, v68, v16
    v_sub_f32 v100, v100, v16
    v_sub_f32 v132, v132, v16
    v_mul_f32 v164, v164, v18
    v_sub_f32 v69, v69, v16
    v_sub_f32 v101, v101, v16
    v_sub_f32 v133, v133, v16
    v_mul_f32 v165, v165, v18
    v_sub_f32 v70, v70, v16
    v_sub_f32 v102, v102, v16
    v_sub_f32 v134, v134, v16
    v_mul_f32 v166, v166, v18
    v_sub_f32 v71, v71, v16
    v_sub_f32 v103, v103, v16
    v_sub_f32 v135, v135, v16
    v_mul_f32 v167, v167, v18
    v_sub_f32 v72, v72, v16
    v_sub_f32 v104, v104, v16
    v_sub_f32 v136, v136, v16
    v_mul_f32 v168, v168, v18
    v_sub_f32 v73, v73, v16
    v_sub_f32 v105, v105, v16
    v_sub_f32 v137, v137, v16
    v_mul_f32 v169, v169, v18
    v_sub_f32 v74, v74, v16
    v_sub_f32 v106, v106, v16
    v_sub_f32 v138, v138, v16
    v_mul_f32 v170, v170, v18
    v_sub_f32 v75, v75, v16
    v_sub_f32 v107, v107, v16
    v_sub_f32 v139, v139, v16
    v_mul_f32 v171, v171, v18
    v_sub_f32 v76, v76, v16
    v_sub_f32 v108, v108, v16
    v_sub_f32 v140, v140, v16
    v_mul_f32 v172, v172, v18
    v_sub_f32 v77, v77, v16
    v_sub_f32 v109, v109, v16
    v_sub_f32 v141, v141, v16
    v_mul_f32 v173, v173, v18
    v_sub_f32 v78, v78, v16
    v_sub_f32 v110, v110, v16
    v_sub_f32 v142, v142, v16
    v_mul_f32 v174, v174, v18
    v_sub_f32 v79, v79, v16
    v_sub_f32 v111, v111, v16
    v_sub_f32 v143, v143, v16
    v_mul_f32 v175, v175, v18
    v_max3_f32 v17, v80, v81, v82
    v_max3_f32 v17, v17, v83, v84
    v_max3_f32 v17, v17, v85, v86
    v_max3_f32 v17, v17, v87, v88
    v_max3_f32 v17, v17, v89, v90
    v_max3_f32 v17, v17, v91, v92
    v_max3_f32 v17, v17, v93, v94
    v_max_f32 v17, v17, v95
    v_mov_b32 v20, v17
    s_nop 1
    v_permlane32_swap_b32 v20, v17
    s_nop 1
    v_max_f32 v17, v17, v20
    v_add_f32 v17, 0x42000000, v17
    v_max_f32 v17, s62, v17
    v_max_f32 v19, 0, v17
    v_exp_f32 v19, -v19
    v_sub_f32 v80, v80, v17
    v_sub_f32 v112, v112, v17
    v_sub_f32 v144, v144, v17
    v_mul_f32 v176, v176, v19
    v_sub_f32 v81, v81, v17
    v_sub_f32 v113, v113, v17
    v_sub_f32 v145, v145, v17
    v_mul_f32 v177, v177, v19
    v_sub_f32 v82, v82, v17
    v_sub_f32 v114, v114, v17
    v_sub_f32 v146, v146, v17
    v_mul_f32 v178, v178, v19
    v_sub_f32 v83, v83, v17
    v_sub_f32 v115, v115, v17
    v_sub_f32 v147, v147, v17
    v_mul_f32 v179, v179, v19
    v_sub_f32 v84, v84, v17
    v_sub_f32 v116, v116, v17
    v_sub_f32 v148, v148, v17
    v_mul_f32 v180, v180, v19
    v_sub_f32 v85, v85, v17
    v_sub_f32 v117, v117, v17
    v_sub_f32 v149, v149, v17
    v_mul_f32 v181, v181, v19
    v_sub_f32 v86, v86, v17
    v_sub_f32 v118, v118, v17
    v_sub_f32 v150, v150, v17
    v_mul_f32 v182, v182, v19
    v_sub_f32 v87, v87, v17
    v_sub_f32 v119, v119, v17
    v_sub_f32 v151, v151, v17
    v_mul_f32 v183, v183, v19
    v_sub_f32 v88, v88, v17
    v_sub_f32 v120, v120, v17
    v_sub_f32 v152, v152, v17
    v_mul_f32 v184, v184, v19
    v_sub_f32 v89, v89, v17
    v_sub_f32 v121, v121, v17
    v_sub_f32 v153, v153, v17
    v_mul_f32 v185, v185, v19
    v_sub_f32 v90, v90, v17
    v_sub_f32 v122, v122, v17
    v_sub_f32 v154, v154, v17
    v_mul_f32 v186, v186, v19
    v_sub_f32 v91, v91, v17
    v_sub_f32 v123, v123, v17
    v_sub_f32 v155, v155, v17
    v_mul_f32 v187, v187, v19
    v_sub_f32 v92, v92, v17
    v_sub_f32 v124, v124, v17
    v_sub_f32 v156, v156, v17
    v_mul_f32 v188, v188, v19
    v_sub_f32 v93, v93, v17
    v_sub_f32 v125, v125, v17
    v_sub_f32 v157, v157, v17
    v_mul_f32 v189, v189, v19
    v_sub_f32 v94, v94, v17
    v_sub_f32 v126, v126, v17
    v_sub_f32 v158, v158, v17
    v_mul_f32 v190, v190, v19
    v_sub_f32 v95, v95, v17
    v_sub_f32 v127, v127, v17
    v_sub_f32 v159, v159, v17
    v_mul_f32 v191, v191, v19
    s_mov_b32 s62, 0
    s_cmp_eq_u32 s64, 1
    s_mov_b32 s64, 0
    s_cbranch_scc1 LAS_96
    v_exp_f32 v224, v64
    v_exp_f32 v225, v65
    v_exp_f32 v226, v66
    v_exp_f32 v227, v67
    v_exp_f32 v228, v68
    v_cvt_pk_bf16_f32 v192, v224, v225
    v_exp_f32 v229, v69
    v_exp_f32 v230, v70
    v_cvt_pk_bf16_f32 v193, v226, v227
    v_exp_f32 v231, v71
    v_exp_f32 v232, v72
    v_cvt_pk_bf16_f32 v194, v228, v229
    v_exp_f32 v233, v73
    v_or_b32 v14, v192, v193
    v_exp_f32 v234, v74
    v_cvt_pk_bf16_f32 v195, v230, v231
    v_exp_f32 v235, v75
    v_exp_f32 v236, v76
    v_cvt_pk_bf16_f32 v196, v232, v233
    v_exp_f32 v237, v77
    v_or3_b32 v14, v14, v194, v195
    v_exp_f32 v238, v78
    v_cvt_pk_bf16_f32 v197, v234, v235
    v_exp_f32 v239, v79
    v_exp_f32 v224, v80
    v_cvt_pk_bf16_f32 v198, v236, v237
    v_exp_f32 v225, v81
    v_or3_b32 v14, v14, v196, v197
    v_exp_f32 v226, v82
    v_cvt_pk_bf16_f32 v199, v238, v239
    v_exp_f32 v227, v83
    v_exp_f32 v228, v84
    v_cvt_pk_bf16_f32 v200, v224, v225
    v_exp_f32 v229, v85
    v_or3_b32 v14, v14, v198, v199
    v_exp_f32 v230, v86
    v_cvt_pk_bf16_f32 v201, v226, v227
    v_exp_f32 v231, v87
    v_exp_f32 v232, v88
    v_cvt_pk_bf16_f32 v202, v228, v229
    v_exp_f32 v233, v89
    v_or3_b32 v14, v14, v200, v201
    v_exp_f32 v234, v90
    v_cvt_pk_bf16_f32 v203, v230, v231
    v_exp_f32 v235, v91
    v_exp_f32 v236, v92
    v_cvt_pk_bf16_f32 v204, v232, v233
    v_exp_f32 v237, v93
    v_or3_b32 v14, v14, v202, v203
    v_exp_f32 v238, v94
    v_cvt_pk_bf16_f32 v205, v234, v235
    v_exp_f32 v239, v95
    v_cvt_pk_bf16_f32 v206, v236, v237
    v_or3_b32 v14, v14, v204, v205
    v_cvt_pk_bf16_f32 v207, v238, v239
    v_or3_b32 v14, v14, v206, v207
    v_and_b32 v14, s67, v14
    v_cmp_ne_u32 vcc, 0, v14
LAS_96:
    s_nop 1
    s_setpc_b64 s[60:61]
LA_RARE1:
    s_nop 7
    s_nop 7
    v_max3_f32 v16, v96, v97, v98
    v_max3_f32 v16, v16, v99, v100
    v_max3_f32 v16, v16, v101, v102
    v_max3_f32 v16, v16, v103, v104
    v_max3_f32 v16, v16, v105, v106
    v_max3_f32 v16, v16, v107, v108
    v_max3_f32 v16, v16, v109, v110
    v_max_f32 v16, v16, v111
    v_mov_b32 v20, v16
    s_nop 1
    v_permlane32_swap_b32 v20, v16
    s_nop 1
    v_max_f32 v16, v16, v20
    v_add_f32 v16, 0x42000000, v16
    v_max_f32 v16, s62, v16
    v_max_f32 v18, 0, v16
    v_exp_f32 v18, -v18
    v_sub_f32 v96, v96, v16
    v_sub_f32 v64, v64, v16
    v_sub_f32 v128, v128, v16
    v_mul_f32 v160, v160, v18
    v_sub_f32 v97, v97, v16
    v_sub_f32 v65, v65, v16
    v_sub_f32 v129, v129, v16
    v_mul_f32 v161, v161, v18
    v_sub_f32 v98, v98, v16
    v_sub_f32 v66, v66, v16
    v_sub_f32 v130, v130, v16
    v_mul_f32 v162, v162, v18
    v_sub_f32 v99, v99, v16
    v_sub_f32 v67, v67, v16
    v_sub_f32 v131, v131, v16
    v_mul_f32 v163, v163, v18
    v_sub_f32 v100, v100, v16
    v_sub_f32 v68, v68, v16
    v_sub_f32 v132, v132, v16
    v_mul_f32 v164, v164, v18
    v_sub_f32 v101, v101, v16
    v_sub_f32 v69, v69, v16
    v_sub_f32 v133, v133, v16
    v_mul_f32 v165, v165, v18
    v_sub_f32 v102, v102, v16
    v_sub_f32 v70, v70, v16
    v_sub_f32 v134, v134, v16
    v_mul_f32 v166, v166, v18
    v_sub_f32 v103, v103, v16
    v_sub_f32 v71, v71, v16
    v_sub_f32 v135, v135, v16
    v_mul_f32 v167, v167, v18
    v_sub_f32 v104, v104, v16
    v_sub_f32 v72, v72, v16
    v_sub_f32 v136, v136, v16
    v_mul_f32 v168, v168, v18
    v_sub_f32 v105, v105, v16
    v_sub_f32 v73, v73, v16
    v_sub_f32 v137, v137, v16
    v_mul_f32 v169, v169, v18
    v_sub_f32 v106, v106, v16
    v_sub_f32 v74, v74, v16
    v_sub_f32 v138, v138, v16
    v_mul_f32 v170, v170, v18
    v_sub_f32 v107, v107, v16
    v_sub_f32 v75, v75, v16
    v_sub_f32 v139, v139, v16
    v_mul_f32 v171, v171, v18
    v_sub_f32 v108, v108, v16
    v_sub_f32 v76, v76, v16
    v_sub_f32 v140, v140, v16
    v_mul_f32 v172, v172, v18
    v_sub_f32 v109, v109, v16
    v_sub_f32 v77, v77, v16
    v_sub_f32 v141, v141, v16
    v_mul_f32 v173, v173, v18
    v_sub_f32 v110, v110, v16
    v_sub_f32 v78, v78, v16
    v_sub_f32 v142, v142, v16
    v_mul_f32 v174, v174, v18
    v_sub_f32 v111, v111, v16
    v_sub_f32 v79, v79, v16
    v_sub_f32 v143, v143, v16
    v_mul_f32 v175, v175, v18
    v_max3_f32 v17, v112, v113, v114
    v_max3_f32 v17, v17, v115, v116
    v_max3_f32 v17, v17, v117, v118
    v_max3_f32 v17, v17, v119, v120
    v_max3_f32 v17, v17, v121, v122
    v_max3_f32 v17, v17, v123, v124
    v_max3_f32 v17, v17, v125, v126
    v_max_f32 v17, v17, v127
    v_mov_b32 v20, v17
    s_nop 1
    v_permlane32_swap_b32 v20, v17
    s_nop 1
    v_max_f32 v17, v17, v20
    v_add_f32 v17, 0x42000000, v17
    v_max_f32 v17, s62, v17
    v_max_f32 v19, 0, v17
    v_exp_f32 v19, -v19
    v_sub_f32 v112, v112, v17
    v_sub_f32 v80, v80, v17
    v_sub_f32 v144, v144, v17
    v_mul_f32 v176, v176, v19
    v_sub_f32 v113, v113, v17
    v_sub_f32 v81, v81, v17
    v_sub_f32 v145, v145, v17
    v_mul_f32 v177, v177, v19
    v_sub_f32 v114, v114, v17
    v_sub_f32 v82, v82, v17
    v_sub_f32 v146, v146, v17
    v_mul_f32 v178, v178, v19
    v_sub_f32 v115, v115, v17
    v_sub_f32 v83, v83, v17
    v_sub_f32 v147, v147, v17
    v_mul_f32 v179, v179, v19
    v_sub_f32 v116, v116, v17
    v_sub_f32 v84, v84, v17
    v_sub_f32 v148, v148, v17
    v_mul_f32 v180, v180, v19
    v_sub_f32 v117, v117, v17
    v_sub_f32 v85, v85, v17
    v_sub_f32 v149, v149, v17
    v_mul_f32 v181, v181, v19
    v_sub_f32 v118, v118, v17
    v_sub_f32 v86, v86, v17
    v_sub_f32 v150, v150, v17
    v_mul_f32 v182, v182, v19
    v_sub_f32 v119, v119, v17
    v_sub_f32 v87, v87, v17
    v_sub_f32 v151, v151, v17
    v_mul_f32 v183, v183, v19
    v_sub_f32 v120, v120, v17
    v_sub_f32 v88, v88, v17
    v_sub_f32 v152, v152, v17
    v_mul_f32 v184, v184, v19
    v_sub_f32 v121, v121, v17
    v_sub_f32 v89, v89, v17
    v_sub_f32 v153, v153, v17
    v_mul_f32 v185, v185, v19
    v_sub_f32 v122, v122, v17
    v_sub_f32 v90, v90, v17
    v_sub_f32 v154, v154, v17
    v_mul_f32 v186, v186, v19
    v_sub_f32 v123, v123, v17
    v_sub_f32 v91, v91, v17
    v_sub_f32 v155, v155, v17
    v_mul_f32 v187, v187, v19
    v_sub_f32 v124, v124, v17
    v_sub_f32 v92, v92, v17
    v_sub_f32 v156, v156, v17
    v_mul_f32 v188, v188, v19
    v_sub_f32 v125, v125, v17
    v_sub_f32 v93, v93, v17
    v_sub_f32 v157, v157, v17
    v_mul_f32 v189, v189, v19
    v_sub_f32 v126, v126, v17
    v_sub_f32 v94, v94, v17
    v_sub_f32 v158, v158, v17
    v_mul_f32 v190, v190, v19
    v_sub_f32 v127, v127, v17
    v_sub_f32 v95, v95, v17
    v_sub_f32 v159, v159, v17
    v_mul_f32 v191, v191, v19
    s_mov_b32 s62, 0
    s_cmp_eq_u32 s64, 1
    s_mov_b32 s64, 0
    s_cbranch_scc1 LAS_97
    v_exp_f32 v224, v96
    v_exp_f32 v225, v97
    v_exp_f32 v226, v98
    v_exp_f32 v227, v99
    v_exp_f32 v228, v100
    v_cvt_pk_bf16_f32 v208, v224, v225
    v_exp_f32 v229, v101
    v_exp_f32 v230, v102
    v_cvt_pk_bf16_f32 v209, v226, v227
    v_exp_f32 v231, v103
    v_exp_f32 v232, v104
    v_cvt_pk_bf16_f32 v210, v228, v229
    v_exp_f32 v233, v105
    v_or_b32 v14, v208, v209
    v_exp_f32 v234, v106
    v_cvt_pk_bf16_f32 v211, v230, v231
    v_exp_f32 v235, v107
    v_exp_f32 v236, v108
    v_cvt_pk_bf16_f32 v212, v232, v233
    v_exp_f32 v237, v109
    v_or3_b32 v14, v14, v210, v211
    v_exp_f32 v238, v110
    v_cvt_pk_bf16_f32 v213, v234, v235
    v_exp_f32 v239, v111
    v_exp_f32 v224, v112
    v_cvt_pk_bf16_f32 v214, v236, v237
    v_exp_f32 v225, v113
    v_or3_b32 v14, v14, v212, v213
    v_exp_f32 v226, v114
    v_cvt_pk_bf16_f32 v215, v238, v239
    v_exp_f32 v227, v115
    v_exp_f32 v228, v116
    v_cvt_pk_bf16_f32 v216, v224, v225
    v_exp_f32 v229, v117
    v_or3_b32 v14, v14, v214, v215
    v_exp_f32 v230, v118
    v_cvt_pk_bf16_f32 v217, v226, v227
    v_exp_f32 v231, v119
    v_exp_f32 v232, v120
    v_cvt_pk_bf16_f32 v218, v228, v229
    v_exp_f32 v233, v121
    v_or3_b32 v14, v14, v216, v217
    v_exp_f32 v234, v122
    v_cvt_pk_bf16_f32 v219, v230, v231
    v_exp_f32 v235, v123
    v_exp_f32 v236, v124
    v_cvt_pk_bf16_f32 v220, v232, v233
    v_exp_f32 v237, v125
    v_or3_b32 v14, v14, v218, v219
    v_exp_f32 v238, v126
    v_cvt_pk_bf16_f32 v221, v234, v235
    v_exp_f32 v239, v127
    v_cvt_pk_bf16_f32 v222, v236, v237
    v_or3_b32 v14, v14, v220, v221
    v_cvt_pk_bf16_f32 v223, v238, v239
    v_or3_b32 v14, v14, v222, v223
    v_and_b32 v14, s67, v14
    v_cmp_ne_u32 vcc, 0, v14
LAS_97:
    s_nop 1
    s_setpc_b64 s[60:61]
LM_FIN:
LM_END:
    s_endpgm
.section .rodata,"a"
.p2align 6
.amdhsa_kernel gated_mix__mha_block__compressed_kv_cla__prompt_kernel
  .amdhsa_next_free_vgpr 512
  .amdhsa_next_free_sgpr 102
  .amdhsa_accum_offset 256
  .amdhsa_group_segment_fixed_size 0
  .amdhsa_kernarg_size 104
  .amdhsa_user_sgpr_count 2
  .amdhsa_user_sgpr_kernarg_segment_ptr 1
  .amdhsa_system_sgpr_workgroup_id_x 1
.end_amdhsa_kernel
```
